```python
import torch

def _softmax(x, axis=-1):
    return torch.softmax(x, dim=axis)
def _gelu(x):
    return torch.nn.functional.gelu(x, approximate="tanh")
def _silu(x):
    return torch.nn.functional.silu(x)
def _sigmoid(x):
    return torch.sigmoid(x)
def _layernorm(x, axis=-1, eps=1e-5):
    m = x.mean(dim=axis, keepdim=True)
    v = x.var(dim=axis, keepdim=True, unbiased=False)
    return (x - m) / torch.sqrt(v + eps)
def _scatter_add(tgt, idx, src, axis=0):
    return tgt.clone().index_add_(axis, idx, src)
def _segment_sum(src, seg, n):
    out = torch.zeros((n,) + src.shape[1:], dtype=src.dtype)
    return out.index_add_(0, seg, src)
def _pad(x, pw):
    flat = tuple(v for pair in reversed(pw) for v in pair)
    return torch.nn.functional.pad(x, flat)

kernel_name = 'standalone__cross_network_dcn__recsys'

def setup_inputs():

    _w = (lambda a: (lambda t: t.to(torch.bfloat16) if t.is_floating_point() else t)(torch.as_tensor(a)))
    B, F, D, L = 16384, 100, 16, 3
    Din = min(F * D, 1024)
    return {
        "x0": _w((lambda *s: torch.randn(*s, dtype=torch.bfloat16) * 0.05)(B, Din)),
        "ws": _w((lambda *s: torch.randn(*s, dtype=torch.bfloat16) * 0.8)(L, Din, Din) * (Din ** -0.5)),
        "bs": _w((lambda *s: torch.randn(*s, dtype=torch.bfloat16) * 3.2)(L, Din) * 0.01),
    }

def reference(x0, ws, bs):
    x = x0
    L = ws.shape[0]
    for l in range(L):
        proj = torch.einsum('bd,de->be', x, ws[l]) + bs[l]
        x = x0 * proj + x
    return x
```

```asm
; @launch grid=(256,1,1) block=(256,1,1) lds=163840
.amdgcn_target "amdgcn-amd-amdhsa--gfx950"
.text
.globl standalone__cross_network_dcn__recsys_kernel
.p2align 8
.type standalone__cross_network_dcn__recsys_kernel,@function
standalone__cross_network_dcn__recsys_kernel:
s_cmp_ge_u32 s2, 256
s_cbranch_scc1 L_end
s_load_dwordx4 s[4:7], s[0:1], 0
s_load_dwordx4 s[8:11], s[0:1], 16
s_load_dwordx4 s[40:43], s[0:1], 32
v_lshrrev_b32 v12, 6, v0
v_and_b32 v13, 63, v0
v_readfirstlane_b32 s28, v12
v_lshlrev_b32 v0, 4, v13
v_add_u32 v1, 0, v0
v_add_u32 v2, 8192, v0
v_add_u32 v3, 16384, v0
v_add_u32 v4, 24576, v0
v_lshl_add_u32 v6, v12, 13, v0
v_add_u32 v7, 0x10000, v6
v_add_u32 v8, 0x20000, v6
v_and_b32 v14, 15, v13
v_lshrrev_b32 v15, 4, v13
v_lshlrev_b32 v9, 4, v15
v_lshl_add_u32 v5, v14, 11, v9
s_and_b32 s3, s2, 7
s_lshr_b32 s34, s2, 4
s_lshl_b32 s34, s34, 3
s_or_b32 s3, s3, s34
s_lshr_b32 s29, s2, 3
s_and_b32 s29, s29, 1
s_lshl_b32 s31, s28, 11
s_lshl_b32 s32, s28, 13
s_mov_b32 s33, 0xffff0000
s_lshl_b32 s3, s3, 18
s_lshl_b32 s39, s29, 2
s_add_u32 s39, s39, s28
s_lshl_b32 s37, s39, 8
s_lshl_b32 s34, s28, 16
s_add_u32 s34, s34, s3
s_lshl_b32 s48, s29, 10
s_xor_b32 s50, s48, 1024
s_add_u32 s48, s48, s34
s_add_u32 s50, s50, s34
s_add_u32 s49, s48, 32768
s_add_u32 s51, s50, 32768
s_mul_i32 s30, s39, 786432
s_add_u32 s30, s30, 1097728
s_waitcnt lgkmcnt(0)
s_mov_b32 s24, s8
s_and_b32 s25, s9, 0xffff
s_mov_b32 s26, 0x1800
s_mov_b32 s27, 0x20000
s_mov_b32 s12, s4
s_and_b32 s13, s5, 0xffff
s_mov_b32 s14, 0x2000000
s_mov_b32 s15, 0x20000
s_mov_b32 s20, s42
s_and_b32 s21, s43, 0xffff
s_mov_b32 s22, 0x10000000
s_mov_b32 s23, 0x20000
s_mov_b32 s16, s10
s_and_b32 s17, s11, 0xffff
s_mov_b32 s18, 0x2000000
s_mov_b32 s19, 0x20000
s_mov_b32 s4, s6
s_and_b32 s5, s7, 0xffff
s_mov_b32 s6, 0x600000
s_mov_b32 s7, 0x20000
s_add_u32 s96, s42, 8454144
s_addc_u32 s97, s43, 0
s_load_dwordx2 s[8:9], s[96:97], 0
v_mov_b32 v24, v12
v_mov_b32 v25, v13
v_mov_b32 v26, v14
v_mov_b32 v27, v15
v_lshrrev_b32 v28, 2, v25
v_and_b32 v29, 3, v25
v_lshlrev_b32 v13, 11, v28
v_lshl_add_u32 v13, v29, 4, v13
s_lshr_b32 s44, s2, 3
s_and_b32 s45, s2, 7
s_lshl_b32 s46, s44, 16
s_lshl_b32 s47, s45, 8
s_add_u32 s46, s46, s47
s_lshl_b32 s47, s28, 6
s_add_u32 s100, s46, s47
s_add_u32 m0, s31, 32768
s_add_u32 s11, s100, 0
buffer_load_dwordx4 v13, s[4:7], s11 offen lds
s_add_u32 m0, s31, 33792
s_add_u32 s11, s100, 32768
buffer_load_dwordx4 v13, s[4:7], s11 offen lds
v_lshlrev_b32 v30, 2, v27
v_xor_b32 v30, v30, v26
v_lshlrev_b32 v30, 4, v30
v_lshl_add_u32 v12, v27, 11, v30
s_xor_b32 s10, s29, 1
s_lshl_b32 s10, s10, 20
s_add_u32 s10, s10, s37
s_add_u32 m0, s31, 65536
s_add_u32 s11, s10, 0
buffer_load_dwordx4 v12, s[4:7], s11 offen lds
s_add_u32 m0, s31, 66560
s_add_u32 s11, s10, 8192
buffer_load_dwordx4 v12, s[4:7], s11 offen lds
s_add_u32 m0, s31, 73728
s_add_u32 s11, s10, 16384
buffer_load_dwordx4 v12, s[4:7], s11 offen lds
s_add_u32 m0, s31, 74752
s_add_u32 s11, s10, 24576
buffer_load_dwordx4 v12, s[4:7], s11 offen lds
s_add_u32 m0, s31, 81920
s_add_u32 s11, s10, 32768
buffer_load_dwordx4 v12, s[4:7], s11 offen lds
s_add_u32 m0, s31, 82944
s_add_u32 s11, s10, 40960
buffer_load_dwordx4 v12, s[4:7], s11 offen lds
s_add_u32 m0, s31, 90112
s_add_u32 s11, s10, 49152
buffer_load_dwordx4 v12, s[4:7], s11 offen lds
s_add_u32 m0, s31, 91136
s_add_u32 s11, s10, 57344
buffer_load_dwordx4 v12, s[4:7], s11 offen lds
s_add_u32 m0, s31, 98304
s_add_u32 s11, s10, 65536
buffer_load_dwordx4 v12, s[4:7], s11 offen lds
s_add_u32 m0, s31, 99328
s_add_u32 s11, s10, 73728
buffer_load_dwordx4 v12, s[4:7], s11 offen lds
s_add_u32 m0, s31, 106496
s_add_u32 s11, s10, 81920
buffer_load_dwordx4 v12, s[4:7], s11 offen lds
s_add_u32 m0, s31, 107520
s_add_u32 s11, s10, 90112
buffer_load_dwordx4 v12, s[4:7], s11 offen lds
s_add_u32 m0, s31, 114688
s_add_u32 s11, s10, 98304
buffer_load_dwordx4 v12, s[4:7], s11 offen lds
s_add_u32 m0, s31, 115712
s_add_u32 s11, s10, 106496
buffer_load_dwordx4 v12, s[4:7], s11 offen lds
s_add_u32 m0, s31, 122880
s_add_u32 s11, s10, 114688
buffer_load_dwordx4 v12, s[4:7], s11 offen lds
s_add_u32 m0, s31, 123904
s_add_u32 s11, s10, 122880
buffer_load_dwordx4 v12, s[4:7], s11 offen lds
s_add_u32 m0, s31, 0
s_nop 0
buffer_load_dwordx4 v5, s[12:15], s50 offen offset:0 lds
s_add_u32 m0, s31, 1024
s_nop 0
buffer_load_dwordx4 v5, s[12:15], s51 offen offset:0 lds
s_add_u32 m0, s31, 8128
s_nop 0
buffer_load_dwordx4 v5, s[12:15], s50 offen offset:64 lds
s_add_u32 m0, s31, 9152
s_nop 0
buffer_load_dwordx4 v5, s[12:15], s51 offen offset:64 lds
v_bfe_u32 v28, v25, 2, 2
v_lshlrev_b32 v30, 11, v24
v_lshl_add_u32 v30, v29, 4, v30
v_lshrrev_b32 v31, 1, v27
v_lshl_add_u32 v14, v31, 10, v30
v_and_b32 v31, 1, v27
v_lshl_add_u32 v31, v31, 3, v28
v_lshl_add_u32 v14, v31, 6, v14
v_add_u32 v14, 0x8000, v14
v_lshl_add_u32 v30, v27, 13, v30
v_lshl_add_u32 v30, v28, 8, v30
v_add_u32 v30, 0x10000, v30
v_xor_b32 v31, 0, v28
v_lshl_add_u32 v16, v31, 6, v30
v_add_u32 v20, 0x10000, v16
v_xor_b32 v31, 1, v28
v_lshl_add_u32 v17, v31, 6, v30
v_add_u32 v21, 0x10000, v17
v_xor_b32 v31, 2, v28
v_lshl_add_u32 v18, v31, 6, v30
v_add_u32 v22, 0x10000, v18
v_xor_b32 v31, 3, v28
v_lshl_add_u32 v19, v31, 6, v30
v_add_u32 v23, 0x10000, v19
s_lshr_b32 s40, s44, 2
s_and_b32 s41, s44, 3
s_and_b32 s42, s45, 4
s_xor_b32 s42, s40, s42
s_and_b32 s43, s42, 3
s_and_b32 s46, s45, 3
s_xor_b32 s46, s43, s46
s_and_b32 s47, s42, 4
s_or_b32 s47, s47, s41
s_lshl_b32 s57, s47, 15
s_lshr_b32 s34, s46, 1
s_lshl_b32 s34, s34, 14
s_add_u32 s57, s57, s34
s_and_b32 s34, s46, 1
s_lshl_b32 s34, s34, 10
s_add_u32 s57, s57, s34
s_and_b32 s47, s41, 1
s_and_b32 s40, s43, 1
s_lshl_b32 s40, s40, 1
s_or_b32 s40, s40, s47
s_or_b32 s47, s47, 2
s_lshr_b32 s43, s43, 1
s_cmp_lt_u32 s42, 4
s_cselect_b32 s47, s47, s43
s_cselect_b32 s46, s46, s40
s_lshr_b32 s40, s41, 1
s_lshl_b32 s40, s40, 2
s_or_b32 s47, s47, s40
s_lshl_b32 s58, s47, 15
s_lshr_b32 s34, s46, 1
s_lshl_b32 s34, s34, 14
s_add_u32 s58, s58, s34
s_and_b32 s34, s46, 1
s_lshl_b32 s34, s34, 10
s_add_u32 s58, s58, s34
s_mul_i32 s40, s45, 786432
s_lshl_b32 s41, s28, 12
s_add_u32 s40, s40, s41
s_add_u32 s40, s40, 1048576
s_add_u32 s57, s40, s57
s_add_u32 s58, s40, s58
s_add_u32 s57, s57, 262144
s_add_u32 s99, s57, 262144
s_getpc_b64 s[92:93]
L_pc:
s_lshr_b32 s94, s2, 3
s_lshl_b32 s94, s94, 2
s_add_u32 s94, s94, s28
s_lshl_b32 s94, s94, 7
s_add_u32 s92, s92, s94
s_addc_u32 s93, s93, 0
s_add_u32 s96, s92, L_q0-L_pc
s_addc_u32 s97, s93, 0
s_load_dword s98, s[96:97], 0
s_add_u32 s96, s92, L_q1-L_pc
s_addc_u32 s97, s93, 0
s_load_dword s98, s[96:97], 0
s_xor_b32 s36, s2, 8
s_mul_i32 s52, s2, 132096
s_add_u32 s52, s52, 16777216
s_mul_i32 s56, s36, 132096
s_add_u32 s56, s56, 16777216
s_add_u32 s56, s56, s32
s_add_u32 s53, s52, 4096
s_add_u32 s54, s52, 32768
s_add_u32 s55, s52, 36864
s_lshl_b32 s35, s2, 7
s_add_u32 s35, s35, 8388608
s_xor_b32 s36, s35, 1024
s_lshr_b32 s59, s37, 1
s_add_u32 s59, s59, 8388608
s_waitcnt vmcnt(20)
ds_read_b64_tr_b16 a[96:97], v14 offset:0
ds_read_b64_tr_b16 a[98:99], v14 offset:256
ds_read_b64_tr_b16 a[100:101], v14 offset:8
ds_read_b64_tr_b16 a[102:103], v14 offset:264
s_waitcnt lgkmcnt(2)
buffer_store_dwordx4 a[96:99], v0, s[20:23], s58 offen offset:0 sc1
s_waitcnt lgkmcnt(0)
buffer_store_dwordx4 a[100:103], v0, s[20:23], s58 offen offset:2048 sc1
v_add_u32 v14, 0x18000, v14
s_add_u32 m0, s31, 16128
s_nop 0
buffer_load_dwordx4 v5, s[12:15], s50 offen offset:256 lds
s_add_u32 m0, s31, 17152
s_nop 0
buffer_load_dwordx4 v5, s[12:15], s51 offen offset:256 lds
s_add_u32 m0, s31, 24256
s_nop 0
buffer_load_dwordx4 v5, s[12:15], s50 offen offset:320 lds
s_add_u32 m0, s31, 25280
s_nop 0
buffer_load_dwordx4 v5, s[12:15], s51 offen offset:320 lds
s_add_u32 m0, s31, 131072
s_add_u32 s11, s10, 262144
buffer_load_dwordx4 v12, s[4:7], s11 offen lds
s_add_u32 m0, s31, 132096
s_add_u32 s11, s10, 270336
buffer_load_dwordx4 v12, s[4:7], s11 offen lds
s_add_u32 m0, s31, 139264
s_add_u32 s11, s10, 278528
buffer_load_dwordx4 v12, s[4:7], s11 offen lds
s_add_u32 m0, s31, 140288
s_add_u32 s11, s10, 286720
buffer_load_dwordx4 v12, s[4:7], s11 offen lds
s_add_u32 m0, s31, 147456
s_add_u32 s11, s10, 294912
buffer_load_dwordx4 v12, s[4:7], s11 offen lds
s_add_u32 m0, s31, 148480
s_add_u32 s11, s10, 303104
buffer_load_dwordx4 v12, s[4:7], s11 offen lds
s_add_u32 m0, s31, 155648
s_add_u32 s11, s10, 311296
buffer_load_dwordx4 v12, s[4:7], s11 offen lds
s_add_u32 m0, s31, 156672
s_add_u32 s11, s10, 319488
buffer_load_dwordx4 v12, s[4:7], s11 offen lds
s_waitcnt lgkmcnt(0)
s_add_u32 s8, s8, 16
s_addc_u32 s9, s9, 0
s_and_b32 s8, s8, -16
s_and_b32 s9, s9, 0x7fffffff
s_add_u32 s40, s3, s37
s_add_u32 s41, s40, 32768
s_add_u32 s42, s40, 65536
s_add_u32 s43, s40, 98304
s_add_u32 s44, s40, 131072
s_add_u32 s45, s40, 163840
s_add_u32 s46, s40, 196608
s_add_u32 s47, s40, 229376
s_waitcnt vmcnt(26)
ds_read_b64_tr_b16 a[160:161], v16 offset:0
ds_read_b64_tr_b16 a[162:163], v16 offset:1024
ds_read_b64_tr_b16 a[164:165], v16 offset:8
ds_read_b64_tr_b16 a[166:167], v16 offset:1032
ds_read_b64_tr_b16 a[168:169], v17 offset:0
ds_read_b64_tr_b16 a[170:171], v17 offset:1024
ds_read_b64_tr_b16 a[172:173], v17 offset:8
ds_read_b64_tr_b16 a[174:175], v17 offset:1032
ds_read_b64_tr_b16 a[176:177], v18 offset:0
ds_read_b64_tr_b16 a[178:179], v18 offset:1024
ds_read_b64_tr_b16 a[180:181], v18 offset:8
ds_read_b64_tr_b16 a[182:183], v18 offset:1032
ds_read_b64_tr_b16 a[184:185], v19 offset:0
ds_read_b64_tr_b16 a[186:187], v19 offset:1024
ds_read_b64_tr_b16 a[188:189], v19 offset:8
ds_read_b64_tr_b16 a[190:191], v19 offset:1032
s_waitcnt vmcnt(18)
ds_read_b64_tr_b16 a[192:193], v16 offset:32768
ds_read_b64_tr_b16 a[194:195], v16 offset:33792
ds_read_b64_tr_b16 a[196:197], v16 offset:32776
ds_read_b64_tr_b16 a[198:199], v16 offset:33800
ds_read_b64_tr_b16 a[200:201], v17 offset:32768
ds_read_b64_tr_b16 a[202:203], v17 offset:33792
ds_read_b64_tr_b16 a[204:205], v17 offset:32776
ds_read_b64_tr_b16 a[206:207], v17 offset:33800
ds_read_b64_tr_b16 a[208:209], v18 offset:32768
ds_read_b64_tr_b16 a[210:211], v18 offset:33792
ds_read_b64_tr_b16 a[212:213], v18 offset:32776
ds_read_b64_tr_b16 a[214:215], v18 offset:33800
ds_read_b64_tr_b16 a[216:217], v19 offset:32768
ds_read_b64_tr_b16 a[218:219], v19 offset:33792
ds_read_b64_tr_b16 a[220:221], v19 offset:32776
ds_read_b64_tr_b16 a[222:223], v19 offset:33800
s_waitcnt vmcnt(14)
s_waitcnt vmcnt(12)
s_barrier
s_cmp_lg_u32 s28, 0
s_cbranch_scc1 L_nf0
s_add_u32 s34, s8, 0
v_mov_b32 v10, s34
v_mov_b32 v11, s9
s_mov_b64 exec, 1
buffer_store_dwordx2 v[10:11], off, s[20:23], s35 sc1
s_mov_b64 exec, -1
L_nf0:
ds_read_b128 a[96:99], v1 offset:0
ds_read_b128 a[128:131], v2 offset:0
ds_read_b128 a[100:103], v1 offset:1024
ds_read_b128 a[132:135], v2 offset:1024
ds_read_b128 a[104:107], v1 offset:2048
ds_read_b128 a[136:139], v2 offset:2048
ds_read_b128 a[108:111], v1 offset:3072
ds_read_b128 a[140:143], v2 offset:3072
ds_read_b128 a[112:115], v1 offset:4096
ds_read_b128 a[144:147], v2 offset:4096
ds_read_b128 a[116:119], v1 offset:5120
ds_read_b128 a[148:151], v2 offset:5120
ds_read_b128 a[120:123], v1 offset:6144
ds_read_b128 a[152:155], v2 offset:6144
ds_read_b128 a[124:127], v1 offset:7168
ds_read_b128 a[156:159], v2 offset:7168
L_q0:
s_waitcnt lgkmcnt(14)
v_mfma_f32_16x16x32_bf16 v[32:35], a[160:163], a[96:99], 1.0
s_add_u32 m0, s31, 65536
s_add_u32 s11, s10, 327680
buffer_load_dwordx4 v12, s[4:7], s11 offen lds
v_mfma_f32_16x16x32_bf16 v[32:35], a[192:195], a[128:131], v[32:35]
v_mfma_f32_16x16x32_bf16 v[64:67], a[196:199], a[128:131], 1.0
v_mfma_f32_16x16x32_bf16 v[64:67], a[164:167], a[96:99], v[64:67]
s_waitcnt lgkmcnt(12)
v_mfma_f32_16x16x32_bf16 v[68:71], a[164:167], a[100:103], 1.0
s_add_u32 m0, s31, 66560
s_add_u32 s11, s10, 335872
buffer_load_dwordx4 v12, s[4:7], s11 offen lds
v_mfma_f32_16x16x32_bf16 v[68:71], a[196:199], a[132:135], v[68:71]
v_mfma_f32_16x16x32_bf16 v[36:39], a[192:195], a[132:135], 1.0
v_mfma_f32_16x16x32_bf16 v[36:39], a[160:163], a[100:103], v[36:39]
s_waitcnt lgkmcnt(10)
v_mfma_f32_16x16x32_bf16 v[40:43], a[160:163], a[104:107], 1.0
s_add_u32 m0, s31, 73728
s_add_u32 s11, s10, 344064
buffer_load_dwordx4 v12, s[4:7], s11 offen lds
v_mfma_f32_16x16x32_bf16 v[40:43], a[192:195], a[136:139], v[40:43]
v_mfma_f32_16x16x32_bf16 v[72:75], a[196:199], a[136:139], 1.0
v_mfma_f32_16x16x32_bf16 v[72:75], a[164:167], a[104:107], v[72:75]
s_waitcnt lgkmcnt(8)
v_mfma_f32_16x16x32_bf16 v[76:79], a[164:167], a[108:111], 1.0
s_add_u32 m0, s31, 74752
s_add_u32 s11, s10, 352256
buffer_load_dwordx4 v12, s[4:7], s11 offen lds
v_mfma_f32_16x16x32_bf16 v[76:79], a[196:199], a[140:143], v[76:79]
v_mfma_f32_16x16x32_bf16 v[44:47], a[192:195], a[140:143], 1.0
v_mfma_f32_16x16x32_bf16 v[44:47], a[160:163], a[108:111], v[44:47]
s_waitcnt lgkmcnt(6)
v_mfma_f32_16x16x32_bf16 v[48:51], a[160:163], a[112:115], 1.0
s_add_u32 m0, s31, 81920
s_add_u32 s11, s10, 360448
buffer_load_dwordx4 v12, s[4:7], s11 offen lds
v_mfma_f32_16x16x32_bf16 v[48:51], a[192:195], a[144:147], v[48:51]
v_mfma_f32_16x16x32_bf16 v[80:83], a[196:199], a[144:147], 1.0
v_mfma_f32_16x16x32_bf16 v[80:83], a[164:167], a[112:115], v[80:83]
s_waitcnt lgkmcnt(4)
v_mfma_f32_16x16x32_bf16 v[84:87], a[164:167], a[116:119], 1.0
s_add_u32 m0, s31, 82944
s_add_u32 s11, s10, 368640
buffer_load_dwordx4 v12, s[4:7], s11 offen lds
v_mfma_f32_16x16x32_bf16 v[84:87], a[196:199], a[148:151], v[84:87]
v_mfma_f32_16x16x32_bf16 v[52:55], a[192:195], a[148:151], 1.0
v_mfma_f32_16x16x32_bf16 v[52:55], a[160:163], a[116:119], v[52:55]
s_waitcnt lgkmcnt(2)
v_mfma_f32_16x16x32_bf16 v[56:59], a[160:163], a[120:123], 1.0
s_add_u32 m0, s31, 90112
s_add_u32 s11, s10, 376832
buffer_load_dwordx4 v12, s[4:7], s11 offen lds
v_mfma_f32_16x16x32_bf16 v[56:59], a[192:195], a[152:155], v[56:59]
v_mfma_f32_16x16x32_bf16 v[88:91], a[196:199], a[152:155], 1.0
v_mfma_f32_16x16x32_bf16 v[88:91], a[164:167], a[120:123], v[88:91]
s_waitcnt lgkmcnt(0)
v_mfma_f32_16x16x32_bf16 v[92:95], a[164:167], a[124:127], 1.0
s_add_u32 m0, s31, 91136
s_add_u32 s11, s10, 385024
buffer_load_dwordx4 v12, s[4:7], s11 offen lds
v_mfma_f32_16x16x32_bf16 v[92:95], a[196:199], a[156:159], v[92:95]
v_mfma_f32_16x16x32_bf16 v[60:63], a[192:195], a[156:159], 1.0
v_mfma_f32_16x16x32_bf16 v[60:63], a[160:163], a[124:127], v[60:63]
v_mfma_f32_16x16x32_bf16 v[96:99], a[168:171], a[96:99], 1.0
s_add_u32 s96, s92, L_q2-L_pc
s_addc_u32 s97, s93, 0
s_load_dword s98, s[96:97], 0
v_mfma_f32_16x16x32_bf16 v[96:99], a[200:203], a[128:131], v[96:99]
s_add_u32 m0, s31, 32256
v_mfma_f32_16x16x32_bf16 v[128:131], a[204:207], a[128:131], 1.0
buffer_load_dwordx4 v5, s[12:15], s50 offen offset:512 lds
v_mfma_f32_16x16x32_bf16 v[128:131], a[172:175], a[96:99], v[128:131]
v_mfma_f32_16x16x32_bf16 v[132:135], a[172:175], a[100:103], 1.0
v_mfma_f32_16x16x32_bf16 v[132:135], a[204:207], a[132:135], v[132:135]
v_mfma_f32_16x16x32_bf16 v[100:103], a[200:203], a[132:135], 1.0
v_mfma_f32_16x16x32_bf16 v[100:103], a[168:171], a[100:103], v[100:103]
v_mfma_f32_16x16x32_bf16 v[104:107], a[168:171], a[104:107], 1.0
s_waitcnt vmcnt(9)
ds_read_b64_tr_b16 a[64:65], v20 offset:0
v_mfma_f32_16x16x32_bf16 v[104:107], a[200:203], a[136:139], v[104:107]
ds_read_b64_tr_b16 a[66:67], v20 offset:1024
s_add_u32 m0, s31, 33280
v_mfma_f32_16x16x32_bf16 v[136:139], a[204:207], a[136:139], 1.0
buffer_load_dwordx4 v5, s[12:15], s51 offen offset:512 lds
ds_read_b64_tr_b16 a[68:69], v20 offset:8
v_mfma_f32_16x16x32_bf16 v[136:139], a[172:175], a[104:107], v[136:139]
ds_read_b64_tr_b16 a[70:71], v20 offset:1032
v_mfma_f32_16x16x32_bf16 v[140:143], a[172:175], a[108:111], 1.0
ds_read_b64_tr_b16 a[72:73], v21 offset:0
v_mfma_f32_16x16x32_bf16 v[140:143], a[204:207], a[140:143], v[140:143]
ds_read_b64_tr_b16 a[74:75], v21 offset:1024
v_mfma_f32_16x16x32_bf16 v[108:111], a[200:203], a[140:143], 1.0
ds_read_b64_tr_b16 a[76:77], v21 offset:8
v_mfma_f32_16x16x32_bf16 v[108:111], a[168:171], a[108:111], v[108:111]
ds_read_b64_tr_b16 a[78:79], v21 offset:1032
v_mfma_f32_16x16x32_bf16 v[112:115], a[168:171], a[112:115], 1.0
ds_read_b64_tr_b16 a[80:81], v22 offset:0
v_mfma_f32_16x16x32_bf16 v[112:115], a[200:203], a[144:147], v[112:115]
ds_read_b64_tr_b16 a[82:83], v22 offset:1024
s_add_u32 m0, s31, 40384
v_mfma_f32_16x16x32_bf16 v[144:147], a[204:207], a[144:147], 1.0
buffer_load_dwordx4 v5, s[12:15], s50 offen offset:576 lds
ds_read_b64_tr_b16 a[84:85], v22 offset:8
v_mfma_f32_16x16x32_bf16 v[144:147], a[172:175], a[112:115], v[144:147]
ds_read_b64_tr_b16 a[86:87], v22 offset:1032
v_mfma_f32_16x16x32_bf16 v[148:151], a[172:175], a[116:119], 1.0
ds_read_b64_tr_b16 a[88:89], v23 offset:0
v_mfma_f32_16x16x32_bf16 v[148:151], a[204:207], a[148:151], v[148:151]
ds_read_b64_tr_b16 a[90:91], v23 offset:1024
v_mfma_f32_16x16x32_bf16 v[116:119], a[200:203], a[148:151], 1.0
ds_read_b64_tr_b16 a[92:93], v23 offset:8
v_mfma_f32_16x16x32_bf16 v[116:119], a[168:171], a[116:119], v[116:119]
ds_read_b64_tr_b16 a[94:95], v23 offset:1032
v_mfma_f32_16x16x32_bf16 v[120:123], a[168:171], a[120:123], 1.0
v_mfma_f32_16x16x32_bf16 v[120:123], a[200:203], a[152:155], v[120:123]
s_add_u32 m0, s31, 41408
v_mfma_f32_16x16x32_bf16 v[152:155], a[204:207], a[152:155], 1.0
buffer_load_dwordx4 v5, s[12:15], s51 offen offset:576 lds
v_mfma_f32_16x16x32_bf16 v[152:155], a[172:175], a[120:123], v[152:155]
v_mfma_f32_16x16x32_bf16 v[156:159], a[172:175], a[124:127], 1.0
v_mfma_f32_16x16x32_bf16 v[156:159], a[204:207], a[156:159], v[156:159]
v_mfma_f32_16x16x32_bf16 v[124:127], a[200:203], a[156:159], 1.0
v_mfma_f32_16x16x32_bf16 v[124:127], a[168:171], a[124:127], v[124:127]
v_mfma_f32_16x16x32_bf16 v[160:163], a[176:179], a[96:99], 1.0
s_add_u32 m0, s31, 98304
s_add_u32 s11, s10, 589824
buffer_load_dwordx4 v12, s[4:7], s11 offen lds
v_mfma_f32_16x16x32_bf16 v[160:163], a[208:211], a[128:131], v[160:163]
s_add_u32 m0, s31, 48384
v_mfma_f32_16x16x32_bf16 v[192:195], a[212:215], a[128:131], 1.0
buffer_load_dwordx4 v5, s[12:15], s50 offen offset:768 lds
v_mfma_f32_16x16x32_bf16 v[192:195], a[180:183], a[96:99], v[192:195]
v_mfma_f32_16x16x32_bf16 v[196:199], a[180:183], a[100:103], 1.0
s_add_u32 m0, s31, 99328
s_add_u32 s11, s10, 598016
buffer_load_dwordx4 v12, s[4:7], s11 offen lds
v_mfma_f32_16x16x32_bf16 v[196:199], a[212:215], a[132:135], v[196:199]
v_mfma_f32_16x16x32_bf16 v[164:167], a[208:211], a[132:135], 1.0
v_mfma_f32_16x16x32_bf16 v[164:167], a[176:179], a[100:103], v[164:167]
v_mfma_f32_16x16x32_bf16 v[168:171], a[176:179], a[104:107], 1.0
s_add_u32 m0, s31, 106496
s_add_u32 s11, s10, 606208
buffer_load_dwordx4 v12, s[4:7], s11 offen lds
v_mfma_f32_16x16x32_bf16 v[168:171], a[208:211], a[136:139], v[168:171]
s_add_u32 m0, s31, 49408
v_mfma_f32_16x16x32_bf16 v[200:203], a[212:215], a[136:139], 1.0
buffer_load_dwordx4 v5, s[12:15], s51 offen offset:768 lds
v_mfma_f32_16x16x32_bf16 v[200:203], a[180:183], a[104:107], v[200:203]
v_mfma_f32_16x16x32_bf16 v[204:207], a[180:183], a[108:111], 1.0
s_add_u32 m0, s31, 107520
s_add_u32 s11, s10, 614400
buffer_load_dwordx4 v12, s[4:7], s11 offen lds
v_mfma_f32_16x16x32_bf16 v[204:207], a[212:215], a[140:143], v[204:207]
v_mfma_f32_16x16x32_bf16 v[172:175], a[208:211], a[140:143], 1.0
v_mfma_f32_16x16x32_bf16 v[172:175], a[176:179], a[108:111], v[172:175]
v_mfma_f32_16x16x32_bf16 v[176:179], a[176:179], a[112:115], 1.0
s_add_u32 m0, s31, 114688
s_add_u32 s11, s10, 622592
buffer_load_dwordx4 v12, s[4:7], s11 offen lds
v_mfma_f32_16x16x32_bf16 v[176:179], a[208:211], a[144:147], v[176:179]
s_add_u32 m0, s31, 56512
v_mfma_f32_16x16x32_bf16 v[208:211], a[212:215], a[144:147], 1.0
buffer_load_dwordx4 v5, s[12:15], s50 offen offset:832 lds
v_mfma_f32_16x16x32_bf16 v[208:211], a[180:183], a[112:115], v[208:211]
v_mfma_f32_16x16x32_bf16 v[212:215], a[180:183], a[116:119], 1.0
s_add_u32 m0, s31, 115712
s_add_u32 s11, s10, 630784
buffer_load_dwordx4 v12, s[4:7], s11 offen lds
v_mfma_f32_16x16x32_bf16 v[212:215], a[212:215], a[148:151], v[212:215]
v_mfma_f32_16x16x32_bf16 v[180:183], a[208:211], a[148:151], 1.0
v_mfma_f32_16x16x32_bf16 v[180:183], a[176:179], a[116:119], v[180:183]
v_mfma_f32_16x16x32_bf16 v[184:187], a[176:179], a[120:123], 1.0
s_add_u32 m0, s31, 122880
s_add_u32 s11, s10, 638976
buffer_load_dwordx4 v12, s[4:7], s11 offen lds
v_mfma_f32_16x16x32_bf16 v[184:187], a[208:211], a[152:155], v[184:187]
s_add_u32 m0, s31, 57536
v_mfma_f32_16x16x32_bf16 v[216:219], a[212:215], a[152:155], 1.0
buffer_load_dwordx4 v5, s[12:15], s51 offen offset:832 lds
v_mfma_f32_16x16x32_bf16 v[216:219], a[180:183], a[120:123], v[216:219]
v_mfma_f32_16x16x32_bf16 v[220:223], a[180:183], a[124:127], 1.0
s_add_u32 m0, s31, 123904
s_add_u32 s11, s10, 647168
buffer_load_dwordx4 v12, s[4:7], s11 offen lds
v_mfma_f32_16x16x32_bf16 v[220:223], a[212:215], a[156:159], v[220:223]
v_mfma_f32_16x16x32_bf16 v[188:191], a[208:211], a[156:159], 1.0
v_mfma_f32_16x16x32_bf16 v[188:191], a[176:179], a[124:127], v[188:191]
s_barrier
v_mfma_f32_16x16x32_bf16 v[224:227], a[184:187], a[96:99], 1.0
v_mfma_f32_16x16x32_bf16 v[224:227], a[216:219], a[128:131], v[224:227]
v_mfma_f32_16x16x32_bf16 a[224:227], a[220:223], a[128:131], 1.0
ds_read_b128 a[128:131], v4 offset:0
s_waitcnt lgkmcnt(1)
s_add_u32 m0, s31, 131072
s_add_u32 s11, s10, 524288
buffer_load_dwordx4 v12, s[4:7], s11 offen lds
v_mfma_f32_16x16x32_bf16 a[224:227], a[188:191], a[96:99], a[224:227]
ds_read_b128 a[96:99], v3 offset:0
v_mfma_f32_16x16x32_bf16 a[228:231], a[188:191], a[100:103], 1.0
s_waitcnt vmcnt(17)
ds_read_b64_tr_b16 a[32:33], v16 offset:0
v_mfma_f32_16x16x32_bf16 a[228:231], a[220:223], a[132:135], a[228:231]
ds_read_b64_tr_b16 a[34:35], v16 offset:1024
v_mfma_f32_16x16x32_bf16 v[228:231], a[216:219], a[132:135], 1.0
ds_read_b128 a[132:135], v4 offset:1024
s_add_u32 m0, s31, 132096
s_add_u32 s11, s10, 532480
buffer_load_dwordx4 v12, s[4:7], s11 offen lds
ds_read_b64_tr_b16 a[36:37], v16 offset:8
v_mfma_f32_16x16x32_bf16 v[228:231], a[184:187], a[100:103], v[228:231]
ds_read_b128 a[100:103], v3 offset:1024
ds_read_b64_tr_b16 a[38:39], v16 offset:1032
v_mfma_f32_16x16x32_bf16 v[232:235], a[184:187], a[104:107], 1.0
ds_read_b64_tr_b16 a[40:41], v17 offset:0
v_mfma_f32_16x16x32_bf16 v[232:235], a[216:219], a[136:139], v[232:235]
ds_read_b64_tr_b16 a[42:43], v17 offset:1024
v_mfma_f32_16x16x32_bf16 a[232:235], a[220:223], a[136:139], 1.0
ds_read_b128 a[136:139], v4 offset:2048
s_add_u32 m0, s31, 139264
s_add_u32 s11, s10, 540672
buffer_load_dwordx4 v12, s[4:7], s11 offen lds
ds_read_b64_tr_b16 a[44:45], v17 offset:8
v_mfma_f32_16x16x32_bf16 a[232:235], a[188:191], a[104:107], a[232:235]
ds_read_b128 a[104:107], v3 offset:2048
ds_read_b64_tr_b16 a[46:47], v17 offset:1032
v_mfma_f32_16x16x32_bf16 a[236:239], a[188:191], a[108:111], 1.0
ds_read_b64_tr_b16 a[48:49], v18 offset:0
v_mfma_f32_16x16x32_bf16 a[236:239], a[220:223], a[140:143], a[236:239]
ds_read_b64_tr_b16 a[50:51], v18 offset:1024
v_mfma_f32_16x16x32_bf16 v[236:239], a[216:219], a[140:143], 1.0
ds_read_b128 a[140:143], v4 offset:3072
s_add_u32 m0, s31, 140288
s_add_u32 s11, s10, 548864
buffer_load_dwordx4 v12, s[4:7], s11 offen lds
ds_read_b64_tr_b16 a[52:53], v18 offset:8
v_mfma_f32_16x16x32_bf16 v[236:239], a[184:187], a[108:111], v[236:239]
ds_read_b128 a[108:111], v3 offset:3072
ds_read_b64_tr_b16 a[54:55], v18 offset:1032
v_mfma_f32_16x16x32_bf16 v[240:243], a[184:187], a[112:115], 1.0
ds_read_b64_tr_b16 a[56:57], v19 offset:0
v_mfma_f32_16x16x32_bf16 v[240:243], a[216:219], a[144:147], v[240:243]
ds_read_b64_tr_b16 a[58:59], v19 offset:1024
v_mfma_f32_16x16x32_bf16 a[240:243], a[220:223], a[144:147], 1.0
ds_read_b128 a[144:147], v4 offset:4096
s_add_u32 m0, s31, 147456
s_add_u32 s11, s10, 557056
buffer_load_dwordx4 v12, s[4:7], s11 offen lds
ds_read_b64_tr_b16 a[60:61], v19 offset:8
v_mfma_f32_16x16x32_bf16 a[240:243], a[188:191], a[112:115], a[240:243]
ds_read_b128 a[112:115], v3 offset:4096
ds_read_b64_tr_b16 a[62:63], v19 offset:1032
v_mfma_f32_16x16x32_bf16 a[244:247], a[188:191], a[116:119], 1.0
v_mfma_f32_16x16x32_bf16 a[244:247], a[220:223], a[148:151], a[244:247]
v_mfma_f32_16x16x32_bf16 v[244:247], a[216:219], a[148:151], 1.0
ds_read_b128 a[148:151], v4 offset:5120
s_add_u32 m0, s31, 148480
s_add_u32 s11, s10, 565248
buffer_load_dwordx4 v12, s[4:7], s11 offen lds
v_mfma_f32_16x16x32_bf16 v[244:247], a[184:187], a[116:119], v[244:247]
ds_read_b128 a[116:119], v3 offset:5120
v_mfma_f32_16x16x32_bf16 v[248:251], a[184:187], a[120:123], 1.0
v_mfma_f32_16x16x32_bf16 v[248:251], a[216:219], a[152:155], v[248:251]
v_mfma_f32_16x16x32_bf16 a[248:251], a[220:223], a[152:155], 1.0
ds_read_b128 a[152:155], v4 offset:6144
s_add_u32 m0, s31, 155648
s_add_u32 s11, s10, 573440
buffer_load_dwordx4 v12, s[4:7], s11 offen lds
v_mfma_f32_16x16x32_bf16 a[248:251], a[188:191], a[120:123], a[248:251]
ds_read_b128 a[120:123], v3 offset:6144
v_mfma_f32_16x16x32_bf16 a[252:255], a[188:191], a[124:127], 1.0
v_mfma_f32_16x16x32_bf16 a[252:255], a[220:223], a[156:159], a[252:255]
v_mfma_f32_16x16x32_bf16 v[252:255], a[216:219], a[156:159], 1.0
ds_read_b128 a[156:159], v4 offset:7168
s_add_u32 m0, s31, 156672
s_add_u32 s11, s10, 581632
buffer_load_dwordx4 v12, s[4:7], s11 offen lds
v_mfma_f32_16x16x32_bf16 v[252:255], a[184:187], a[124:127], v[252:255]
ds_read_b128 a[124:127], v3 offset:7168
s_waitcnt lgkmcnt(15)
v_mfma_f32_16x16x32_bf16 v[32:35], a[64:67], a[96:99], v[32:35]
v_mfma_f32_16x16x32_bf16 v[32:35], a[32:35], a[128:131], v[32:35]
v_mfma_f32_16x16x32_bf16 v[64:67], a[36:39], a[128:131], v[64:67]
v_mfma_f32_16x16x32_bf16 v[64:67], a[68:71], a[96:99], v[64:67]
s_waitcnt lgkmcnt(6)
s_add_u32 m0, s31, 65536
v_mfma_f32_16x16x32_bf16 v[68:71], a[68:71], a[100:103], v[68:71]
buffer_load_dwordx4 v5, s[12:15], s48 offen offset:0 lds
v_mfma_f32_16x16x32_bf16 v[68:71], a[36:39], a[132:135], v[68:71]
v_mfma_f32_16x16x32_bf16 v[36:39], a[32:35], a[132:135], v[36:39]
v_mfma_f32_16x16x32_bf16 v[36:39], a[64:67], a[100:103], v[36:39]
v_mfma_f32_16x16x32_bf16 v[40:43], a[64:67], a[104:107], v[40:43]
v_mfma_f32_16x16x32_bf16 v[40:43], a[32:35], a[136:139], v[40:43]
v_mfma_f32_16x16x32_bf16 v[72:75], a[36:39], a[136:139], v[72:75]
v_mfma_f32_16x16x32_bf16 v[72:75], a[68:71], a[104:107], v[72:75]
v_mfma_f32_16x16x32_bf16 v[76:79], a[68:71], a[108:111], v[76:79]
v_mfma_f32_16x16x32_bf16 v[76:79], a[36:39], a[140:143], v[76:79]
v_mfma_f32_16x16x32_bf16 v[44:47], a[32:35], a[140:143], v[44:47]
v_mfma_f32_16x16x32_bf16 v[44:47], a[64:67], a[108:111], v[44:47]
v_mfma_f32_16x16x32_bf16 v[48:51], a[64:67], a[112:115], v[48:51]
v_mfma_f32_16x16x32_bf16 v[48:51], a[32:35], a[144:147], v[48:51]
v_mfma_f32_16x16x32_bf16 v[80:83], a[36:39], a[144:147], v[80:83]
v_mfma_f32_16x16x32_bf16 v[80:83], a[68:71], a[112:115], v[80:83]
s_add_u32 m0, s31, 66560
s_waitcnt lgkmcnt(4)
v_mfma_f32_16x16x32_bf16 v[84:87], a[68:71], a[116:119], v[84:87]
buffer_load_dwordx4 v5, s[12:15], s49 offen offset:0 lds
v_mfma_f32_16x16x32_bf16 v[84:87], a[36:39], a[148:151], v[84:87]
v_mfma_f32_16x16x32_bf16 v[52:55], a[32:35], a[148:151], v[52:55]
v_mfma_f32_16x16x32_bf16 v[52:55], a[64:67], a[116:119], v[52:55]
s_waitcnt lgkmcnt(2)
v_mfma_f32_16x16x32_bf16 v[56:59], a[64:67], a[120:123], v[56:59]
v_mfma_f32_16x16x32_bf16 v[56:59], a[32:35], a[152:155], v[56:59]
v_mfma_f32_16x16x32_bf16 v[88:91], a[36:39], a[152:155], v[88:91]
v_mfma_f32_16x16x32_bf16 v[88:91], a[68:71], a[120:123], v[88:91]
s_waitcnt lgkmcnt(0)
v_mfma_f32_16x16x32_bf16 v[92:95], a[68:71], a[124:127], v[92:95]
v_mfma_f32_16x16x32_bf16 v[92:95], a[36:39], a[156:159], v[92:95]
v_mfma_f32_16x16x32_bf16 v[60:63], a[32:35], a[156:159], v[60:63]
v_mfma_f32_16x16x32_bf16 v[60:63], a[64:67], a[124:127], v[60:63]
v_mfma_f32_16x16x32_bf16 v[96:99], a[72:75], a[96:99], v[96:99]
v_mfma_f32_16x16x32_bf16 v[96:99], a[40:43], a[128:131], v[96:99]
v_mfma_f32_16x16x32_bf16 v[128:131], a[44:47], a[128:131], v[128:131]
v_mfma_f32_16x16x32_bf16 v[128:131], a[76:79], a[96:99], v[128:131]
s_add_u32 m0, s31, 73472
v_mfma_f32_16x16x32_bf16 v[132:135], a[76:79], a[100:103], v[132:135]
buffer_load_dwordx4 v5, s[12:15], s48 offen offset:256 lds
v_mfma_f32_16x16x32_bf16 v[132:135], a[44:47], a[132:135], v[132:135]
v_mfma_f32_16x16x32_bf16 v[100:103], a[40:43], a[132:135], v[100:103]
v_mfma_f32_16x16x32_bf16 v[100:103], a[72:75], a[100:103], v[100:103]
v_mfma_f32_16x16x32_bf16 v[104:107], a[72:75], a[104:107], v[104:107]
v_mfma_f32_16x16x32_bf16 v[104:107], a[40:43], a[136:139], v[104:107]
v_mfma_f32_16x16x32_bf16 v[136:139], a[44:47], a[136:139], v[136:139]
v_mfma_f32_16x16x32_bf16 v[136:139], a[76:79], a[104:107], v[136:139]
v_mfma_f32_16x16x32_bf16 v[140:143], a[76:79], a[108:111], v[140:143]
v_mfma_f32_16x16x32_bf16 v[140:143], a[44:47], a[140:143], v[140:143]
v_mfma_f32_16x16x32_bf16 v[108:111], a[40:43], a[140:143], v[108:111]
v_mfma_f32_16x16x32_bf16 v[108:111], a[72:75], a[108:111], v[108:111]
v_mfma_f32_16x16x32_bf16 v[112:115], a[72:75], a[112:115], v[112:115]
v_mfma_f32_16x16x32_bf16 v[112:115], a[40:43], a[144:147], v[112:115]
v_mfma_f32_16x16x32_bf16 v[144:147], a[44:47], a[144:147], v[144:147]
v_mfma_f32_16x16x32_bf16 v[144:147], a[76:79], a[112:115], v[144:147]
s_add_u32 m0, s31, 74496
v_mfma_f32_16x16x32_bf16 v[148:151], a[76:79], a[116:119], v[148:151]
buffer_load_dwordx4 v5, s[12:15], s49 offen offset:256 lds
v_mfma_f32_16x16x32_bf16 v[148:151], a[44:47], a[148:151], v[148:151]
v_mfma_f32_16x16x32_bf16 v[116:119], a[40:43], a[148:151], v[116:119]
v_mfma_f32_16x16x32_bf16 v[116:119], a[72:75], a[116:119], v[116:119]
v_mfma_f32_16x16x32_bf16 v[120:123], a[72:75], a[120:123], v[120:123]
v_mfma_f32_16x16x32_bf16 v[120:123], a[40:43], a[152:155], v[120:123]
v_mfma_f32_16x16x32_bf16 v[152:155], a[44:47], a[152:155], v[152:155]
v_and_b32 v10, 0x1f0, v0
v_lshlrev_b32 v10, 6, v10
buffer_load_dwordx2 v[10:11], v10, s[20:23], s59 offen sc1
v_mfma_f32_16x16x32_bf16 v[152:155], a[76:79], a[120:123], v[152:155]
v_mfma_f32_16x16x32_bf16 v[156:159], a[76:79], a[124:127], v[156:159]
v_mfma_f32_16x16x32_bf16 v[156:159], a[44:47], a[156:159], v[156:159]
v_mfma_f32_16x16x32_bf16 v[124:127], a[40:43], a[156:159], v[124:127]
v_mfma_f32_16x16x32_bf16 v[124:127], a[72:75], a[124:127], v[124:127]
v_mfma_f32_16x16x32_bf16 v[160:163], a[80:83], a[96:99], v[160:163]
v_mfma_f32_16x16x32_bf16 v[160:163], a[48:51], a[128:131], v[160:163]
v_mfma_f32_16x16x32_bf16 v[192:195], a[52:55], a[128:131], v[192:195]
v_mfma_f32_16x16x32_bf16 v[192:195], a[84:87], a[96:99], v[192:195]
s_add_u32 m0, s31, 81408
v_mfma_f32_16x16x32_bf16 v[196:199], a[84:87], a[100:103], v[196:199]
buffer_load_dwordx4 v5, s[12:15], s48 offen offset:512 lds
v_mfma_f32_16x16x32_bf16 v[196:199], a[52:55], a[132:135], v[196:199]
v_mfma_f32_16x16x32_bf16 v[164:167], a[48:51], a[132:135], v[164:167]
v_mfma_f32_16x16x32_bf16 v[164:167], a[80:83], a[100:103], v[164:167]
v_mfma_f32_16x16x32_bf16 v[168:171], a[80:83], a[104:107], v[168:171]
s_waitcnt vmcnt(14)
ds_read_b64_tr_b16 a[0:1], v16 offset:32768
v_mfma_f32_16x16x32_bf16 v[168:171], a[48:51], a[136:139], v[168:171]
ds_read_b64_tr_b16 a[2:3], v16 offset:33792
v_mfma_f32_16x16x32_bf16 v[200:203], a[52:55], a[136:139], v[200:203]
ds_read_b64_tr_b16 a[4:5], v16 offset:32776
v_mfma_f32_16x16x32_bf16 v[200:203], a[84:87], a[104:107], v[200:203]
ds_read_b64_tr_b16 a[6:7], v16 offset:33800
v_mfma_f32_16x16x32_bf16 v[204:207], a[84:87], a[108:111], v[204:207]
ds_read_b64_tr_b16 a[8:9], v17 offset:32768
v_mfma_f32_16x16x32_bf16 v[204:207], a[52:55], a[140:143], v[204:207]
ds_read_b64_tr_b16 a[10:11], v17 offset:33792
v_mfma_f32_16x16x32_bf16 v[172:175], a[48:51], a[140:143], v[172:175]
ds_read_b64_tr_b16 a[12:13], v17 offset:32776
v_mfma_f32_16x16x32_bf16 v[172:175], a[80:83], a[108:111], v[172:175]
ds_read_b64_tr_b16 a[14:15], v17 offset:33800
v_mfma_f32_16x16x32_bf16 v[176:179], a[80:83], a[112:115], v[176:179]
ds_read_b64_tr_b16 a[16:17], v18 offset:32768
v_mfma_f32_16x16x32_bf16 v[176:179], a[48:51], a[144:147], v[176:179]
ds_read_b64_tr_b16 a[18:19], v18 offset:33792
v_mfma_f32_16x16x32_bf16 v[208:211], a[52:55], a[144:147], v[208:211]
ds_read_b64_tr_b16 a[20:21], v18 offset:32776
v_mfma_f32_16x16x32_bf16 v[208:211], a[84:87], a[112:115], v[208:211]
ds_read_b64_tr_b16 a[22:23], v18 offset:33800
s_add_u32 m0, s31, 82432
v_mfma_f32_16x16x32_bf16 v[212:215], a[84:87], a[116:119], v[212:215]
buffer_load_dwordx4 v5, s[12:15], s49 offen offset:512 lds
ds_read_b64_tr_b16 a[24:25], v19 offset:32768
v_mfma_f32_16x16x32_bf16 v[212:215], a[52:55], a[148:151], v[212:215]
ds_read_b64_tr_b16 a[26:27], v19 offset:33792
v_mfma_f32_16x16x32_bf16 v[180:183], a[48:51], a[148:151], v[180:183]
ds_read_b64_tr_b16 a[28:29], v19 offset:32776
v_mfma_f32_16x16x32_bf16 v[180:183], a[80:83], a[116:119], v[180:183]
ds_read_b64_tr_b16 a[30:31], v19 offset:33800
v_mfma_f32_16x16x32_bf16 v[184:187], a[80:83], a[120:123], v[184:187]
v_mfma_f32_16x16x32_bf16 v[184:187], a[48:51], a[152:155], v[184:187]
v_mfma_f32_16x16x32_bf16 v[216:219], a[52:55], a[152:155], v[216:219]
v_mfma_f32_16x16x32_bf16 v[216:219], a[84:87], a[120:123], v[216:219]
v_mfma_f32_16x16x32_bf16 v[220:223], a[84:87], a[124:127], v[220:223]
v_mfma_f32_16x16x32_bf16 v[220:223], a[52:55], a[156:159], v[220:223]
v_mfma_f32_16x16x32_bf16 v[188:191], a[48:51], a[156:159], v[188:191]
v_mfma_f32_16x16x32_bf16 v[188:191], a[80:83], a[124:127], v[188:191]
s_barrier
v_mfma_f32_16x16x32_bf16 v[224:227], a[88:91], a[96:99], v[224:227]
v_mfma_f32_16x16x32_bf16 v[224:227], a[56:59], a[128:131], v[224:227]
v_mfma_f32_16x16x32_bf16 a[224:227], a[60:63], a[128:131], a[224:227]
ds_read_b128 a[128:131], v2 offset:32768
s_waitcnt vmcnt(7)
ds_read_b64_tr_b16 a[164:165], v20 offset:0
v_mfma_f32_16x16x32_bf16 a[224:227], a[92:95], a[96:99], a[224:227]
ds_read_b128 a[96:99], v1 offset:32768
ds_read_b64_tr_b16 a[166:167], v20 offset:1024
s_add_u32 m0, s31, 89344
v_mfma_f32_16x16x32_bf16 a[228:231], a[92:95], a[100:103], a[228:231]
buffer_load_dwordx4 v5, s[12:15], s48 offen offset:768 lds
ds_read_b64_tr_b16 a[196:197], v20 offset:8
v_mfma_f32_16x16x32_bf16 a[228:231], a[60:63], a[132:135], a[228:231]
ds_read_b64_tr_b16 a[198:199], v20 offset:1032
v_mfma_f32_16x16x32_bf16 v[228:231], a[56:59], a[132:135], v[228:231]
ds_read_b128 a[132:135], v2 offset:33792
ds_read_b64_tr_b16 a[192:193], v21 offset:0
v_mfma_f32_16x16x32_bf16 v[228:231], a[88:91], a[100:103], v[228:231]
ds_read_b128 a[100:103], v1 offset:33792
ds_read_b64_tr_b16 a[194:195], v21 offset:1024
v_mfma_f32_16x16x32_bf16 v[232:235], a[88:91], a[104:107], v[232:235]
ds_read_b64_tr_b16 a[160:161], v21 offset:8
v_mfma_f32_16x16x32_bf16 v[232:235], a[56:59], a[136:139], v[232:235]
ds_read_b64_tr_b16 a[162:163], v21 offset:1032
v_mfma_f32_16x16x32_bf16 a[232:235], a[60:63], a[136:139], a[232:235]
ds_read_b128 a[136:139], v2 offset:34816
ds_read_b64_tr_b16 a[172:173], v22 offset:0
v_mfma_f32_16x16x32_bf16 a[232:235], a[92:95], a[104:107], a[232:235]
ds_read_b128 a[104:107], v1 offset:34816
ds_read_b64_tr_b16 a[174:175], v22 offset:1024
v_mfma_f32_16x16x32_bf16 a[236:239], a[92:95], a[108:111], a[236:239]
ds_read_b64_tr_b16 a[204:205], v22 offset:8
v_mfma_f32_16x16x32_bf16 a[236:239], a[60:63], a[140:143], a[236:239]
ds_read_b64_tr_b16 a[206:207], v22 offset:1032
v_mfma_f32_16x16x32_bf16 v[236:239], a[56:59], a[140:143], v[236:239]
ds_read_b128 a[140:143], v2 offset:35840
ds_read_b64_tr_b16 a[200:201], v23 offset:0
v_mfma_f32_16x16x32_bf16 v[236:239], a[88:91], a[108:111], v[236:239]
ds_read_b128 a[108:111], v1 offset:35840
ds_read_b64_tr_b16 a[202:203], v23 offset:1024
v_mfma_f32_16x16x32_bf16 v[240:243], a[88:91], a[112:115], v[240:243]
ds_read_b64_tr_b16 a[168:169], v23 offset:8
v_mfma_f32_16x16x32_bf16 v[240:243], a[56:59], a[144:147], v[240:243]
ds_read_b64_tr_b16 a[170:171], v23 offset:1032
v_mfma_f32_16x16x32_bf16 a[240:243], a[60:63], a[144:147], a[240:243]
ds_read_b128 a[144:147], v2 offset:36864
v_mfma_f32_16x16x32_bf16 a[240:243], a[92:95], a[112:115], a[240:243]
ds_read_b128 a[112:115], v1 offset:36864
s_add_u32 m0, s31, 90368
v_mfma_f32_16x16x32_bf16 a[244:247], a[92:95], a[116:119], a[244:247]
buffer_load_dwordx4 v5, s[12:15], s49 offen offset:768 lds
v_mfma_f32_16x16x32_bf16 a[244:247], a[60:63], a[148:151], a[244:247]
v_mfma_f32_16x16x32_bf16 v[244:247], a[56:59], a[148:151], v[244:247]
ds_read_b128 a[148:151], v2 offset:37888
v_mfma_f32_16x16x32_bf16 v[244:247], a[88:91], a[116:119], v[244:247]
ds_read_b128 a[116:119], v1 offset:37888
v_mfma_f32_16x16x32_bf16 v[248:251], a[88:91], a[120:123], v[248:251]
v_mfma_f32_16x16x32_bf16 v[248:251], a[56:59], a[152:155], v[248:251]
v_mfma_f32_16x16x32_bf16 a[248:251], a[60:63], a[152:155], a[248:251]
ds_read_b128 a[152:155], v2 offset:38912
s_waitcnt vmcnt(4)
s_add_u32 s34, s8, 0
v_subrev_u32 v10, s34, v10
v_xor_b32 v11, s9, v11
s_nop 0
v_cmp_gt_u64 vcc, 16, v[10:11]
s_nop 3
s_cmp_lg_u64 vcc, -1
s_cbranch_scc1 L_wspin0
L_wback0:
v_mfma_f32_16x16x32_bf16 a[248:251], a[92:95], a[120:123], a[248:251]
ds_read_b128 a[120:123], v1 offset:38912
v_mfma_f32_16x16x32_bf16 a[252:255], a[92:95], a[124:127], a[252:255]
buffer_load_dwordx4 a[180:183], v0, s[20:23], s30 offen offset:0 sc1
v_mfma_f32_16x16x32_bf16 a[252:255], a[60:63], a[156:159], a[252:255]
buffer_load_dwordx4 a[212:215], v0, s[20:23], s30 offen offset:1024 sc1
v_mfma_f32_16x16x32_bf16 v[252:255], a[56:59], a[156:159], v[252:255]
buffer_load_dwordx4 a[208:211], v0, s[20:23], s30 offen offset:2048 sc1
ds_read_b128 a[156:159], v2 offset:39936
v_mfma_f32_16x16x32_bf16 v[252:255], a[88:91], a[124:127], v[252:255]
buffer_load_dwordx4 a[176:179], v0, s[20:23], s30 offen offset:3072 sc1
s_add_u32 s30, s30, 0x1000
ds_read_b128 a[124:127], v1 offset:39936
s_waitcnt lgkmcnt(15)
v_mfma_f32_16x16x32_bf16 v[32:35], a[164:167], a[96:99], v[32:35]
v_mfma_f32_16x16x32_bf16 v[32:35], a[0:3], a[128:131], v[32:35]
buffer_load_dwordx4 a[188:191], v0, s[20:23], s30 offen offset:0 sc1
v_mfma_f32_16x16x32_bf16 v[64:67], a[4:7], a[128:131], v[64:67]
v_mfma_f32_16x16x32_bf16 v[64:67], a[196:199], a[96:99], v[64:67]
v_mfma_f32_16x16x32_bf16 v[68:71], a[196:199], a[100:103], v[68:71]
v_mfma_f32_16x16x32_bf16 v[68:71], a[4:7], a[132:135], v[68:71]
buffer_load_dwordx4 a[220:223], v0, s[20:23], s30 offen offset:1024 sc1
s_add_u32 m0, s31, 98240
v_mfma_f32_16x16x32_bf16 v[36:39], a[0:3], a[132:135], v[36:39]
buffer_load_dwordx4 v5, s[12:15], s48 offen offset:64 lds
v_mfma_f32_16x16x32_bf16 v[36:39], a[164:167], a[100:103], v[36:39]
v_mfma_f32_16x16x32_bf16 v[40:43], a[164:167], a[104:107], v[40:43]
v_mfma_f32_16x16x32_bf16 v[40:43], a[0:3], a[136:139], v[40:43]
buffer_load_dwordx4 a[216:219], v0, s[20:23], s30 offen offset:2048 sc1
v_mfma_f32_16x16x32_bf16 v[72:75], a[4:7], a[136:139], v[72:75]
v_mfma_f32_16x16x32_bf16 v[72:75], a[196:199], a[104:107], v[72:75]
s_waitcnt lgkmcnt(11)
v_mfma_f32_16x16x32_bf16 v[76:79], a[196:199], a[108:111], v[76:79]
v_mfma_f32_16x16x32_bf16 v[76:79], a[4:7], a[140:143], v[76:79]
buffer_load_dwordx4 a[184:187], v0, s[20:23], s30 offen offset:3072 sc1
s_add_u32 s30, s30, 0x1000
v_mfma_f32_16x16x32_bf16 v[44:47], a[0:3], a[140:143], v[44:47]
v_mfma_f32_16x16x32_bf16 v[44:47], a[164:167], a[108:111], v[44:47]
s_waitcnt lgkmcnt(6)
v_mfma_f32_16x16x32_bf16 v[48:51], a[164:167], a[112:115], v[48:51]
v_mfma_f32_16x16x32_bf16 v[48:51], a[0:3], a[144:147], v[48:51]
buffer_load_dwordx4 a[68:71], v0, s[20:23], s30 offen offset:0 sc1
v_mfma_f32_16x16x32_bf16 v[80:83], a[4:7], a[144:147], v[80:83]
v_mfma_f32_16x16x32_bf16 v[80:83], a[196:199], a[112:115], v[80:83]
s_waitcnt lgkmcnt(4)
v_mfma_f32_16x16x32_bf16 v[84:87], a[196:199], a[116:119], v[84:87]
v_mfma_f32_16x16x32_bf16 v[84:87], a[4:7], a[148:151], v[84:87]
buffer_load_dwordx4 a[36:39], v0, s[20:23], s30 offen offset:1024 sc1
v_mfma_f32_16x16x32_bf16 v[52:55], a[0:3], a[148:151], v[52:55]
v_mfma_f32_16x16x32_bf16 v[52:55], a[164:167], a[116:119], v[52:55]
s_waitcnt lgkmcnt(2)
v_mfma_f32_16x16x32_bf16 v[56:59], a[164:167], a[120:123], v[56:59]
v_mfma_f32_16x16x32_bf16 v[56:59], a[0:3], a[152:155], v[56:59]
buffer_load_dwordx4 a[32:35], v0, s[20:23], s30 offen offset:2048 sc1
v_mfma_f32_16x16x32_bf16 v[88:91], a[4:7], a[152:155], v[88:91]
v_mfma_f32_16x16x32_bf16 v[88:91], a[196:199], a[120:123], v[88:91]
s_waitcnt lgkmcnt(0)
v_mfma_f32_16x16x32_bf16 v[92:95], a[196:199], a[124:127], v[92:95]
buffer_load_dwordx4 a[64:67], v0, s[20:23], s30 offen offset:3072 sc1
s_add_u32 s30, s30, 0x1000
v_mfma_f32_16x16x32_bf16 v[92:95], a[4:7], a[156:159], v[92:95]
buffer_load_dwordx4 a[76:79], v0, s[20:23], s30 offen offset:0 sc1
s_add_u32 m0, s31, 99264
v_mfma_f32_16x16x32_bf16 v[60:63], a[0:3], a[156:159], v[60:63]
buffer_load_dwordx4 a[44:47], v0, s[20:23], s30 offen offset:1024 sc1
buffer_load_dwordx4 v5, s[12:15], s49 offen offset:64 lds
v_mfma_f32_16x16x32_bf16 v[60:63], a[164:167], a[124:127], v[60:63]
buffer_load_dwordx4 a[40:43], v0, s[20:23], s30 offen offset:2048 sc1
v_mfma_f32_16x16x32_bf16 v[96:99], a[192:195], a[96:99], v[96:99]
v_mfma_f32_16x16x32_bf16 v[96:99], a[8:11], a[128:131], v[96:99]
buffer_load_dwordx4 a[72:75], v0, s[20:23], s30 offen offset:3072 sc1
s_add_u32 s30, s30, 0x1000
v_mfma_f32_16x16x32_bf16 v[128:131], a[12:15], a[128:131], v[128:131]
v_mfma_f32_16x16x32_bf16 v[128:131], a[160:163], a[96:99], v[128:131]
v_mfma_f32_16x16x32_bf16 v[132:135], a[160:163], a[100:103], v[132:135]
v_mfma_f32_16x16x32_bf16 v[132:135], a[12:15], a[132:135], v[132:135]
buffer_load_dwordx4 a[84:87], v0, s[20:23], s30 offen offset:0 sc1
v_mfma_f32_16x16x32_bf16 v[100:103], a[8:11], a[132:135], v[100:103]
v_mfma_f32_16x16x32_bf16 v[100:103], a[192:195], a[100:103], v[100:103]
v_mfma_f32_16x16x32_bf16 v[104:107], a[192:195], a[104:107], v[104:107]
v_mfma_f32_16x16x32_bf16 v[104:107], a[8:11], a[136:139], v[104:107]
buffer_load_dwordx4 a[52:55], v0, s[20:23], s30 offen offset:1024 sc1
v_mfma_f32_16x16x32_bf16 v[136:139], a[12:15], a[136:139], v[136:139]
v_mfma_f32_16x16x32_bf16 v[136:139], a[160:163], a[104:107], v[136:139]
v_mfma_f32_16x16x32_bf16 v[140:143], a[160:163], a[108:111], v[140:143]
v_mfma_f32_16x16x32_bf16 v[140:143], a[12:15], a[140:143], v[140:143]
buffer_load_dwordx4 a[48:51], v0, s[20:23], s30 offen offset:2048 sc1
v_mfma_f32_16x16x32_bf16 v[108:111], a[8:11], a[140:143], v[108:111]
v_mfma_f32_16x16x32_bf16 v[108:111], a[192:195], a[108:111], v[108:111]
v_mfma_f32_16x16x32_bf16 v[112:115], a[192:195], a[112:115], v[112:115]
v_mfma_f32_16x16x32_bf16 v[112:115], a[8:11], a[144:147], v[112:115]
buffer_load_dwordx4 a[80:83], v0, s[20:23], s30 offen offset:3072 sc1
s_add_u32 s30, s30, 0x1000
v_mfma_f32_16x16x32_bf16 v[144:147], a[12:15], a[144:147], v[144:147]
v_mfma_f32_16x16x32_bf16 v[144:147], a[160:163], a[112:115], v[144:147]
v_mfma_f32_16x16x32_bf16 v[148:151], a[160:163], a[116:119], v[148:151]
v_mfma_f32_16x16x32_bf16 v[148:151], a[12:15], a[148:151], v[148:151]
buffer_load_dwordx4 a[92:95], v0, s[20:23], s30 offen offset:0 sc1
s_add_u32 m0, s31, 106176
v_mfma_f32_16x16x32_bf16 v[116:119], a[8:11], a[148:151], v[116:119]
buffer_load_dwordx4 v5, s[12:15], s48 offen offset:320 lds
v_mfma_f32_16x16x32_bf16 v[116:119], a[192:195], a[116:119], v[116:119]
v_mfma_f32_16x16x32_bf16 v[120:123], a[192:195], a[120:123], v[120:123]
v_mfma_f32_16x16x32_bf16 v[120:123], a[8:11], a[152:155], v[120:123]
buffer_load_dwordx4 a[60:63], v0, s[20:23], s30 offen offset:1024 sc1
v_mfma_f32_16x16x32_bf16 v[152:155], a[12:15], a[152:155], v[152:155]
v_mfma_f32_16x16x32_bf16 v[152:155], a[160:163], a[120:123], v[152:155]
v_mfma_f32_16x16x32_bf16 v[156:159], a[160:163], a[124:127], v[156:159]
buffer_load_dwordx4 a[56:59], v0, s[20:23], s30 offen offset:2048 sc1
v_mfma_f32_16x16x32_bf16 v[156:159], a[12:15], a[156:159], v[156:159]
buffer_load_dwordx4 a[88:91], v0, s[20:23], s30 offen offset:3072 sc1
s_add_u32 s30, s30, 0x1000
v_mfma_f32_16x16x32_bf16 v[124:127], a[8:11], a[156:159], v[124:127]
buffer_load_dwordx4 a[196:199], v0, s[20:23], s30 offen offset:0 sc1
v_mfma_f32_16x16x32_bf16 v[124:127], a[192:195], a[124:127], v[124:127]
buffer_load_dwordx4 a[164:167], v0, s[20:23], s30 offen offset:1024 sc1
v_mfma_f32_16x16x32_bf16 v[160:163], a[172:175], a[96:99], v[160:163]
v_mfma_f32_16x16x32_bf16 v[160:163], a[16:19], a[128:131], v[160:163]
buffer_load_dwordx4 a[160:163], v0, s[20:23], s30 offen offset:2048 sc1
v_mfma_f32_16x16x32_bf16 v[192:195], a[20:23], a[128:131], v[192:195]
v_mfma_f32_16x16x32_bf16 v[192:195], a[204:207], a[96:99], v[192:195]
v_mfma_f32_16x16x32_bf16 v[196:199], a[204:207], a[100:103], v[196:199]
v_mfma_f32_16x16x32_bf16 v[196:199], a[20:23], a[132:135], v[196:199]
buffer_load_dwordx4 a[192:195], v0, s[20:23], s30 offen offset:3072 sc1
s_add_u32 s30, s30, 0x1000
v_mfma_f32_16x16x32_bf16 v[164:167], a[16:19], a[132:135], v[164:167]
v_mfma_f32_16x16x32_bf16 v[164:167], a[172:175], a[100:103], v[164:167]
v_mfma_f32_16x16x32_bf16 v[168:171], a[172:175], a[104:107], v[168:171]
v_mfma_f32_16x16x32_bf16 v[168:171], a[16:19], a[136:139], v[168:171]
v_mfma_f32_16x16x32_bf16 v[200:203], a[20:23], a[136:139], v[200:203]
v_mfma_f32_16x16x32_bf16 v[200:203], a[204:207], a[104:107], v[200:203]
v_mfma_f32_16x16x32_bf16 v[204:207], a[204:207], a[108:111], v[204:207]
v_mfma_f32_16x16x32_bf16 v[204:207], a[20:23], a[140:143], v[204:207]
s_add_u32 m0, s31, 107200
v_mfma_f32_16x16x32_bf16 v[172:175], a[16:19], a[140:143], v[172:175]
buffer_load_dwordx4 v5, s[12:15], s49 offen offset:320 lds
v_mfma_f32_16x16x32_bf16 v[172:175], a[172:175], a[108:111], v[172:175]
v_mfma_f32_16x16x32_bf16 v[176:179], a[172:175], a[112:115], v[176:179]
v_mfma_f32_16x16x32_bf16 v[176:179], a[16:19], a[144:147], v[176:179]
v_mfma_f32_16x16x32_bf16 v[208:211], a[20:23], a[144:147], v[208:211]
v_mfma_f32_16x16x32_bf16 v[208:211], a[204:207], a[112:115], v[208:211]
v_mfma_f32_16x16x32_bf16 v[212:215], a[204:207], a[116:119], v[212:215]
v_mfma_f32_16x16x32_bf16 v[212:215], a[20:23], a[148:151], v[212:215]
v_mfma_f32_16x16x32_bf16 v[180:183], a[16:19], a[148:151], v[180:183]
v_mfma_f32_16x16x32_bf16 v[180:183], a[172:175], a[116:119], v[180:183]
v_mfma_f32_16x16x32_bf16 v[184:187], a[172:175], a[120:123], v[184:187]
v_mfma_f32_16x16x32_bf16 v[184:187], a[16:19], a[152:155], v[184:187]
v_mfma_f32_16x16x32_bf16 v[216:219], a[20:23], a[152:155], v[216:219]
v_mfma_f32_16x16x32_bf16 v[216:219], a[204:207], a[120:123], v[216:219]
v_mfma_f32_16x16x32_bf16 v[220:223], a[204:207], a[124:127], v[220:223]
buffer_load_dwordx4 a[204:207], v0, s[20:23], s30 offen offset:0 sc1
v_mfma_f32_16x16x32_bf16 v[220:223], a[20:23], a[156:159], v[220:223]
v_mfma_f32_16x16x32_bf16 v[188:191], a[16:19], a[156:159], v[188:191]
v_mfma_f32_16x16x32_bf16 v[188:191], a[172:175], a[124:127], v[188:191]
buffer_load_dwordx4 a[172:175], v0, s[20:23], s30 offen offset:1024 sc1
s_barrier
v_mfma_f32_16x16x32_bf16 v[224:227], a[200:203], a[96:99], v[224:227]
v_mfma_f32_16x16x32_bf16 v[224:227], a[24:27], a[128:131], v[224:227]
v_mfma_f32_16x16x32_bf16 a[224:227], a[28:31], a[128:131], a[224:227]
ds_read_b128 a[128:131], v4 offset:32768
v_mfma_f32_16x16x32_bf16 a[224:227], a[168:171], a[96:99], a[224:227]
ds_read_b128 a[96:99], v3 offset:32768
v_mfma_f32_16x16x32_bf16 a[228:231], a[168:171], a[100:103], a[228:231]
v_mfma_f32_16x16x32_bf16 a[228:231], a[28:31], a[132:135], a[228:231]
s_add_u32 m0, s31, 114112
v_mfma_f32_16x16x32_bf16 v[228:231], a[24:27], a[132:135], v[228:231]
ds_read_b128 a[132:135], v4 offset:33792
buffer_load_dwordx4 v5, s[12:15], s48 offen offset:576 lds
v_mfma_f32_16x16x32_bf16 v[228:231], a[200:203], a[100:103], v[228:231]
ds_read_b128 a[100:103], v3 offset:33792
v_mfma_f32_16x16x32_bf16 v[232:235], a[200:203], a[104:107], v[232:235]
v_mfma_f32_16x16x32_bf16 v[232:235], a[24:27], a[136:139], v[232:235]
v_mfma_f32_16x16x32_bf16 a[232:235], a[28:31], a[136:139], a[232:235]
ds_read_b128 a[136:139], v4 offset:34816
v_mfma_f32_16x16x32_bf16 a[232:235], a[168:171], a[104:107], a[232:235]
ds_read_b128 a[104:107], v3 offset:34816
v_mfma_f32_16x16x32_bf16 a[236:239], a[168:171], a[108:111], a[236:239]
v_mfma_f32_16x16x32_bf16 a[236:239], a[28:31], a[140:143], a[236:239]
v_mfma_f32_16x16x32_bf16 v[236:239], a[24:27], a[140:143], v[236:239]
ds_read_b128 a[140:143], v4 offset:35840
v_mfma_f32_16x16x32_bf16 v[236:239], a[200:203], a[108:111], v[236:239]
ds_read_b128 a[108:111], v3 offset:35840
v_mfma_f32_16x16x32_bf16 v[240:243], a[200:203], a[112:115], v[240:243]
v_mfma_f32_16x16x32_bf16 v[240:243], a[24:27], a[144:147], v[240:243]
v_mfma_f32_16x16x32_bf16 a[240:243], a[28:31], a[144:147], a[240:243]
ds_read_b128 a[144:147], v4 offset:36864
v_mfma_f32_16x16x32_bf16 a[240:243], a[168:171], a[112:115], a[240:243]
ds_read_b128 a[112:115], v3 offset:36864
v_mfma_f32_16x16x32_bf16 a[244:247], a[168:171], a[116:119], a[244:247]
v_mfma_f32_16x16x32_bf16 a[244:247], a[28:31], a[148:151], a[244:247]
v_mfma_f32_16x16x32_bf16 v[244:247], a[24:27], a[148:151], v[244:247]
ds_read_b128 a[148:151], v4 offset:37888
v_mfma_f32_16x16x32_bf16 v[244:247], a[200:203], a[116:119], v[244:247]
ds_read_b128 a[116:119], v3 offset:37888
v_mfma_f32_16x16x32_bf16 v[248:251], a[200:203], a[120:123], v[248:251]
v_mfma_f32_16x16x32_bf16 v[248:251], a[24:27], a[152:155], v[248:251]
v_mfma_f32_16x16x32_bf16 a[248:251], a[28:31], a[152:155], a[248:251]
ds_read_b128 a[152:155], v4 offset:38912
v_mfma_f32_16x16x32_bf16 a[248:251], a[168:171], a[120:123], a[248:251]
ds_read_b128 a[120:123], v3 offset:38912
v_mfma_f32_16x16x32_bf16 a[252:255], a[168:171], a[124:127], a[252:255]
buffer_load_dwordx4 a[168:171], v0, s[20:23], s30 offen offset:2048 sc1
v_mfma_f32_16x16x32_bf16 a[252:255], a[28:31], a[156:159], a[252:255]
s_add_u32 m0, s31, 115136
v_mfma_f32_16x16x32_bf16 v[252:255], a[24:27], a[156:159], v[252:255]
ds_read_b128 a[156:159], v4 offset:39936
buffer_load_dwordx4 v5, s[12:15], s49 offen offset:576 lds
v_mfma_f32_16x16x32_bf16 v[252:255], a[200:203], a[124:127], v[252:255]
buffer_load_dwordx4 a[200:203], v0, s[20:23], s30 offen offset:3072 sc1
s_add_u32 s30, s30, 0x1000
ds_read_b128 a[124:127], v3 offset:39936
s_waitcnt vmcnt(34) lgkmcnt(14)
v_mfma_f32_16x16x32_bf16 v[32:35], a[180:183], a[96:99], v[32:35]
v_mfma_f32_16x16x32_bf16 v[32:35], a[212:215], a[128:131], v[32:35]
v_mfma_f32_16x16x32_bf16 v[64:67], a[176:179], a[128:131], v[64:67]
v_mfma_f32_16x16x32_bf16 v[64:67], a[208:211], a[96:99], v[64:67]
s_waitcnt lgkmcnt(12)
v_mfma_f32_16x16x32_bf16 v[68:71], a[208:211], a[100:103], v[68:71]
v_mfma_f32_16x16x32_bf16 v[68:71], a[176:179], a[132:135], v[68:71]
v_mfma_f32_16x16x32_bf16 v[36:39], a[212:215], a[132:135], v[36:39]
v_mfma_f32_16x16x32_bf16 v[36:39], a[180:183], a[100:103], v[36:39]
s_waitcnt lgkmcnt(10)
v_mfma_f32_16x16x32_bf16 v[40:43], a[180:183], a[104:107], v[40:43]
v_mfma_f32_16x16x32_bf16 v[40:43], a[212:215], a[136:139], v[40:43]
v_mfma_f32_16x16x32_bf16 v[72:75], a[176:179], a[136:139], v[72:75]
v_mfma_f32_16x16x32_bf16 v[72:75], a[208:211], a[104:107], v[72:75]
s_waitcnt lgkmcnt(8)
v_mfma_f32_16x16x32_bf16 v[76:79], a[208:211], a[108:111], v[76:79]
v_mfma_f32_16x16x32_bf16 v[76:79], a[176:179], a[140:143], v[76:79]
v_mfma_f32_16x16x32_bf16 v[44:47], a[212:215], a[140:143], v[44:47]
v_mfma_f32_16x16x32_bf16 v[44:47], a[180:183], a[108:111], v[44:47]
s_waitcnt lgkmcnt(6)
v_mfma_f32_16x16x32_bf16 v[48:51], a[180:183], a[112:115], v[48:51]
v_mfma_f32_16x16x32_bf16 v[48:51], a[212:215], a[144:147], v[48:51]
v_mfma_f32_16x16x32_bf16 v[80:83], a[176:179], a[144:147], v[80:83]
v_mfma_f32_16x16x32_bf16 v[80:83], a[208:211], a[112:115], v[80:83]
s_waitcnt lgkmcnt(4)
v_mfma_f32_16x16x32_bf16 v[84:87], a[208:211], a[116:119], v[84:87]
v_mfma_f32_16x16x32_bf16 v[84:87], a[176:179], a[148:151], v[84:87]
s_add_u32 m0, s31, 122048
v_mfma_f32_16x16x32_bf16 v[52:55], a[212:215], a[148:151], v[52:55]
buffer_load_dwordx4 v5, s[12:15], s48 offen offset:832 lds
v_mfma_f32_16x16x32_bf16 v[52:55], a[180:183], a[116:119], v[52:55]
s_waitcnt lgkmcnt(2)
v_mfma_f32_16x16x32_bf16 v[56:59], a[180:183], a[120:123], v[56:59]
v_mfma_f32_16x16x32_bf16 v[56:59], a[212:215], a[152:155], v[56:59]
v_mfma_f32_16x16x32_bf16 v[88:91], a[176:179], a[152:155], v[88:91]
v_mfma_f32_16x16x32_bf16 v[88:91], a[208:211], a[120:123], v[88:91]
s_waitcnt lgkmcnt(0)
v_mfma_f32_16x16x32_bf16 v[92:95], a[208:211], a[124:127], v[92:95]
buffer_load_dwordx4 a[208:211], v0, s[20:23], s30 offen offset:0 sc1
v_mfma_f32_16x16x32_bf16 v[92:95], a[176:179], a[156:159], v[92:95]
buffer_load_dwordx4 a[176:179], v0, s[20:23], s30 offen offset:1024 sc1
v_mfma_f32_16x16x32_bf16 v[60:63], a[212:215], a[156:159], v[60:63]
buffer_load_dwordx4 a[212:215], v0, s[20:23], s30 offen offset:2048 sc1
v_mfma_f32_16x16x32_bf16 v[60:63], a[180:183], a[124:127], v[60:63]
buffer_load_dwordx4 a[180:183], v0, s[20:23], s30 offen offset:3072 sc1
s_add_u32 s30, s30, 0x1000
s_waitcnt vmcnt(34)
v_mfma_f32_16x16x32_bf16 v[96:99], a[188:191], a[96:99], v[96:99]
v_mfma_f32_16x16x32_bf16 v[96:99], a[220:223], a[128:131], v[96:99]
v_mfma_f32_16x16x32_bf16 v[128:131], a[184:187], a[128:131], v[128:131]
v_mfma_f32_16x16x32_bf16 v[128:131], a[216:219], a[96:99], v[128:131]
v_mfma_f32_16x16x32_bf16 v[132:135], a[216:219], a[100:103], v[132:135]
v_mfma_f32_16x16x32_bf16 v[132:135], a[184:187], a[132:135], v[132:135]
v_mfma_f32_16x16x32_bf16 v[100:103], a[220:223], a[132:135], v[100:103]
v_mfma_f32_16x16x32_bf16 v[100:103], a[188:191], a[100:103], v[100:103]
v_mfma_f32_16x16x32_bf16 v[104:107], a[188:191], a[104:107], v[104:107]
v_mfma_f32_16x16x32_bf16 v[104:107], a[220:223], a[136:139], v[104:107]
v_mfma_f32_16x16x32_bf16 v[136:139], a[184:187], a[136:139], v[136:139]
v_mfma_f32_16x16x32_bf16 v[136:139], a[216:219], a[104:107], v[136:139]
v_mfma_f32_16x16x32_bf16 v[140:143], a[216:219], a[108:111], v[140:143]
v_mfma_f32_16x16x32_bf16 v[140:143], a[184:187], a[140:143], v[140:143]
s_add_u32 m0, s31, 123072
v_mfma_f32_16x16x32_bf16 v[108:111], a[220:223], a[140:143], v[108:111]
buffer_load_dwordx4 v5, s[12:15], s49 offen offset:832 lds
v_mfma_f32_16x16x32_bf16 v[108:111], a[188:191], a[108:111], v[108:111]
v_mfma_f32_16x16x32_bf16 v[112:115], a[188:191], a[112:115], v[112:115]
v_mfma_f32_16x16x32_bf16 v[112:115], a[220:223], a[144:147], v[112:115]
v_mfma_f32_16x16x32_bf16 v[144:147], a[184:187], a[144:147], v[144:147]
v_mfma_f32_16x16x32_bf16 v[144:147], a[216:219], a[112:115], v[144:147]
v_mfma_f32_16x16x32_bf16 v[148:151], a[216:219], a[116:119], v[148:151]
v_mfma_f32_16x16x32_bf16 v[148:151], a[184:187], a[148:151], v[148:151]
v_mfma_f32_16x16x32_bf16 v[116:119], a[220:223], a[148:151], v[116:119]
v_mfma_f32_16x16x32_bf16 v[116:119], a[188:191], a[116:119], v[116:119]
v_mfma_f32_16x16x32_bf16 v[120:123], a[188:191], a[120:123], v[120:123]
v_mfma_f32_16x16x32_bf16 v[120:123], a[220:223], a[152:155], v[120:123]
v_mfma_f32_16x16x32_bf16 v[152:155], a[184:187], a[152:155], v[152:155]
v_mfma_f32_16x16x32_bf16 v[152:155], a[216:219], a[120:123], v[152:155]
v_mfma_f32_16x16x32_bf16 v[156:159], a[216:219], a[124:127], v[156:159]
buffer_load_dwordx4 a[216:219], v0, s[20:23], s30 offen offset:0 sc1
v_mfma_f32_16x16x32_bf16 v[156:159], a[184:187], a[156:159], v[156:159]
buffer_load_dwordx4 a[184:187], v0, s[20:23], s30 offen offset:1024 sc1
v_mfma_f32_16x16x32_bf16 v[124:127], a[220:223], a[156:159], v[124:127]
buffer_load_dwordx4 a[220:223], v0, s[20:23], s30 offen offset:2048 sc1
v_mfma_f32_16x16x32_bf16 v[124:127], a[188:191], a[124:127], v[124:127]
buffer_load_dwordx4 a[188:191], v0, s[20:23], s30 offen offset:3072 sc1
s_add_u32 s30, s30, 0x1000
s_waitcnt vmcnt(35)
v_mfma_f32_16x16x32_bf16 v[160:163], a[68:71], a[96:99], v[160:163]
v_mfma_f32_16x16x32_bf16 v[160:163], a[36:39], a[128:131], v[160:163]
v_mfma_f32_16x16x32_bf16 v[192:195], a[64:67], a[128:131], v[192:195]
v_mfma_f32_16x16x32_bf16 v[192:195], a[32:35], a[96:99], v[192:195]
s_add_u32 m0, s31, 0
v_mfma_f32_16x16x32_bf16 v[196:199], a[32:35], a[100:103], v[196:199]
s_add_u32 s11, s50, 128
buffer_load_dwordx4 v5, s[12:15], s11 offen offset:0 lds
v_mfma_f32_16x16x32_bf16 v[196:199], a[64:67], a[132:135], v[196:199]
v_mfma_f32_16x16x32_bf16 v[164:167], a[36:39], a[132:135], v[164:167]
v_mfma_f32_16x16x32_bf16 v[164:167], a[68:71], a[100:103], v[164:167]
v_mfma_f32_16x16x32_bf16 v[168:171], a[68:71], a[104:107], v[168:171]
v_mfma_f32_16x16x32_bf16 v[168:171], a[36:39], a[136:139], v[168:171]
v_mfma_f32_16x16x32_bf16 v[200:203], a[64:67], a[136:139], v[200:203]
v_mfma_f32_16x16x32_bf16 v[200:203], a[32:35], a[104:107], v[200:203]
v_mfma_f32_16x16x32_bf16 v[204:207], a[32:35], a[108:111], v[204:207]
v_mfma_f32_16x16x32_bf16 v[204:207], a[64:67], a[140:143], v[204:207]
v_mfma_f32_16x16x32_bf16 v[172:175], a[36:39], a[140:143], v[172:175]
v_mfma_f32_16x16x32_bf16 v[172:175], a[68:71], a[108:111], v[172:175]
v_mfma_f32_16x16x32_bf16 v[176:179], a[68:71], a[112:115], v[176:179]
v_mfma_f32_16x16x32_bf16 v[176:179], a[36:39], a[144:147], v[176:179]
v_mfma_f32_16x16x32_bf16 v[208:211], a[64:67], a[144:147], v[208:211]
v_mfma_f32_16x16x32_bf16 v[208:211], a[32:35], a[112:115], v[208:211]
v_mfma_f32_16x16x32_bf16 v[212:215], a[32:35], a[116:119], v[212:215]
v_mfma_f32_16x16x32_bf16 v[212:215], a[64:67], a[148:151], v[212:215]
v_mfma_f32_16x16x32_bf16 v[180:183], a[36:39], a[148:151], v[180:183]
v_mfma_f32_16x16x32_bf16 v[180:183], a[68:71], a[116:119], v[180:183]
v_mfma_f32_16x16x32_bf16 v[184:187], a[68:71], a[120:123], v[184:187]
v_mfma_f32_16x16x32_bf16 v[184:187], a[36:39], a[152:155], v[184:187]
v_mfma_f32_16x16x32_bf16 v[216:219], a[64:67], a[152:155], v[216:219]
v_mfma_f32_16x16x32_bf16 v[216:219], a[32:35], a[120:123], v[216:219]
s_add_u32 m0, s31, 896
v_mfma_f32_16x16x32_bf16 v[220:223], a[32:35], a[124:127], v[220:223]
buffer_load_dwordx4 a[32:35], v0, s[20:23], s30 offen offset:0 sc1
buffer_load_dwordx4 v5, s[12:15], s51 offen offset:128 lds
v_mfma_f32_16x16x32_bf16 v[220:223], a[64:67], a[156:159], v[220:223]
buffer_load_dwordx4 a[64:67], v0, s[20:23], s30 offen offset:1024 sc1
v_mfma_f32_16x16x32_bf16 v[188:191], a[36:39], a[156:159], v[188:191]
buffer_load_dwordx4 a[36:39], v0, s[20:23], s30 offen offset:2048 sc1
v_mfma_f32_16x16x32_bf16 v[188:191], a[68:71], a[124:127], v[188:191]
buffer_load_dwordx4 a[68:71], v0, s[20:23], s30 offen offset:3072 sc1
s_add_u32 s30, s30, 0x1000
s_barrier
s_waitcnt vmcnt(36)
v_mfma_f32_16x16x32_bf16 v[224:227], a[76:79], a[96:99], v[224:227]
v_mfma_f32_16x16x32_bf16 v[224:227], a[44:47], a[128:131], v[224:227]
v_mfma_f32_16x16x32_bf16 a[224:227], a[72:75], a[128:131], a[224:227]
v_xor_b32 v2, 0x12000, v6
ds_read_b128 a[128:131], v2 offset:0
v_mfma_f32_16x16x32_bf16 a[224:227], a[40:43], a[96:99], a[224:227]
v_xor_b32 v1, 0x10000, v6
ds_read_b128 a[0:3], v1 offset:0
v_mfma_f32_16x16x32_bf16 a[228:231], a[40:43], a[100:103], a[228:231]
v_mfma_f32_16x16x32_bf16 a[228:231], a[72:75], a[132:135], a[228:231]
v_mfma_f32_16x16x32_bf16 v[228:231], a[44:47], a[132:135], v[228:231]
ds_read_b128 a[132:135], v2 offset:1024
v_mfma_f32_16x16x32_bf16 v[228:231], a[76:79], a[100:103], v[228:231]
ds_read_b128 a[4:7], v1 offset:1024
v_mfma_f32_16x16x32_bf16 v[232:235], a[76:79], a[104:107], v[232:235]
v_mfma_f32_16x16x32_bf16 v[232:235], a[44:47], a[136:139], v[232:235]
v_mfma_f32_16x16x32_bf16 a[232:235], a[72:75], a[136:139], a[232:235]
ds_read_b128 a[136:139], v2 offset:2048
v_mfma_f32_16x16x32_bf16 a[232:235], a[40:43], a[104:107], a[232:235]
ds_read_b128 a[8:11], v1 offset:2048
v_mfma_f32_16x16x32_bf16 a[236:239], a[40:43], a[108:111], a[236:239]
v_mfma_f32_16x16x32_bf16 a[236:239], a[72:75], a[140:143], a[236:239]
v_mfma_f32_16x16x32_bf16 v[236:239], a[44:47], a[140:143], v[236:239]
ds_read_b128 a[140:143], v2 offset:3072
v_mfma_f32_16x16x32_bf16 v[236:239], a[76:79], a[108:111], v[236:239]
ds_read_b128 a[12:15], v1 offset:3072
v_mfma_f32_16x16x32_bf16 v[240:243], a[76:79], a[112:115], v[240:243]
v_mfma_f32_16x16x32_bf16 v[240:243], a[44:47], a[144:147], v[240:243]
v_mfma_f32_16x16x32_bf16 a[240:243], a[72:75], a[144:147], a[240:243]
ds_read_b128 a[144:147], v2 offset:4096
v_mfma_f32_16x16x32_bf16 a[240:243], a[40:43], a[112:115], a[240:243]
ds_read_b128 a[16:19], v1 offset:4096
s_add_u32 m0, s31, 8000
v_mfma_f32_16x16x32_bf16 a[244:247], a[40:43], a[116:119], a[244:247]
buffer_load_dwordx4 v5, s[12:15], s50 offen offset:192 lds
v_mfma_f32_16x16x32_bf16 a[244:247], a[72:75], a[148:151], a[244:247]
v_mfma_f32_16x16x32_bf16 v[244:247], a[44:47], a[148:151], v[244:247]
ds_read_b128 a[148:151], v2 offset:5120
v_mfma_f32_16x16x32_bf16 v[244:247], a[76:79], a[116:119], v[244:247]
ds_read_b128 a[20:23], v1 offset:5120
v_mfma_f32_16x16x32_bf16 v[248:251], a[76:79], a[120:123], v[248:251]
v_mfma_f32_16x16x32_bf16 v[248:251], a[44:47], a[152:155], v[248:251]
v_mfma_f32_16x16x32_bf16 a[248:251], a[72:75], a[152:155], a[248:251]
ds_read_b128 a[152:155], v2 offset:6144
v_mfma_f32_16x16x32_bf16 a[248:251], a[40:43], a[120:123], a[248:251]
ds_read_b128 a[24:27], v1 offset:6144
v_mfma_f32_16x16x32_bf16 a[252:255], a[40:43], a[124:127], a[252:255]
v_mfma_f32_16x16x32_bf16 a[252:255], a[72:75], a[156:159], a[252:255]
buffer_load_dwordx4 a[72:75], v0, s[20:23], s30 offen offset:0 sc1
v_mfma_f32_16x16x32_bf16 v[252:255], a[44:47], a[156:159], v[252:255]
ds_read_b128 a[156:159], v2 offset:7168
v_mfma_f32_16x16x32_bf16 v[252:255], a[76:79], a[124:127], v[252:255]
buffer_load_dwordx4 a[76:79], v0, s[20:23], s30 offen offset:1024 sc1
ds_read_b128 a[28:31], v1 offset:7168
L_q1:
s_waitcnt vmcnt(35) lgkmcnt(14)
v_mfma_f32_16x16x32_bf16 v[32:35], a[84:87], a[0:3], v[32:35]
v_mfma_f32_16x16x32_bf16 v[32:35], a[52:55], a[128:131], v[32:35]
v_mfma_f32_16x16x32_bf16 v[64:67], a[80:83], a[128:131], v[64:67]
v_mfma_f32_16x16x32_bf16 v[64:67], a[48:51], a[0:3], v[64:67]
s_waitcnt lgkmcnt(12)
v_mfma_f32_16x16x32_bf16 v[68:71], a[48:51], a[4:7], v[68:71]
v_mfma_f32_16x16x32_bf16 v[68:71], a[80:83], a[132:135], v[68:71]
v_mfma_f32_16x16x32_bf16 v[36:39], a[52:55], a[132:135], v[36:39]
v_mfma_f32_16x16x32_bf16 v[36:39], a[84:87], a[4:7], v[36:39]
s_waitcnt lgkmcnt(10)
v_mfma_f32_16x16x32_bf16 v[40:43], a[84:87], a[8:11], v[40:43]
v_mfma_f32_16x16x32_bf16 v[40:43], a[52:55], a[136:139], v[40:43]
v_mfma_f32_16x16x32_bf16 v[72:75], a[80:83], a[136:139], v[72:75]
v_mfma_f32_16x16x32_bf16 v[72:75], a[48:51], a[8:11], v[72:75]
s_add_u32 m0, s31, 9024
s_waitcnt lgkmcnt(8)
v_mfma_f32_16x16x32_bf16 v[76:79], a[48:51], a[12:15], v[76:79]
buffer_load_dwordx4 v5, s[12:15], s51 offen offset:192 lds
v_mfma_f32_16x16x32_bf16 v[76:79], a[80:83], a[140:143], v[76:79]
v_mfma_f32_16x16x32_bf16 v[44:47], a[52:55], a[140:143], v[44:47]
v_mfma_f32_16x16x32_bf16 v[44:47], a[84:87], a[12:15], v[44:47]
s_waitcnt lgkmcnt(6)
v_mfma_f32_16x16x32_bf16 v[48:51], a[84:87], a[16:19], v[48:51]
v_mfma_f32_16x16x32_bf16 v[48:51], a[52:55], a[144:147], v[48:51]
v_mfma_f32_16x16x32_bf16 v[80:83], a[80:83], a[144:147], v[80:83]
v_mfma_f32_16x16x32_bf16 v[80:83], a[48:51], a[16:19], v[80:83]
s_waitcnt lgkmcnt(4)
v_mfma_f32_16x16x32_bf16 v[84:87], a[48:51], a[20:23], v[84:87]
v_mfma_f32_16x16x32_bf16 v[84:87], a[80:83], a[148:151], v[84:87]
v_mfma_f32_16x16x32_bf16 v[52:55], a[52:55], a[148:151], v[52:55]
v_mfma_f32_16x16x32_bf16 v[52:55], a[84:87], a[20:23], v[52:55]
s_waitcnt lgkmcnt(2)
v_mfma_f32_16x16x32_bf16 v[56:59], a[84:87], a[24:27], v[56:59]
v_mfma_f32_16x16x32_bf16 v[56:59], a[52:55], a[152:155], v[56:59]
v_mfma_f32_16x16x32_bf16 v[88:91], a[80:83], a[152:155], v[88:91]
v_mfma_f32_16x16x32_bf16 v[88:91], a[48:51], a[24:27], v[88:91]
s_waitcnt lgkmcnt(0)
v_mfma_f32_16x16x32_bf16 v[92:95], a[48:51], a[28:31], v[92:95]
v_mfma_f32_16x16x32_bf16 v[92:95], a[80:83], a[156:159], v[92:95]
buffer_load_dwordx4 a[80:83], v0, s[20:23], s30 offen offset:2048 sc1
v_mfma_f32_16x16x32_bf16 v[60:63], a[52:55], a[156:159], v[60:63]
v_mfma_f32_16x16x32_bf16 v[60:63], a[84:87], a[28:31], v[60:63]
buffer_load_dwordx4 a[84:87], v0, s[20:23], s30 offen offset:3072 sc1
s_add_u32 s30, s30, 0x1000
s_waitcnt vmcnt(33)
v_mfma_f32_16x16x32_bf16 v[96:99], a[92:95], a[0:3], v[96:99]
s_add_u32 s96, s92, L_q3-L_pc
s_addc_u32 s97, s93, 0
s_load_dword s98, s[96:97], 0
v_mfma_f32_16x16x32_bf16 v[96:99], a[60:63], a[128:131], v[96:99]
v_mfma_f32_16x16x32_bf16 v[128:131], a[88:91], a[128:131], v[128:131]
v_mfma_f32_16x16x32_bf16 v[128:131], a[56:59], a[0:3], v[128:131]
s_add_u32 m0, s31, 16000
v_mfma_f32_16x16x32_bf16 v[132:135], a[56:59], a[4:7], v[132:135]
buffer_load_dwordx4 v5, s[12:15], s50 offen offset:384 lds
v_mfma_f32_16x16x32_bf16 v[132:135], a[88:91], a[132:135], v[132:135]
v_mfma_f32_16x16x32_bf16 v[100:103], a[60:63], a[132:135], v[100:103]
v_mfma_f32_16x16x32_bf16 v[100:103], a[92:95], a[4:7], v[100:103]
v_mfma_f32_16x16x32_bf16 v[104:107], a[92:95], a[8:11], v[104:107]
v_mfma_f32_16x16x32_bf16 v[104:107], a[60:63], a[136:139], v[104:107]
v_mfma_f32_16x16x32_bf16 v[136:139], a[88:91], a[136:139], v[136:139]
v_mfma_f32_16x16x32_bf16 v[136:139], a[56:59], a[8:11], v[136:139]
v_mfma_f32_16x16x32_bf16 v[140:143], a[56:59], a[12:15], v[140:143]
v_mfma_f32_16x16x32_bf16 v[140:143], a[88:91], a[140:143], v[140:143]
v_mfma_f32_16x16x32_bf16 v[108:111], a[60:63], a[140:143], v[108:111]
v_mfma_f32_16x16x32_bf16 v[108:111], a[92:95], a[12:15], v[108:111]
v_mfma_f32_16x16x32_bf16 v[112:115], a[92:95], a[16:19], v[112:115]
v_mfma_f32_16x16x32_bf16 v[112:115], a[60:63], a[144:147], v[112:115]
v_mfma_f32_16x16x32_bf16 v[144:147], a[88:91], a[144:147], v[144:147]
v_mfma_f32_16x16x32_bf16 v[144:147], a[56:59], a[16:19], v[144:147]
v_mfma_f32_16x16x32_bf16 v[148:151], a[56:59], a[20:23], v[148:151]
v_mfma_f32_16x16x32_bf16 v[148:151], a[88:91], a[148:151], v[148:151]
v_mfma_f32_16x16x32_bf16 v[116:119], a[60:63], a[148:151], v[116:119]
v_mfma_f32_16x16x32_bf16 v[116:119], a[92:95], a[20:23], v[116:119]
v_mfma_f32_16x16x32_bf16 v[120:123], a[92:95], a[24:27], v[120:123]
v_mfma_f32_16x16x32_bf16 v[120:123], a[60:63], a[152:155], v[120:123]
v_mfma_f32_16x16x32_bf16 v[152:155], a[88:91], a[152:155], v[152:155]
v_mfma_f32_16x16x32_bf16 v[152:155], a[56:59], a[24:27], v[152:155]
s_add_u32 m0, s31, 17024
v_mfma_f32_16x16x32_bf16 v[156:159], a[56:59], a[28:31], v[156:159]
buffer_load_dwordx4 v5, s[12:15], s51 offen offset:384 lds
v_mfma_f32_16x16x32_bf16 v[156:159], a[88:91], a[156:159], v[156:159]
buffer_load_dwordx4 a[88:91], v0, s[20:23], s30 offen offset:0 sc1
v_mfma_f32_16x16x32_bf16 v[124:127], a[60:63], a[156:159], v[124:127]
v_mfma_f32_16x16x32_bf16 v[124:127], a[92:95], a[28:31], v[124:127]
buffer_load_dwordx4 a[92:95], v0, s[20:23], s30 offen offset:1024 sc1
s_waitcnt vmcnt(33)
v_mfma_f32_16x16x32_bf16 v[160:163], a[196:199], a[0:3], v[160:163]
v_mfma_f32_16x16x32_bf16 v[160:163], a[164:167], a[128:131], v[160:163]
v_mfma_f32_16x16x32_bf16 v[192:195], a[192:195], a[128:131], v[192:195]
v_mfma_f32_16x16x32_bf16 v[192:195], a[160:163], a[0:3], v[192:195]
v_mfma_f32_16x16x32_bf16 v[196:199], a[160:163], a[4:7], v[196:199]
v_mfma_f32_16x16x32_bf16 v[196:199], a[192:195], a[132:135], v[196:199]
v_mfma_f32_16x16x32_bf16 v[164:167], a[164:167], a[132:135], v[164:167]
v_mfma_f32_16x16x32_bf16 v[164:167], a[196:199], a[4:7], v[164:167]
v_mfma_f32_16x16x32_bf16 v[168:171], a[196:199], a[8:11], v[168:171]
v_mfma_f32_16x16x32_bf16 v[168:171], a[164:167], a[136:139], v[168:171]
v_mfma_f32_16x16x32_bf16 v[200:203], a[192:195], a[136:139], v[200:203]
v_mfma_f32_16x16x32_bf16 v[200:203], a[160:163], a[8:11], v[200:203]
v_mfma_f32_16x16x32_bf16 v[204:207], a[160:163], a[12:15], v[204:207]
v_mfma_f32_16x16x32_bf16 v[204:207], a[192:195], a[140:143], v[204:207]
v_mfma_f32_16x16x32_bf16 v[172:175], a[164:167], a[140:143], v[172:175]
v_mfma_f32_16x16x32_bf16 v[172:175], a[196:199], a[12:15], v[172:175]
v_mfma_f32_16x16x32_bf16 v[176:179], a[196:199], a[16:19], v[176:179]
v_mfma_f32_16x16x32_bf16 v[176:179], a[164:167], a[144:147], v[176:179]
v_mfma_f32_16x16x32_bf16 v[208:211], a[192:195], a[144:147], v[208:211]
v_mfma_f32_16x16x32_bf16 v[208:211], a[160:163], a[16:19], v[208:211]
s_add_u32 m0, s31, 24128
v_mfma_f32_16x16x32_bf16 v[212:215], a[160:163], a[20:23], v[212:215]
buffer_load_dwordx4 v5, s[12:15], s50 offen offset:448 lds
v_mfma_f32_16x16x32_bf16 v[212:215], a[192:195], a[148:151], v[212:215]
v_mfma_f32_16x16x32_bf16 v[180:183], a[164:167], a[148:151], v[180:183]
v_mfma_f32_16x16x32_bf16 v[180:183], a[196:199], a[20:23], v[180:183]
v_mfma_f32_16x16x32_bf16 v[184:187], a[196:199], a[24:27], v[184:187]
v_mfma_f32_16x16x32_bf16 v[184:187], a[164:167], a[152:155], v[184:187]
v_mfma_f32_16x16x32_bf16 v[216:219], a[192:195], a[152:155], v[216:219]
v_mfma_f32_16x16x32_bf16 v[216:219], a[160:163], a[24:27], v[216:219]
v_mfma_f32_16x16x32_bf16 v[220:223], a[160:163], a[28:31], v[220:223]
buffer_load_dwordx4 a[160:163], v0, s[20:23], s30 offen offset:2048 sc1
v_mfma_f32_16x16x32_bf16 v[220:223], a[192:195], a[156:159], v[220:223]
buffer_load_dwordx4 a[192:195], v0, s[20:23], s30 offen offset:3072 sc1
s_add_u32 s30, s30, 0x1000
v_mfma_f32_16x16x32_bf16 v[188:191], a[164:167], a[156:159], v[188:191]
buffer_load_dwordx4 a[164:167], v0, s[20:23], s30 offen offset:0 sc1
v_mfma_f32_16x16x32_bf16 v[188:191], a[196:199], a[28:31], v[188:191]
buffer_load_dwordx4 a[196:199], v0, s[20:23], s30 offen offset:1024 sc1
s_waitcnt vmcnt(31)
v_mfma_f32_16x16x32_bf16 v[224:227], a[204:207], a[0:3], v[224:227]
v_mfma_f32_16x16x32_bf16 v[224:227], a[172:175], a[128:131], v[224:227]
v_mfma_f32_16x16x32_bf16 a[224:227], a[200:203], a[128:131], a[224:227]
v_xor_b32 v4, 0x16000, v6
ds_read_b128 a[128:131], v4 offset:0
v_mfma_f32_16x16x32_bf16 a[224:227], a[168:171], a[0:3], a[224:227]
v_xor_b32 v3, 0x14000, v6
ds_read_b128 a[96:99], v3 offset:0
v_mfma_f32_16x16x32_bf16 a[228:231], a[168:171], a[4:7], a[228:231]
v_mfma_f32_16x16x32_bf16 a[228:231], a[200:203], a[132:135], a[228:231]
v_mfma_f32_16x16x32_bf16 v[228:231], a[172:175], a[132:135], v[228:231]
ds_read_b128 a[132:135], v4 offset:1024
v_mfma_f32_16x16x32_bf16 v[228:231], a[204:207], a[4:7], v[228:231]
ds_read_b128 a[100:103], v3 offset:1024
v_mfma_f32_16x16x32_bf16 v[232:235], a[204:207], a[8:11], v[232:235]
v_mfma_f32_16x16x32_bf16 v[232:235], a[172:175], a[136:139], v[232:235]
v_mfma_f32_16x16x32_bf16 a[232:235], a[200:203], a[136:139], a[232:235]
ds_read_b128 a[136:139], v4 offset:2048
v_mfma_f32_16x16x32_bf16 a[232:235], a[168:171], a[8:11], a[232:235]
ds_read_b128 a[104:107], v3 offset:2048
s_add_u32 m0, s31, 25152
v_mfma_f32_16x16x32_bf16 a[236:239], a[168:171], a[12:15], a[236:239]
buffer_load_dwordx4 v5, s[12:15], s51 offen offset:448 lds
v_mfma_f32_16x16x32_bf16 a[236:239], a[200:203], a[140:143], a[236:239]
v_mfma_f32_16x16x32_bf16 v[236:239], a[172:175], a[140:143], v[236:239]
ds_read_b128 a[140:143], v4 offset:3072
v_mfma_f32_16x16x32_bf16 v[236:239], a[204:207], a[12:15], v[236:239]
ds_read_b128 a[108:111], v3 offset:3072
v_mfma_f32_16x16x32_bf16 v[240:243], a[204:207], a[16:19], v[240:243]
v_mfma_f32_16x16x32_bf16 v[240:243], a[172:175], a[144:147], v[240:243]
v_mfma_f32_16x16x32_bf16 a[240:243], a[200:203], a[144:147], a[240:243]
ds_read_b128 a[144:147], v4 offset:4096
v_mfma_f32_16x16x32_bf16 a[240:243], a[168:171], a[16:19], a[240:243]
ds_read_b128 a[112:115], v3 offset:4096
v_mfma_f32_16x16x32_bf16 a[244:247], a[168:171], a[20:23], a[244:247]
v_mfma_f32_16x16x32_bf16 a[244:247], a[200:203], a[148:151], a[244:247]
v_mfma_f32_16x16x32_bf16 v[244:247], a[172:175], a[148:151], v[244:247]
ds_read_b128 a[148:151], v4 offset:5120
v_mfma_f32_16x16x32_bf16 v[244:247], a[204:207], a[20:23], v[244:247]
ds_read_b128 a[116:119], v3 offset:5120
v_mfma_f32_16x16x32_bf16 v[248:251], a[204:207], a[24:27], v[248:251]
v_mfma_f32_16x16x32_bf16 v[248:251], a[172:175], a[152:155], v[248:251]
v_mfma_f32_16x16x32_bf16 a[248:251], a[200:203], a[152:155], a[248:251]
ds_read_b128 a[152:155], v4 offset:6144
v_mfma_f32_16x16x32_bf16 a[248:251], a[168:171], a[24:27], a[248:251]
ds_read_b128 a[120:123], v3 offset:6144
v_mfma_f32_16x16x32_bf16 a[252:255], a[168:171], a[28:31], a[252:255]
buffer_load_dwordx4 a[168:171], v0, s[20:23], s30 offen offset:2048 sc1
v_mfma_f32_16x16x32_bf16 a[252:255], a[200:203], a[156:159], a[252:255]
buffer_load_dwordx4 a[200:203], v0, s[20:23], s30 offen offset:3072 sc1
s_add_u32 s30, s30, 0x1000
v_mfma_f32_16x16x32_bf16 v[252:255], a[172:175], a[156:159], v[252:255]
buffer_load_dwordx4 a[172:175], v0, s[20:23], s30 offen offset:0 sc1
ds_read_b128 a[156:159], v4 offset:7168
v_mfma_f32_16x16x32_bf16 v[252:255], a[204:207], a[28:31], v[252:255]
buffer_load_dwordx4 a[204:207], v0, s[20:23], s30 offen offset:1024 sc1
ds_read_b128 a[124:127], v3 offset:7168
s_waitcnt vmcnt(31) lgkmcnt(14)
v_mfma_f32_16x16x32_bf16 v[32:35], a[208:211], a[96:99], v[32:35]
v_mfma_f32_16x16x32_bf16 v[32:35], a[176:179], a[128:131], v[32:35]
v_mfma_f32_16x16x32_bf16 v[64:67], a[180:183], a[128:131], v[64:67]
v_mfma_f32_16x16x32_bf16 v[64:67], a[212:215], a[96:99], v[64:67]
s_add_u32 m0, s31, 32128
s_waitcnt lgkmcnt(12)
v_mfma_f32_16x16x32_bf16 v[68:71], a[212:215], a[100:103], v[68:71]
buffer_load_dwordx4 v5, s[12:15], s50 offen offset:640 lds
v_mfma_f32_16x16x32_bf16 v[68:71], a[180:183], a[132:135], v[68:71]
v_mfma_f32_16x16x32_bf16 v[36:39], a[176:179], a[132:135], v[36:39]
v_mfma_f32_16x16x32_bf16 v[36:39], a[208:211], a[100:103], v[36:39]
s_waitcnt lgkmcnt(10)
v_mfma_f32_16x16x32_bf16 v[40:43], a[208:211], a[104:107], v[40:43]
v_mfma_f32_16x16x32_bf16 v[40:43], a[176:179], a[136:139], v[40:43]
v_mfma_f32_16x16x32_bf16 v[72:75], a[180:183], a[136:139], v[72:75]
s_add_u32 m0, s31, 139264
s_add_u32 s11, s100, 2097152
buffer_load_dwordx4 v13, s[4:7], s11 offen lds
v_mfma_f32_16x16x32_bf16 v[72:75], a[212:215], a[104:107], v[72:75]
s_waitcnt lgkmcnt(8)
v_mfma_f32_16x16x32_bf16 v[76:79], a[212:215], a[108:111], v[76:79]
v_mfma_f32_16x16x32_bf16 v[76:79], a[180:183], a[140:143], v[76:79]
v_mfma_f32_16x16x32_bf16 v[44:47], a[176:179], a[140:143], v[44:47]
v_mfma_f32_16x16x32_bf16 v[44:47], a[208:211], a[108:111], v[44:47]
s_waitcnt lgkmcnt(6)
v_mfma_f32_16x16x32_bf16 v[48:51], a[208:211], a[112:115], v[48:51]
v_mfma_f32_16x16x32_bf16 v[48:51], a[176:179], a[144:147], v[48:51]
v_mfma_f32_16x16x32_bf16 v[80:83], a[180:183], a[144:147], v[80:83]
v_mfma_f32_16x16x32_bf16 v[80:83], a[212:215], a[112:115], v[80:83]
s_waitcnt lgkmcnt(4)
v_mfma_f32_16x16x32_bf16 v[84:87], a[212:215], a[116:119], v[84:87]
v_mfma_f32_16x16x32_bf16 v[84:87], a[180:183], a[148:151], v[84:87]
v_mfma_f32_16x16x32_bf16 v[52:55], a[176:179], a[148:151], v[52:55]
v_mfma_f32_16x16x32_bf16 v[52:55], a[208:211], a[116:119], v[52:55]
s_waitcnt lgkmcnt(2)
v_mfma_f32_16x16x32_bf16 v[56:59], a[208:211], a[120:123], v[56:59]
v_mfma_f32_16x16x32_bf16 v[56:59], a[176:179], a[152:155], v[56:59]
v_mfma_f32_16x16x32_bf16 v[88:91], a[180:183], a[152:155], v[88:91]
s_add_u32 m0, s31, 140288
s_add_u32 s11, s100, 2129920
buffer_load_dwordx4 v13, s[4:7], s11 offen lds
v_mfma_f32_16x16x32_bf16 v[88:91], a[212:215], a[120:123], v[88:91]
s_waitcnt lgkmcnt(0)
v_mfma_f32_16x16x32_bf16 v[92:95], a[212:215], a[124:127], v[92:95]
buffer_load_dwordx4 a[212:215], v0, s[20:23], s30 offen offset:2048 sc1
v_mfma_f32_16x16x32_bf16 v[92:95], a[180:183], a[156:159], v[92:95]
buffer_load_dwordx4 a[180:183], v0, s[20:23], s30 offen offset:3072 sc1
s_add_u32 s30, s30, 0x1000
v_mfma_f32_16x16x32_bf16 v[60:63], a[176:179], a[156:159], v[60:63]
buffer_load_dwordx4 a[176:179], v0, s[20:23], s30 offen offset:0 sc1
v_mfma_f32_16x16x32_bf16 v[60:63], a[208:211], a[124:127], v[60:63]
buffer_load_dwordx4 a[208:211], v0, s[20:23], s30 offen offset:1024 sc1
s_waitcnt vmcnt(33)
v_mfma_f32_16x16x32_bf16 v[96:99], a[216:219], a[96:99], v[96:99]
v_mfma_f32_16x16x32_bf16 v[96:99], a[184:187], a[128:131], v[96:99]
v_mfma_f32_16x16x32_bf16 v[128:131], a[188:191], a[128:131], v[128:131]
v_mfma_f32_16x16x32_bf16 v[128:131], a[220:223], a[96:99], v[128:131]
s_add_u32 m0, s31, 33152
v_mfma_f32_16x16x32_bf16 v[132:135], a[220:223], a[100:103], v[132:135]
buffer_load_dwordx4 v5, s[12:15], s51 offen offset:640 lds
v_mfma_f32_16x16x32_bf16 v[132:135], a[188:191], a[132:135], v[132:135]
v_mfma_f32_16x16x32_bf16 v[100:103], a[184:187], a[132:135], v[100:103]
v_mfma_f32_16x16x32_bf16 v[100:103], a[216:219], a[100:103], v[100:103]
v_mfma_f32_16x16x32_bf16 v[104:107], a[216:219], a[104:107], v[104:107]
v_mfma_f32_16x16x32_bf16 v[104:107], a[184:187], a[136:139], v[104:107]
v_mfma_f32_16x16x32_bf16 v[136:139], a[188:191], a[136:139], v[136:139]
s_add_u32 m0, s31, 147456
s_add_u32 s11, s100, 4194304
buffer_load_dwordx4 v13, s[4:7], s11 offen lds
v_mfma_f32_16x16x32_bf16 v[136:139], a[220:223], a[104:107], v[136:139]
v_mfma_f32_16x16x32_bf16 v[140:143], a[220:223], a[108:111], v[140:143]
v_mfma_f32_16x16x32_bf16 v[140:143], a[188:191], a[140:143], v[140:143]
v_mfma_f32_16x16x32_bf16 v[108:111], a[184:187], a[140:143], v[108:111]
v_mfma_f32_16x16x32_bf16 v[108:111], a[216:219], a[108:111], v[108:111]
v_mfma_f32_16x16x32_bf16 v[112:115], a[216:219], a[112:115], v[112:115]
v_mfma_f32_16x16x32_bf16 v[112:115], a[184:187], a[144:147], v[112:115]
v_mfma_f32_16x16x32_bf16 v[144:147], a[188:191], a[144:147], v[144:147]
v_mfma_f32_16x16x32_bf16 v[144:147], a[220:223], a[112:115], v[144:147]
v_mfma_f32_16x16x32_bf16 v[148:151], a[220:223], a[116:119], v[148:151]
v_mfma_f32_16x16x32_bf16 v[148:151], a[188:191], a[148:151], v[148:151]
v_mfma_f32_16x16x32_bf16 v[116:119], a[184:187], a[148:151], v[116:119]
v_mfma_f32_16x16x32_bf16 v[116:119], a[216:219], a[116:119], v[116:119]
v_mfma_f32_16x16x32_bf16 v[120:123], a[216:219], a[120:123], v[120:123]
v_mfma_f32_16x16x32_bf16 v[120:123], a[184:187], a[152:155], v[120:123]
v_mfma_f32_16x16x32_bf16 v[152:155], a[188:191], a[152:155], v[152:155]
s_add_u32 m0, s31, 148480
s_add_u32 s11, s100, 4227072
buffer_load_dwordx4 v13, s[4:7], s11 offen lds
v_mfma_f32_16x16x32_bf16 v[152:155], a[220:223], a[120:123], v[152:155]
v_mfma_f32_16x16x32_bf16 v[156:159], a[220:223], a[124:127], v[156:159]
buffer_load_dwordx4 a[220:223], v0, s[20:23], s30 offen offset:2048 sc1
v_mfma_f32_16x16x32_bf16 v[156:159], a[188:191], a[156:159], v[156:159]
buffer_load_dwordx4 a[188:191], v0, s[20:23], s30 offen offset:3072 sc1
s_add_u32 s30, s30, 0x1000
v_mfma_f32_16x16x32_bf16 v[124:127], a[184:187], a[156:159], v[124:127]
buffer_load_dwordx4 a[184:187], v0, s[20:23], s30 offen offset:0 sc1
v_mfma_f32_16x16x32_bf16 v[124:127], a[216:219], a[124:127], v[124:127]
buffer_load_dwordx4 a[216:219], v0, s[20:23], s30 offen offset:1024 sc1
s_waitcnt vmcnt(34)
v_mfma_f32_16x16x32_bf16 v[160:163], a[32:35], a[96:99], v[160:163]
v_mfma_f32_16x16x32_bf16 v[160:163], a[64:67], a[128:131], v[160:163]
v_mfma_f32_16x16x32_bf16 v[192:195], a[68:71], a[128:131], v[192:195]
v_mfma_f32_16x16x32_bf16 v[192:195], a[36:39], a[96:99], v[192:195]
s_add_u32 m0, s31, 40256
v_mfma_f32_16x16x32_bf16 v[196:199], a[36:39], a[100:103], v[196:199]
buffer_load_dwordx4 v5, s[12:15], s50 offen offset:704 lds
v_mfma_f32_16x16x32_bf16 v[196:199], a[68:71], a[132:135], v[196:199]
v_mfma_f32_16x16x32_bf16 v[164:167], a[64:67], a[132:135], v[164:167]
v_mfma_f32_16x16x32_bf16 v[164:167], a[32:35], a[100:103], v[164:167]
v_mfma_f32_16x16x32_bf16 v[168:171], a[32:35], a[104:107], v[168:171]
v_mfma_f32_16x16x32_bf16 v[168:171], a[64:67], a[136:139], v[168:171]
v_mfma_f32_16x16x32_bf16 v[200:203], a[68:71], a[136:139], v[200:203]
v_mfma_f32_16x16x32_bf16 v[200:203], a[36:39], a[104:107], v[200:203]
v_mfma_f32_16x16x32_bf16 v[204:207], a[36:39], a[108:111], v[204:207]
v_mfma_f32_16x16x32_bf16 v[204:207], a[68:71], a[140:143], v[204:207]
v_mfma_f32_16x16x32_bf16 v[172:175], a[64:67], a[140:143], v[172:175]
v_mfma_f32_16x16x32_bf16 v[172:175], a[32:35], a[108:111], v[172:175]
v_mfma_f32_16x16x32_bf16 v[176:179], a[32:35], a[112:115], v[176:179]
v_mfma_f32_16x16x32_bf16 v[176:179], a[64:67], a[144:147], v[176:179]
v_mfma_f32_16x16x32_bf16 v[208:211], a[68:71], a[144:147], v[208:211]
v_mfma_f32_16x16x32_bf16 v[208:211], a[36:39], a[112:115], v[208:211]
v_mfma_f32_16x16x32_bf16 v[212:215], a[36:39], a[116:119], v[212:215]
v_mfma_f32_16x16x32_bf16 v[212:215], a[68:71], a[148:151], v[212:215]
v_mfma_f32_16x16x32_bf16 v[180:183], a[64:67], a[148:151], v[180:183]
v_mfma_f32_16x16x32_bf16 v[180:183], a[32:35], a[116:119], v[180:183]
v_mfma_f32_16x16x32_bf16 v[184:187], a[32:35], a[120:123], v[184:187]
v_mfma_f32_16x16x32_bf16 v[184:187], a[64:67], a[152:155], v[184:187]
v_mfma_f32_16x16x32_bf16 v[216:219], a[68:71], a[152:155], v[216:219]
v_mfma_f32_16x16x32_bf16 v[216:219], a[36:39], a[120:123], v[216:219]
v_mfma_f32_16x16x32_bf16 v[220:223], a[36:39], a[124:127], v[220:223]
v_mfma_f32_16x16x32_bf16 v[220:223], a[68:71], a[156:159], v[220:223]
buffer_load_dwordx4 a[68:71], v0, s[20:23], s30 offen offset:2048 sc1
v_mfma_f32_16x16x32_bf16 v[188:191], a[64:67], a[156:159], v[188:191]
buffer_load_dwordx4 a[64:67], v0, s[20:23], s30 offen offset:3072 sc1
s_add_u32 s30, s30, 0x1000
v_mfma_f32_16x16x32_bf16 v[188:191], a[32:35], a[124:127], v[188:191]
s_barrier
s_waitcnt vmcnt(31)
v_mfma_f32_16x16x32_bf16 v[224:227], a[72:75], a[96:99], v[224:227]
v_mfma_f32_16x16x32_bf16 v[224:227], a[76:79], a[128:131], v[224:227]
v_mfma_f32_16x16x32_bf16 a[224:227], a[84:87], a[128:131], a[224:227]
ds_read_b128 a[128:131], v2 offset:32768
v_mfma_f32_16x16x32_bf16 a[224:227], a[80:83], a[96:99], a[224:227]
ds_read_b128 a[32:35], v1 offset:32768
s_add_u32 m0, s31, 41280
v_mfma_f32_16x16x32_bf16 a[228:231], a[80:83], a[100:103], a[228:231]
buffer_load_dwordx4 v5, s[12:15], s51 offen offset:704 lds
v_mfma_f32_16x16x32_bf16 a[228:231], a[84:87], a[132:135], a[228:231]
v_mfma_f32_16x16x32_bf16 v[228:231], a[76:79], a[132:135], v[228:231]
ds_read_b128 a[132:135], v2 offset:33792
v_mfma_f32_16x16x32_bf16 v[228:231], a[72:75], a[100:103], v[228:231]
ds_read_b128 a[36:39], v1 offset:33792
v_mfma_f32_16x16x32_bf16 v[232:235], a[72:75], a[104:107], v[232:235]
v_mfma_f32_16x16x32_bf16 v[232:235], a[76:79], a[136:139], v[232:235]
v_mfma_f32_16x16x32_bf16 a[232:235], a[84:87], a[136:139], a[232:235]
ds_read_b128 a[136:139], v2 offset:34816
v_mfma_f32_16x16x32_bf16 a[232:235], a[80:83], a[104:107], a[232:235]
ds_read_b128 a[40:43], v1 offset:34816
v_mfma_f32_16x16x32_bf16 a[236:239], a[80:83], a[108:111], a[236:239]
v_mfma_f32_16x16x32_bf16 a[236:239], a[84:87], a[140:143], a[236:239]
v_mfma_f32_16x16x32_bf16 v[236:239], a[76:79], a[140:143], v[236:239]
ds_read_b128 a[140:143], v2 offset:35840
v_mfma_f32_16x16x32_bf16 v[236:239], a[72:75], a[108:111], v[236:239]
ds_read_b128 a[44:47], v1 offset:35840
v_mfma_f32_16x16x32_bf16 v[240:243], a[72:75], a[112:115], v[240:243]
v_mfma_f32_16x16x32_bf16 v[240:243], a[76:79], a[144:147], v[240:243]
v_mfma_f32_16x16x32_bf16 a[240:243], a[84:87], a[144:147], a[240:243]
ds_read_b128 a[144:147], v2 offset:36864
v_mfma_f32_16x16x32_bf16 a[240:243], a[80:83], a[112:115], a[240:243]
ds_read_b128 a[48:51], v1 offset:36864
v_mfma_f32_16x16x32_bf16 a[244:247], a[80:83], a[116:119], a[244:247]
v_mfma_f32_16x16x32_bf16 a[244:247], a[84:87], a[148:151], a[244:247]
v_mfma_f32_16x16x32_bf16 v[244:247], a[76:79], a[148:151], v[244:247]
ds_read_b128 a[148:151], v2 offset:37888
v_mfma_f32_16x16x32_bf16 v[244:247], a[72:75], a[116:119], v[244:247]
ds_read_b128 a[52:55], v1 offset:37888
v_mfma_f32_16x16x32_bf16 v[248:251], a[72:75], a[120:123], v[248:251]
v_mfma_f32_16x16x32_bf16 v[248:251], a[76:79], a[152:155], v[248:251]
v_mfma_f32_16x16x32_bf16 a[248:251], a[84:87], a[152:155], a[248:251]
ds_read_b128 a[152:155], v2 offset:38912
v_mfma_f32_16x16x32_bf16 a[248:251], a[80:83], a[120:123], a[248:251]
ds_read_b128 a[56:59], v1 offset:38912
v_mfma_f32_16x16x32_bf16 a[252:255], a[80:83], a[124:127], a[252:255]
buffer_load_dwordx4 a[80:83], v0, s[20:23], s30 offen offset:0 sc1
v_mfma_f32_16x16x32_bf16 a[252:255], a[84:87], a[156:159], a[252:255]
buffer_load_dwordx4 a[84:87], v0, s[20:23], s30 offen offset:1024 sc1
v_mfma_f32_16x16x32_bf16 v[252:255], a[76:79], a[156:159], v[252:255]
buffer_load_dwordx4 a[76:79], v0, s[20:23], s30 offen offset:2048 sc1
ds_read_b128 a[156:159], v2 offset:39936
v_mfma_f32_16x16x32_bf16 v[252:255], a[72:75], a[124:127], v[252:255]
buffer_load_dwordx4 a[72:75], v0, s[20:23], s30 offen offset:3072 sc1
s_add_u32 s30, s30, 0x1000
ds_read_b128 a[60:63], v1 offset:39936
s_waitcnt vmcnt(29) lgkmcnt(14)
v_mfma_f32_16x16x32_bf16 v[32:35], a[88:91], a[32:35], v[32:35]
v_mfma_f32_16x16x32_bf16 v[32:35], a[92:95], a[128:131], v[32:35]
v_mfma_f32_16x16x32_bf16 v[64:67], a[192:195], a[128:131], v[64:67]
v_mfma_f32_16x16x32_bf16 v[64:67], a[160:163], a[32:35], v[64:67]
s_add_u32 m0, s31, 48256
s_waitcnt lgkmcnt(12)
v_mfma_f32_16x16x32_bf16 v[68:71], a[160:163], a[36:39], v[68:71]
buffer_load_dwordx4 v5, s[12:15], s50 offen offset:896 lds
v_mfma_f32_16x16x32_bf16 v[68:71], a[192:195], a[132:135], v[68:71]
v_mfma_f32_16x16x32_bf16 v[36:39], a[92:95], a[132:135], v[36:39]
v_mfma_f32_16x16x32_bf16 v[36:39], a[88:91], a[36:39], v[36:39]
s_waitcnt lgkmcnt(10)
v_mfma_f32_16x16x32_bf16 v[40:43], a[88:91], a[40:43], v[40:43]
v_mfma_f32_16x16x32_bf16 v[40:43], a[92:95], a[136:139], v[40:43]
v_mfma_f32_16x16x32_bf16 v[72:75], a[192:195], a[136:139], v[72:75]
v_mfma_f32_16x16x32_bf16 v[72:75], a[160:163], a[40:43], v[72:75]
s_waitcnt lgkmcnt(8)
v_mfma_f32_16x16x32_bf16 v[76:79], a[160:163], a[44:47], v[76:79]
v_mfma_f32_16x16x32_bf16 v[76:79], a[192:195], a[140:143], v[76:79]
v_mfma_f32_16x16x32_bf16 v[44:47], a[92:95], a[140:143], v[44:47]
v_mfma_f32_16x16x32_bf16 v[44:47], a[88:91], a[44:47], v[44:47]
s_waitcnt lgkmcnt(6)
v_mfma_f32_16x16x32_bf16 v[48:51], a[88:91], a[48:51], v[48:51]
v_mfma_f32_16x16x32_bf16 v[48:51], a[92:95], a[144:147], v[48:51]
v_mfma_f32_16x16x32_bf16 v[80:83], a[192:195], a[144:147], v[80:83]
v_mfma_f32_16x16x32_bf16 v[80:83], a[160:163], a[48:51], v[80:83]
s_waitcnt lgkmcnt(4)
v_mfma_f32_16x16x32_bf16 v[84:87], a[160:163], a[52:55], v[84:87]
v_mfma_f32_16x16x32_bf16 v[84:87], a[192:195], a[148:151], v[84:87]
v_mfma_f32_16x16x32_bf16 v[52:55], a[92:95], a[148:151], v[52:55]
v_mfma_f32_16x16x32_bf16 v[52:55], a[88:91], a[52:55], v[52:55]
s_waitcnt lgkmcnt(2)
v_mfma_f32_16x16x32_bf16 v[56:59], a[88:91], a[56:59], v[56:59]
v_mfma_f32_16x16x32_bf16 v[56:59], a[92:95], a[152:155], v[56:59]
v_mfma_f32_16x16x32_bf16 v[88:91], a[192:195], a[152:155], v[88:91]
v_mfma_f32_16x16x32_bf16 v[88:91], a[160:163], a[56:59], v[88:91]
s_waitcnt lgkmcnt(0)
v_mfma_f32_16x16x32_bf16 v[92:95], a[160:163], a[60:63], v[92:95]
buffer_load_dwordx4 a[160:163], v0, s[20:23], s30 offen offset:0 sc1
v_mfma_f32_16x16x32_bf16 v[92:95], a[192:195], a[156:159], v[92:95]
buffer_load_dwordx4 a[192:195], v0, s[20:23], s30 offen offset:1024 sc1
v_mfma_f32_16x16x32_bf16 v[60:63], a[92:95], a[156:159], v[60:63]
buffer_load_dwordx4 a[92:95], v0, s[20:23], s30 offen offset:2048 sc1
v_mfma_f32_16x16x32_bf16 v[60:63], a[88:91], a[60:63], v[60:63]
buffer_load_dwordx4 a[88:91], v0, s[20:23], s30 offen offset:3072 sc1
s_add_u32 s30, s30, 0x1000
s_waitcnt vmcnt(29)
v_mfma_f32_16x16x32_bf16 v[96:99], a[164:167], a[32:35], v[96:99]
v_mfma_f32_16x16x32_bf16 v[96:99], a[196:199], a[128:131], v[96:99]
v_mfma_f32_16x16x32_bf16 v[128:131], a[200:203], a[128:131], v[128:131]
v_mfma_f32_16x16x32_bf16 v[128:131], a[168:171], a[32:35], v[128:131]
s_add_u32 m0, s31, 49280
v_mfma_f32_16x16x32_bf16 v[132:135], a[168:171], a[36:39], v[132:135]
buffer_load_dwordx4 v5, s[12:15], s51 offen offset:896 lds
v_mfma_f32_16x16x32_bf16 v[132:135], a[200:203], a[132:135], v[132:135]
v_mfma_f32_16x16x32_bf16 v[100:103], a[196:199], a[132:135], v[100:103]
v_mfma_f32_16x16x32_bf16 v[100:103], a[164:167], a[36:39], v[100:103]
v_mfma_f32_16x16x32_bf16 v[104:107], a[164:167], a[40:43], v[104:107]
v_mfma_f32_16x16x32_bf16 v[104:107], a[196:199], a[136:139], v[104:107]
v_mfma_f32_16x16x32_bf16 v[136:139], a[200:203], a[136:139], v[136:139]
v_mfma_f32_16x16x32_bf16 v[136:139], a[168:171], a[40:43], v[136:139]
v_mfma_f32_16x16x32_bf16 v[140:143], a[168:171], a[44:47], v[140:143]
v_mfma_f32_16x16x32_bf16 v[140:143], a[200:203], a[140:143], v[140:143]
v_mfma_f32_16x16x32_bf16 v[108:111], a[196:199], a[140:143], v[108:111]
v_mfma_f32_16x16x32_bf16 v[108:111], a[164:167], a[44:47], v[108:111]
v_mfma_f32_16x16x32_bf16 v[112:115], a[164:167], a[48:51], v[112:115]
v_mfma_f32_16x16x32_bf16 v[112:115], a[196:199], a[144:147], v[112:115]
v_mfma_f32_16x16x32_bf16 v[144:147], a[200:203], a[144:147], v[144:147]
v_mfma_f32_16x16x32_bf16 v[144:147], a[168:171], a[48:51], v[144:147]
v_mfma_f32_16x16x32_bf16 v[148:151], a[168:171], a[52:55], v[148:151]
v_mfma_f32_16x16x32_bf16 v[148:151], a[200:203], a[148:151], v[148:151]
v_mfma_f32_16x16x32_bf16 v[116:119], a[196:199], a[148:151], v[116:119]
v_mfma_f32_16x16x32_bf16 v[116:119], a[164:167], a[52:55], v[116:119]
v_mfma_f32_16x16x32_bf16 v[120:123], a[164:167], a[56:59], v[120:123]
v_mfma_f32_16x16x32_bf16 v[120:123], a[196:199], a[152:155], v[120:123]
v_mfma_f32_16x16x32_bf16 v[152:155], a[200:203], a[152:155], v[152:155]
v_mfma_f32_16x16x32_bf16 v[152:155], a[168:171], a[56:59], v[152:155]
v_mfma_f32_16x16x32_bf16 v[156:159], a[168:171], a[60:63], v[156:159]
buffer_load_dwordx4 a[168:171], v0, s[20:23], s30 offen offset:0 sc1
v_mfma_f32_16x16x32_bf16 v[156:159], a[200:203], a[156:159], v[156:159]
buffer_load_dwordx4 a[200:203], v0, s[20:23], s30 offen offset:1024 sc1
v_mfma_f32_16x16x32_bf16 v[124:127], a[196:199], a[156:159], v[124:127]
buffer_load_dwordx4 a[196:199], v0, s[20:23], s30 offen offset:2048 sc1
v_mfma_f32_16x16x32_bf16 v[124:127], a[164:167], a[60:63], v[124:127]
buffer_load_dwordx4 a[164:167], v0, s[20:23], s30 offen offset:3072 sc1
s_add_u32 s30, s30, 0x1000
s_waitcnt vmcnt(27)
v_mfma_f32_16x16x32_bf16 v[160:163], a[172:175], a[32:35], v[160:163]
v_mfma_f32_16x16x32_bf16 v[160:163], a[204:207], a[128:131], v[160:163]
v_mfma_f32_16x16x32_bf16 v[192:195], a[180:183], a[128:131], v[192:195]
v_mfma_f32_16x16x32_bf16 v[192:195], a[212:215], a[32:35], v[192:195]
s_add_u32 m0, s31, 56384
v_mfma_f32_16x16x32_bf16 v[196:199], a[212:215], a[36:39], v[196:199]
buffer_load_dwordx4 v5, s[12:15], s50 offen offset:960 lds
v_mfma_f32_16x16x32_bf16 v[196:199], a[180:183], a[132:135], v[196:199]
v_mfma_f32_16x16x32_bf16 v[164:167], a[204:207], a[132:135], v[164:167]
v_mfma_f32_16x16x32_bf16 v[164:167], a[172:175], a[36:39], v[164:167]
v_mfma_f32_16x16x32_bf16 v[168:171], a[172:175], a[40:43], v[168:171]
v_mfma_f32_16x16x32_bf16 v[168:171], a[204:207], a[136:139], v[168:171]
v_mfma_f32_16x16x32_bf16 v[200:203], a[180:183], a[136:139], v[200:203]
v_mfma_f32_16x16x32_bf16 v[200:203], a[212:215], a[40:43], v[200:203]
v_mfma_f32_16x16x32_bf16 v[204:207], a[212:215], a[44:47], v[204:207]
v_mfma_f32_16x16x32_bf16 v[204:207], a[180:183], a[140:143], v[204:207]
v_mfma_f32_16x16x32_bf16 v[172:175], a[204:207], a[140:143], v[172:175]
v_mfma_f32_16x16x32_bf16 v[172:175], a[172:175], a[44:47], v[172:175]
v_mfma_f32_16x16x32_bf16 v[176:179], a[172:175], a[48:51], v[176:179]
v_mfma_f32_16x16x32_bf16 v[176:179], a[204:207], a[144:147], v[176:179]
v_mfma_f32_16x16x32_bf16 v[208:211], a[180:183], a[144:147], v[208:211]
v_mfma_f32_16x16x32_bf16 v[208:211], a[212:215], a[48:51], v[208:211]
v_mfma_f32_16x16x32_bf16 v[212:215], a[212:215], a[52:55], v[212:215]
v_mfma_f32_16x16x32_bf16 v[212:215], a[180:183], a[148:151], v[212:215]
v_mfma_f32_16x16x32_bf16 v[180:183], a[204:207], a[148:151], v[180:183]
v_mfma_f32_16x16x32_bf16 v[180:183], a[172:175], a[52:55], v[180:183]
v_mfma_f32_16x16x32_bf16 v[184:187], a[172:175], a[56:59], v[184:187]
v_mfma_f32_16x16x32_bf16 v[184:187], a[204:207], a[152:155], v[184:187]
v_mfma_f32_16x16x32_bf16 v[216:219], a[180:183], a[152:155], v[216:219]
v_mfma_f32_16x16x32_bf16 v[216:219], a[212:215], a[56:59], v[216:219]
v_mfma_f32_16x16x32_bf16 v[220:223], a[212:215], a[60:63], v[220:223]
buffer_load_dwordx4 a[212:215], v0, s[20:23], s30 offen offset:0 sc1
v_mfma_f32_16x16x32_bf16 v[220:223], a[180:183], a[156:159], v[220:223]
buffer_load_dwordx4 a[180:183], v0, s[20:23], s30 offen offset:1024 sc1
v_mfma_f32_16x16x32_bf16 v[188:191], a[204:207], a[156:159], v[188:191]
buffer_load_dwordx4 a[204:207], v0, s[20:23], s30 offen offset:2048 sc1
v_mfma_f32_16x16x32_bf16 v[188:191], a[172:175], a[60:63], v[188:191]
buffer_load_dwordx4 a[172:175], v0, s[20:23], s30 offen offset:3072 sc1
s_add_u32 s30, s30, 0x1000
s_waitcnt vmcnt(25)
v_mfma_f32_16x16x32_bf16 v[224:227], a[176:179], a[32:35], v[224:227]
v_mfma_f32_16x16x32_bf16 v[224:227], a[208:211], a[128:131], v[224:227]
v_mfma_f32_16x16x32_bf16 a[224:227], a[188:191], a[128:131], a[224:227]
ds_read_b128 a[128:131], v4 offset:32768
v_mfma_f32_16x16x32_bf16 a[224:227], a[220:223], a[32:35], a[224:227]
ds_read_b128 a[96:99], v3 offset:32768
s_add_u32 m0, s31, 57408
v_mfma_f32_16x16x32_bf16 a[228:231], a[220:223], a[36:39], a[228:231]
buffer_load_dwordx4 v5, s[12:15], s51 offen offset:960 lds
v_mfma_f32_16x16x32_bf16 a[228:231], a[188:191], a[132:135], a[228:231]
v_mfma_f32_16x16x32_bf16 v[228:231], a[208:211], a[132:135], v[228:231]
ds_read_b128 a[132:135], v4 offset:33792
v_mfma_f32_16x16x32_bf16 v[228:231], a[176:179], a[36:39], v[228:231]
ds_read_b128 a[100:103], v3 offset:33792
v_mfma_f32_16x16x32_bf16 v[232:235], a[176:179], a[40:43], v[232:235]
v_mfma_f32_16x16x32_bf16 v[232:235], a[208:211], a[136:139], v[232:235]
v_mfma_f32_16x16x32_bf16 a[232:235], a[188:191], a[136:139], a[232:235]
ds_read_b128 a[136:139], v4 offset:34816
ds_read_b64_tr_b16 v[16:17], v14 offset:8192
v_mfma_f32_16x16x32_bf16 a[232:235], a[220:223], a[40:43], a[232:235]
ds_read_b128 a[104:107], v3 offset:34816
v_mfma_f32_16x16x32_bf16 a[236:239], a[220:223], a[44:47], a[236:239]
ds_read_b64_tr_b16 v[18:19], v14 offset:8448
v_mfma_f32_16x16x32_bf16 a[236:239], a[188:191], a[140:143], a[236:239]
v_mfma_f32_16x16x32_bf16 v[236:239], a[208:211], a[140:143], v[236:239]
ds_read_b128 a[140:143], v4 offset:35840
ds_read_b64_tr_b16 v[20:21], v14 offset:8200
v_mfma_f32_16x16x32_bf16 v[236:239], a[176:179], a[44:47], v[236:239]
ds_read_b128 a[108:111], v3 offset:35840
v_mfma_f32_16x16x32_bf16 v[240:243], a[176:179], a[48:51], v[240:243]
ds_read_b64_tr_b16 v[22:23], v14 offset:8456
v_mfma_f32_16x16x32_bf16 v[240:243], a[208:211], a[144:147], v[240:243]
v_mfma_f32_16x16x32_bf16 a[240:243], a[188:191], a[144:147], a[240:243]
ds_read_b128 a[144:147], v4 offset:36864
ds_read_b64_tr_b16 v[24:25], v14 offset:16384
v_mfma_f32_16x16x32_bf16 a[240:243], a[220:223], a[48:51], a[240:243]
ds_read_b128 a[112:115], v3 offset:36864
v_mfma_f32_16x16x32_bf16 a[244:247], a[220:223], a[52:55], a[244:247]
ds_read_b64_tr_b16 v[26:27], v14 offset:16640
v_mfma_f32_16x16x32_bf16 a[244:247], a[188:191], a[148:151], a[244:247]
v_mfma_f32_16x16x32_bf16 v[244:247], a[208:211], a[148:151], v[244:247]
ds_read_b128 a[148:151], v4 offset:37888
ds_read_b64_tr_b16 v[28:29], v14 offset:16392
v_mfma_f32_16x16x32_bf16 v[244:247], a[176:179], a[52:55], v[244:247]
ds_read_b128 a[116:119], v3 offset:37888
v_mfma_f32_16x16x32_bf16 v[248:251], a[176:179], a[56:59], v[248:251]
ds_read_b64_tr_b16 v[30:31], v14 offset:16648
v_mfma_f32_16x16x32_bf16 v[248:251], a[208:211], a[152:155], v[248:251]
v_mfma_f32_16x16x32_bf16 a[248:251], a[188:191], a[152:155], a[248:251]
ds_read_b128 a[152:155], v4 offset:38912
v_mfma_f32_16x16x32_bf16 a[248:251], a[220:223], a[56:59], a[248:251]
ds_read_b128 a[120:123], v3 offset:38912
v_mfma_f32_16x16x32_bf16 a[252:255], a[220:223], a[60:63], a[252:255]
buffer_load_dwordx4 a[220:223], v0, s[20:23], s30 offen offset:0 sc1
v_mfma_f32_16x16x32_bf16 a[252:255], a[188:191], a[156:159], a[252:255]
buffer_load_dwordx4 a[188:191], v0, s[20:23], s30 offen offset:1024 sc1
v_mfma_f32_16x16x32_bf16 v[252:255], a[208:211], a[156:159], v[252:255]
buffer_load_dwordx4 a[208:211], v0, s[20:23], s30 offen offset:2048 sc1
ds_read_b128 a[156:159], v4 offset:39936
v_mfma_f32_16x16x32_bf16 v[252:255], a[176:179], a[60:63], v[252:255]
buffer_load_dwordx4 a[176:179], v0, s[20:23], s30 offen offset:3072 sc1
s_add_u32 s30, s30, 0x1000
ds_read_b128 a[124:127], v3 offset:39936
s_waitcnt vmcnt(25) lgkmcnt(15)
v_mfma_f32_16x16x32_bf16 v[32:35], a[184:187], a[96:99], v[32:35]
v_mfma_f32_16x16x32_bf16 v[32:35], a[216:219], a[128:131], v[32:35]
v_mfma_f32_16x16x32_bf16 v[64:67], a[64:67], a[128:131], v[64:67]
v_mfma_f32_16x16x32_bf16 v[64:67], a[68:71], a[96:99], v[64:67]
v_mfma_f32_16x16x32_bf16 v[68:71], a[68:71], a[100:103], v[68:71]
buffer_store_dwordx4 v[16:19], v0, s[20:23], s57 offen offset:0 sc1
v_mfma_f32_16x16x32_bf16 v[68:71], a[64:67], a[132:135], v[68:71]
v_mfma_f32_16x16x32_bf16 v[36:39], a[216:219], a[132:135], v[36:39]
v_mfma_f32_16x16x32_bf16 v[36:39], a[184:187], a[100:103], v[36:39]
v_mfma_f32_16x16x32_bf16 v[40:43], a[184:187], a[104:107], v[40:43]
v_mfma_f32_16x16x32_bf16 v[40:43], a[216:219], a[136:139], v[40:43]
v_mfma_f32_16x16x32_bf16 v[72:75], a[64:67], a[136:139], v[72:75]
v_mfma_f32_16x16x32_bf16 v[72:75], a[68:71], a[104:107], v[72:75]
s_waitcnt lgkmcnt(13)
v_mfma_f32_16x16x32_bf16 v[76:79], a[68:71], a[108:111], v[76:79]
v_mfma_f32_16x16x32_bf16 v[76:79], a[64:67], a[140:143], v[76:79]
v_mfma_f32_16x16x32_bf16 v[44:47], a[216:219], a[140:143], v[44:47]
v_mfma_f32_16x16x32_bf16 v[44:47], a[184:187], a[108:111], v[44:47]
s_waitcnt lgkmcnt(9)
v_mfma_f32_16x16x32_bf16 v[48:51], a[184:187], a[112:115], v[48:51]
v_mfma_f32_16x16x32_bf16 v[48:51], a[216:219], a[144:147], v[48:51]
v_mfma_f32_16x16x32_bf16 v[80:83], a[64:67], a[144:147], v[80:83]
v_mfma_f32_16x16x32_bf16 v[80:83], a[68:71], a[112:115], v[80:83]
s_waitcnt lgkmcnt(5)
v_mfma_f32_16x16x32_bf16 v[84:87], a[68:71], a[116:119], v[84:87]
buffer_store_dwordx4 v[20:23], v0, s[20:23], s57 offen offset:2048 sc1
v_mfma_f32_16x16x32_bf16 v[84:87], a[64:67], a[148:151], v[84:87]
v_mfma_f32_16x16x32_bf16 v[52:55], a[216:219], a[148:151], v[52:55]
v_mfma_f32_16x16x32_bf16 v[52:55], a[184:187], a[116:119], v[52:55]
s_waitcnt lgkmcnt(2)
v_mfma_f32_16x16x32_bf16 v[56:59], a[184:187], a[120:123], v[56:59]
v_mfma_f32_16x16x32_bf16 v[56:59], a[216:219], a[152:155], v[56:59]
v_mfma_f32_16x16x32_bf16 v[88:91], a[64:67], a[152:155], v[88:91]
v_mfma_f32_16x16x32_bf16 v[88:91], a[68:71], a[120:123], v[88:91]
s_waitcnt lgkmcnt(0)
v_mfma_f32_16x16x32_bf16 v[92:95], a[68:71], a[124:127], v[92:95]
buffer_load_dwordx4 a[68:71], v0, s[20:23], s30 offen offset:0 sc1
v_mfma_f32_16x16x32_bf16 v[92:95], a[64:67], a[156:159], v[92:95]
buffer_load_dwordx4 a[64:67], v0, s[20:23], s30 offen offset:1024 sc1
v_mfma_f32_16x16x32_bf16 v[60:63], a[216:219], a[156:159], v[60:63]
buffer_load_dwordx4 a[216:219], v0, s[20:23], s30 offen offset:2048 sc1
v_mfma_f32_16x16x32_bf16 v[60:63], a[184:187], a[124:127], v[60:63]
buffer_load_dwordx4 a[184:187], v0, s[20:23], s30 offen offset:3072 sc1
s_add_u32 s30, s30, 0x1000
s_waitcnt vmcnt(26)
v_mfma_f32_16x16x32_bf16 v[96:99], a[80:83], a[96:99], v[96:99]
v_mfma_f32_16x16x32_bf16 v[96:99], a[84:87], a[128:131], v[96:99]
v_mfma_f32_16x16x32_bf16 v[128:131], a[72:75], a[128:131], v[128:131]
v_mfma_f32_16x16x32_bf16 v[128:131], a[76:79], a[96:99], v[128:131]
v_mfma_f32_16x16x32_bf16 v[132:135], a[76:79], a[100:103], v[132:135]
buffer_store_dwordx4 v[24:27], v0, s[20:23], s99 offen offset:0 sc1
v_mfma_f32_16x16x32_bf16 v[132:135], a[72:75], a[132:135], v[132:135]
v_mfma_f32_16x16x32_bf16 v[100:103], a[84:87], a[132:135], v[100:103]
v_mfma_f32_16x16x32_bf16 v[100:103], a[80:83], a[100:103], v[100:103]
v_mfma_f32_16x16x32_bf16 v[104:107], a[80:83], a[104:107], v[104:107]
v_mfma_f32_16x16x32_bf16 v[104:107], a[84:87], a[136:139], v[104:107]
v_mfma_f32_16x16x32_bf16 v[136:139], a[72:75], a[136:139], v[136:139]
v_mfma_f32_16x16x32_bf16 v[136:139], a[76:79], a[104:107], v[136:139]
v_mfma_f32_16x16x32_bf16 v[140:143], a[76:79], a[108:111], v[140:143]
v_mfma_f32_16x16x32_bf16 v[140:143], a[72:75], a[140:143], v[140:143]
v_mfma_f32_16x16x32_bf16 v[108:111], a[84:87], a[140:143], v[108:111]
v_mfma_f32_16x16x32_bf16 v[108:111], a[80:83], a[108:111], v[108:111]
v_mfma_f32_16x16x32_bf16 v[112:115], a[80:83], a[112:115], v[112:115]
v_mfma_f32_16x16x32_bf16 v[112:115], a[84:87], a[144:147], v[112:115]
v_mfma_f32_16x16x32_bf16 v[144:147], a[72:75], a[144:147], v[144:147]
v_mfma_f32_16x16x32_bf16 v[144:147], a[76:79], a[112:115], v[144:147]
v_mfma_f32_16x16x32_bf16 v[148:151], a[76:79], a[116:119], v[148:151]
buffer_store_dwordx4 v[28:31], v0, s[20:23], s99 offen offset:2048 sc1
v_mfma_f32_16x16x32_bf16 v[148:151], a[72:75], a[148:151], v[148:151]
v_mfma_f32_16x16x32_bf16 v[116:119], a[84:87], a[148:151], v[116:119]
v_mfma_f32_16x16x32_bf16 v[116:119], a[80:83], a[116:119], v[116:119]
v_mfma_f32_16x16x32_bf16 v[120:123], a[80:83], a[120:123], v[120:123]
v_mfma_f32_16x16x32_bf16 v[120:123], a[84:87], a[152:155], v[120:123]
v_mfma_f32_16x16x32_bf16 v[152:155], a[72:75], a[152:155], v[152:155]
v_mfma_f32_16x16x32_bf16 v[152:155], a[76:79], a[120:123], v[152:155]
v_mfma_f32_16x16x32_bf16 v[156:159], a[76:79], a[124:127], v[156:159]
buffer_load_dwordx4 a[76:79], v0, s[20:23], s30 offen offset:0 sc1
v_mfma_f32_16x16x32_bf16 v[156:159], a[72:75], a[156:159], v[156:159]
buffer_load_dwordx4 a[72:75], v0, s[20:23], s30 offen offset:1024 sc1
v_mfma_f32_16x16x32_bf16 v[124:127], a[84:87], a[156:159], v[124:127]
buffer_load_dwordx4 a[84:87], v0, s[20:23], s30 offen offset:2048 sc1
v_mfma_f32_16x16x32_bf16 v[124:127], a[80:83], a[124:127], v[124:127]
buffer_load_dwordx4 a[80:83], v0, s[20:23], s30 offen offset:3072 sc1
s_add_u32 s30, s30, 0x1000
s_waitcnt vmcnt(27)
v_mfma_f32_16x16x32_bf16 v[160:163], a[160:163], a[96:99], v[160:163]
v_mfma_f32_16x16x32_bf16 v[160:163], a[192:195], a[128:131], v[160:163]
v_mfma_f32_16x16x32_bf16 v[192:195], a[88:91], a[128:131], v[192:195]
v_mfma_f32_16x16x32_bf16 v[192:195], a[92:95], a[96:99], v[192:195]
v_mfma_f32_16x16x32_bf16 v[196:199], a[92:95], a[100:103], v[196:199]
v_mfma_f32_16x16x32_bf16 v[196:199], a[88:91], a[132:135], v[196:199]
v_mfma_f32_16x16x32_bf16 v[164:167], a[192:195], a[132:135], v[164:167]
v_mfma_f32_16x16x32_bf16 v[164:167], a[160:163], a[100:103], v[164:167]
v_mfma_f32_16x16x32_bf16 v[168:171], a[160:163], a[104:107], v[168:171]
v_mfma_f32_16x16x32_bf16 v[168:171], a[192:195], a[136:139], v[168:171]
v_mfma_f32_16x16x32_bf16 v[200:203], a[88:91], a[136:139], v[200:203]
v_mfma_f32_16x16x32_bf16 v[200:203], a[92:95], a[104:107], v[200:203]
v_mfma_f32_16x16x32_bf16 v[204:207], a[92:95], a[108:111], v[204:207]
v_mfma_f32_16x16x32_bf16 v[204:207], a[88:91], a[140:143], v[204:207]
v_mfma_f32_16x16x32_bf16 v[172:175], a[192:195], a[140:143], v[172:175]
v_mfma_f32_16x16x32_bf16 v[172:175], a[160:163], a[108:111], v[172:175]
v_mfma_f32_16x16x32_bf16 v[176:179], a[160:163], a[112:115], v[176:179]
v_mfma_f32_16x16x32_bf16 v[176:179], a[192:195], a[144:147], v[176:179]
v_mfma_f32_16x16x32_bf16 v[208:211], a[88:91], a[144:147], v[208:211]
v_mfma_f32_16x16x32_bf16 v[208:211], a[92:95], a[112:115], v[208:211]
v_mfma_f32_16x16x32_bf16 v[212:215], a[92:95], a[116:119], v[212:215]
v_mfma_f32_16x16x32_bf16 v[212:215], a[88:91], a[148:151], v[212:215]
v_mfma_f32_16x16x32_bf16 v[180:183], a[192:195], a[148:151], v[180:183]
v_mfma_f32_16x16x32_bf16 v[180:183], a[160:163], a[116:119], v[180:183]
v_mfma_f32_16x16x32_bf16 v[184:187], a[160:163], a[120:123], v[184:187]
v_mfma_f32_16x16x32_bf16 v[184:187], a[192:195], a[152:155], v[184:187]
v_mfma_f32_16x16x32_bf16 v[216:219], a[88:91], a[152:155], v[216:219]
v_mfma_f32_16x16x32_bf16 v[216:219], a[92:95], a[120:123], v[216:219]
v_mfma_f32_16x16x32_bf16 v[220:223], a[92:95], a[124:127], v[220:223]
buffer_load_dwordx4 a[92:95], v0, s[20:23], s30 offen offset:0 sc1
v_mfma_f32_16x16x32_bf16 v[220:223], a[88:91], a[156:159], v[220:223]
buffer_load_dwordx4 a[88:91], v0, s[20:23], s30 offen offset:1024 sc1
v_mfma_f32_16x16x32_bf16 v[188:191], a[192:195], a[156:159], v[188:191]
buffer_load_dwordx4 a[192:195], v0, s[20:23], s30 offen offset:2048 sc1
v_mfma_f32_16x16x32_bf16 v[188:191], a[160:163], a[124:127], v[188:191]
buffer_load_dwordx4 a[160:163], v0, s[20:23], s30 offen offset:3072 sc1
s_add_u32 s30, s30, 0x1000
s_barrier
s_waitcnt vmcnt(26)
v_mfma_f32_16x16x32_bf16 v[224:227], a[168:171], a[96:99], v[224:227]
v_mfma_f32_16x16x32_bf16 v[224:227], a[200:203], a[128:131], v[224:227]
v_mfma_f32_16x16x32_bf16 a[224:227], a[164:167], a[128:131], a[224:227]
v_xor_b32 v2, 0x2000, v0
ds_read_b128 a[128:131], v2 offset:0
v_mfma_f32_16x16x32_bf16 a[224:227], a[196:199], a[96:99], a[224:227]
v_xor_b32 v1, 0x0, v0
ds_read_b128 a[96:99], v1 offset:0
v_mfma_f32_16x16x32_bf16 a[228:231], a[196:199], a[100:103], a[228:231]
v_mfma_f32_16x16x32_bf16 a[228:231], a[164:167], a[132:135], a[228:231]
v_mfma_f32_16x16x32_bf16 v[228:231], a[200:203], a[132:135], v[228:231]
ds_read_b128 a[132:135], v2 offset:1024
v_mfma_f32_16x16x32_bf16 v[228:231], a[168:171], a[100:103], v[228:231]
ds_read_b128 a[100:103], v1 offset:1024
v_mfma_f32_16x16x32_bf16 v[232:235], a[168:171], a[104:107], v[232:235]
v_mfma_f32_16x16x32_bf16 v[232:235], a[200:203], a[136:139], v[232:235]
v_mfma_f32_16x16x32_bf16 a[232:235], a[164:167], a[136:139], a[232:235]
ds_read_b128 a[136:139], v2 offset:2048
v_mfma_f32_16x16x32_bf16 a[232:235], a[196:199], a[104:107], a[232:235]
ds_read_b128 a[104:107], v1 offset:2048
v_mfma_f32_16x16x32_bf16 a[236:239], a[196:199], a[108:111], a[236:239]
v_mfma_f32_16x16x32_bf16 a[236:239], a[164:167], a[140:143], a[236:239]
v_mfma_f32_16x16x32_bf16 v[236:239], a[200:203], a[140:143], v[236:239]
ds_read_b128 a[140:143], v2 offset:3072
v_mfma_f32_16x16x32_bf16 v[236:239], a[168:171], a[108:111], v[236:239]
ds_read_b128 a[108:111], v1 offset:3072
v_mfma_f32_16x16x32_bf16 v[240:243], a[168:171], a[112:115], v[240:243]
v_mfma_f32_16x16x32_bf16 v[240:243], a[200:203], a[144:147], v[240:243]
v_mfma_f32_16x16x32_bf16 a[240:243], a[164:167], a[144:147], a[240:243]
ds_read_b128 a[144:147], v2 offset:4096
v_mfma_f32_16x16x32_bf16 a[240:243], a[196:199], a[112:115], a[240:243]
ds_read_b128 a[112:115], v1 offset:4096
v_mfma_f32_16x16x32_bf16 a[244:247], a[196:199], a[116:119], a[244:247]
v_mfma_f32_16x16x32_bf16 a[244:247], a[164:167], a[148:151], a[244:247]
v_mfma_f32_16x16x32_bf16 v[244:247], a[200:203], a[148:151], v[244:247]
ds_read_b128 a[148:151], v2 offset:5120
v_mfma_f32_16x16x32_bf16 v[244:247], a[168:171], a[116:119], v[244:247]
ds_read_b128 a[116:119], v1 offset:5120
v_mfma_f32_16x16x32_bf16 v[248:251], a[168:171], a[120:123], v[248:251]
v_mfma_f32_16x16x32_bf16 v[248:251], a[200:203], a[152:155], v[248:251]
v_mfma_f32_16x16x32_bf16 a[248:251], a[164:167], a[152:155], a[248:251]
ds_read_b128 a[152:155], v2 offset:6144
v_mfma_f32_16x16x32_bf16 a[248:251], a[196:199], a[120:123], a[248:251]
ds_read_b128 a[120:123], v1 offset:6144
v_mfma_f32_16x16x32_bf16 a[252:255], a[196:199], a[124:127], a[252:255]
buffer_load_dwordx4 a[196:199], v0, s[20:23], s30 offen offset:0 sc1
v_mfma_f32_16x16x32_bf16 a[252:255], a[164:167], a[156:159], a[252:255]
buffer_load_dwordx4 a[164:167], v0, s[20:23], s30 offen offset:1024 sc1
v_mfma_f32_16x16x32_bf16 v[252:255], a[200:203], a[156:159], v[252:255]
buffer_load_dwordx4 a[200:203], v0, s[20:23], s30 offen offset:2048 sc1
ds_read_b128 a[156:159], v2 offset:7168
v_mfma_f32_16x16x32_bf16 v[252:255], a[168:171], a[124:127], v[252:255]
buffer_load_dwordx4 a[168:171], v0, s[20:23], s30 offen offset:3072 sc1
s_add_u32 s30, s30, 0x1000
ds_read_b128 a[124:127], v1 offset:7168
L_q2:
s_waitcnt vmcnt(25) lgkmcnt(14)
v_mfma_f32_16x16x32_bf16 v[32:35], a[212:215], a[96:99], v[32:35]
v_mfma_f32_16x16x32_bf16 v[32:35], a[180:183], a[128:131], v[32:35]
s_add_u32 m0, s31, 65408
v_mfma_f32_16x16x32_bf16 v[64:67], a[172:175], a[128:131], v[64:67]
buffer_load_dwordx4 v5, s[12:15], s48 offen offset:128 lds
v_mfma_f32_16x16x32_bf16 v[64:67], a[204:207], a[96:99], v[64:67]
s_waitcnt lgkmcnt(12)
v_mfma_f32_16x16x32_bf16 v[68:71], a[204:207], a[100:103], v[68:71]
v_mfma_f32_16x16x32_bf16 v[68:71], a[172:175], a[132:135], v[68:71]
v_mfma_f32_16x16x32_bf16 v[36:39], a[180:183], a[132:135], v[36:39]
v_mfma_f32_16x16x32_bf16 v[36:39], a[212:215], a[100:103], v[36:39]
s_waitcnt lgkmcnt(10)
v_mfma_f32_16x16x32_bf16 v[40:43], a[212:215], a[104:107], v[40:43]
v_mfma_f32_16x16x32_bf16 v[40:43], a[180:183], a[136:139], v[40:43]
v_mfma_f32_16x16x32_bf16 v[72:75], a[172:175], a[136:139], v[72:75]
v_mfma_f32_16x16x32_bf16 v[72:75], a[204:207], a[104:107], v[72:75]
s_waitcnt lgkmcnt(8)
v_mfma_f32_16x16x32_bf16 v[76:79], a[204:207], a[108:111], v[76:79]
v_mfma_f32_16x16x32_bf16 v[76:79], a[172:175], a[140:143], v[76:79]
v_mfma_f32_16x16x32_bf16 v[44:47], a[180:183], a[140:143], v[44:47]
v_mfma_f32_16x16x32_bf16 v[44:47], a[212:215], a[108:111], v[44:47]
s_waitcnt lgkmcnt(6)
v_mfma_f32_16x16x32_bf16 v[48:51], a[212:215], a[112:115], v[48:51]
v_mfma_f32_16x16x32_bf16 v[48:51], a[180:183], a[144:147], v[48:51]
v_mfma_f32_16x16x32_bf16 v[80:83], a[172:175], a[144:147], v[80:83]
v_mfma_f32_16x16x32_bf16 v[80:83], a[204:207], a[112:115], v[80:83]
s_waitcnt lgkmcnt(4)
v_mfma_f32_16x16x32_bf16 v[84:87], a[204:207], a[116:119], v[84:87]
v_mfma_f32_16x16x32_bf16 v[84:87], a[172:175], a[148:151], v[84:87]
v_mfma_f32_16x16x32_bf16 v[52:55], a[180:183], a[148:151], v[52:55]
v_mfma_f32_16x16x32_bf16 v[52:55], a[212:215], a[116:119], v[52:55]
s_waitcnt lgkmcnt(2)
v_mfma_f32_16x16x32_bf16 v[56:59], a[212:215], a[120:123], v[56:59]
v_mfma_f32_16x16x32_bf16 v[56:59], a[180:183], a[152:155], v[56:59]
v_mfma_f32_16x16x32_bf16 v[88:91], a[172:175], a[152:155], v[88:91]
v_mfma_f32_16x16x32_bf16 v[88:91], a[204:207], a[120:123], v[88:91]
s_waitcnt lgkmcnt(0)
v_mfma_f32_16x16x32_bf16 v[92:95], a[204:207], a[124:127], v[92:95]
buffer_load_dwordx4 a[204:207], v0, s[20:23], s30 offen offset:0 sc1
v_mfma_f32_16x16x32_bf16 v[92:95], a[172:175], a[156:159], v[92:95]
buffer_load_dwordx4 a[172:175], v0, s[20:23], s30 offen offset:1024 sc1
v_mfma_f32_16x16x32_bf16 v[60:63], a[180:183], a[156:159], v[60:63]
buffer_load_dwordx4 a[180:183], v0, s[20:23], s30 offen offset:2048 sc1
v_mfma_f32_16x16x32_bf16 v[60:63], a[212:215], a[124:127], v[60:63]
buffer_load_dwordx4 a[212:215], v0, s[20:23], s30 offen offset:3072 sc1
s_add_u32 s30, s30, 0x1000
s_waitcnt vmcnt(25)
v_mfma_f32_16x16x32_bf16 v[96:99], a[220:223], a[96:99], v[96:99]
s_add_u32 s96, s92, L_q4-L_pc
s_addc_u32 s97, s93, 0
s_load_dword s98, s[96:97], 0
v_mfma_f32_16x16x32_bf16 v[96:99], a[188:191], a[128:131], v[96:99]
s_add_u32 m0, s31, 66432
v_mfma_f32_16x16x32_bf16 v[128:131], a[176:179], a[128:131], v[128:131]
buffer_load_dwordx4 v5, s[12:15], s49 offen offset:128 lds
v_mfma_f32_16x16x32_bf16 v[128:131], a[208:211], a[96:99], v[128:131]
v_mfma_f32_16x16x32_bf16 v[132:135], a[208:211], a[100:103], v[132:135]
v_mfma_f32_16x16x32_bf16 v[132:135], a[176:179], a[132:135], v[132:135]
v_mfma_f32_16x16x32_bf16 v[100:103], a[188:191], a[132:135], v[100:103]
v_mfma_f32_16x16x32_bf16 v[100:103], a[220:223], a[100:103], v[100:103]
v_mfma_f32_16x16x32_bf16 v[104:107], a[220:223], a[104:107], v[104:107]
v_mfma_f32_16x16x32_bf16 v[104:107], a[188:191], a[136:139], v[104:107]
v_mfma_f32_16x16x32_bf16 v[136:139], a[176:179], a[136:139], v[136:139]
v_mfma_f32_16x16x32_bf16 v[136:139], a[208:211], a[104:107], v[136:139]
v_mfma_f32_16x16x32_bf16 v[140:143], a[208:211], a[108:111], v[140:143]
v_mfma_f32_16x16x32_bf16 v[140:143], a[176:179], a[140:143], v[140:143]
v_mfma_f32_16x16x32_bf16 v[108:111], a[188:191], a[140:143], v[108:111]
v_mfma_f32_16x16x32_bf16 v[108:111], a[220:223], a[108:111], v[108:111]
v_mfma_f32_16x16x32_bf16 v[112:115], a[220:223], a[112:115], v[112:115]
v_mfma_f32_16x16x32_bf16 v[112:115], a[188:191], a[144:147], v[112:115]
v_mfma_f32_16x16x32_bf16 v[144:147], a[176:179], a[144:147], v[144:147]
v_mfma_f32_16x16x32_bf16 v[144:147], a[208:211], a[112:115], v[144:147]
v_mfma_f32_16x16x32_bf16 v[148:151], a[208:211], a[116:119], v[148:151]
v_mfma_f32_16x16x32_bf16 v[148:151], a[176:179], a[148:151], v[148:151]
v_mfma_f32_16x16x32_bf16 v[116:119], a[188:191], a[148:151], v[116:119]
v_mfma_f32_16x16x32_bf16 v[116:119], a[220:223], a[116:119], v[116:119]
v_mfma_f32_16x16x32_bf16 v[120:123], a[220:223], a[120:123], v[120:123]
v_mfma_f32_16x16x32_bf16 v[120:123], a[188:191], a[152:155], v[120:123]
v_mfma_f32_16x16x32_bf16 v[152:155], a[176:179], a[152:155], v[152:155]
v_mfma_f32_16x16x32_bf16 v[152:155], a[208:211], a[120:123], v[152:155]
v_mfma_f32_16x16x32_bf16 v[156:159], a[208:211], a[124:127], v[156:159]
buffer_load_dwordx4 a[208:211], v0, s[20:23], s30 offen offset:0 sc1
v_mfma_f32_16x16x32_bf16 v[156:159], a[176:179], a[156:159], v[156:159]
buffer_load_dwordx4 a[176:179], v0, s[20:23], s30 offen offset:1024 sc1
v_mfma_f32_16x16x32_bf16 v[124:127], a[188:191], a[156:159], v[124:127]
buffer_load_dwordx4 a[188:191], v0, s[20:23], s30 offen offset:2048 sc1
v_mfma_f32_16x16x32_bf16 v[124:127], a[220:223], a[124:127], v[124:127]
buffer_load_dwordx4 a[220:223], v0, s[20:23], s30 offen offset:3072 sc1
s_add_u32 s30, s30, 0x1000
s_waitcnt vmcnt(24)
v_mfma_f32_16x16x32_bf16 v[160:163], a[68:71], a[96:99], v[160:163]
v_mfma_f32_16x16x32_bf16 v[160:163], a[64:67], a[128:131], v[160:163]
s_add_u32 m0, s31, 73344
v_mfma_f32_16x16x32_bf16 v[192:195], a[184:187], a[128:131], v[192:195]
buffer_load_dwordx4 v5, s[12:15], s48 offen offset:384 lds
v_mfma_f32_16x16x32_bf16 v[192:195], a[216:219], a[96:99], v[192:195]
v_mfma_f32_16x16x32_bf16 v[196:199], a[216:219], a[100:103], v[196:199]
buffer_load_dwordx4 v[12:15], v9, s[24:27], s37 offen offset:0
v_mfma_f32_16x16x32_bf16 v[196:199], a[184:187], a[132:135], v[196:199]
v_mfma_f32_16x16x32_bf16 v[164:167], a[64:67], a[132:135], v[164:167]
v_mfma_f32_16x16x32_bf16 v[164:167], a[68:71], a[100:103], v[164:167]
v_mfma_f32_16x16x32_bf16 v[168:171], a[68:71], a[104:107], v[168:171]
buffer_load_dwordx4 v[16:19], v9, s[24:27], s37 offen offset:64
v_mfma_f32_16x16x32_bf16 v[168:171], a[64:67], a[136:139], v[168:171]
v_mfma_f32_16x16x32_bf16 v[200:203], a[184:187], a[136:139], v[200:203]
v_mfma_f32_16x16x32_bf16 v[200:203], a[216:219], a[104:107], v[200:203]
v_mfma_f32_16x16x32_bf16 v[204:207], a[216:219], a[108:111], v[204:207]
v_mfma_f32_16x16x32_bf16 v[204:207], a[184:187], a[140:143], v[204:207]
v_mfma_f32_16x16x32_bf16 v[172:175], a[64:67], a[140:143], v[172:175]
v_mfma_f32_16x16x32_bf16 v[172:175], a[68:71], a[108:111], v[172:175]
v_mfma_f32_16x16x32_bf16 v[176:179], a[68:71], a[112:115], v[176:179]
v_mfma_f32_16x16x32_bf16 v[176:179], a[64:67], a[144:147], v[176:179]
v_mfma_f32_16x16x32_bf16 v[208:211], a[184:187], a[144:147], v[208:211]
v_mfma_f32_16x16x32_bf16 v[208:211], a[216:219], a[112:115], v[208:211]
v_mfma_f32_16x16x32_bf16 v[212:215], a[216:219], a[116:119], v[212:215]
v_mfma_f32_16x16x32_bf16 v[212:215], a[184:187], a[148:151], v[212:215]
v_mfma_f32_16x16x32_bf16 v[180:183], a[64:67], a[148:151], v[180:183]
v_mfma_f32_16x16x32_bf16 v[180:183], a[68:71], a[116:119], v[180:183]
v_mfma_f32_16x16x32_bf16 v[184:187], a[68:71], a[120:123], v[184:187]
v_mfma_f32_16x16x32_bf16 v[184:187], a[64:67], a[152:155], v[184:187]
v_mfma_f32_16x16x32_bf16 v[216:219], a[184:187], a[152:155], v[216:219]
v_mfma_f32_16x16x32_bf16 v[216:219], a[216:219], a[120:123], v[216:219]
v_mfma_f32_16x16x32_bf16 v[220:223], a[216:219], a[124:127], v[220:223]
buffer_load_dwordx4 a[216:219], v0, s[20:23], s30 offen offset:0 sc1
v_mfma_f32_16x16x32_bf16 v[220:223], a[184:187], a[156:159], v[220:223]
buffer_load_dwordx4 a[184:187], v0, s[20:23], s30 offen offset:1024 sc1
v_mfma_f32_16x16x32_bf16 v[188:191], a[64:67], a[156:159], v[188:191]
buffer_load_dwordx4 a[64:67], v0, s[20:23], s30 offen offset:2048 sc1
v_mfma_f32_16x16x32_bf16 v[188:191], a[68:71], a[124:127], v[188:191]
buffer_load_dwordx4 a[68:71], v0, s[20:23], s30 offen offset:3072 sc1
s_add_u32 s30, s30, 0x1000
s_waitcnt vmcnt(25)
v_mfma_f32_16x16x32_bf16 v[224:227], a[76:79], a[96:99], v[224:227]
v_mfma_f32_16x16x32_bf16 v[224:227], a[72:75], a[128:131], v[224:227]
s_add_u32 m0, s31, 74368
v_mfma_f32_16x16x32_bf16 a[224:227], a[80:83], a[128:131], a[224:227]
v_xor_b32 v4, 0x6000, v0
ds_read_b128 a[128:131], v4 offset:0
buffer_load_dwordx4 v5, s[12:15], s49 offen offset:384 lds
v_mfma_f32_16x16x32_bf16 a[224:227], a[84:87], a[96:99], a[224:227]
v_xor_b32 v3, 0x4000, v0
ds_read_b128 a[96:99], v3 offset:0
v_mfma_f32_16x16x32_bf16 a[228:231], a[84:87], a[100:103], a[228:231]
v_mfma_f32_16x16x32_bf16 a[228:231], a[80:83], a[132:135], a[228:231]
v_mfma_f32_16x16x32_bf16 v[228:231], a[72:75], a[132:135], v[228:231]
ds_read_b128 a[132:135], v4 offset:1024
v_mfma_f32_16x16x32_bf16 v[228:231], a[76:79], a[100:103], v[228:231]
ds_read_b128 a[100:103], v3 offset:1024
v_mfma_f32_16x16x32_bf16 v[232:235], a[76:79], a[104:107], v[232:235]
v_mfma_f32_16x16x32_bf16 v[232:235], a[72:75], a[136:139], v[232:235]
v_mfma_f32_16x16x32_bf16 a[232:235], a[80:83], a[136:139], a[232:235]
ds_read_b128 a[136:139], v4 offset:2048
v_mfma_f32_16x16x32_bf16 a[232:235], a[84:87], a[104:107], a[232:235]
ds_read_b128 a[104:107], v3 offset:2048
v_mfma_f32_16x16x32_bf16 a[236:239], a[84:87], a[108:111], a[236:239]
v_mfma_f32_16x16x32_bf16 a[236:239], a[80:83], a[140:143], a[236:239]
v_mfma_f32_16x16x32_bf16 v[236:239], a[72:75], a[140:143], v[236:239]
ds_read_b128 a[140:143], v4 offset:3072
v_mfma_f32_16x16x32_bf16 v[236:239], a[76:79], a[108:111], v[236:239]
ds_read_b128 a[108:111], v3 offset:3072
v_mfma_f32_16x16x32_bf16 v[240:243], a[76:79], a[112:115], v[240:243]
v_mfma_f32_16x16x32_bf16 v[240:243], a[72:75], a[144:147], v[240:243]
v_mfma_f32_16x16x32_bf16 a[240:243], a[80:83], a[144:147], a[240:243]
ds_read_b128 a[144:147], v4 offset:4096
v_mfma_f32_16x16x32_bf16 a[240:243], a[84:87], a[112:115], a[240:243]
ds_read_b128 a[112:115], v3 offset:4096
v_mfma_f32_16x16x32_bf16 a[244:247], a[84:87], a[116:119], a[244:247]
v_mfma_f32_16x16x32_bf16 a[244:247], a[80:83], a[148:151], a[244:247]
v_mfma_f32_16x16x32_bf16 v[244:247], a[72:75], a[148:151], v[244:247]
ds_read_b128 a[148:151], v4 offset:5120
v_mfma_f32_16x16x32_bf16 v[244:247], a[76:79], a[116:119], v[244:247]
ds_read_b128 a[116:119], v3 offset:5120
v_mfma_f32_16x16x32_bf16 v[248:251], a[76:79], a[120:123], v[248:251]
v_mfma_f32_16x16x32_bf16 v[248:251], a[72:75], a[152:155], v[248:251]
v_mfma_f32_16x16x32_bf16 a[248:251], a[80:83], a[152:155], a[248:251]
ds_read_b128 a[152:155], v4 offset:6144
v_mfma_f32_16x16x32_bf16 a[248:251], a[84:87], a[120:123], a[248:251]
ds_read_b128 a[120:123], v3 offset:6144
v_mfma_f32_16x16x32_bf16 a[252:255], a[84:87], a[124:127], a[252:255]
buffer_load_dwordx4 a[84:87], v0, s[20:23], s30 offen offset:0 sc1
v_mfma_f32_16x16x32_bf16 a[252:255], a[80:83], a[156:159], a[252:255]
buffer_load_dwordx4 a[80:83], v0, s[20:23], s30 offen offset:1024 sc1
v_mfma_f32_16x16x32_bf16 v[252:255], a[72:75], a[156:159], v[252:255]
buffer_load_dwordx4 a[72:75], v0, s[20:23], s30 offen offset:2048 sc1
ds_read_b128 a[156:159], v4 offset:7168
v_mfma_f32_16x16x32_bf16 v[252:255], a[76:79], a[124:127], v[252:255]
buffer_load_dwordx4 a[76:79], v0, s[20:23], s30 offen offset:3072 sc1
s_add_u32 s30, s30, 0x1000
ds_read_b128 a[124:127], v3 offset:7168
s_waitcnt vmcnt(26) lgkmcnt(14)
v_mfma_f32_16x16x32_bf16 v[32:35], a[92:95], a[96:99], v[32:35]
v_mfma_f32_16x16x32_bf16 v[32:35], a[88:91], a[128:131], v[32:35]
s_add_u32 m0, s31, 81280
v_mfma_f32_16x16x32_bf16 v[64:67], a[160:163], a[128:131], v[64:67]
buffer_load_dwordx4 v5, s[12:15], s48 offen offset:640 lds
v_mfma_f32_16x16x32_bf16 v[64:67], a[192:195], a[96:99], v[64:67]
s_waitcnt lgkmcnt(12)
v_mfma_f32_16x16x32_bf16 v[68:71], a[192:195], a[100:103], v[68:71]
v_mfma_f32_16x16x32_bf16 v[68:71], a[160:163], a[132:135], v[68:71]
v_mfma_f32_16x16x32_bf16 v[36:39], a[88:91], a[132:135], v[36:39]
v_mfma_f32_16x16x32_bf16 v[36:39], a[92:95], a[100:103], v[36:39]
s_waitcnt lgkmcnt(10)
v_mfma_f32_16x16x32_bf16 v[40:43], a[92:95], a[104:107], v[40:43]
v_mfma_f32_16x16x32_bf16 v[40:43], a[88:91], a[136:139], v[40:43]
v_mfma_f32_16x16x32_bf16 v[72:75], a[160:163], a[136:139], v[72:75]
v_mfma_f32_16x16x32_bf16 v[72:75], a[192:195], a[104:107], v[72:75]
s_waitcnt lgkmcnt(8)
v_mfma_f32_16x16x32_bf16 v[76:79], a[192:195], a[108:111], v[76:79]
v_mfma_f32_16x16x32_bf16 v[76:79], a[160:163], a[140:143], v[76:79]
v_mfma_f32_16x16x32_bf16 v[44:47], a[88:91], a[140:143], v[44:47]
v_mfma_f32_16x16x32_bf16 v[44:47], a[92:95], a[108:111], v[44:47]
s_waitcnt lgkmcnt(6)
v_mfma_f32_16x16x32_bf16 v[48:51], a[92:95], a[112:115], v[48:51]
v_mfma_f32_16x16x32_bf16 v[48:51], a[88:91], a[144:147], v[48:51]
v_mfma_f32_16x16x32_bf16 v[80:83], a[160:163], a[144:147], v[80:83]
v_mfma_f32_16x16x32_bf16 v[80:83], a[192:195], a[112:115], v[80:83]
s_waitcnt lgkmcnt(4)
v_mfma_f32_16x16x32_bf16 v[84:87], a[192:195], a[116:119], v[84:87]
v_mfma_f32_16x16x32_bf16 v[84:87], a[160:163], a[148:151], v[84:87]
v_mfma_f32_16x16x32_bf16 v[52:55], a[88:91], a[148:151], v[52:55]
v_mfma_f32_16x16x32_bf16 v[52:55], a[92:95], a[116:119], v[52:55]
s_waitcnt lgkmcnt(2)
v_mfma_f32_16x16x32_bf16 v[56:59], a[92:95], a[120:123], v[56:59]
v_mfma_f32_16x16x32_bf16 v[56:59], a[88:91], a[152:155], v[56:59]
v_mfma_f32_16x16x32_bf16 v[88:91], a[160:163], a[152:155], v[88:91]
v_mfma_f32_16x16x32_bf16 v[88:91], a[192:195], a[120:123], v[88:91]
s_waitcnt lgkmcnt(0)
v_mfma_f32_16x16x32_bf16 v[92:95], a[192:195], a[124:127], v[92:95]
buffer_load_dwordx4 a[192:195], v0, s[20:23], s30 offen offset:0 sc1
v_mfma_f32_16x16x32_bf16 v[92:95], a[160:163], a[156:159], v[92:95]
buffer_load_dwordx4 a[160:163], v0, s[20:23], s30 offen offset:1024 sc1
v_mfma_f32_16x16x32_bf16 v[60:63], a[88:91], a[156:159], v[60:63]
buffer_load_dwordx4 a[88:91], v0, s[20:23], s30 offen offset:2048 sc1
v_mfma_f32_16x16x32_bf16 v[60:63], a[92:95], a[124:127], v[60:63]
buffer_load_dwordx4 a[92:95], v0, s[20:23], s30 offen offset:3072 sc1
s_add_u32 s30, s30, 0x1000
s_waitcnt vmcnt(27)
v_mfma_f32_16x16x32_bf16 v[96:99], a[196:199], a[96:99], v[96:99]
v_mfma_f32_16x16x32_bf16 v[96:99], a[164:167], a[128:131], v[96:99]
s_add_u32 m0, s31, 82304
v_mfma_f32_16x16x32_bf16 v[128:131], a[168:171], a[128:131], v[128:131]
buffer_load_dwordx4 v5, s[12:15], s49 offen offset:640 lds
v_mfma_f32_16x16x32_bf16 v[128:131], a[200:203], a[96:99], v[128:131]
v_mfma_f32_16x16x32_bf16 v[132:135], a[200:203], a[100:103], v[132:135]
s_waitcnt vmcnt(16)
v_lshlrev_b32 v28, 16, v12
v_and_b32 v29, s33, v12
v_mfma_f32_16x16x32_bf16 v[132:135], a[168:171], a[132:135], v[132:135]
v_lshlrev_b32 v30, 16, v13
v_and_b32 v31, s33, v13
v_mfma_f32_16x16x32_bf16 v[100:103], a[164:167], a[132:135], v[100:103]
v_add_f32 v32, v32, v28
v_add_f32 v33, v33, v29
v_mfma_f32_16x16x32_bf16 v[100:103], a[196:199], a[100:103], v[100:103]
v_add_f32 v34, v34, v30
v_add_f32 v35, v35, v31
v_mfma_f32_16x16x32_bf16 v[104:107], a[196:199], a[104:107], v[104:107]
v_add_f32 v36, v36, v28
v_add_f32 v37, v37, v29
v_mfma_f32_16x16x32_bf16 v[104:107], a[164:167], a[136:139], v[104:107]
v_add_f32 v38, v38, v30
v_add_f32 v39, v39, v31
v_mfma_f32_16x16x32_bf16 v[136:139], a[168:171], a[136:139], v[136:139]
v_add_f32 v40, v40, v28
v_add_f32 v41, v41, v29
v_mfma_f32_16x16x32_bf16 v[136:139], a[200:203], a[104:107], v[136:139]
v_add_f32 v42, v42, v30
v_add_f32 v43, v43, v31
v_mfma_f32_16x16x32_bf16 v[140:143], a[200:203], a[108:111], v[140:143]
v_add_f32 v44, v44, v28
v_add_f32 v45, v45, v29
v_mfma_f32_16x16x32_bf16 v[140:143], a[168:171], a[140:143], v[140:143]
v_add_f32 v46, v46, v30
v_add_f32 v47, v47, v31
v_mfma_f32_16x16x32_bf16 v[108:111], a[164:167], a[140:143], v[108:111]
v_add_f32 v48, v48, v28
v_add_f32 v49, v49, v29
v_mfma_f32_16x16x32_bf16 v[108:111], a[196:199], a[108:111], v[108:111]
v_add_f32 v50, v50, v30
v_add_f32 v51, v51, v31
v_mfma_f32_16x16x32_bf16 v[112:115], a[196:199], a[112:115], v[112:115]
v_add_f32 v52, v52, v28
v_add_f32 v53, v53, v29
v_mfma_f32_16x16x32_bf16 v[112:115], a[164:167], a[144:147], v[112:115]
v_add_f32 v54, v54, v30
v_add_f32 v55, v55, v31
v_mfma_f32_16x16x32_bf16 v[144:147], a[168:171], a[144:147], v[144:147]
v_add_f32 v56, v56, v28
v_add_f32 v57, v57, v29
v_mfma_f32_16x16x32_bf16 v[144:147], a[200:203], a[112:115], v[144:147]
v_add_f32 v58, v58, v30
v_add_f32 v59, v59, v31
v_mfma_f32_16x16x32_bf16 v[148:151], a[200:203], a[116:119], v[148:151]
v_add_f32 v60, v60, v28
v_add_f32 v61, v61, v29
v_mfma_f32_16x16x32_bf16 v[148:151], a[168:171], a[148:151], v[148:151]
v_add_f32 v62, v62, v30
v_add_f32 v63, v63, v31
v_mfma_f32_16x16x32_bf16 v[116:119], a[164:167], a[148:151], v[116:119]
v_lshlrev_b32 v28, 16, v14
v_and_b32 v29, s33, v14
v_mfma_f32_16x16x32_bf16 v[116:119], a[196:199], a[116:119], v[116:119]
v_lshlrev_b32 v30, 16, v15
v_and_b32 v31, s33, v15
v_mfma_f32_16x16x32_bf16 v[120:123], a[196:199], a[120:123], v[120:123]
v_add_f32 v64, v64, v28
v_add_f32 v65, v65, v29
v_mfma_f32_16x16x32_bf16 v[120:123], a[164:167], a[152:155], v[120:123]
v_add_f32 v66, v66, v30
v_add_f32 v67, v67, v31
v_mfma_f32_16x16x32_bf16 v[152:155], a[168:171], a[152:155], v[152:155]
v_add_f32 v68, v68, v28
v_add_f32 v69, v69, v29
v_mfma_f32_16x16x32_bf16 v[152:155], a[200:203], a[120:123], v[152:155]
v_add_f32 v70, v70, v30
v_add_f32 v71, v71, v31
v_mfma_f32_16x16x32_bf16 v[156:159], a[200:203], a[124:127], v[156:159]
buffer_load_dwordx4 a[200:203], v0, s[20:23], s30 offen offset:0 sc1
v_add_f32 v72, v72, v28
v_mfma_f32_16x16x32_bf16 v[156:159], a[168:171], a[156:159], v[156:159]
buffer_load_dwordx4 a[168:171], v0, s[20:23], s30 offen offset:1024 sc1
v_add_f32 v73, v73, v29
v_mfma_f32_16x16x32_bf16 v[124:127], a[164:167], a[156:159], v[124:127]
buffer_load_dwordx4 a[164:167], v0, s[20:23], s30 offen offset:2048 sc1
v_add_f32 v74, v74, v30
v_mfma_f32_16x16x32_bf16 v[124:127], a[196:199], a[124:127], v[124:127]
buffer_load_dwordx4 a[196:199], v0, s[20:23], s30 offen offset:3072 sc1
s_add_u32 s30, s30, 0x1000
v_mfma_f32_16x16x32_bf16 v[160:163], a[204:207], a[96:99], v[160:163]
v_add_f32 v75, v75, v31
v_add_f32 v76, v76, v28
v_mfma_f32_16x16x32_bf16 v[160:163], a[172:175], a[128:131], v[160:163]
v_add_f32 v77, v77, v29
v_add_f32 v78, v78, v30
s_add_u32 m0, s31, 89216
v_mfma_f32_16x16x32_bf16 v[192:195], a[212:215], a[128:131], v[192:195]
buffer_load_dwordx4 v5, s[12:15], s48 offen offset:896 lds
v_mfma_f32_16x16x32_bf16 v[192:195], a[180:183], a[96:99], v[192:195]
v_add_f32 v79, v79, v31
v_add_f32 v80, v80, v28
v_mfma_f32_16x16x32_bf16 v[196:199], a[180:183], a[100:103], v[196:199]
v_add_f32 v81, v81, v29
v_add_f32 v82, v82, v30
v_mfma_f32_16x16x32_bf16 v[196:199], a[212:215], a[132:135], v[196:199]
v_add_f32 v83, v83, v31
v_add_f32 v84, v84, v28
v_mfma_f32_16x16x32_bf16 v[164:167], a[172:175], a[132:135], v[164:167]
v_add_f32 v85, v85, v29
v_add_f32 v86, v86, v30
v_mfma_f32_16x16x32_bf16 v[164:167], a[204:207], a[100:103], v[164:167]
v_add_f32 v87, v87, v31
v_add_f32 v88, v88, v28
v_mfma_f32_16x16x32_bf16 v[168:171], a[204:207], a[104:107], v[168:171]
v_add_f32 v89, v89, v29
v_add_f32 v90, v90, v30
v_mfma_f32_16x16x32_bf16 v[168:171], a[172:175], a[136:139], v[168:171]
v_add_f32 v91, v91, v31
v_add_f32 v92, v92, v28
v_mfma_f32_16x16x32_bf16 v[200:203], a[212:215], a[136:139], v[200:203]
v_add_f32 v93, v93, v29
v_add_f32 v94, v94, v30
v_mfma_f32_16x16x32_bf16 v[200:203], a[180:183], a[104:107], v[200:203]
v_add_f32 v95, v95, v31
s_waitcnt vmcnt(20)
v_lshlrev_b32 v28, 16, v16
v_mfma_f32_16x16x32_bf16 v[204:207], a[180:183], a[108:111], v[204:207]
v_and_b32 v29, s33, v16
v_lshlrev_b32 v30, 16, v17
v_mfma_f32_16x16x32_bf16 v[204:207], a[212:215], a[140:143], v[204:207]
v_and_b32 v31, s33, v17
v_add_f32 v96, v96, v28
v_mfma_f32_16x16x32_bf16 v[172:175], a[172:175], a[140:143], v[172:175]
v_add_f32 v97, v97, v29
v_add_f32 v98, v98, v30
v_mfma_f32_16x16x32_bf16 v[172:175], a[204:207], a[108:111], v[172:175]
v_add_f32 v99, v99, v31
v_add_f32 v100, v100, v28
v_mfma_f32_16x16x32_bf16 v[176:179], a[204:207], a[112:115], v[176:179]
v_add_f32 v101, v101, v29
v_add_f32 v102, v102, v30
v_mfma_f32_16x16x32_bf16 v[176:179], a[172:175], a[144:147], v[176:179]
v_add_f32 v103, v103, v31
v_add_f32 v104, v104, v28
v_mfma_f32_16x16x32_bf16 v[208:211], a[212:215], a[144:147], v[208:211]
v_add_f32 v105, v105, v29
v_add_f32 v106, v106, v30
v_mfma_f32_16x16x32_bf16 v[208:211], a[180:183], a[112:115], v[208:211]
v_add_f32 v107, v107, v31
v_add_f32 v108, v108, v28
v_mfma_f32_16x16x32_bf16 v[212:215], a[180:183], a[116:119], v[212:215]
v_add_f32 v109, v109, v29
v_add_f32 v110, v110, v30
v_mfma_f32_16x16x32_bf16 v[212:215], a[212:215], a[148:151], v[212:215]
v_add_f32 v111, v111, v31
v_add_f32 v112, v112, v28
v_mfma_f32_16x16x32_bf16 v[180:183], a[172:175], a[148:151], v[180:183]
v_add_f32 v113, v113, v29
v_add_f32 v114, v114, v30
v_mfma_f32_16x16x32_bf16 v[180:183], a[204:207], a[116:119], v[180:183]
v_add_f32 v115, v115, v31
v_add_f32 v116, v116, v28
v_mfma_f32_16x16x32_bf16 v[184:187], a[204:207], a[120:123], v[184:187]
v_add_f32 v117, v117, v29
v_add_f32 v118, v118, v30
v_mfma_f32_16x16x32_bf16 v[184:187], a[172:175], a[152:155], v[184:187]
v_add_f32 v119, v119, v31
v_add_f32 v120, v120, v28
v_mfma_f32_16x16x32_bf16 v[216:219], a[212:215], a[152:155], v[216:219]
v_add_f32 v121, v121, v29
v_add_f32 v122, v122, v30
v_mfma_f32_16x16x32_bf16 v[216:219], a[180:183], a[120:123], v[216:219]
v_add_f32 v123, v123, v31
v_add_f32 v124, v124, v28
v_mfma_f32_16x16x32_bf16 v[220:223], a[180:183], a[124:127], v[220:223]
buffer_load_dwordx4 a[180:183], v0, s[20:23], s30 offen offset:0 sc1
v_add_f32 v125, v125, v29
v_mfma_f32_16x16x32_bf16 v[220:223], a[212:215], a[156:159], v[220:223]
buffer_load_dwordx4 a[212:215], v0, s[20:23], s30 offen offset:1024 sc1
v_add_f32 v126, v126, v30
v_mfma_f32_16x16x32_bf16 v[188:191], a[172:175], a[156:159], v[188:191]
buffer_load_dwordx4 a[172:175], v0, s[20:23], s30 offen offset:2048 sc1
v_add_f32 v127, v127, v31
v_mfma_f32_16x16x32_bf16 v[188:191], a[204:207], a[124:127], v[188:191]
buffer_load_dwordx4 a[204:207], v0, s[20:23], s30 offen offset:3072 sc1
s_add_u32 s30, s30, 0x1000
s_barrier
v_mfma_f32_16x16x32_bf16 v[224:227], a[208:211], a[96:99], v[224:227]
s_cmp_lg_u32 s28, 0
s_cbranch_scc1 L_nf1
s_add_u32 s34, s8, 1
v_mov_b32 v10, s34
v_mov_b32 v11, s9
s_mov_b64 exec, 1
buffer_store_dwordx2 v[10:11], off, s[20:23], s35 sc1
s_mov_b64 exec, -1
L_nf1:
v_mfma_f32_16x16x32_bf16 v[224:227], a[176:179], a[128:131], v[224:227]
v_lshlrev_b32 v28, 16, v18
v_and_b32 v29, s33, v18
s_add_u32 m0, s31, 90240
v_mfma_f32_16x16x32_bf16 a[224:227], a[220:223], a[128:131], a[224:227]
ds_read_b128 a[128:131], v2 offset:32768
buffer_load_dwordx4 v5, s[12:15], s49 offen offset:896 lds
v_mfma_f32_16x16x32_bf16 a[224:227], a[188:191], a[96:99], a[224:227]
ds_read_b128 a[96:99], v1 offset:32768
v_lshlrev_b32 v30, 16, v19
v_mfma_f32_16x16x32_bf16 a[228:231], a[188:191], a[100:103], a[228:231]
v_and_b32 v31, s33, v19
v_add_f32 v128, v128, v28
v_mfma_f32_16x16x32_bf16 a[228:231], a[220:223], a[132:135], a[228:231]
v_add_f32 v129, v129, v29
v_add_f32 v130, v130, v30
v_mfma_f32_16x16x32_bf16 v[228:231], a[176:179], a[132:135], v[228:231]
ds_read_b128 a[132:135], v2 offset:33792
v_add_f32 v131, v131, v31
v_mfma_f32_16x16x32_bf16 v[228:231], a[208:211], a[100:103], v[228:231]
ds_read_b128 a[100:103], v1 offset:33792
v_add_f32 v132, v132, v28
v_mfma_f32_16x16x32_bf16 v[232:235], a[208:211], a[104:107], v[232:235]
v_add_f32 v133, v133, v29
v_add_f32 v134, v134, v30
v_mfma_f32_16x16x32_bf16 v[232:235], a[176:179], a[136:139], v[232:235]
v_add_f32 v135, v135, v31
v_add_f32 v136, v136, v28
v_mfma_f32_16x16x32_bf16 a[232:235], a[220:223], a[136:139], a[232:235]
ds_read_b128 a[136:139], v2 offset:34816
v_add_f32 v137, v137, v29
v_mfma_f32_16x16x32_bf16 a[232:235], a[188:191], a[104:107], a[232:235]
ds_read_b128 a[104:107], v1 offset:34816
v_add_f32 v138, v138, v30
v_mfma_f32_16x16x32_bf16 a[236:239], a[188:191], a[108:111], a[236:239]
v_add_f32 v139, v139, v31
v_add_f32 v140, v140, v28
v_mfma_f32_16x16x32_bf16 a[236:239], a[220:223], a[140:143], a[236:239]
v_add_f32 v141, v141, v29
v_add_f32 v142, v142, v30
v_mfma_f32_16x16x32_bf16 v[236:239], a[176:179], a[140:143], v[236:239]
ds_read_b128 a[140:143], v2 offset:35840
v_add_f32 v143, v143, v31
v_mfma_f32_16x16x32_bf16 v[236:239], a[208:211], a[108:111], v[236:239]
ds_read_b128 a[108:111], v1 offset:35840
v_add_f32 v144, v144, v28
v_mfma_f32_16x16x32_bf16 v[240:243], a[208:211], a[112:115], v[240:243]
v_add_f32 v145, v145, v29
v_add_f32 v146, v146, v30
v_mfma_f32_16x16x32_bf16 v[240:243], a[176:179], a[144:147], v[240:243]
v_add_f32 v147, v147, v31
v_add_f32 v148, v148, v28
v_mfma_f32_16x16x32_bf16 a[240:243], a[220:223], a[144:147], a[240:243]
ds_read_b128 a[144:147], v2 offset:36864
v_add_f32 v149, v149, v29
v_mfma_f32_16x16x32_bf16 a[240:243], a[188:191], a[112:115], a[240:243]
ds_read_b128 a[112:115], v1 offset:36864
v_add_f32 v150, v150, v30
v_mfma_f32_16x16x32_bf16 a[244:247], a[188:191], a[116:119], a[244:247]
v_add_f32 v151, v151, v31
v_add_f32 v152, v152, v28
v_mfma_f32_16x16x32_bf16 a[244:247], a[220:223], a[148:151], a[244:247]
v_add_f32 v153, v153, v29
v_add_f32 v154, v154, v30
v_mfma_f32_16x16x32_bf16 v[244:247], a[176:179], a[148:151], v[244:247]
ds_read_b128 a[148:151], v2 offset:37888
v_add_f32 v155, v155, v31
v_mfma_f32_16x16x32_bf16 v[244:247], a[208:211], a[116:119], v[244:247]
ds_read_b128 a[116:119], v1 offset:37888
v_add_f32 v156, v156, v28
v_mfma_f32_16x16x32_bf16 v[248:251], a[208:211], a[120:123], v[248:251]
v_add_f32 v157, v157, v29
v_add_f32 v158, v158, v30
v_mfma_f32_16x16x32_bf16 v[248:251], a[176:179], a[152:155], v[248:251]
v_add_f32 v159, v159, v31
v_mfma_f32_16x16x32_bf16 a[248:251], a[220:223], a[152:155], a[248:251]
ds_read_b128 a[152:155], v2 offset:38912
v_mfma_f32_16x16x32_bf16 a[248:251], a[188:191], a[120:123], a[248:251]
ds_read_b128 a[120:123], v1 offset:38912
v_mfma_f32_16x16x32_bf16 a[252:255], a[188:191], a[124:127], a[252:255]
buffer_load_dwordx4 a[188:191], v0, s[20:23], s30 offen offset:0 sc1
v_mfma_f32_16x16x32_bf16 a[252:255], a[220:223], a[156:159], a[252:255]
buffer_load_dwordx4 a[220:223], v0, s[20:23], s30 offen offset:1024 sc1
v_mfma_f32_16x16x32_bf16 v[252:255], a[176:179], a[156:159], v[252:255]
buffer_load_dwordx4 a[176:179], v0, s[20:23], s30 offen offset:2048 sc1
ds_read_b128 a[156:159], v2 offset:39936
v_mfma_f32_16x16x32_bf16 v[252:255], a[208:211], a[124:127], v[252:255]
buffer_load_dwordx4 a[208:211], v0, s[20:23], s30 offen offset:3072 sc1
s_add_u32 s30, s30, 0x1000
ds_read_b128 a[124:127], v1 offset:39936
s_waitcnt vmcnt(25) lgkmcnt(14)
v_mfma_f32_16x16x32_bf16 v[32:35], a[216:219], a[96:99], v[32:35]
v_mfma_f32_16x16x32_bf16 v[32:35], a[184:187], a[128:131], v[32:35]
s_add_u32 m0, s31, 98112
v_mfma_f32_16x16x32_bf16 v[64:67], a[68:71], a[128:131], v[64:67]
buffer_load_dwordx4 v5, s[12:15], s48 offen offset:192 lds
v_mfma_f32_16x16x32_bf16 v[64:67], a[64:67], a[96:99], v[64:67]
s_waitcnt lgkmcnt(12)
v_mfma_f32_16x16x32_bf16 v[68:71], a[64:67], a[100:103], v[68:71]
v_mfma_f32_16x16x32_bf16 v[68:71], a[68:71], a[132:135], v[68:71]
v_mfma_f32_16x16x32_bf16 v[36:39], a[184:187], a[132:135], v[36:39]
v_mfma_f32_16x16x32_bf16 v[36:39], a[216:219], a[100:103], v[36:39]
s_waitcnt lgkmcnt(10)
v_mfma_f32_16x16x32_bf16 v[40:43], a[216:219], a[104:107], v[40:43]
v_mfma_f32_16x16x32_bf16 v[40:43], a[184:187], a[136:139], v[40:43]
v_mfma_f32_16x16x32_bf16 v[72:75], a[68:71], a[136:139], v[72:75]
v_mfma_f32_16x16x32_bf16 v[72:75], a[64:67], a[104:107], v[72:75]
s_waitcnt lgkmcnt(8)
v_mfma_f32_16x16x32_bf16 v[76:79], a[64:67], a[108:111], v[76:79]
v_mfma_f32_16x16x32_bf16 v[76:79], a[68:71], a[140:143], v[76:79]
v_mfma_f32_16x16x32_bf16 v[44:47], a[184:187], a[140:143], v[44:47]
v_mfma_f32_16x16x32_bf16 v[44:47], a[216:219], a[108:111], v[44:47]
s_waitcnt lgkmcnt(6)
v_mfma_f32_16x16x32_bf16 v[48:51], a[216:219], a[112:115], v[48:51]
v_mfma_f32_16x16x32_bf16 v[48:51], a[184:187], a[144:147], v[48:51]
v_mfma_f32_16x16x32_bf16 v[80:83], a[68:71], a[144:147], v[80:83]
v_mfma_f32_16x16x32_bf16 v[80:83], a[64:67], a[112:115], v[80:83]
s_waitcnt lgkmcnt(4)
v_mfma_f32_16x16x32_bf16 v[84:87], a[64:67], a[116:119], v[84:87]
v_mfma_f32_16x16x32_bf16 v[84:87], a[68:71], a[148:151], v[84:87]
v_mfma_f32_16x16x32_bf16 v[52:55], a[184:187], a[148:151], v[52:55]
v_mfma_f32_16x16x32_bf16 v[52:55], a[216:219], a[116:119], v[52:55]
s_waitcnt lgkmcnt(2)
v_mfma_f32_16x16x32_bf16 v[56:59], a[216:219], a[120:123], v[56:59]
v_mfma_f32_16x16x32_bf16 v[56:59], a[184:187], a[152:155], v[56:59]
v_mfma_f32_16x16x32_bf16 v[88:91], a[68:71], a[152:155], v[88:91]
v_mfma_f32_16x16x32_bf16 v[88:91], a[64:67], a[120:123], v[88:91]
s_waitcnt lgkmcnt(0)
v_mfma_f32_16x16x32_bf16 v[92:95], a[64:67], a[124:127], v[92:95]
buffer_load_dwordx4 a[64:67], v0, s[20:23], s30 offen offset:0 sc1
v_mfma_f32_16x16x32_bf16 v[92:95], a[68:71], a[156:159], v[92:95]
buffer_load_dwordx4 a[68:71], v0, s[20:23], s30 offen offset:1024 sc1
v_mfma_f32_16x16x32_bf16 v[60:63], a[184:187], a[156:159], v[60:63]
buffer_load_dwordx4 a[184:187], v0, s[20:23], s30 offen offset:2048 sc1
v_mfma_f32_16x16x32_bf16 v[60:63], a[216:219], a[124:127], v[60:63]
buffer_load_dwordx4 a[216:219], v0, s[20:23], s30 offen offset:3072 sc1
s_add_u32 s30, s30, 0x1000
s_waitcnt vmcnt(25)
v_mfma_f32_16x16x32_bf16 v[96:99], a[84:87], a[96:99], v[96:99]
v_mfma_f32_16x16x32_bf16 v[96:99], a[80:83], a[128:131], v[96:99]
s_add_u32 m0, s31, 99136
v_mfma_f32_16x16x32_bf16 v[128:131], a[76:79], a[128:131], v[128:131]
buffer_load_dwordx4 v5, s[12:15], s49 offen offset:192 lds
v_mfma_f32_16x16x32_bf16 v[128:131], a[72:75], a[96:99], v[128:131]
v_mfma_f32_16x16x32_bf16 v[132:135], a[72:75], a[100:103], v[132:135]
v_mfma_f32_16x16x32_bf16 v[132:135], a[76:79], a[132:135], v[132:135]
v_mfma_f32_16x16x32_bf16 v[100:103], a[80:83], a[132:135], v[100:103]
v_mfma_f32_16x16x32_bf16 v[100:103], a[84:87], a[100:103], v[100:103]
v_mfma_f32_16x16x32_bf16 v[104:107], a[84:87], a[104:107], v[104:107]
v_mfma_f32_16x16x32_bf16 v[104:107], a[80:83], a[136:139], v[104:107]
v_mfma_f32_16x16x32_bf16 v[136:139], a[76:79], a[136:139], v[136:139]
v_mfma_f32_16x16x32_bf16 v[136:139], a[72:75], a[104:107], v[136:139]
v_mfma_f32_16x16x32_bf16 v[140:143], a[72:75], a[108:111], v[140:143]
v_mfma_f32_16x16x32_bf16 v[140:143], a[76:79], a[140:143], v[140:143]
v_mfma_f32_16x16x32_bf16 v[108:111], a[80:83], a[140:143], v[108:111]
v_mfma_f32_16x16x32_bf16 v[108:111], a[84:87], a[108:111], v[108:111]
v_mfma_f32_16x16x32_bf16 v[112:115], a[84:87], a[112:115], v[112:115]
v_mfma_f32_16x16x32_bf16 v[112:115], a[80:83], a[144:147], v[112:115]
v_mfma_f32_16x16x32_bf16 v[144:147], a[76:79], a[144:147], v[144:147]
v_mfma_f32_16x16x32_bf16 v[144:147], a[72:75], a[112:115], v[144:147]
v_mfma_f32_16x16x32_bf16 v[148:151], a[72:75], a[116:119], v[148:151]
v_mfma_f32_16x16x32_bf16 v[148:151], a[76:79], a[148:151], v[148:151]
v_mfma_f32_16x16x32_bf16 v[116:119], a[80:83], a[148:151], v[116:119]
v_mfma_f32_16x16x32_bf16 v[116:119], a[84:87], a[116:119], v[116:119]
v_mfma_f32_16x16x32_bf16 v[120:123], a[84:87], a[120:123], v[120:123]
v_mfma_f32_16x16x32_bf16 v[120:123], a[80:83], a[152:155], v[120:123]
v_mfma_f32_16x16x32_bf16 v[152:155], a[76:79], a[152:155], v[152:155]
v_mfma_f32_16x16x32_bf16 v[152:155], a[72:75], a[120:123], v[152:155]
v_mfma_f32_16x16x32_bf16 v[156:159], a[72:75], a[124:127], v[156:159]
v_mfma_f32_16x16x32_bf16 v[156:159], a[76:79], a[156:159], v[156:159]
v_mfma_f32_16x16x32_bf16 v[124:127], a[80:83], a[156:159], v[124:127]
v_mfma_f32_16x16x32_bf16 v[124:127], a[84:87], a[124:127], v[124:127]
s_waitcnt vmcnt(21)
v_mfma_f32_16x16x32_bf16 v[160:163], a[192:195], a[96:99], v[160:163]
v_mfma_f32_16x16x32_bf16 v[160:163], a[160:163], a[128:131], v[160:163]
s_add_u32 m0, s31, 106048
v_mfma_f32_16x16x32_bf16 v[192:195], a[92:95], a[128:131], v[192:195]
buffer_load_dwordx4 v5, s[12:15], s48 offen offset:448 lds
v_mfma_f32_16x16x32_bf16 v[192:195], a[88:91], a[96:99], v[192:195]
v_mfma_f32_16x16x32_bf16 v[196:199], a[88:91], a[100:103], v[196:199]
v_mfma_f32_16x16x32_bf16 v[196:199], a[92:95], a[132:135], v[196:199]
v_mfma_f32_16x16x32_bf16 v[164:167], a[160:163], a[132:135], v[164:167]
v_mfma_f32_16x16x32_bf16 v[164:167], a[192:195], a[100:103], v[164:167]
v_mfma_f32_16x16x32_bf16 v[168:171], a[192:195], a[104:107], v[168:171]
v_mfma_f32_16x16x32_bf16 v[168:171], a[160:163], a[136:139], v[168:171]
v_mfma_f32_16x16x32_bf16 v[200:203], a[92:95], a[136:139], v[200:203]
v_mfma_f32_16x16x32_bf16 v[200:203], a[88:91], a[104:107], v[200:203]
v_mfma_f32_16x16x32_bf16 v[204:207], a[88:91], a[108:111], v[204:207]
v_mfma_f32_16x16x32_bf16 v[204:207], a[92:95], a[140:143], v[204:207]
v_mfma_f32_16x16x32_bf16 v[172:175], a[160:163], a[140:143], v[172:175]
v_mfma_f32_16x16x32_bf16 v[172:175], a[192:195], a[108:111], v[172:175]
v_mfma_f32_16x16x32_bf16 v[176:179], a[192:195], a[112:115], v[176:179]
v_mfma_f32_16x16x32_bf16 v[176:179], a[160:163], a[144:147], v[176:179]
v_mfma_f32_16x16x32_bf16 v[208:211], a[92:95], a[144:147], v[208:211]
v_mfma_f32_16x16x32_bf16 v[208:211], a[88:91], a[112:115], v[208:211]
v_mfma_f32_16x16x32_bf16 v[212:215], a[88:91], a[116:119], v[212:215]
v_mfma_f32_16x16x32_bf16 v[212:215], a[92:95], a[148:151], v[212:215]
v_mfma_f32_16x16x32_bf16 v[180:183], a[160:163], a[148:151], v[180:183]
v_mfma_f32_16x16x32_bf16 v[180:183], a[192:195], a[116:119], v[180:183]
v_mfma_f32_16x16x32_bf16 v[184:187], a[192:195], a[120:123], v[184:187]
v_mfma_f32_16x16x32_bf16 v[184:187], a[160:163], a[152:155], v[184:187]
v_mfma_f32_16x16x32_bf16 v[216:219], a[92:95], a[152:155], v[216:219]
v_mfma_f32_16x16x32_bf16 v[216:219], a[88:91], a[120:123], v[216:219]
v_mfma_f32_16x16x32_bf16 v[220:223], a[88:91], a[124:127], v[220:223]
v_mfma_f32_16x16x32_bf16 v[220:223], a[92:95], a[156:159], v[220:223]
v_mfma_f32_16x16x32_bf16 v[188:191], a[160:163], a[156:159], v[188:191]
buffer_load_dwordx4 a[160:163], v0, s[20:23], s30 offen offset:0 sc1
v_mfma_f32_16x16x32_bf16 v[188:191], a[192:195], a[124:127], v[188:191]
buffer_load_dwordx4 a[192:195], v0, s[20:23], s30 offen offset:1024 sc1
s_waitcnt vmcnt(19)
v_mfma_f32_16x16x32_bf16 v[224:227], a[200:203], a[96:99], v[224:227]
v_mfma_f32_16x16x32_bf16 v[224:227], a[168:171], a[128:131], v[224:227]
s_add_u32 m0, s31, 107072
v_mfma_f32_16x16x32_bf16 a[224:227], a[196:199], a[128:131], a[224:227]
ds_read_b128 a[128:131], v4 offset:32768
buffer_load_dwordx4 v5, s[12:15], s49 offen offset:448 lds
v_mfma_f32_16x16x32_bf16 a[224:227], a[164:167], a[96:99], a[224:227]
ds_read_b128 a[96:99], v3 offset:32768
v_mfma_f32_16x16x32_bf16 a[228:231], a[164:167], a[100:103], a[228:231]
v_mfma_f32_16x16x32_bf16 a[228:231], a[196:199], a[132:135], a[228:231]
v_mfma_f32_16x16x32_bf16 v[228:231], a[168:171], a[132:135], v[228:231]
ds_read_b128 a[132:135], v4 offset:33792
v_mfma_f32_16x16x32_bf16 v[228:231], a[200:203], a[100:103], v[228:231]
ds_read_b128 a[100:103], v3 offset:33792
v_mfma_f32_16x16x32_bf16 v[232:235], a[200:203], a[104:107], v[232:235]
v_mfma_f32_16x16x32_bf16 v[232:235], a[168:171], a[136:139], v[232:235]
v_mfma_f32_16x16x32_bf16 a[232:235], a[196:199], a[136:139], a[232:235]
ds_read_b128 a[136:139], v4 offset:34816
v_mfma_f32_16x16x32_bf16 a[232:235], a[164:167], a[104:107], a[232:235]
ds_read_b128 a[104:107], v3 offset:34816
v_mfma_f32_16x16x32_bf16 a[236:239], a[164:167], a[108:111], a[236:239]
v_mfma_f32_16x16x32_bf16 a[236:239], a[196:199], a[140:143], a[236:239]
v_mfma_f32_16x16x32_bf16 v[236:239], a[168:171], a[140:143], v[236:239]
ds_read_b128 a[140:143], v4 offset:35840
v_mfma_f32_16x16x32_bf16 v[236:239], a[200:203], a[108:111], v[236:239]
ds_read_b128 a[108:111], v3 offset:35840
v_mfma_f32_16x16x32_bf16 v[240:243], a[200:203], a[112:115], v[240:243]
v_mfma_f32_16x16x32_bf16 v[240:243], a[168:171], a[144:147], v[240:243]
v_mfma_f32_16x16x32_bf16 a[240:243], a[196:199], a[144:147], a[240:243]
ds_read_b128 a[144:147], v4 offset:36864
v_mfma_f32_16x16x32_bf16 a[240:243], a[164:167], a[112:115], a[240:243]
ds_read_b128 a[112:115], v3 offset:36864
v_mfma_f32_16x16x32_bf16 a[244:247], a[164:167], a[116:119], a[244:247]
v_mfma_f32_16x16x32_bf16 a[244:247], a[196:199], a[148:151], a[244:247]
v_mfma_f32_16x16x32_bf16 v[244:247], a[168:171], a[148:151], v[244:247]
ds_read_b128 a[148:151], v4 offset:37888
v_mfma_f32_16x16x32_bf16 v[244:247], a[200:203], a[116:119], v[244:247]
ds_read_b128 a[116:119], v3 offset:37888
v_mfma_f32_16x16x32_bf16 v[248:251], a[200:203], a[120:123], v[248:251]
v_mfma_f32_16x16x32_bf16 v[248:251], a[168:171], a[152:155], v[248:251]
v_mfma_f32_16x16x32_bf16 a[248:251], a[196:199], a[152:155], a[248:251]
ds_read_b128 a[152:155], v4 offset:38912
v_mfma_f32_16x16x32_bf16 a[248:251], a[164:167], a[120:123], a[248:251]
ds_read_b128 a[120:123], v3 offset:38912
v_mfma_f32_16x16x32_bf16 a[252:255], a[164:167], a[124:127], a[252:255]
buffer_load_dwordx4 a[164:167], v0, s[20:23], s30 offen offset:2048 sc1
v_mfma_f32_16x16x32_bf16 a[252:255], a[196:199], a[156:159], a[252:255]
buffer_load_dwordx4 a[196:199], v0, s[20:23], s30 offen offset:3072 sc1
s_add_u32 s30, s30, 0x1000
v_mfma_f32_16x16x32_bf16 v[252:255], a[168:171], a[156:159], v[252:255]
buffer_load_dwordx4 a[168:171], v0, s[20:23], s30 offen offset:0 sc1
ds_read_b128 a[156:159], v4 offset:39936
v_mfma_f32_16x16x32_bf16 v[252:255], a[200:203], a[124:127], v[252:255]
buffer_load_dwordx4 a[200:203], v0, s[20:23], s30 offen offset:1024 sc1
ds_read_b128 a[124:127], v3 offset:39936
s_waitcnt vmcnt(19) lgkmcnt(14)
v_mfma_f32_16x16x32_bf16 v[32:35], a[180:183], a[96:99], v[32:35]
v_mfma_f32_16x16x32_bf16 v[32:35], a[212:215], a[128:131], v[32:35]
s_add_u32 m0, s31, 113984
v_mfma_f32_16x16x32_bf16 v[64:67], a[204:207], a[128:131], v[64:67]
buffer_load_dwordx4 v5, s[12:15], s48 offen offset:704 lds
v_mfma_f32_16x16x32_bf16 v[64:67], a[172:175], a[96:99], v[64:67]
s_waitcnt lgkmcnt(12)
v_mfma_f32_16x16x32_bf16 v[68:71], a[172:175], a[100:103], v[68:71]
buffer_load_dwordx4 v[20:23], v9, s[24:27], s37 offen offset:128
v_mfma_f32_16x16x32_bf16 v[68:71], a[204:207], a[132:135], v[68:71]
v_mfma_f32_16x16x32_bf16 v[36:39], a[212:215], a[132:135], v[36:39]
v_mfma_f32_16x16x32_bf16 v[36:39], a[180:183], a[100:103], v[36:39]
s_waitcnt lgkmcnt(10)
v_mfma_f32_16x16x32_bf16 v[40:43], a[180:183], a[104:107], v[40:43]
buffer_load_dwordx4 v[24:27], v9, s[24:27], s37 offen offset:192
v_mfma_f32_16x16x32_bf16 v[40:43], a[212:215], a[136:139], v[40:43]
v_mfma_f32_16x16x32_bf16 v[72:75], a[204:207], a[136:139], v[72:75]
v_mfma_f32_16x16x32_bf16 v[72:75], a[172:175], a[104:107], v[72:75]
s_waitcnt lgkmcnt(8)
v_mfma_f32_16x16x32_bf16 v[76:79], a[172:175], a[108:111], v[76:79]
v_mfma_f32_16x16x32_bf16 v[76:79], a[204:207], a[140:143], v[76:79]
v_mfma_f32_16x16x32_bf16 v[44:47], a[212:215], a[140:143], v[44:47]
v_mfma_f32_16x16x32_bf16 v[44:47], a[180:183], a[108:111], v[44:47]
s_waitcnt lgkmcnt(6)
v_mfma_f32_16x16x32_bf16 v[48:51], a[180:183], a[112:115], v[48:51]
v_mfma_f32_16x16x32_bf16 v[48:51], a[212:215], a[144:147], v[48:51]
v_mfma_f32_16x16x32_bf16 v[80:83], a[204:207], a[144:147], v[80:83]
v_mfma_f32_16x16x32_bf16 v[80:83], a[172:175], a[112:115], v[80:83]
s_waitcnt lgkmcnt(4)
v_mfma_f32_16x16x32_bf16 v[84:87], a[172:175], a[116:119], v[84:87]
v_mfma_f32_16x16x32_bf16 v[84:87], a[204:207], a[148:151], v[84:87]
v_mfma_f32_16x16x32_bf16 v[52:55], a[212:215], a[148:151], v[52:55]
v_mfma_f32_16x16x32_bf16 v[52:55], a[180:183], a[116:119], v[52:55]
s_waitcnt lgkmcnt(2)
v_mfma_f32_16x16x32_bf16 v[56:59], a[180:183], a[120:123], v[56:59]
v_mfma_f32_16x16x32_bf16 v[56:59], a[212:215], a[152:155], v[56:59]
v_mfma_f32_16x16x32_bf16 v[88:91], a[204:207], a[152:155], v[88:91]
v_mfma_f32_16x16x32_bf16 v[88:91], a[172:175], a[120:123], v[88:91]
s_waitcnt lgkmcnt(0)
v_mfma_f32_16x16x32_bf16 v[92:95], a[172:175], a[124:127], v[92:95]
buffer_load_dwordx4 a[172:175], v0, s[20:23], s30 offen offset:2048 sc1
v_mfma_f32_16x16x32_bf16 v[92:95], a[204:207], a[156:159], v[92:95]
buffer_load_dwordx4 a[204:207], v0, s[20:23], s30 offen offset:3072 sc1
s_add_u32 s30, s30, 0x1000
v_mfma_f32_16x16x32_bf16 v[60:63], a[212:215], a[156:159], v[60:63]
buffer_load_dwordx4 a[212:215], v0, s[20:23], s30 offen offset:0 sc1
v_mfma_f32_16x16x32_bf16 v[60:63], a[180:183], a[124:127], v[60:63]
buffer_load_dwordx4 a[180:183], v0, s[20:23], s30 offen offset:1024 sc1
s_waitcnt vmcnt(21)
v_mfma_f32_16x16x32_bf16 v[96:99], a[188:191], a[96:99], v[96:99]
v_mfma_f32_16x16x32_bf16 v[96:99], a[220:223], a[128:131], v[96:99]
s_add_u32 m0, s31, 115008
v_mfma_f32_16x16x32_bf16 v[128:131], a[208:211], a[128:131], v[128:131]
buffer_load_dwordx4 v5, s[12:15], s49 offen offset:704 lds
v_mfma_f32_16x16x32_bf16 v[128:131], a[176:179], a[96:99], v[128:131]
v_mfma_f32_16x16x32_bf16 v[132:135], a[176:179], a[100:103], v[132:135]
v_mfma_f32_16x16x32_bf16 v[132:135], a[208:211], a[132:135], v[132:135]
v_mfma_f32_16x16x32_bf16 v[100:103], a[220:223], a[132:135], v[100:103]
v_mfma_f32_16x16x32_bf16 v[100:103], a[188:191], a[100:103], v[100:103]
v_mfma_f32_16x16x32_bf16 v[104:107], a[188:191], a[104:107], v[104:107]
v_mfma_f32_16x16x32_bf16 v[104:107], a[220:223], a[136:139], v[104:107]
v_mfma_f32_16x16x32_bf16 v[136:139], a[208:211], a[136:139], v[136:139]
v_mfma_f32_16x16x32_bf16 v[136:139], a[176:179], a[104:107], v[136:139]
v_mfma_f32_16x16x32_bf16 v[140:143], a[176:179], a[108:111], v[140:143]
v_mfma_f32_16x16x32_bf16 v[140:143], a[208:211], a[140:143], v[140:143]
v_mfma_f32_16x16x32_bf16 v[108:111], a[220:223], a[140:143], v[108:111]
v_mfma_f32_16x16x32_bf16 v[108:111], a[188:191], a[108:111], v[108:111]
v_mfma_f32_16x16x32_bf16 v[112:115], a[188:191], a[112:115], v[112:115]
v_mfma_f32_16x16x32_bf16 v[112:115], a[220:223], a[144:147], v[112:115]
v_mfma_f32_16x16x32_bf16 v[144:147], a[208:211], a[144:147], v[144:147]
v_mfma_f32_16x16x32_bf16 v[144:147], a[176:179], a[112:115], v[144:147]
v_mfma_f32_16x16x32_bf16 v[148:151], a[176:179], a[116:119], v[148:151]
v_mfma_f32_16x16x32_bf16 v[148:151], a[208:211], a[148:151], v[148:151]
v_mfma_f32_16x16x32_bf16 v[116:119], a[220:223], a[148:151], v[116:119]
v_mfma_f32_16x16x32_bf16 v[116:119], a[188:191], a[116:119], v[116:119]
v_mfma_f32_16x16x32_bf16 v[120:123], a[188:191], a[120:123], v[120:123]
v_mfma_f32_16x16x32_bf16 v[120:123], a[220:223], a[152:155], v[120:123]
v_mfma_f32_16x16x32_bf16 v[152:155], a[208:211], a[152:155], v[152:155]
v_mfma_f32_16x16x32_bf16 v[152:155], a[176:179], a[120:123], v[152:155]
v_mfma_f32_16x16x32_bf16 v[156:159], a[176:179], a[124:127], v[156:159]
buffer_load_dwordx4 a[176:179], v0, s[20:23], s30 offen offset:2048 sc1
v_mfma_f32_16x16x32_bf16 v[156:159], a[208:211], a[156:159], v[156:159]
buffer_load_dwordx4 a[208:211], v0, s[20:23], s30 offen offset:3072 sc1
s_add_u32 s30, s30, 0x3000
v_mfma_f32_16x16x32_bf16 v[124:127], a[220:223], a[156:159], v[124:127]
buffer_load_dwordx4 a[220:223], v0, s[20:23], s30 offen offset:0 sc1
v_mfma_f32_16x16x32_bf16 v[124:127], a[188:191], a[124:127], v[124:127]
buffer_load_dwordx4 a[188:191], v0, s[20:23], s30 offen offset:1024 sc1
s_waitcnt vmcnt(21)
v_mfma_f32_16x16x32_bf16 v[160:163], a[64:67], a[96:99], v[160:163]
v_mfma_f32_16x16x32_bf16 v[160:163], a[68:71], a[128:131], v[160:163]
s_add_u32 m0, s31, 121920
v_mfma_f32_16x16x32_bf16 v[192:195], a[216:219], a[128:131], v[192:195]
buffer_load_dwordx4 v5, s[12:15], s48 offen offset:960 lds
v_mfma_f32_16x16x32_bf16 v[192:195], a[184:187], a[96:99], v[192:195]
v_mfma_f32_16x16x32_bf16 v[196:199], a[184:187], a[100:103], v[196:199]
v_mfma_f32_16x16x32_bf16 v[196:199], a[216:219], a[132:135], v[196:199]
v_mfma_f32_16x16x32_bf16 v[164:167], a[68:71], a[132:135], v[164:167]
v_mfma_f32_16x16x32_bf16 v[164:167], a[64:67], a[100:103], v[164:167]
v_mfma_f32_16x16x32_bf16 v[168:171], a[64:67], a[104:107], v[168:171]
v_mfma_f32_16x16x32_bf16 v[168:171], a[68:71], a[136:139], v[168:171]
v_mfma_f32_16x16x32_bf16 v[200:203], a[216:219], a[136:139], v[200:203]
v_mfma_f32_16x16x32_bf16 v[200:203], a[184:187], a[104:107], v[200:203]
v_mfma_f32_16x16x32_bf16 v[204:207], a[184:187], a[108:111], v[204:207]
v_mfma_f32_16x16x32_bf16 v[204:207], a[216:219], a[140:143], v[204:207]
v_mfma_f32_16x16x32_bf16 v[172:175], a[68:71], a[140:143], v[172:175]
v_mfma_f32_16x16x32_bf16 v[172:175], a[64:67], a[108:111], v[172:175]
v_mfma_f32_16x16x32_bf16 v[176:179], a[64:67], a[112:115], v[176:179]
v_mfma_f32_16x16x32_bf16 v[176:179], a[68:71], a[144:147], v[176:179]
v_mfma_f32_16x16x32_bf16 v[208:211], a[216:219], a[144:147], v[208:211]
v_mfma_f32_16x16x32_bf16 v[208:211], a[184:187], a[112:115], v[208:211]
v_mfma_f32_16x16x32_bf16 v[212:215], a[184:187], a[116:119], v[212:215]
v_mfma_f32_16x16x32_bf16 v[212:215], a[216:219], a[148:151], v[212:215]
v_mfma_f32_16x16x32_bf16 v[180:183], a[68:71], a[148:151], v[180:183]
v_mfma_f32_16x16x32_bf16 v[180:183], a[64:67], a[116:119], v[180:183]
v_mfma_f32_16x16x32_bf16 v[184:187], a[64:67], a[120:123], v[184:187]
v_mfma_f32_16x16x32_bf16 v[184:187], a[68:71], a[152:155], v[184:187]
v_mfma_f32_16x16x32_bf16 v[216:219], a[216:219], a[152:155], v[216:219]
v_mfma_f32_16x16x32_bf16 v[216:219], a[184:187], a[120:123], v[216:219]
v_mfma_f32_16x16x32_bf16 v[220:223], a[184:187], a[124:127], v[220:223]
buffer_load_dwordx4 a[184:187], v0, s[20:23], s30 offen offset:2048 sc1
v_mfma_f32_16x16x32_bf16 v[220:223], a[216:219], a[156:159], v[220:223]
buffer_load_dwordx4 a[216:219], v0, s[20:23], s30 offen offset:3072 sc1
s_add_u32 s30, s30, 0x1000
v_mfma_f32_16x16x32_bf16 v[188:191], a[68:71], a[156:159], v[188:191]
v_mfma_f32_16x16x32_bf16 v[188:191], a[64:67], a[124:127], v[188:191]
s_barrier
s_waitcnt vmcnt(17)
v_mfma_f32_16x16x32_bf16 v[224:227], a[160:163], a[96:99], v[224:227]
v_mfma_f32_16x16x32_bf16 v[224:227], a[192:195], a[128:131], v[224:227]
s_add_u32 m0, s31, 122944
v_mfma_f32_16x16x32_bf16 a[224:227], a[196:199], a[128:131], a[224:227]
v_xor_b32 v2, 0x12000, v6
ds_read_b128 a[128:131], v2 offset:0
buffer_load_dwordx4 v5, s[12:15], s49 offen offset:960 lds
v_mfma_f32_16x16x32_bf16 a[224:227], a[164:167], a[96:99], a[224:227]
v_xor_b32 v1, 0x10000, v6
ds_read_b128 a[64:67], v1 offset:0
v_mfma_f32_16x16x32_bf16 a[228:231], a[164:167], a[100:103], a[228:231]
s_waitcnt vmcnt(14)
v_lshlrev_b32 v28, 16, v20
v_and_b32 v29, s33, v20
v_mfma_f32_16x16x32_bf16 a[228:231], a[196:199], a[132:135], a[228:231]
v_lshlrev_b32 v30, 16, v21
v_and_b32 v31, s33, v21
v_mfma_f32_16x16x32_bf16 v[228:231], a[192:195], a[132:135], v[228:231]
ds_read_b128 a[132:135], v2 offset:1024
v_add_f32 v160, v160, v28
v_mfma_f32_16x16x32_bf16 v[228:231], a[160:163], a[100:103], v[228:231]
ds_read_b128 a[68:71], v1 offset:1024
v_add_f32 v161, v161, v29
v_mfma_f32_16x16x32_bf16 v[232:235], a[160:163], a[104:107], v[232:235]
v_add_f32 v162, v162, v30
v_add_f32 v163, v163, v31
v_mfma_f32_16x16x32_bf16 v[232:235], a[192:195], a[136:139], v[232:235]
v_add_f32 v164, v164, v28
v_add_f32 v165, v165, v29
v_mfma_f32_16x16x32_bf16 a[232:235], a[196:199], a[136:139], a[232:235]
ds_read_b128 a[136:139], v2 offset:2048
v_add_f32 v166, v166, v30
v_mfma_f32_16x16x32_bf16 a[232:235], a[164:167], a[104:107], a[232:235]
ds_read_b128 a[72:75], v1 offset:2048
v_add_f32 v167, v167, v31
v_mfma_f32_16x16x32_bf16 a[236:239], a[164:167], a[108:111], a[236:239]
v_add_f32 v168, v168, v28
v_add_f32 v169, v169, v29
v_mfma_f32_16x16x32_bf16 a[236:239], a[196:199], a[140:143], a[236:239]
v_add_f32 v170, v170, v30
v_add_f32 v171, v171, v31
v_mfma_f32_16x16x32_bf16 v[236:239], a[192:195], a[140:143], v[236:239]
ds_read_b128 a[140:143], v2 offset:3072
v_add_f32 v172, v172, v28
v_mfma_f32_16x16x32_bf16 v[236:239], a[160:163], a[108:111], v[236:239]
ds_read_b128 a[76:79], v1 offset:3072
v_add_f32 v173, v173, v29
v_mfma_f32_16x16x32_bf16 v[240:243], a[160:163], a[112:115], v[240:243]
v_add_f32 v174, v174, v30
v_add_f32 v175, v175, v31
v_mfma_f32_16x16x32_bf16 v[240:243], a[192:195], a[144:147], v[240:243]
v_add_f32 v176, v176, v28
v_add_f32 v177, v177, v29
v_mfma_f32_16x16x32_bf16 a[240:243], a[196:199], a[144:147], a[240:243]
ds_read_b128 a[144:147], v2 offset:4096
v_add_f32 v178, v178, v30
v_mfma_f32_16x16x32_bf16 a[240:243], a[164:167], a[112:115], a[240:243]
ds_read_b128 a[80:83], v1 offset:4096
v_add_f32 v179, v179, v31
v_mfma_f32_16x16x32_bf16 a[244:247], a[164:167], a[116:119], a[244:247]
v_add_f32 v180, v180, v28
v_add_f32 v181, v181, v29
v_mfma_f32_16x16x32_bf16 a[244:247], a[196:199], a[148:151], a[244:247]
v_add_f32 v182, v182, v30
v_add_f32 v183, v183, v31
v_mfma_f32_16x16x32_bf16 v[244:247], a[192:195], a[148:151], v[244:247]
ds_read_b128 a[148:151], v2 offset:5120
v_add_f32 v184, v184, v28
v_mfma_f32_16x16x32_bf16 v[244:247], a[160:163], a[116:119], v[244:247]
ds_read_b128 a[84:87], v1 offset:5120
v_add_f32 v185, v185, v29
v_mfma_f32_16x16x32_bf16 v[248:251], a[160:163], a[120:123], v[248:251]
v_add_f32 v186, v186, v30
v_add_f32 v187, v187, v31
v_mfma_f32_16x16x32_bf16 v[248:251], a[192:195], a[152:155], v[248:251]
v_add_f32 v188, v188, v28
v_add_f32 v189, v189, v29
v_mfma_f32_16x16x32_bf16 a[248:251], a[196:199], a[152:155], a[248:251]
ds_read_b128 a[152:155], v2 offset:6144
v_add_f32 v190, v190, v30
v_mfma_f32_16x16x32_bf16 a[248:251], a[164:167], a[120:123], a[248:251]
ds_read_b128 a[88:91], v1 offset:6144
v_add_f32 v191, v191, v31
v_mfma_f32_16x16x32_bf16 a[252:255], a[164:167], a[124:127], a[252:255]
buffer_load_dwordx4 a[164:167], v0, s[20:23], s30 offen offset:0 sc1
v_lshlrev_b32 v28, 16, v22
v_mfma_f32_16x16x32_bf16 a[252:255], a[196:199], a[156:159], a[252:255]
buffer_load_dwordx4 a[196:199], v0, s[20:23], s30 offen offset:1024 sc1
v_and_b32 v29, s33, v22
v_mfma_f32_16x16x32_bf16 v[252:255], a[192:195], a[156:159], v[252:255]
buffer_load_dwordx4 a[192:195], v0, s[20:23], s30 offen offset:2048 sc1
ds_read_b128 a[156:159], v2 offset:7168
v_mfma_f32_16x16x32_bf16 v[252:255], a[160:163], a[124:127], v[252:255]
buffer_load_dwordx4 a[160:163], v0, s[20:23], s30 offen offset:3072 sc1
s_add_u32 s30, s30, 0x3000
ds_read_b128 a[92:95], v1 offset:7168
L_q3:
s_waitcnt vmcnt(15) lgkmcnt(14)
v_mfma_f32_16x16x32_bf16 v[32:35], a[168:171], a[64:67], v[32:35]
v_lshlrev_b32 v30, 16, v23
v_mfma_f32_16x16x32_bf16 v[32:35], a[200:203], a[128:131], v[32:35]
v_and_b32 v31, s33, v23
v_add_f32 v192, v192, v28
v_mfma_f32_16x16x32_bf16 v[64:67], a[204:207], a[128:131], v[64:67]
v_add_f32 v193, v193, v29
v_add_f32 v194, v194, v30
v_mfma_f32_16x16x32_bf16 v[64:67], a[172:175], a[64:67], v[64:67]
v_add_f32 v195, v195, v31
v_add_f32 v196, v196, v28
s_waitcnt lgkmcnt(12)
v_mfma_f32_16x16x32_bf16 v[68:71], a[172:175], a[68:71], v[68:71]
v_add_f32 v197, v197, v29
v_mfma_f32_16x16x32_bf16 v[68:71], a[204:207], a[132:135], v[68:71]
v_add_f32 v198, v198, v30
v_add_f32 v199, v199, v31
v_mfma_f32_16x16x32_bf16 v[36:39], a[200:203], a[132:135], v[36:39]
v_add_f32 v200, v200, v28
v_add_f32 v201, v201, v29
v_mfma_f32_16x16x32_bf16 v[36:39], a[168:171], a[68:71], v[36:39]
v_add_f32 v202, v202, v30
v_add_f32 v203, v203, v31
s_waitcnt lgkmcnt(10)
v_mfma_f32_16x16x32_bf16 v[40:43], a[168:171], a[72:75], v[40:43]
v_add_f32 v204, v204, v28
v_mfma_f32_16x16x32_bf16 v[40:43], a[200:203], a[136:139], v[40:43]
v_add_f32 v205, v205, v29
v_add_f32 v206, v206, v30
v_mfma_f32_16x16x32_bf16 v[72:75], a[204:207], a[136:139], v[72:75]
v_add_f32 v207, v207, v31
v_add_f32 v208, v208, v28
v_mfma_f32_16x16x32_bf16 v[72:75], a[172:175], a[72:75], v[72:75]
v_add_f32 v209, v209, v29
v_add_f32 v210, v210, v30
s_waitcnt lgkmcnt(8)
v_mfma_f32_16x16x32_bf16 v[76:79], a[172:175], a[76:79], v[76:79]
v_add_f32 v211, v211, v31
v_mfma_f32_16x16x32_bf16 v[76:79], a[204:207], a[140:143], v[76:79]
v_add_f32 v212, v212, v28
v_add_f32 v213, v213, v29
v_mfma_f32_16x16x32_bf16 v[44:47], a[200:203], a[140:143], v[44:47]
v_add_f32 v214, v214, v30
v_add_f32 v215, v215, v31
v_mfma_f32_16x16x32_bf16 v[44:47], a[168:171], a[76:79], v[44:47]
v_add_f32 v216, v216, v28
v_add_f32 v217, v217, v29
s_waitcnt lgkmcnt(6)
v_mfma_f32_16x16x32_bf16 v[48:51], a[168:171], a[80:83], v[48:51]
v_add_f32 v218, v218, v30
v_mfma_f32_16x16x32_bf16 v[48:51], a[200:203], a[144:147], v[48:51]
v_add_f32 v219, v219, v31
v_add_f32 v220, v220, v28
v_mfma_f32_16x16x32_bf16 v[80:83], a[204:207], a[144:147], v[80:83]
v_add_f32 v221, v221, v29
v_add_f32 v222, v222, v30
v_mfma_f32_16x16x32_bf16 v[80:83], a[172:175], a[80:83], v[80:83]
v_add_f32 v223, v223, v31
v_lshlrev_b32 v28, 16, v24
s_waitcnt lgkmcnt(4)
v_mfma_f32_16x16x32_bf16 v[84:87], a[172:175], a[84:87], v[84:87]
v_and_b32 v29, s33, v24
v_mfma_f32_16x16x32_bf16 v[84:87], a[204:207], a[148:151], v[84:87]
v_lshlrev_b32 v30, 16, v25
v_and_b32 v31, s33, v25
v_mfma_f32_16x16x32_bf16 v[52:55], a[200:203], a[148:151], v[52:55]
v_add_f32 v224, v224, v28
v_add_f32 v225, v225, v29
v_mfma_f32_16x16x32_bf16 v[52:55], a[168:171], a[84:87], v[52:55]
v_add_f32 v226, v226, v30
v_add_f32 v227, v227, v31
s_waitcnt lgkmcnt(2)
v_mfma_f32_16x16x32_bf16 v[56:59], a[168:171], a[88:91], v[56:59]
v_add_f32 v228, v228, v28
v_mfma_f32_16x16x32_bf16 v[56:59], a[200:203], a[152:155], v[56:59]
v_add_f32 v229, v229, v29
v_add_f32 v230, v230, v30
v_mfma_f32_16x16x32_bf16 v[88:91], a[204:207], a[152:155], v[88:91]
v_add_f32 v231, v231, v31
v_add_f32 v232, v232, v28
v_mfma_f32_16x16x32_bf16 v[88:91], a[172:175], a[88:91], v[88:91]
v_add_f32 v233, v233, v29
v_add_f32 v234, v234, v30
s_waitcnt lgkmcnt(0)
v_mfma_f32_16x16x32_bf16 v[92:95], a[172:175], a[92:95], v[92:95]
buffer_load_dwordx4 a[172:175], v0, s[20:23], s30 offen offset:0 sc1
v_mfma_f32_16x16x32_bf16 v[92:95], a[204:207], a[156:159], v[92:95]
buffer_load_dwordx4 a[204:207], v0, s[20:23], s30 offen offset:1024 sc1
v_add_f32 v235, v235, v31
v_mfma_f32_16x16x32_bf16 v[60:63], a[200:203], a[156:159], v[60:63]
buffer_load_dwordx4 a[200:203], v0, s[20:23], s30 offen offset:2048 sc1
v_add_f32 v236, v236, v28
v_mfma_f32_16x16x32_bf16 v[60:63], a[168:171], a[92:95], v[60:63]
buffer_load_dwordx4 a[168:171], v0, s[20:23], s30 offen offset:3072 sc1
s_add_u32 s30, s30, 0x1000
s_waitcnt vmcnt(14)
v_mfma_f32_16x16x32_bf16 v[96:99], a[212:215], a[64:67], v[96:99]
v_add_f32 v237, v237, v29
s_add_u32 s96, s92, L_q5-L_pc
s_addc_u32 s97, s93, 0
s_load_dword s98, s[96:97], 0
v_mfma_f32_16x16x32_bf16 v[96:99], a[180:183], a[128:131], v[96:99]
v_mfma_f32_16x16x32_bf16 v[128:131], a[208:211], a[128:131], v[128:131]
v_xor_b32 v4, 0x16000, v6
ds_read_b128 a[128:131], v4 offset:0
v_mfma_f32_16x16x32_bf16 v[128:131], a[176:179], a[64:67], v[128:131]
v_xor_b32 v3, 0x14000, v6
ds_read_b128 a[96:99], v3 offset:0
v_mfma_f32_16x16x32_bf16 v[132:135], a[176:179], a[68:71], v[132:135]
v_add_f32 v238, v238, v30
v_add_f32 v239, v239, v31
v_mfma_f32_16x16x32_bf16 v[132:135], a[208:211], a[132:135], v[132:135]
v_add_f32 v240, v240, v28
v_add_f32 v241, v241, v29
v_mfma_f32_16x16x32_bf16 v[100:103], a[180:183], a[132:135], v[100:103]
ds_read_b128 a[132:135], v4 offset:1024
v_add_f32 v242, v242, v30
v_mfma_f32_16x16x32_bf16 v[100:103], a[212:215], a[68:71], v[100:103]
ds_read_b128 a[100:103], v3 offset:1024
v_add_f32 v243, v243, v31
v_mfma_f32_16x16x32_bf16 v[104:107], a[212:215], a[72:75], v[104:107]
v_add_f32 v244, v244, v28
v_add_f32 v245, v245, v29
v_mfma_f32_16x16x32_bf16 v[104:107], a[180:183], a[136:139], v[104:107]
v_add_f32 v246, v246, v30
v_add_f32 v247, v247, v31
v_mfma_f32_16x16x32_bf16 v[136:139], a[208:211], a[136:139], v[136:139]
ds_read_b128 a[136:139], v4 offset:2048
v_add_f32 v248, v248, v28
v_mfma_f32_16x16x32_bf16 v[136:139], a[176:179], a[72:75], v[136:139]
ds_read_b128 a[104:107], v3 offset:2048
v_add_f32 v249, v249, v29
v_mfma_f32_16x16x32_bf16 v[140:143], a[176:179], a[76:79], v[140:143]
v_add_f32 v250, v250, v30
v_add_f32 v251, v251, v31
v_mfma_f32_16x16x32_bf16 v[140:143], a[208:211], a[140:143], v[140:143]
v_add_f32 v252, v252, v28
v_add_f32 v253, v253, v29
v_mfma_f32_16x16x32_bf16 v[108:111], a[180:183], a[140:143], v[108:111]
ds_read_b128 a[140:143], v4 offset:3072
v_add_f32 v254, v254, v30
v_mfma_f32_16x16x32_bf16 v[108:111], a[212:215], a[76:79], v[108:111]
ds_read_b128 a[108:111], v3 offset:3072
v_add_f32 v255, v255, v31
v_mfma_f32_16x16x32_bf16 v[112:115], a[212:215], a[80:83], v[112:115]
v_lshlrev_b32 v28, 16, v26
v_and_b32 v29, s33, v26
v_mfma_f32_16x16x32_bf16 v[112:115], a[180:183], a[144:147], v[112:115]
v_lshlrev_b32 v30, 16, v27
v_and_b32 v31, s33, v27
v_mfma_f32_16x16x32_bf16 v[144:147], a[208:211], a[144:147], v[144:147]
ds_read_b128 a[144:147], v4 offset:4096
v_accvgpr_read_b32 v12, a224
v_mfma_f32_16x16x32_bf16 v[144:147], a[176:179], a[80:83], v[144:147]
ds_read_b128 a[112:115], v3 offset:4096
v_accvgpr_read_b32 v13, a225
v_mfma_f32_16x16x32_bf16 v[148:151], a[176:179], a[84:87], v[148:151]
v_accvgpr_read_b32 v14, a226
v_accvgpr_read_b32 v15, a227
v_mfma_f32_16x16x32_bf16 v[148:151], a[208:211], a[148:151], v[148:151]
v_add_f32 v12, v12, v28
v_add_f32 v13, v13, v29
v_mfma_f32_16x16x32_bf16 v[116:119], a[180:183], a[148:151], v[116:119]
ds_read_b128 a[148:151], v4 offset:5120
v_add_f32 v14, v14, v30
v_mfma_f32_16x16x32_bf16 v[116:119], a[212:215], a[84:87], v[116:119]
ds_read_b128 a[116:119], v3 offset:5120
v_add_f32 v15, v15, v31
v_mfma_f32_16x16x32_bf16 v[120:123], a[212:215], a[88:91], v[120:123]
v_accvgpr_write_b32 a224, v12
v_accvgpr_write_b32 a225, v13
v_mfma_f32_16x16x32_bf16 v[120:123], a[180:183], a[152:155], v[120:123]
v_accvgpr_write_b32 a226, v14
v_accvgpr_write_b32 a227, v15
v_mfma_f32_16x16x32_bf16 v[152:155], a[208:211], a[152:155], v[152:155]
ds_read_b128 a[152:155], v4 offset:6144
v_accvgpr_read_b32 v12, a228
v_mfma_f32_16x16x32_bf16 v[152:155], a[176:179], a[88:91], v[152:155]
ds_read_b128 a[120:123], v3 offset:6144
v_accvgpr_read_b32 v13, a229
v_mfma_f32_16x16x32_bf16 v[156:159], a[176:179], a[92:95], v[156:159]
buffer_load_dwordx4 a[176:179], v0, s[20:23], s30 offen offset:0 sc1
v_accvgpr_read_b32 v14, a230
v_mfma_f32_16x16x32_bf16 v[156:159], a[208:211], a[156:159], v[156:159]
buffer_load_dwordx4 a[208:211], v0, s[20:23], s30 offen offset:1024 sc1
v_accvgpr_read_b32 v15, a231
v_mfma_f32_16x16x32_bf16 v[124:127], a[180:183], a[156:159], v[124:127]
buffer_load_dwordx4 a[180:183], v0, s[20:23], s30 offen offset:2048 sc1
ds_read_b128 a[156:159], v4 offset:7168
v_mfma_f32_16x16x32_bf16 v[124:127], a[212:215], a[92:95], v[124:127]
buffer_load_dwordx4 a[212:215], v0, s[20:23], s30 offen offset:3072 sc1
s_add_u32 s30, s30, 0x3000
ds_read_b128 a[124:127], v3 offset:7168
s_waitcnt vmcnt(13) lgkmcnt(14)
v_mfma_f32_16x16x32_bf16 v[32:35], a[220:223], a[96:99], v[32:35]
v_add_f32 v12, v12, v28
v_mfma_f32_16x16x32_bf16 v[32:35], a[188:191], a[128:131], v[32:35]
v_add_f32 v13, v13, v29
v_add_f32 v14, v14, v30
v_mfma_f32_16x16x32_bf16 v[64:67], a[216:219], a[128:131], v[64:67]
v_add_f32 v15, v15, v31
v_accvgpr_write_b32 a228, v12
v_mfma_f32_16x16x32_bf16 v[64:67], a[184:187], a[96:99], v[64:67]
v_accvgpr_write_b32 a229, v13
v_accvgpr_write_b32 a230, v14
s_waitcnt lgkmcnt(12)
v_mfma_f32_16x16x32_bf16 v[68:71], a[184:187], a[100:103], v[68:71]
v_accvgpr_write_b32 a231, v15
v_mfma_f32_16x16x32_bf16 v[68:71], a[216:219], a[132:135], v[68:71]
v_accvgpr_read_b32 v12, a232
v_accvgpr_read_b32 v13, a233
v_mfma_f32_16x16x32_bf16 v[36:39], a[188:191], a[132:135], v[36:39]
v_accvgpr_read_b32 v14, a234
v_accvgpr_read_b32 v15, a235
v_mfma_f32_16x16x32_bf16 v[36:39], a[220:223], a[100:103], v[36:39]
v_add_f32 v12, v12, v28
v_add_f32 v13, v13, v29
s_waitcnt lgkmcnt(10)
v_mfma_f32_16x16x32_bf16 v[40:43], a[220:223], a[104:107], v[40:43]
v_add_f32 v14, v14, v30
v_mfma_f32_16x16x32_bf16 v[40:43], a[188:191], a[136:139], v[40:43]
v_add_f32 v15, v15, v31
v_accvgpr_write_b32 a232, v12
v_mfma_f32_16x16x32_bf16 v[72:75], a[216:219], a[136:139], v[72:75]
v_accvgpr_write_b32 a233, v13
v_accvgpr_write_b32 a234, v14
v_mfma_f32_16x16x32_bf16 v[72:75], a[184:187], a[104:107], v[72:75]
v_accvgpr_write_b32 a235, v15
v_accvgpr_read_b32 v12, a236
s_waitcnt lgkmcnt(8)
v_mfma_f32_16x16x32_bf16 v[76:79], a[184:187], a[108:111], v[76:79]
v_accvgpr_read_b32 v13, a237
v_mfma_f32_16x16x32_bf16 v[76:79], a[216:219], a[140:143], v[76:79]
v_accvgpr_read_b32 v14, a238
v_accvgpr_read_b32 v15, a239
v_mfma_f32_16x16x32_bf16 v[44:47], a[188:191], a[140:143], v[44:47]
v_add_f32 v12, v12, v28
v_add_f32 v13, v13, v29
v_mfma_f32_16x16x32_bf16 v[44:47], a[220:223], a[108:111], v[44:47]
v_add_f32 v14, v14, v30
v_add_f32 v15, v15, v31
s_waitcnt lgkmcnt(6)
v_mfma_f32_16x16x32_bf16 v[48:51], a[220:223], a[112:115], v[48:51]
v_accvgpr_write_b32 a236, v12
v_mfma_f32_16x16x32_bf16 v[48:51], a[188:191], a[144:147], v[48:51]
v_accvgpr_write_b32 a237, v13
v_accvgpr_write_b32 a238, v14
v_mfma_f32_16x16x32_bf16 v[80:83], a[216:219], a[144:147], v[80:83]
v_accvgpr_write_b32 a239, v15
v_accvgpr_read_b32 v12, a240
v_mfma_f32_16x16x32_bf16 v[80:83], a[184:187], a[112:115], v[80:83]
v_accvgpr_read_b32 v13, a241
v_accvgpr_read_b32 v14, a242
s_waitcnt lgkmcnt(4)
v_mfma_f32_16x16x32_bf16 v[84:87], a[184:187], a[116:119], v[84:87]
v_accvgpr_read_b32 v15, a243
v_mfma_f32_16x16x32_bf16 v[84:87], a[216:219], a[148:151], v[84:87]
v_add_f32 v12, v12, v28
v_add_f32 v13, v13, v29
v_mfma_f32_16x16x32_bf16 v[52:55], a[188:191], a[148:151], v[52:55]
v_add_f32 v14, v14, v30
v_add_f32 v15, v15, v31
v_mfma_f32_16x16x32_bf16 v[52:55], a[220:223], a[116:119], v[52:55]
v_accvgpr_write_b32 a240, v12
v_accvgpr_write_b32 a241, v13
s_waitcnt lgkmcnt(2)
v_mfma_f32_16x16x32_bf16 v[56:59], a[220:223], a[120:123], v[56:59]
v_accvgpr_write_b32 a242, v14
v_mfma_f32_16x16x32_bf16 v[56:59], a[188:191], a[152:155], v[56:59]
v_accvgpr_write_b32 a243, v15
v_accvgpr_read_b32 v12, a244
v_mfma_f32_16x16x32_bf16 v[88:91], a[216:219], a[152:155], v[88:91]
v_accvgpr_read_b32 v13, a245
v_accvgpr_read_b32 v14, a246
v_mfma_f32_16x16x32_bf16 v[88:91], a[184:187], a[120:123], v[88:91]
v_accvgpr_read_b32 v15, a247
v_add_f32 v12, v12, v28
s_waitcnt lgkmcnt(0)
v_mfma_f32_16x16x32_bf16 v[92:95], a[184:187], a[124:127], v[92:95]
buffer_load_dwordx4 a[184:187], v0, s[20:23], s30 offen offset:0 sc1
v_mfma_f32_16x16x32_bf16 v[92:95], a[216:219], a[156:159], v[92:95]
buffer_load_dwordx4 a[216:219], v0, s[20:23], s30 offen offset:1024 sc1
v_add_f32 v13, v13, v29
v_mfma_f32_16x16x32_bf16 v[60:63], a[188:191], a[156:159], v[60:63]
buffer_load_dwordx4 a[188:191], v0, s[20:23], s30 offen offset:2048 sc1
v_add_f32 v14, v14, v30
v_mfma_f32_16x16x32_bf16 v[60:63], a[220:223], a[124:127], v[60:63]
buffer_load_dwordx4 a[220:223], v0, s[20:23], s30 offen offset:3072 sc1
s_add_u32 s30, s30, 0x1000
s_waitcnt vmcnt(16)
s_barrier
s_waitcnt vmcnt(12)
v_mfma_f32_16x16x32_bf16 v[96:99], a[164:167], a[96:99], v[96:99]
v_mfma_f32_16x16x32_bf16 v[96:99], a[196:199], a[128:131], v[96:99]
v_add_f32 v15, v15, v31
v_accvgpr_write_b32 a244, v12
v_mfma_f32_16x16x32_bf16 v[128:131], a[160:163], a[128:131], v[128:131]
ds_read_b128 a[128:131], v2 offset:32768
v_accvgpr_write_b32 a245, v13
v_mfma_f32_16x16x32_bf16 v[128:131], a[192:195], a[96:99], v[128:131]
ds_read_b128 a[96:99], v1 offset:32768
v_accvgpr_write_b32 a246, v14
v_mfma_f32_16x16x32_bf16 v[132:135], a[192:195], a[100:103], v[132:135]
v_accvgpr_write_b32 a247, v15
v_accvgpr_read_b32 v12, a248
v_mfma_f32_16x16x32_bf16 v[132:135], a[160:163], a[132:135], v[132:135]
v_accvgpr_read_b32 v13, a249
v_accvgpr_read_b32 v14, a250
v_mfma_f32_16x16x32_bf16 v[100:103], a[196:199], a[132:135], v[100:103]
ds_read_b128 a[132:135], v2 offset:33792
v_accvgpr_read_b32 v15, a251
v_mfma_f32_16x16x32_bf16 v[100:103], a[164:167], a[100:103], v[100:103]
ds_read_b128 a[100:103], v1 offset:33792
v_add_f32 v12, v12, v28
v_mfma_f32_16x16x32_bf16 v[104:107], a[164:167], a[104:107], v[104:107]
v_add_f32 v13, v13, v29
v_add_f32 v14, v14, v30
v_mfma_f32_16x16x32_bf16 v[104:107], a[196:199], a[136:139], v[104:107]
v_add_f32 v15, v15, v31
v_accvgpr_write_b32 a248, v12
v_mfma_f32_16x16x32_bf16 v[136:139], a[160:163], a[136:139], v[136:139]
ds_read_b128 a[136:139], v2 offset:34816
v_accvgpr_write_b32 a249, v13
v_mfma_f32_16x16x32_bf16 v[136:139], a[192:195], a[104:107], v[136:139]
ds_read_b128 a[104:107], v1 offset:34816
v_accvgpr_write_b32 a250, v14
v_mfma_f32_16x16x32_bf16 v[140:143], a[192:195], a[108:111], v[140:143]
v_accvgpr_write_b32 a251, v15
v_accvgpr_read_b32 v12, a252
v_mfma_f32_16x16x32_bf16 v[140:143], a[160:163], a[140:143], v[140:143]
v_accvgpr_read_b32 v13, a253
v_accvgpr_read_b32 v14, a254
v_mfma_f32_16x16x32_bf16 v[108:111], a[196:199], a[140:143], v[108:111]
ds_read_b128 a[140:143], v2 offset:35840
v_accvgpr_read_b32 v15, a255
v_mfma_f32_16x16x32_bf16 v[108:111], a[164:167], a[108:111], v[108:111]
ds_read_b128 a[108:111], v1 offset:35840
v_add_f32 v12, v12, v28
v_mfma_f32_16x16x32_bf16 v[112:115], a[164:167], a[112:115], v[112:115]
v_add_f32 v13, v13, v29
v_add_f32 v14, v14, v30
v_mfma_f32_16x16x32_bf16 v[112:115], a[196:199], a[144:147], v[112:115]
v_add_f32 v15, v15, v31
v_accvgpr_write_b32 a252, v12
v_mfma_f32_16x16x32_bf16 v[144:147], a[160:163], a[144:147], v[144:147]
ds_read_b128 a[144:147], v2 offset:36864
v_accvgpr_write_b32 a253, v13
v_mfma_f32_16x16x32_bf16 v[144:147], a[192:195], a[112:115], v[144:147]
ds_read_b128 a[112:115], v1 offset:36864
v_accvgpr_write_b32 a254, v14
v_mfma_f32_16x16x32_bf16 v[148:151], a[192:195], a[116:119], v[148:151]
v_accvgpr_write_b32 a255, v15
v_mfma_f32_16x16x32_bf16 v[148:151], a[160:163], a[148:151], v[148:151]
v_mfma_f32_16x16x32_bf16 v[116:119], a[196:199], a[148:151], v[116:119]
ds_read_b128 a[148:151], v2 offset:37888
v_mfma_f32_16x16x32_bf16 v[116:119], a[164:167], a[116:119], v[116:119]
ds_read_b128 a[116:119], v1 offset:37888
v_mfma_f32_16x16x32_bf16 v[120:123], a[164:167], a[120:123], v[120:123]
v_mfma_f32_16x16x32_bf16 v[120:123], a[196:199], a[152:155], v[120:123]
v_mfma_f32_16x16x32_bf16 v[152:155], a[160:163], a[152:155], v[152:155]
ds_read_b128 a[152:155], v2 offset:38912
v_mfma_f32_16x16x32_bf16 v[152:155], a[192:195], a[120:123], v[152:155]
ds_read_b128 a[120:123], v1 offset:38912
v_mfma_f32_16x16x32_bf16 v[156:159], a[192:195], a[124:127], v[156:159]
buffer_load_dwordx4 a[192:195], v0, s[20:23], s30 offen offset:0 sc1
v_mfma_f32_16x16x32_bf16 v[156:159], a[160:163], a[156:159], v[156:159]
buffer_load_dwordx4 a[160:163], v0, s[20:23], s30 offen offset:1024 sc1
v_mfma_f32_16x16x32_bf16 v[124:127], a[196:199], a[156:159], v[124:127]
buffer_load_dwordx4 a[196:199], v0, s[20:23], s30 offen offset:2048 sc1
ds_read_b128 a[156:159], v2 offset:39936
v_mfma_f32_16x16x32_bf16 v[124:127], a[164:167], a[124:127], v[124:127]
buffer_load_dwordx4 a[164:167], v0, s[20:23], s30 offen offset:3072 sc1
s_add_u32 s30, s30, 0xffff5000
ds_read_b128 a[124:127], v1 offset:39936
s_waitcnt vmcnt(12) lgkmcnt(14)
v_mfma_f32_16x16x32_bf16 v[32:35], a[172:175], a[96:99], v[32:35]
v_mfma_f32_16x16x32_bf16 v[32:35], a[204:207], a[128:131], v[32:35]
v_mfma_f32_16x16x32_bf16 v[64:67], a[168:171], a[128:131], v[64:67]
v_mfma_f32_16x16x32_bf16 v[64:67], a[200:203], a[96:99], v[64:67]
s_waitcnt lgkmcnt(12)
v_mfma_f32_16x16x32_bf16 v[68:71], a[200:203], a[100:103], v[68:71]
v_mfma_f32_16x16x32_bf16 v[68:71], a[168:171], a[132:135], v[68:71]
ds_write_b128 v8, a[96:99] offset:0
v_mfma_f32_16x16x32_bf16 v[36:39], a[204:207], a[132:135], v[36:39]
v_mfma_f32_16x16x32_bf16 v[36:39], a[172:175], a[100:103], v[36:39]
s_waitcnt lgkmcnt(11)
v_mfma_f32_16x16x32_bf16 v[40:43], a[172:175], a[104:107], v[40:43]
v_mfma_f32_16x16x32_bf16 v[40:43], a[204:207], a[136:139], v[40:43]
ds_write_b128 v8, a[100:103] offset:1024
v_mfma_f32_16x16x32_bf16 v[72:75], a[168:171], a[136:139], v[72:75]
v_mfma_f32_16x16x32_bf16 v[72:75], a[200:203], a[104:107], v[72:75]
s_waitcnt lgkmcnt(10)
v_mfma_f32_16x16x32_bf16 v[76:79], a[200:203], a[108:111], v[76:79]
v_mfma_f32_16x16x32_bf16 v[76:79], a[168:171], a[140:143], v[76:79]
ds_write_b128 v8, a[104:107] offset:2048
v_mfma_f32_16x16x32_bf16 v[44:47], a[204:207], a[140:143], v[44:47]
v_mfma_f32_16x16x32_bf16 v[44:47], a[172:175], a[108:111], v[44:47]
s_waitcnt lgkmcnt(9)
v_mfma_f32_16x16x32_bf16 v[48:51], a[172:175], a[112:115], v[48:51]
v_mfma_f32_16x16x32_bf16 v[48:51], a[204:207], a[144:147], v[48:51]
ds_write_b128 v8, a[108:111] offset:3072
v_mfma_f32_16x16x32_bf16 v[80:83], a[168:171], a[144:147], v[80:83]
v_mfma_f32_16x16x32_bf16 v[80:83], a[200:203], a[112:115], v[80:83]
s_waitcnt lgkmcnt(8)
v_mfma_f32_16x16x32_bf16 v[84:87], a[200:203], a[116:119], v[84:87]
v_mfma_f32_16x16x32_bf16 v[84:87], a[168:171], a[148:151], v[84:87]
ds_write_b128 v8, a[112:115] offset:4096
v_mfma_f32_16x16x32_bf16 v[52:55], a[204:207], a[148:151], v[52:55]
v_mfma_f32_16x16x32_bf16 v[52:55], a[172:175], a[116:119], v[52:55]
s_waitcnt lgkmcnt(7)
v_mfma_f32_16x16x32_bf16 v[56:59], a[172:175], a[120:123], v[56:59]
v_mfma_f32_16x16x32_bf16 v[56:59], a[204:207], a[152:155], v[56:59]
ds_write_b128 v8, a[116:119] offset:5120
v_mfma_f32_16x16x32_bf16 v[88:91], a[168:171], a[152:155], v[88:91]
v_mfma_f32_16x16x32_bf16 v[88:91], a[200:203], a[120:123], v[88:91]
s_waitcnt lgkmcnt(6)
v_mfma_f32_16x16x32_bf16 v[92:95], a[200:203], a[124:127], v[92:95]
buffer_load_dwordx4 a[200:203], v0, s[20:23], s30 offen offset:0 sc1
v_mfma_f32_16x16x32_bf16 v[92:95], a[168:171], a[156:159], v[92:95]
buffer_load_dwordx4 a[168:171], v0, s[20:23], s30 offen offset:1024 sc1
ds_write_b128 v8, a[120:123] offset:6144
v_mfma_f32_16x16x32_bf16 v[60:63], a[204:207], a[156:159], v[60:63]
buffer_load_dwordx4 a[204:207], v0, s[20:23], s30 offen offset:2048 sc1
v_mfma_f32_16x16x32_bf16 v[60:63], a[172:175], a[124:127], v[60:63]
buffer_load_dwordx4 a[172:175], v0, s[20:23], s30 offen offset:3072 sc1
s_add_u32 s30, s30, 0x1000
s_waitcnt vmcnt(12)
v_mfma_f32_16x16x32_bf16 v[96:99], a[176:179], a[96:99], v[96:99]
v_mfma_f32_16x16x32_bf16 v[96:99], a[208:211], a[128:131], v[96:99]
ds_write_b128 v8, a[124:127] offset:7168
v_mfma_f32_16x16x32_bf16 v[128:131], a[212:215], a[128:131], v[128:131]
ds_read_b128 a[128:131], v4 offset:32768
v_mfma_f32_16x16x32_bf16 v[128:131], a[180:183], a[96:99], v[128:131]
ds_read_b128 a[96:99], v3 offset:32768
v_mfma_f32_16x16x32_bf16 v[132:135], a[180:183], a[100:103], v[132:135]
v_mfma_f32_16x16x32_bf16 v[132:135], a[212:215], a[132:135], v[132:135]
v_mfma_f32_16x16x32_bf16 v[100:103], a[208:211], a[132:135], v[100:103]
ds_read_b128 a[132:135], v4 offset:33792
v_mfma_f32_16x16x32_bf16 v[100:103], a[176:179], a[100:103], v[100:103]
ds_read_b128 a[100:103], v3 offset:33792
v_mfma_f32_16x16x32_bf16 v[104:107], a[176:179], a[104:107], v[104:107]
v_mfma_f32_16x16x32_bf16 v[104:107], a[208:211], a[136:139], v[104:107]
v_mfma_f32_16x16x32_bf16 v[136:139], a[212:215], a[136:139], v[136:139]
ds_read_b128 a[136:139], v4 offset:34816
v_mfma_f32_16x16x32_bf16 v[136:139], a[180:183], a[104:107], v[136:139]
ds_read_b128 a[104:107], v3 offset:34816
v_mfma_f32_16x16x32_bf16 v[140:143], a[180:183], a[108:111], v[140:143]
v_mfma_f32_16x16x32_bf16 v[140:143], a[212:215], a[140:143], v[140:143]
v_mfma_f32_16x16x32_bf16 v[108:111], a[208:211], a[140:143], v[108:111]
ds_read_b128 a[140:143], v4 offset:35840
v_mfma_f32_16x16x32_bf16 v[108:111], a[176:179], a[108:111], v[108:111]
ds_read_b128 a[108:111], v3 offset:35840
v_mfma_f32_16x16x32_bf16 v[112:115], a[176:179], a[112:115], v[112:115]
v_mfma_f32_16x16x32_bf16 v[112:115], a[208:211], a[144:147], v[112:115]
v_mfma_f32_16x16x32_bf16 v[144:147], a[212:215], a[144:147], v[144:147]
ds_read_b128 a[144:147], v4 offset:36864
v_mfma_f32_16x16x32_bf16 v[144:147], a[180:183], a[112:115], v[144:147]
ds_read_b128 a[112:115], v3 offset:36864
v_mfma_f32_16x16x32_bf16 v[148:151], a[180:183], a[116:119], v[148:151]
v_mfma_f32_16x16x32_bf16 v[148:151], a[212:215], a[148:151], v[148:151]
v_mfma_f32_16x16x32_bf16 v[116:119], a[208:211], a[148:151], v[116:119]
ds_read_b128 a[148:151], v4 offset:37888
v_mfma_f32_16x16x32_bf16 v[116:119], a[176:179], a[116:119], v[116:119]
ds_read_b128 a[116:119], v3 offset:37888
v_mfma_f32_16x16x32_bf16 v[120:123], a[176:179], a[120:123], v[120:123]
v_mfma_f32_16x16x32_bf16 v[120:123], a[208:211], a[152:155], v[120:123]
v_mfma_f32_16x16x32_bf16 v[152:155], a[212:215], a[152:155], v[152:155]
ds_read_b128 a[152:155], v4 offset:38912
v_mfma_f32_16x16x32_bf16 v[152:155], a[180:183], a[120:123], v[152:155]
ds_read_b128 a[120:123], v3 offset:38912
v_mfma_f32_16x16x32_bf16 v[156:159], a[180:183], a[124:127], v[156:159]
buffer_load_dwordx4 a[180:183], v0, s[20:23], s30 offen offset:0 sc1
v_mfma_f32_16x16x32_bf16 v[156:159], a[212:215], a[156:159], v[156:159]
buffer_load_dwordx4 a[212:215], v0, s[20:23], s30 offen offset:1024 sc1
v_mfma_f32_16x16x32_bf16 v[124:127], a[208:211], a[156:159], v[124:127]
buffer_load_dwordx4 a[208:211], v0, s[20:23], s30 offen offset:2048 sc1
ds_read_b128 a[156:159], v4 offset:39936
v_mfma_f32_16x16x32_bf16 v[124:127], a[176:179], a[124:127], v[124:127]
buffer_load_dwordx4 a[176:179], v0, s[20:23], s30 offen offset:3072 sc1
s_add_u32 s30, s30, 0x3000
ds_read_b128 a[124:127], v3 offset:39936
s_waitcnt vmcnt(12) lgkmcnt(14)
v_mfma_f32_16x16x32_bf16 v[32:35], a[184:187], a[96:99], v[32:35]
v_mfma_f32_16x16x32_bf16 v[32:35], a[216:219], a[128:131], v[32:35]
v_mfma_f32_16x16x32_bf16 v[64:67], a[220:223], a[128:131], v[64:67]
v_mfma_f32_16x16x32_bf16 v[64:67], a[188:191], a[96:99], v[64:67]
s_waitcnt lgkmcnt(12)
v_mfma_f32_16x16x32_bf16 v[68:71], a[188:191], a[100:103], v[68:71]
v_mfma_f32_16x16x32_bf16 v[68:71], a[220:223], a[132:135], v[68:71]
v_mfma_f32_16x16x32_bf16 v[36:39], a[216:219], a[132:135], v[36:39]
v_mfma_f32_16x16x32_bf16 v[36:39], a[184:187], a[100:103], v[36:39]
s_waitcnt lgkmcnt(10)
v_mfma_f32_16x16x32_bf16 v[40:43], a[184:187], a[104:107], v[40:43]
v_accvgpr_read_b32 v12, a0
v_mfma_f32_16x16x32_bf16 v[40:43], a[216:219], a[136:139], v[40:43]
v_accvgpr_read_b32 v13, a1
v_accvgpr_read_b32 v14, a2
v_mfma_f32_16x16x32_bf16 v[72:75], a[220:223], a[136:139], v[72:75]
v_accvgpr_read_b32 v15, a3
v_lshlrev_b32 v24, 16, v12
v_mfma_f32_16x16x32_bf16 v[72:75], a[188:191], a[104:107], v[72:75]
v_and_b32 v25, s33, v12
v_lshlrev_b32 v26, 16, v13
s_waitcnt lgkmcnt(8)
v_mfma_f32_16x16x32_bf16 v[76:79], a[188:191], a[108:111], v[76:79]
v_and_b32 v27, s33, v13
v_mfma_f32_16x16x32_bf16 v[76:79], a[220:223], a[140:143], v[76:79]
v_mul_f32 v24, v24, v32
v_mul_f32 v25, v25, v33
v_mfma_f32_16x16x32_bf16 v[44:47], a[216:219], a[140:143], v[44:47]
v_mul_f32 v26, v26, v34
v_mul_f32 v27, v27, v35
v_mfma_f32_16x16x32_bf16 v[44:47], a[184:187], a[108:111], v[44:47]
v_cvt_pk_bf16_f32 v12, v24, v25
v_cvt_pk_bf16_f32 v13, v26, v27
s_waitcnt lgkmcnt(6)
v_mfma_f32_16x16x32_bf16 v[48:51], a[184:187], a[112:115], v[48:51]
v_lshlrev_b32 v24, 16, v14
v_mfma_f32_16x16x32_bf16 v[48:51], a[216:219], a[144:147], v[48:51]
v_and_b32 v25, s33, v14
v_lshlrev_b32 v26, 16, v15
v_mfma_f32_16x16x32_bf16 v[80:83], a[220:223], a[144:147], v[80:83]
v_and_b32 v27, s33, v15
v_mul_f32 v24, v24, v64
v_mfma_f32_16x16x32_bf16 v[80:83], a[188:191], a[112:115], v[80:83]
v_mul_f32 v25, v25, v65
v_mul_f32 v26, v26, v66
s_waitcnt lgkmcnt(4)
v_mfma_f32_16x16x32_bf16 v[84:87], a[188:191], a[116:119], v[84:87]
v_mul_f32 v27, v27, v67
v_mfma_f32_16x16x32_bf16 v[84:87], a[220:223], a[148:151], v[84:87]
v_cvt_pk_bf16_f32 v14, v24, v25
v_cvt_pk_bf16_f32 v15, v26, v27
v_mfma_f32_16x16x32_bf16 v[52:55], a[216:219], a[148:151], v[52:55]
ds_write_b128 v6, v[12:15] offset:0
buffer_store_dwordx4 v[12:15], v6, s[20:23], s52 offen offset:0 sc1
v_mfma_f32_16x16x32_bf16 v[52:55], a[184:187], a[116:119], v[52:55]
v_accvgpr_read_b32 v16, a4
v_accvgpr_read_b32 v17, a5
s_waitcnt lgkmcnt(3)
v_mfma_f32_16x16x32_bf16 v[56:59], a[184:187], a[120:123], v[56:59]
v_accvgpr_read_b32 v18, a6
v_mfma_f32_16x16x32_bf16 v[56:59], a[216:219], a[152:155], v[56:59]
v_accvgpr_read_b32 v19, a7
v_lshlrev_b32 v24, 16, v16
v_mfma_f32_16x16x32_bf16 v[88:91], a[220:223], a[152:155], v[88:91]
v_and_b32 v25, s33, v16
v_lshlrev_b32 v26, 16, v17
v_mfma_f32_16x16x32_bf16 v[88:91], a[188:191], a[120:123], v[88:91]
v_and_b32 v27, s33, v17
v_mul_f32 v24, v24, v36
s_waitcnt lgkmcnt(1)
v_mfma_f32_16x16x32_bf16 v[92:95], a[188:191], a[124:127], v[92:95]
buffer_load_dwordx4 a[188:191], v0, s[20:23], s30 offen offset:0 sc1
v_mfma_f32_16x16x32_bf16 v[92:95], a[220:223], a[156:159], v[92:95]
buffer_load_dwordx4 a[220:223], v0, s[20:23], s30 offen offset:1024 sc1
v_mul_f32 v25, v25, v37
v_mfma_f32_16x16x32_bf16 v[60:63], a[216:219], a[156:159], v[60:63]
buffer_load_dwordx4 a[216:219], v0, s[20:23], s30 offen offset:2048 sc1
v_mul_f32 v26, v26, v38
v_mfma_f32_16x16x32_bf16 v[60:63], a[184:187], a[124:127], v[60:63]
buffer_load_dwordx4 a[184:187], v0, s[20:23], s30 offen offset:3072 sc1
s_add_u32 s30, s30, 0x1000
s_waitcnt vmcnt(13)
v_mfma_f32_16x16x32_bf16 v[96:99], a[192:195], a[96:99], v[96:99]
v_mul_f32 v27, v27, v39
v_mfma_f32_16x16x32_bf16 v[96:99], a[160:163], a[128:131], v[96:99]
v_cvt_pk_bf16_f32 v16, v24, v25
v_cvt_pk_bf16_f32 v17, v26, v27
v_mfma_f32_16x16x32_bf16 v[128:131], a[164:167], a[128:131], v[128:131]
ds_read_b128 a[128:131], v2 offset:0
v_lshlrev_b32 v24, 16, v18
v_mfma_f32_16x16x32_bf16 v[128:131], a[196:199], a[96:99], v[128:131]
v_and_b32 v25, s33, v18
v_lshlrev_b32 v26, 16, v19
v_mfma_f32_16x16x32_bf16 v[132:135], a[196:199], a[100:103], v[132:135]
v_and_b32 v27, s33, v19
v_mul_f32 v24, v24, v68
v_mfma_f32_16x16x32_bf16 v[132:135], a[164:167], a[132:135], v[132:135]
v_mul_f32 v25, v25, v69
v_mul_f32 v26, v26, v70
v_mfma_f32_16x16x32_bf16 v[100:103], a[160:163], a[132:135], v[100:103]
ds_read_b128 a[132:135], v2 offset:1024
v_mul_f32 v27, v27, v71
v_mfma_f32_16x16x32_bf16 v[100:103], a[192:195], a[100:103], v[100:103]
v_cvt_pk_bf16_f32 v18, v24, v25
v_cvt_pk_bf16_f32 v19, v26, v27
v_mfma_f32_16x16x32_bf16 v[104:107], a[192:195], a[104:107], v[104:107]
ds_write_b128 v6, v[16:19] offset:1024
buffer_store_dwordx4 v[16:19], v6, s[20:23], s52 offen offset:1024 sc1
v_mfma_f32_16x16x32_bf16 v[104:107], a[160:163], a[136:139], v[104:107]
v_accvgpr_read_b32 v20, a8
v_accvgpr_read_b32 v21, a9
v_mfma_f32_16x16x32_bf16 v[136:139], a[164:167], a[136:139], v[136:139]
ds_read_b128 a[136:139], v2 offset:2048
v_accvgpr_read_b32 v22, a10
v_mfma_f32_16x16x32_bf16 v[136:139], a[196:199], a[104:107], v[136:139]
v_accvgpr_read_b32 v23, a11
v_lshlrev_b32 v24, 16, v20
v_mfma_f32_16x16x32_bf16 v[140:143], a[196:199], a[108:111], v[140:143]
v_and_b32 v25, s33, v20
v_lshlrev_b32 v26, 16, v21
v_mfma_f32_16x16x32_bf16 v[140:143], a[164:167], a[140:143], v[140:143]
v_and_b32 v27, s33, v21
v_mul_f32 v24, v24, v40
v_mfma_f32_16x16x32_bf16 v[108:111], a[160:163], a[140:143], v[108:111]
ds_read_b128 a[140:143], v2 offset:3072
v_mul_f32 v25, v25, v41
v_mfma_f32_16x16x32_bf16 v[108:111], a[192:195], a[108:111], v[108:111]
v_mul_f32 v26, v26, v42
v_mul_f32 v27, v27, v43
v_mfma_f32_16x16x32_bf16 v[112:115], a[192:195], a[112:115], v[112:115]
v_and_b32 v10, 0x1f0, v0
v_lshlrev_b32 v10, 6, v10
buffer_load_dwordx2 v[10:11], v10, s[20:23], s59 offen sc1
v_mfma_f32_16x16x32_bf16 v[112:115], a[160:163], a[144:147], v[112:115]
v_cvt_pk_bf16_f32 v20, v24, v25
v_cvt_pk_bf16_f32 v21, v26, v27
v_mfma_f32_16x16x32_bf16 v[144:147], a[164:167], a[144:147], v[144:147]
ds_read_b128 a[144:147], v2 offset:4096
v_lshlrev_b32 v24, 16, v22
v_mfma_f32_16x16x32_bf16 v[144:147], a[196:199], a[112:115], v[144:147]
v_and_b32 v25, s33, v22
v_lshlrev_b32 v26, 16, v23
v_mfma_f32_16x16x32_bf16 v[148:151], a[196:199], a[116:119], v[148:151]
v_and_b32 v27, s33, v23
v_mul_f32 v24, v24, v72
v_mfma_f32_16x16x32_bf16 v[148:151], a[164:167], a[148:151], v[148:151]
v_mul_f32 v25, v25, v73
v_mul_f32 v26, v26, v74
v_mfma_f32_16x16x32_bf16 v[116:119], a[160:163], a[148:151], v[116:119]
ds_read_b128 a[148:151], v2 offset:5120
v_mul_f32 v27, v27, v75
v_mfma_f32_16x16x32_bf16 v[116:119], a[192:195], a[116:119], v[116:119]
v_cvt_pk_bf16_f32 v22, v24, v25
v_cvt_pk_bf16_f32 v23, v26, v27
v_mfma_f32_16x16x32_bf16 v[120:123], a[192:195], a[120:123], v[120:123]
ds_write_b128 v6, v[20:23] offset:2048
buffer_store_dwordx4 v[20:23], v6, s[20:23], s52 offen offset:2048 sc1
v_mfma_f32_16x16x32_bf16 v[120:123], a[160:163], a[152:155], v[120:123]
v_accvgpr_read_b32 v12, a12
v_accvgpr_read_b32 v13, a13
v_mfma_f32_16x16x32_bf16 v[152:155], a[164:167], a[152:155], v[152:155]
ds_read_b128 a[152:155], v2 offset:6144
v_accvgpr_read_b32 v14, a14
v_mfma_f32_16x16x32_bf16 v[152:155], a[196:199], a[120:123], v[152:155]
v_accvgpr_read_b32 v15, a15
v_lshlrev_b32 v24, 16, v12
v_mfma_f32_16x16x32_bf16 v[156:159], a[196:199], a[124:127], v[156:159]
buffer_load_dwordx4 a[196:199], v0, s[20:23], s30 offen offset:0 sc1
v_and_b32 v25, s33, v12
v_mfma_f32_16x16x32_bf16 v[156:159], a[164:167], a[156:159], v[156:159]
buffer_load_dwordx4 a[164:167], v0, s[20:23], s30 offen offset:1024 sc1
v_lshlrev_b32 v26, 16, v13
v_mfma_f32_16x16x32_bf16 v[124:127], a[160:163], a[156:159], v[124:127]
buffer_load_dwordx4 a[160:163], v0, s[20:23], s30 offen offset:2048 sc1
ds_read_b128 a[156:159], v2 offset:7168
v_mfma_f32_16x16x32_bf16 v[124:127], a[192:195], a[124:127], v[124:127]
buffer_load_dwordx4 a[192:195], v0, s[20:23], s30 offen offset:3072 sc1
s_add_u32 s30, s30, 0x3000
s_waitcnt vmcnt(16) lgkmcnt(9)
v_mfma_f32_16x16x32_bf16 v[160:163], a[200:203], a[64:67], v[160:163]
v_and_b32 v27, s33, v13
v_mfma_f32_16x16x32_bf16 v[160:163], a[168:171], a[128:131], v[160:163]
v_mul_f32 v24, v24, v44
v_mul_f32 v25, v25, v45
v_mfma_f32_16x16x32_bf16 v[192:195], a[172:175], a[128:131], v[192:195]
v_mul_f32 v26, v26, v46
v_mul_f32 v27, v27, v47
v_mfma_f32_16x16x32_bf16 v[192:195], a[204:207], a[64:67], v[192:195]
v_cvt_pk_bf16_f32 v12, v24, v25
v_cvt_pk_bf16_f32 v13, v26, v27
s_waitcnt lgkmcnt(8)
v_mfma_f32_16x16x32_bf16 v[196:199], a[204:207], a[68:71], v[196:199]
v_lshlrev_b32 v24, 16, v14
v_mfma_f32_16x16x32_bf16 v[196:199], a[172:175], a[132:135], v[196:199]
v_and_b32 v25, s33, v14
v_lshlrev_b32 v26, 16, v15
v_mfma_f32_16x16x32_bf16 v[164:167], a[168:171], a[132:135], v[164:167]
v_and_b32 v27, s33, v15
v_mul_f32 v24, v24, v76
v_mfma_f32_16x16x32_bf16 v[164:167], a[200:203], a[68:71], v[164:167]
v_mul_f32 v25, v25, v77
v_mul_f32 v26, v26, v78
s_waitcnt lgkmcnt(6)
v_mfma_f32_16x16x32_bf16 v[168:171], a[200:203], a[72:75], v[168:171]
v_mul_f32 v27, v27, v79
v_mfma_f32_16x16x32_bf16 v[168:171], a[168:171], a[136:139], v[168:171]
v_cvt_pk_bf16_f32 v14, v24, v25
v_cvt_pk_bf16_f32 v15, v26, v27
v_mfma_f32_16x16x32_bf16 v[200:203], a[172:175], a[136:139], v[200:203]
ds_write_b128 v6, v[12:15] offset:3072
buffer_store_dwordx4 v[12:15], v6, s[20:23], s52 offen offset:3072 sc1
v_mfma_f32_16x16x32_bf16 v[200:203], a[204:207], a[72:75], v[200:203]
v_accvgpr_read_b32 v16, a16
v_accvgpr_read_b32 v17, a17
s_waitcnt lgkmcnt(6)
v_mfma_f32_16x16x32_bf16 v[204:207], a[204:207], a[76:79], v[204:207]
v_accvgpr_read_b32 v18, a18
v_mfma_f32_16x16x32_bf16 v[204:207], a[172:175], a[140:143], v[204:207]
v_accvgpr_read_b32 v19, a19
v_lshlrev_b32 v24, 16, v16
v_mfma_f32_16x16x32_bf16 v[172:175], a[168:171], a[140:143], v[172:175]
v_and_b32 v25, s33, v16
v_lshlrev_b32 v26, 16, v17
v_mfma_f32_16x16x32_bf16 v[172:175], a[200:203], a[76:79], v[172:175]
v_and_b32 v27, s33, v17
v_mul_f32 v24, v24, v48
s_waitcnt lgkmcnt(5)
v_mfma_f32_16x16x32_bf16 v[176:179], a[200:203], a[80:83], v[176:179]
v_mul_f32 v25, v25, v49
v_mfma_f32_16x16x32_bf16 v[176:179], a[168:171], a[144:147], v[176:179]
v_mul_f32 v26, v26, v50
v_mul_f32 v27, v27, v51
v_mfma_f32_16x16x32_bf16 v[208:211], a[172:175], a[144:147], v[208:211]
v_cvt_pk_bf16_f32 v16, v24, v25
v_cvt_pk_bf16_f32 v17, v26, v27
v_mfma_f32_16x16x32_bf16 v[208:211], a[204:207], a[80:83], v[208:211]
v_lshlrev_b32 v24, 16, v18
v_and_b32 v25, s33, v18
s_waitcnt lgkmcnt(4)
v_mfma_f32_16x16x32_bf16 v[212:215], a[204:207], a[84:87], v[212:215]
v_lshlrev_b32 v26, 16, v19
v_mfma_f32_16x16x32_bf16 v[212:215], a[172:175], a[148:151], v[212:215]
v_and_b32 v27, s33, v19
v_mul_f32 v24, v24, v80
v_mfma_f32_16x16x32_bf16 v[180:183], a[168:171], a[148:151], v[180:183]
v_mul_f32 v25, v25, v81
v_mul_f32 v26, v26, v82
v_mfma_f32_16x16x32_bf16 v[180:183], a[200:203], a[84:87], v[180:183]
v_mul_f32 v27, v27, v83
v_cvt_pk_bf16_f32 v18, v24, v25
s_waitcnt lgkmcnt(2)
v_mfma_f32_16x16x32_bf16 v[184:187], a[200:203], a[88:91], v[184:187]
v_cvt_pk_bf16_f32 v19, v26, v27
v_mfma_f32_16x16x32_bf16 v[184:187], a[168:171], a[152:155], v[184:187]
ds_write_b128 v6, v[16:19] offset:4096
buffer_store_dwordx4 v[16:19], v6, s[20:23], s53 offen offset:0 sc1
v_mfma_f32_16x16x32_bf16 v[216:219], a[172:175], a[152:155], v[216:219]
v_accvgpr_read_b32 v20, a20
v_accvgpr_read_b32 v21, a21
v_mfma_f32_16x16x32_bf16 v[216:219], a[204:207], a[88:91], v[216:219]
v_accvgpr_read_b32 v22, a22
v_accvgpr_read_b32 v23, a23
s_waitcnt lgkmcnt(2)
v_mfma_f32_16x16x32_bf16 v[220:223], a[204:207], a[92:95], v[220:223]
buffer_load_dwordx4 a[204:207], v0, s[20:23], s30 offen offset:0 sc1
v_mfma_f32_16x16x32_bf16 v[220:223], a[172:175], a[156:159], v[220:223]
buffer_load_dwordx4 a[172:175], v0, s[20:23], s30 offen offset:1024 sc1
v_lshlrev_b32 v24, 16, v20
v_mfma_f32_16x16x32_bf16 v[188:191], a[168:171], a[156:159], v[188:191]
buffer_load_dwordx4 a[168:171], v0, s[20:23], s30 offen offset:2048 sc1
v_and_b32 v25, s33, v20
v_mfma_f32_16x16x32_bf16 v[188:191], a[200:203], a[92:95], v[188:191]
buffer_load_dwordx4 a[200:203], v0, s[20:23], s30 offen offset:3072 sc1
s_add_u32 s30, s30, 0x1000
s_waitcnt vmcnt(18)
v_mfma_f32_16x16x32_bf16 v[224:227], a[180:183], a[64:67], v[224:227]
v_lshlrev_b32 v26, 16, v21
v_mfma_f32_16x16x32_bf16 v[224:227], a[212:215], a[128:131], v[224:227]
v_and_b32 v27, s33, v21
v_mul_f32 v24, v24, v52
v_mfma_f32_16x16x32_bf16 a[224:227], a[176:179], a[128:131], a[224:227]
ds_read_b128 a[128:131], v4 offset:0
v_mul_f32 v25, v25, v53
v_mfma_f32_16x16x32_bf16 a[224:227], a[208:211], a[64:67], a[224:227]
ds_read_b128 a[96:99], v3 offset:0
v_mul_f32 v26, v26, v54
v_mfma_f32_16x16x32_bf16 a[228:231], a[208:211], a[68:71], a[228:231]
v_mul_f32 v27, v27, v55
v_cvt_pk_bf16_f32 v20, v24, v25
v_mfma_f32_16x16x32_bf16 a[228:231], a[176:179], a[132:135], a[228:231]
v_cvt_pk_bf16_f32 v21, v26, v27
v_lshlrev_b32 v24, 16, v22
v_mfma_f32_16x16x32_bf16 v[228:231], a[212:215], a[132:135], v[228:231]
ds_read_b128 a[132:135], v4 offset:1024
v_and_b32 v25, s33, v22
v_mfma_f32_16x16x32_bf16 v[228:231], a[180:183], a[68:71], v[228:231]
ds_read_b128 a[100:103], v3 offset:1024
v_lshlrev_b32 v26, 16, v23
v_mfma_f32_16x16x32_bf16 v[232:235], a[180:183], a[72:75], v[232:235]
v_and_b32 v27, s33, v23
v_mul_f32 v24, v24, v84
v_mfma_f32_16x16x32_bf16 v[232:235], a[212:215], a[136:139], v[232:235]
v_mul_f32 v25, v25, v85
v_mul_f32 v26, v26, v86
v_mfma_f32_16x16x32_bf16 a[232:235], a[176:179], a[136:139], a[232:235]
ds_read_b128 a[136:139], v4 offset:2048
v_mul_f32 v27, v27, v87
v_mfma_f32_16x16x32_bf16 a[232:235], a[208:211], a[72:75], a[232:235]
ds_read_b128 a[104:107], v3 offset:2048
v_cvt_pk_bf16_f32 v22, v24, v25
v_mfma_f32_16x16x32_bf16 a[236:239], a[208:211], a[76:79], a[236:239]
v_cvt_pk_bf16_f32 v23, v26, v27
ds_write_b128 v6, v[20:23] offset:5120
v_mfma_f32_16x16x32_bf16 a[236:239], a[176:179], a[140:143], a[236:239]
buffer_store_dwordx4 v[20:23], v6, s[20:23], s53 offen offset:1024 sc1
v_accvgpr_read_b32 v12, a24
v_mfma_f32_16x16x32_bf16 v[236:239], a[212:215], a[140:143], v[236:239]
ds_read_b128 a[140:143], v4 offset:3072
v_accvgpr_read_b32 v13, a25
v_mfma_f32_16x16x32_bf16 v[236:239], a[180:183], a[76:79], v[236:239]
ds_read_b128 a[108:111], v3 offset:3072
v_accvgpr_read_b32 v14, a26
v_mfma_f32_16x16x32_bf16 v[240:243], a[180:183], a[80:83], v[240:243]
s_waitcnt vmcnt(12)
s_add_u32 s34, s8, 1
v_subrev_u32 v10, s34, v10
v_xor_b32 v11, s9, v11
s_nop 0
v_cmp_gt_u64 vcc, 15, v[10:11]
s_nop 3
s_cmp_lg_u64 vcc, -1
s_cbranch_scc1 L_wspin1
L_wback1:
v_mfma_f32_16x16x32_bf16 v[240:243], a[212:215], a[144:147], v[240:243]
v_accvgpr_read_b32 v15, a27
v_lshlrev_b32 v24, 16, v12
v_mfma_f32_16x16x32_bf16 a[240:243], a[176:179], a[144:147], a[240:243]
ds_read_b128 a[144:147], v4 offset:4096
v_and_b32 v25, s33, v12
v_mfma_f32_16x16x32_bf16 a[240:243], a[208:211], a[80:83], a[240:243]
ds_read_b128 a[112:115], v3 offset:4096
v_lshlrev_b32 v26, 16, v13
v_mfma_f32_16x16x32_bf16 a[244:247], a[208:211], a[84:87], a[244:247]
v_and_b32 v27, s33, v13
v_mul_f32 v24, v24, v56
v_mfma_f32_16x16x32_bf16 a[244:247], a[176:179], a[148:151], a[244:247]
v_mul_f32 v25, v25, v57
v_mul_f32 v26, v26, v58
v_mfma_f32_16x16x32_bf16 v[244:247], a[212:215], a[148:151], v[244:247]
ds_read_b128 a[148:151], v4 offset:5120
v_mul_f32 v27, v27, v59
v_mfma_f32_16x16x32_bf16 v[244:247], a[180:183], a[84:87], v[244:247]
ds_read_b128 a[116:119], v3 offset:5120
v_cvt_pk_bf16_f32 v12, v24, v25
v_mfma_f32_16x16x32_bf16 v[248:251], a[180:183], a[88:91], v[248:251]
v_cvt_pk_bf16_f32 v13, v26, v27
v_lshlrev_b32 v24, 16, v14
v_mfma_f32_16x16x32_bf16 v[248:251], a[212:215], a[152:155], v[248:251]
v_and_b32 v25, s33, v14
v_lshlrev_b32 v26, 16, v15
v_mfma_f32_16x16x32_bf16 a[248:251], a[176:179], a[152:155], a[248:251]
ds_read_b128 a[152:155], v4 offset:6144
v_and_b32 v27, s33, v15
v_mfma_f32_16x16x32_bf16 a[248:251], a[208:211], a[88:91], a[248:251]
ds_read_b128 a[120:123], v3 offset:6144
v_mul_f32 v24, v24, v88
v_mfma_f32_16x16x32_bf16 a[252:255], a[208:211], a[92:95], a[252:255]
buffer_load_dwordx4 a[208:211], v0, s[20:23], s30 offen offset:0 sc1
v_mul_f32 v25, v25, v89
v_mfma_f32_16x16x32_bf16 a[252:255], a[176:179], a[156:159], a[252:255]
buffer_load_dwordx4 a[176:179], v0, s[20:23], s30 offen offset:1024 sc1
v_mul_f32 v26, v26, v90
v_mfma_f32_16x16x32_bf16 v[252:255], a[212:215], a[156:159], v[252:255]
buffer_load_dwordx4 a[212:215], v0, s[20:23], s30 offen offset:2048 sc1
ds_read_b128 a[156:159], v4 offset:7168
v_mfma_f32_16x16x32_bf16 v[252:255], a[180:183], a[92:95], v[252:255]
buffer_load_dwordx4 a[180:183], v0, s[20:23], s30 offen offset:3072 sc1
s_add_u32 s30, s30, 0x3000
ds_read_b128 a[124:127], v3 offset:7168
s_waitcnt lgkmcnt(15)
v_mfma_f32_16x16x32_bf16 v[160:163], a[188:191], a[96:99], v[160:163]
v_mul_f32 v27, v27, v91
v_mfma_f32_16x16x32_bf16 v[160:163], a[220:223], a[128:131], v[160:163]
v_cvt_pk_bf16_f32 v14, v24, v25
v_cvt_pk_bf16_f32 v15, v26, v27
v_mfma_f32_16x16x32_bf16 v[192:195], a[184:187], a[128:131], v[192:195]
ds_write_b128 v6, v[12:15] offset:6144
buffer_store_dwordx4 v[12:15], v6, s[20:23], s53 offen offset:2048 sc1
v_mfma_f32_16x16x32_bf16 v[192:195], a[216:219], a[96:99], v[192:195]
v_accvgpr_read_b32 v16, a28
v_accvgpr_read_b32 v17, a29
s_waitcnt lgkmcnt(14)
v_mfma_f32_16x16x32_bf16 v[196:199], a[216:219], a[100:103], v[196:199]
v_accvgpr_read_b32 v18, a30
v_mfma_f32_16x16x32_bf16 v[196:199], a[184:187], a[132:135], v[196:199]
v_accvgpr_read_b32 v19, a31
v_lshlrev_b32 v24, 16, v16
v_mfma_f32_16x16x32_bf16 v[164:167], a[220:223], a[132:135], v[164:167]
v_and_b32 v25, s33, v16
v_lshlrev_b32 v26, 16, v17
v_mfma_f32_16x16x32_bf16 v[164:167], a[188:191], a[100:103], v[164:167]
v_and_b32 v27, s33, v17
v_mul_f32 v24, v24, v60
s_waitcnt lgkmcnt(12)
v_mfma_f32_16x16x32_bf16 v[168:171], a[188:191], a[104:107], v[168:171]
v_mul_f32 v25, v25, v61
v_mfma_f32_16x16x32_bf16 v[168:171], a[220:223], a[136:139], v[168:171]
v_mul_f32 v26, v26, v62
v_mul_f32 v27, v27, v63
v_mfma_f32_16x16x32_bf16 v[200:203], a[184:187], a[136:139], v[200:203]
v_cvt_pk_bf16_f32 v16, v24, v25
v_cvt_pk_bf16_f32 v17, v26, v27
v_mfma_f32_16x16x32_bf16 v[200:203], a[216:219], a[104:107], v[200:203]
v_lshlrev_b32 v24, 16, v18
v_and_b32 v25, s33, v18
s_waitcnt lgkmcnt(9)
v_mfma_f32_16x16x32_bf16 v[204:207], a[216:219], a[108:111], v[204:207]
v_lshlrev_b32 v26, 16, v19
v_mfma_f32_16x16x32_bf16 v[204:207], a[184:187], a[140:143], v[204:207]
v_and_b32 v27, s33, v19
v_mul_f32 v24, v24, v92
v_mfma_f32_16x16x32_bf16 v[172:175], a[220:223], a[140:143], v[172:175]
v_mul_f32 v25, v25, v93
v_mul_f32 v26, v26, v94
v_mfma_f32_16x16x32_bf16 v[172:175], a[188:191], a[108:111], v[172:175]
v_mul_f32 v27, v27, v95
v_cvt_pk_bf16_f32 v18, v24, v25
s_waitcnt lgkmcnt(7)
v_mfma_f32_16x16x32_bf16 v[176:179], a[188:191], a[112:115], v[176:179]
v_cvt_pk_bf16_f32 v19, v26, v27
v_mfma_f32_16x16x32_bf16 v[176:179], a[220:223], a[144:147], v[176:179]
ds_write_b128 v6, v[16:19] offset:7168
buffer_store_dwordx4 v[16:19], v6, s[20:23], s53 offen offset:3072 sc1
v_mfma_f32_16x16x32_bf16 v[208:211], a[184:187], a[144:147], v[208:211]
v_accvgpr_read_b32 v20, a32
v_accvgpr_read_b32 v21, a33
v_mfma_f32_16x16x32_bf16 v[208:211], a[216:219], a[112:115], v[208:211]
v_accvgpr_read_b32 v22, a34
v_accvgpr_read_b32 v23, a35
s_waitcnt lgkmcnt(6)
v_mfma_f32_16x16x32_bf16 v[212:215], a[216:219], a[116:119], v[212:215]
v_lshlrev_b32 v24, 16, v20
v_mfma_f32_16x16x32_bf16 v[212:215], a[184:187], a[148:151], v[212:215]
v_and_b32 v25, s33, v20
v_lshlrev_b32 v26, 16, v21
v_mfma_f32_16x16x32_bf16 v[180:183], a[220:223], a[148:151], v[180:183]
v_and_b32 v27, s33, v21
v_mul_f32 v24, v24, v96
v_mfma_f32_16x16x32_bf16 v[180:183], a[188:191], a[116:119], v[180:183]
v_mul_f32 v25, v25, v97
v_mul_f32 v26, v26, v98
s_waitcnt lgkmcnt(4)
v_mfma_f32_16x16x32_bf16 v[184:187], a[188:191], a[120:123], v[184:187]
v_mul_f32 v27, v27, v99
v_mfma_f32_16x16x32_bf16 v[184:187], a[220:223], a[152:155], v[184:187]
v_cvt_pk_bf16_f32 v20, v24, v25
v_cvt_pk_bf16_f32 v21, v26, v27
v_mfma_f32_16x16x32_bf16 v[216:219], a[184:187], a[152:155], v[216:219]
v_lshlrev_b32 v24, 16, v22
v_and_b32 v25, s33, v22
v_mfma_f32_16x16x32_bf16 v[216:219], a[216:219], a[120:123], v[216:219]
v_lshlrev_b32 v26, 16, v23
v_and_b32 v27, s33, v23
s_waitcnt lgkmcnt(2)
v_mfma_f32_16x16x32_bf16 v[220:223], a[216:219], a[124:127], v[220:223]
buffer_load_dwordx4 a[216:219], v0, s[20:23], s30 offen offset:0 sc1
v_mfma_f32_16x16x32_bf16 v[220:223], a[184:187], a[156:159], v[220:223]
buffer_load_dwordx4 a[184:187], v0, s[20:23], s30 offen offset:1024 sc1
v_mul_f32 v24, v24, v128
v_mfma_f32_16x16x32_bf16 v[188:191], a[220:223], a[156:159], v[188:191]
buffer_load_dwordx4 a[220:223], v0, s[20:23], s30 offen offset:2048 sc1
v_mul_f32 v25, v25, v129
v_mfma_f32_16x16x32_bf16 v[188:191], a[188:191], a[124:127], v[188:191]
buffer_load_dwordx4 a[188:191], v0, s[20:23], s30 offen offset:3072 sc1
s_add_u32 s30, s30, 0x1000
s_waitcnt vmcnt(17)
v_mfma_f32_16x16x32_bf16 v[224:227], a[196:199], a[96:99], v[224:227]
v_mul_f32 v26, v26, v130
v_mfma_f32_16x16x32_bf16 v[224:227], a[164:167], a[128:131], v[224:227]
v_mul_f32 v27, v27, v131
v_cvt_pk_bf16_f32 v22, v24, v25
v_mfma_f32_16x16x32_bf16 a[224:227], a[192:195], a[128:131], a[224:227]
ds_read_b128 a[128:131], v2 offset:32768
v_cvt_pk_bf16_f32 v23, v26, v27
v_mfma_f32_16x16x32_bf16 a[224:227], a[160:163], a[96:99], a[224:227]
ds_read_b128 a[96:99], v1 offset:32768
ds_write_b128 v6, v[20:23] offset:32768
v_mfma_f32_16x16x32_bf16 a[228:231], a[160:163], a[100:103], a[228:231]
buffer_store_dwordx4 v[20:23], v6, s[20:23], s54 offen offset:0 sc1
v_accvgpr_read_b32 v12, a36
v_mfma_f32_16x16x32_bf16 a[228:231], a[192:195], a[132:135], a[228:231]
v_accvgpr_read_b32 v13, a37
v_accvgpr_read_b32 v14, a38
v_mfma_f32_16x16x32_bf16 v[228:231], a[164:167], a[132:135], v[228:231]
ds_read_b128 a[132:135], v2 offset:33792
v_accvgpr_read_b32 v15, a39
v_mfma_f32_16x16x32_bf16 v[228:231], a[196:199], a[100:103], v[228:231]
ds_read_b128 a[100:103], v1 offset:33792
v_lshlrev_b32 v24, 16, v12
v_mfma_f32_16x16x32_bf16 v[232:235], a[196:199], a[104:107], v[232:235]
v_and_b32 v25, s33, v12
v_lshlrev_b32 v26, 16, v13
v_mfma_f32_16x16x32_bf16 v[232:235], a[164:167], a[136:139], v[232:235]
v_and_b32 v27, s33, v13
v_mul_f32 v24, v24, v100
v_mfma_f32_16x16x32_bf16 a[232:235], a[192:195], a[136:139], a[232:235]
ds_read_b128 a[136:139], v2 offset:34816
v_mul_f32 v25, v25, v101
v_mfma_f32_16x16x32_bf16 a[232:235], a[160:163], a[104:107], a[232:235]
ds_read_b128 a[104:107], v1 offset:34816
v_mul_f32 v26, v26, v102
v_mfma_f32_16x16x32_bf16 a[236:239], a[160:163], a[108:111], a[236:239]
v_mul_f32 v27, v27, v103
v_cvt_pk_bf16_f32 v12, v24, v25
v_mfma_f32_16x16x32_bf16 a[236:239], a[192:195], a[140:143], a[236:239]
v_cvt_pk_bf16_f32 v13, v26, v27
v_lshlrev_b32 v24, 16, v14
v_mfma_f32_16x16x32_bf16 v[236:239], a[164:167], a[140:143], v[236:239]
ds_read_b128 a[140:143], v2 offset:35840
v_and_b32 v25, s33, v14
v_mfma_f32_16x16x32_bf16 v[236:239], a[196:199], a[108:111], v[236:239]
ds_read_b128 a[108:111], v1 offset:35840
v_lshlrev_b32 v26, 16, v15
v_mfma_f32_16x16x32_bf16 v[240:243], a[196:199], a[112:115], v[240:243]
v_and_b32 v27, s33, v15
v_mul_f32 v24, v24, v132
v_mfma_f32_16x16x32_bf16 v[240:243], a[164:167], a[144:147], v[240:243]
v_mul_f32 v25, v25, v133
v_mul_f32 v26, v26, v134
v_mfma_f32_16x16x32_bf16 a[240:243], a[192:195], a[144:147], a[240:243]
ds_read_b128 a[144:147], v2 offset:36864
v_mul_f32 v27, v27, v135
v_mfma_f32_16x16x32_bf16 a[240:243], a[160:163], a[112:115], a[240:243]
ds_read_b128 a[112:115], v1 offset:36864
v_cvt_pk_bf16_f32 v14, v24, v25
v_mfma_f32_16x16x32_bf16 a[244:247], a[160:163], a[116:119], a[244:247]
v_cvt_pk_bf16_f32 v15, v26, v27
ds_write_b128 v6, v[12:15] offset:33792
v_mfma_f32_16x16x32_bf16 a[244:247], a[192:195], a[148:151], a[244:247]
buffer_store_dwordx4 v[12:15], v6, s[20:23], s54 offen offset:1024 sc1
v_accvgpr_read_b32 v16, a40
v_mfma_f32_16x16x32_bf16 v[244:247], a[164:167], a[148:151], v[244:247]
ds_read_b128 a[148:151], v2 offset:37888
v_accvgpr_read_b32 v17, a41
v_mfma_f32_16x16x32_bf16 v[244:247], a[196:199], a[116:119], v[244:247]
ds_read_b128 a[116:119], v1 offset:37888
v_accvgpr_read_b32 v18, a42
v_mfma_f32_16x16x32_bf16 v[248:251], a[196:199], a[120:123], v[248:251]
v_accvgpr_read_b32 v19, a43
v_lshlrev_b32 v24, 16, v16
v_mfma_f32_16x16x32_bf16 v[248:251], a[164:167], a[152:155], v[248:251]
v_and_b32 v25, s33, v16
v_lshlrev_b32 v26, 16, v17
v_mfma_f32_16x16x32_bf16 a[248:251], a[192:195], a[152:155], a[248:251]
ds_read_b128 a[152:155], v2 offset:38912
v_and_b32 v27, s33, v17
v_mfma_f32_16x16x32_bf16 a[248:251], a[160:163], a[120:123], a[248:251]
ds_read_b128 a[120:123], v1 offset:38912
v_mul_f32 v24, v24, v104
v_mfma_f32_16x16x32_bf16 a[252:255], a[160:163], a[124:127], a[252:255]
buffer_load_dwordx4 a[160:163], v0, s[20:23], s30 offen offset:0 sc1
v_mul_f32 v25, v25, v105
v_mfma_f32_16x16x32_bf16 a[252:255], a[192:195], a[156:159], a[252:255]
buffer_load_dwordx4 a[192:195], v0, s[20:23], s30 offen offset:1024 sc1
v_mul_f32 v26, v26, v106
v_mfma_f32_16x16x32_bf16 v[252:255], a[164:167], a[156:159], v[252:255]
buffer_load_dwordx4 a[164:167], v0, s[20:23], s30 offen offset:2048 sc1
ds_read_b128 a[156:159], v2 offset:39936
v_mfma_f32_16x16x32_bf16 v[252:255], a[196:199], a[124:127], v[252:255]
buffer_load_dwordx4 a[196:199], v0, s[20:23], s30 offen offset:3072 sc1
s_add_u32 s30, s30, 0x1000
ds_read_b128 a[124:127], v1 offset:39936
s_waitcnt vmcnt(17) lgkmcnt(15)
v_mfma_f32_16x16x32_bf16 v[160:163], a[204:207], a[96:99], v[160:163]
v_mul_f32 v27, v27, v107
v_mfma_f32_16x16x32_bf16 v[160:163], a[172:175], a[128:131], v[160:163]
v_cvt_pk_bf16_f32 v16, v24, v25
v_cvt_pk_bf16_f32 v17, v26, v27
v_mfma_f32_16x16x32_bf16 v[192:195], a[200:203], a[128:131], v[192:195]
v_lshlrev_b32 v24, 16, v18
v_and_b32 v25, s33, v18
v_mfma_f32_16x16x32_bf16 v[192:195], a[168:171], a[96:99], v[192:195]
v_lshlrev_b32 v26, 16, v19
v_and_b32 v27, s33, v19
s_waitcnt lgkmcnt(13)
v_mfma_f32_16x16x32_bf16 v[196:199], a[168:171], a[100:103], v[196:199]
v_mul_f32 v24, v24, v136
v_mfma_f32_16x16x32_bf16 v[196:199], a[200:203], a[132:135], v[196:199]
v_mul_f32 v25, v25, v137
v_mul_f32 v26, v26, v138
v_mfma_f32_16x16x32_bf16 v[164:167], a[172:175], a[132:135], v[164:167]
v_mul_f32 v27, v27, v139
v_cvt_pk_bf16_f32 v18, v24, v25
v_mfma_f32_16x16x32_bf16 v[164:167], a[204:207], a[100:103], v[164:167]
v_cvt_pk_bf16_f32 v19, v26, v27
ds_write_b128 v6, v[16:19] offset:34816
s_waitcnt lgkmcnt(12)
v_mfma_f32_16x16x32_bf16 v[168:171], a[204:207], a[104:107], v[168:171]
buffer_store_dwordx4 v[16:19], v6, s[20:23], s54 offen offset:2048 sc1
v_mfma_f32_16x16x32_bf16 v[168:171], a[172:175], a[136:139], v[168:171]
v_accvgpr_read_b32 v20, a44
v_accvgpr_read_b32 v21, a45
v_mfma_f32_16x16x32_bf16 v[200:203], a[200:203], a[136:139], v[200:203]
v_accvgpr_read_b32 v22, a46
v_accvgpr_read_b32 v23, a47
v_mfma_f32_16x16x32_bf16 v[200:203], a[168:171], a[104:107], v[200:203]
v_lshlrev_b32 v24, 16, v20
v_and_b32 v25, s33, v20
s_waitcnt lgkmcnt(10)
v_mfma_f32_16x16x32_bf16 v[204:207], a[168:171], a[108:111], v[204:207]
v_lshlrev_b32 v26, 16, v21
v_mfma_f32_16x16x32_bf16 v[204:207], a[200:203], a[140:143], v[204:207]
v_and_b32 v27, s33, v21
v_mul_f32 v24, v24, v108
v_mfma_f32_16x16x32_bf16 v[172:175], a[172:175], a[140:143], v[172:175]
v_mul_f32 v25, v25, v109
v_mul_f32 v26, v26, v110
v_mfma_f32_16x16x32_bf16 v[172:175], a[204:207], a[108:111], v[172:175]
v_mul_f32 v27, v27, v111
v_cvt_pk_bf16_f32 v20, v24, v25
s_waitcnt lgkmcnt(8)
v_mfma_f32_16x16x32_bf16 v[176:179], a[204:207], a[112:115], v[176:179]
v_cvt_pk_bf16_f32 v21, v26, v27
v_mfma_f32_16x16x32_bf16 v[176:179], a[172:175], a[144:147], v[176:179]
v_lshlrev_b32 v24, 16, v22
v_and_b32 v25, s33, v22
v_mfma_f32_16x16x32_bf16 v[208:211], a[200:203], a[144:147], v[208:211]
v_lshlrev_b32 v26, 16, v23
v_and_b32 v27, s33, v23
v_mfma_f32_16x16x32_bf16 v[208:211], a[168:171], a[112:115], v[208:211]
v_mul_f32 v24, v24, v140
v_mul_f32 v25, v25, v141
s_waitcnt lgkmcnt(5)
v_mfma_f32_16x16x32_bf16 v[212:215], a[168:171], a[116:119], v[212:215]
v_mul_f32 v26, v26, v142
v_mfma_f32_16x16x32_bf16 v[212:215], a[200:203], a[148:151], v[212:215]
v_mul_f32 v27, v27, v143
v_cvt_pk_bf16_f32 v22, v24, v25
v_mfma_f32_16x16x32_bf16 v[180:183], a[172:175], a[148:151], v[180:183]
v_cvt_pk_bf16_f32 v23, v26, v27
ds_write_b128 v6, v[20:23] offset:35840
v_mfma_f32_16x16x32_bf16 v[180:183], a[204:207], a[116:119], v[180:183]
buffer_store_dwordx4 v[20:23], v6, s[20:23], s54 offen offset:3072 sc1
v_accvgpr_read_b32 v12, a48
s_waitcnt lgkmcnt(4)
v_mfma_f32_16x16x32_bf16 v[184:187], a[204:207], a[120:123], v[184:187]
v_accvgpr_read_b32 v13, a49
v_mfma_f32_16x16x32_bf16 v[184:187], a[172:175], a[152:155], v[184:187]
v_accvgpr_read_b32 v14, a50
v_accvgpr_read_b32 v15, a51
v_mfma_f32_16x16x32_bf16 v[216:219], a[200:203], a[152:155], v[216:219]
v_lshlrev_b32 v24, 16, v12
v_and_b32 v25, s33, v12
v_mfma_f32_16x16x32_bf16 v[216:219], a[168:171], a[120:123], v[216:219]
v_lshlrev_b32 v26, 16, v13
v_and_b32 v27, s33, v13
s_waitcnt lgkmcnt(2)
v_mfma_f32_16x16x32_bf16 v[220:223], a[168:171], a[124:127], v[220:223]
buffer_load_dwordx4 a[168:171], v0, s[20:23], s30 offen offset:0 sc1
v_mfma_f32_16x16x32_bf16 v[220:223], a[200:203], a[156:159], v[220:223]
buffer_load_dwordx4 a[200:203], v0, s[20:23], s30 offen offset:1024 sc1
v_mul_f32 v24, v24, v112
v_mfma_f32_16x16x32_bf16 v[188:191], a[172:175], a[156:159], v[188:191]
buffer_load_dwordx4 a[172:175], v0, s[20:23], s30 offen offset:2048 sc1
v_mul_f32 v25, v25, v113
v_mfma_f32_16x16x32_bf16 v[188:191], a[204:207], a[124:127], v[188:191]
buffer_load_dwordx4 a[204:207], v0, s[20:23], s30 offen offset:3072 sc1
s_add_u32 s30, s30, 0x1000
s_waitcnt vmcnt(18)
v_mfma_f32_16x16x32_bf16 v[224:227], a[208:211], a[96:99], v[224:227]
v_mul_f32 v26, v26, v114
v_mfma_f32_16x16x32_bf16 v[224:227], a[176:179], a[128:131], v[224:227]
v_mul_f32 v27, v27, v115
v_cvt_pk_bf16_f32 v12, v24, v25
v_mfma_f32_16x16x32_bf16 a[224:227], a[180:183], a[128:131], a[224:227]
ds_read_b128 a[128:131], v4 offset:32768
v_cvt_pk_bf16_f32 v13, v26, v27
v_mfma_f32_16x16x32_bf16 a[224:227], a[212:215], a[96:99], a[224:227]
ds_read_b128 a[96:99], v3 offset:32768
v_lshlrev_b32 v24, 16, v14
v_mfma_f32_16x16x32_bf16 a[228:231], a[212:215], a[100:103], a[228:231]
v_and_b32 v25, s33, v14
v_lshlrev_b32 v26, 16, v15
v_mfma_f32_16x16x32_bf16 a[228:231], a[180:183], a[132:135], a[228:231]
v_and_b32 v27, s33, v15
v_mul_f32 v24, v24, v144
v_mfma_f32_16x16x32_bf16 v[228:231], a[176:179], a[132:135], v[228:231]
ds_read_b128 a[132:135], v4 offset:33792
v_mul_f32 v25, v25, v145
v_mfma_f32_16x16x32_bf16 v[228:231], a[208:211], a[100:103], v[228:231]
ds_read_b128 a[100:103], v3 offset:33792
v_mul_f32 v26, v26, v146
v_mfma_f32_16x16x32_bf16 v[232:235], a[208:211], a[104:107], v[232:235]
v_mul_f32 v27, v27, v147
v_cvt_pk_bf16_f32 v14, v24, v25
v_mfma_f32_16x16x32_bf16 v[232:235], a[176:179], a[136:139], v[232:235]
v_cvt_pk_bf16_f32 v15, v26, v27
ds_write_b128 v6, v[12:15] offset:36864
v_mfma_f32_16x16x32_bf16 a[232:235], a[180:183], a[136:139], a[232:235]
ds_read_b128 a[136:139], v4 offset:34816
buffer_store_dwordx4 v[12:15], v6, s[20:23], s55 offen offset:0 sc1
v_mfma_f32_16x16x32_bf16 a[232:235], a[212:215], a[104:107], a[232:235]
ds_read_b128 a[104:107], v3 offset:34816
v_accvgpr_read_b32 v16, a52
v_mfma_f32_16x16x32_bf16 a[236:239], a[212:215], a[108:111], a[236:239]
v_accvgpr_read_b32 v17, a53
v_accvgpr_read_b32 v18, a54
v_mfma_f32_16x16x32_bf16 a[236:239], a[180:183], a[140:143], a[236:239]
v_accvgpr_read_b32 v19, a55
v_lshlrev_b32 v24, 16, v16
v_mfma_f32_16x16x32_bf16 v[236:239], a[176:179], a[140:143], v[236:239]
ds_read_b128 a[140:143], v4 offset:35840
v_and_b32 v25, s33, v16
v_mfma_f32_16x16x32_bf16 v[236:239], a[208:211], a[108:111], v[236:239]
ds_read_b128 a[108:111], v3 offset:35840
v_lshlrev_b32 v26, 16, v17
v_mfma_f32_16x16x32_bf16 v[240:243], a[208:211], a[112:115], v[240:243]
v_and_b32 v27, s33, v17
v_mul_f32 v24, v24, v116
v_mfma_f32_16x16x32_bf16 v[240:243], a[176:179], a[144:147], v[240:243]
v_mul_f32 v25, v25, v117
v_mul_f32 v26, v26, v118
v_mfma_f32_16x16x32_bf16 a[240:243], a[180:183], a[144:147], a[240:243]
ds_read_b128 a[144:147], v4 offset:36864
v_mul_f32 v27, v27, v119
v_mfma_f32_16x16x32_bf16 a[240:243], a[212:215], a[112:115], a[240:243]
ds_read_b128 a[112:115], v3 offset:36864
v_cvt_pk_bf16_f32 v16, v24, v25
v_mfma_f32_16x16x32_bf16 a[244:247], a[212:215], a[116:119], a[244:247]
v_cvt_pk_bf16_f32 v17, v26, v27
v_lshlrev_b32 v24, 16, v18
v_mfma_f32_16x16x32_bf16 a[244:247], a[180:183], a[148:151], a[244:247]
v_and_b32 v25, s33, v18
v_lshlrev_b32 v26, 16, v19
v_mfma_f32_16x16x32_bf16 v[244:247], a[176:179], a[148:151], v[244:247]
ds_read_b128 a[148:151], v4 offset:37888
v_and_b32 v27, s33, v19
v_mfma_f32_16x16x32_bf16 v[244:247], a[208:211], a[116:119], v[244:247]
ds_read_b128 a[116:119], v3 offset:37888
v_mul_f32 v24, v24, v148
v_mfma_f32_16x16x32_bf16 v[248:251], a[208:211], a[120:123], v[248:251]
v_mul_f32 v25, v25, v149
v_mul_f32 v26, v26, v150
v_mfma_f32_16x16x32_bf16 v[248:251], a[176:179], a[152:155], v[248:251]
v_mul_f32 v27, v27, v151
v_cvt_pk_bf16_f32 v18, v24, v25
v_mfma_f32_16x16x32_bf16 a[248:251], a[180:183], a[152:155], a[248:251]
ds_read_b128 a[152:155], v4 offset:38912
v_cvt_pk_bf16_f32 v19, v26, v27
v_mfma_f32_16x16x32_bf16 a[248:251], a[212:215], a[120:123], a[248:251]
ds_read_b128 a[120:123], v3 offset:38912
ds_write_b128 v6, v[16:19] offset:37888
v_mfma_f32_16x16x32_bf16 a[252:255], a[212:215], a[124:127], a[252:255]
buffer_load_dwordx4 a[212:215], v0, s[20:23], s30 offen offset:0 sc1
buffer_store_dwordx4 v[16:19], v6, s[20:23], s55 offen offset:1024 sc1
v_mfma_f32_16x16x32_bf16 a[252:255], a[180:183], a[156:159], a[252:255]
buffer_load_dwordx4 a[180:183], v0, s[20:23], s30 offen offset:1024 sc1
v_accvgpr_read_b32 v20, a56
v_mfma_f32_16x16x32_bf16 v[252:255], a[176:179], a[156:159], v[252:255]
buffer_load_dwordx4 a[176:179], v0, s[20:23], s30 offen offset:2048 sc1
ds_read_b128 a[156:159], v4 offset:39936
v_mfma_f32_16x16x32_bf16 v[252:255], a[208:211], a[124:127], v[252:255]
buffer_load_dwordx4 a[208:211], v0, s[20:23], s30 offen offset:3072 sc1
s_add_u32 s30, s30, 0x3000
ds_read_b128 a[124:127], v3 offset:39936
s_waitcnt vmcnt(18) lgkmcnt(15)
v_mfma_f32_16x16x32_bf16 v[160:163], a[216:219], a[96:99], v[160:163]
v_accvgpr_read_b32 v21, a57
v_mfma_f32_16x16x32_bf16 v[160:163], a[184:187], a[128:131], v[160:163]
v_accvgpr_read_b32 v22, a58
v_accvgpr_read_b32 v23, a59
v_mfma_f32_16x16x32_bf16 v[192:195], a[188:191], a[128:131], v[192:195]
v_lshlrev_b32 v24, 16, v20
v_and_b32 v25, s33, v20
v_mfma_f32_16x16x32_bf16 v[192:195], a[220:223], a[96:99], v[192:195]
v_lshlrev_b32 v26, 16, v21
v_and_b32 v27, s33, v21
s_waitcnt lgkmcnt(14)
v_mfma_f32_16x16x32_bf16 v[196:199], a[220:223], a[100:103], v[196:199]
v_mul_f32 v24, v24, v120
v_mfma_f32_16x16x32_bf16 v[196:199], a[188:191], a[132:135], v[196:199]
v_mul_f32 v25, v25, v121
v_mul_f32 v26, v26, v122
v_mfma_f32_16x16x32_bf16 v[164:167], a[184:187], a[132:135], v[164:167]
v_mul_f32 v27, v27, v123
v_cvt_pk_bf16_f32 v20, v24, v25
v_mfma_f32_16x16x32_bf16 v[164:167], a[216:219], a[100:103], v[164:167]
v_cvt_pk_bf16_f32 v21, v26, v27
v_lshlrev_b32 v24, 16, v22
s_waitcnt lgkmcnt(11)
v_mfma_f32_16x16x32_bf16 v[168:171], a[216:219], a[104:107], v[168:171]
v_and_b32 v25, s33, v22
v_mfma_f32_16x16x32_bf16 v[168:171], a[184:187], a[136:139], v[168:171]
v_lshlrev_b32 v26, 16, v23
v_and_b32 v27, s33, v23
v_mfma_f32_16x16x32_bf16 v[200:203], a[188:191], a[136:139], v[200:203]
v_mul_f32 v24, v24, v152
v_mul_f32 v25, v25, v153
v_mfma_f32_16x16x32_bf16 v[200:203], a[220:223], a[104:107], v[200:203]
v_mul_f32 v26, v26, v154
v_mul_f32 v27, v27, v155
s_waitcnt lgkmcnt(9)
v_mfma_f32_16x16x32_bf16 v[204:207], a[220:223], a[108:111], v[204:207]
v_cvt_pk_bf16_f32 v22, v24, v25
v_mfma_f32_16x16x32_bf16 v[204:207], a[188:191], a[140:143], v[204:207]
v_cvt_pk_bf16_f32 v23, v26, v27
ds_write_b128 v6, v[20:23] offset:38912
v_mfma_f32_16x16x32_bf16 v[172:175], a[184:187], a[140:143], v[172:175]
buffer_store_dwordx4 v[20:23], v6, s[20:23], s55 offen offset:2048 sc1
v_accvgpr_read_b32 v12, a60
v_mfma_f32_16x16x32_bf16 v[172:175], a[216:219], a[108:111], v[172:175]
v_accvgpr_read_b32 v13, a61
v_accvgpr_read_b32 v14, a62
s_waitcnt lgkmcnt(8)
v_mfma_f32_16x16x32_bf16 v[176:179], a[216:219], a[112:115], v[176:179]
v_accvgpr_read_b32 v15, a63
v_mfma_f32_16x16x32_bf16 v[176:179], a[184:187], a[144:147], v[176:179]
v_lshlrev_b32 v24, 16, v12
v_and_b32 v25, s33, v12
v_mfma_f32_16x16x32_bf16 v[208:211], a[188:191], a[144:147], v[208:211]
v_lshlrev_b32 v26, 16, v13
v_and_b32 v27, s33, v13
v_mfma_f32_16x16x32_bf16 v[208:211], a[220:223], a[112:115], v[208:211]
v_mul_f32 v24, v24, v124
v_mul_f32 v25, v25, v125
s_waitcnt lgkmcnt(6)
v_mfma_f32_16x16x32_bf16 v[212:215], a[220:223], a[116:119], v[212:215]
v_mul_f32 v26, v26, v126
v_mfma_f32_16x16x32_bf16 v[212:215], a[188:191], a[148:151], v[212:215]
v_mul_f32 v27, v27, v127
v_cvt_pk_bf16_f32 v12, v24, v25
v_mfma_f32_16x16x32_bf16 v[180:183], a[184:187], a[148:151], v[180:183]
v_cvt_pk_bf16_f32 v13, v26, v27
v_lshlrev_b32 v24, 16, v14
v_mfma_f32_16x16x32_bf16 v[180:183], a[216:219], a[116:119], v[180:183]
v_and_b32 v25, s33, v14
v_lshlrev_b32 v26, 16, v15
s_waitcnt lgkmcnt(4)
v_mfma_f32_16x16x32_bf16 v[184:187], a[216:219], a[120:123], v[184:187]
v_and_b32 v27, s33, v15
v_mfma_f32_16x16x32_bf16 v[184:187], a[184:187], a[152:155], v[184:187]
v_mul_f32 v24, v24, v156
v_mul_f32 v25, v25, v157
v_mfma_f32_16x16x32_bf16 v[216:219], a[188:191], a[152:155], v[216:219]
v_mul_f32 v26, v26, v158
v_mul_f32 v27, v27, v159
v_mfma_f32_16x16x32_bf16 v[216:219], a[220:223], a[120:123], v[216:219]
v_cvt_pk_bf16_f32 v14, v24, v25
v_cvt_pk_bf16_f32 v15, v26, v27
s_waitcnt lgkmcnt(1)
v_mfma_f32_16x16x32_bf16 v[220:223], a[220:223], a[124:127], v[220:223]
buffer_load_dwordx4 a[220:223], v0, s[20:23], s30 offen offset:0 sc1
v_mfma_f32_16x16x32_bf16 v[220:223], a[188:191], a[156:159], v[220:223]
buffer_load_dwordx4 a[188:191], v0, s[20:23], s30 offen offset:1024 sc1
ds_write_b128 v6, v[12:15] offset:39936
v_mfma_f32_16x16x32_bf16 v[188:191], a[184:187], a[156:159], v[188:191]
buffer_load_dwordx4 a[184:187], v0, s[20:23], s30 offen offset:2048 sc1
buffer_store_dwordx4 v[12:15], v6, s[20:23], s55 offen offset:3072 sc1
v_mfma_f32_16x16x32_bf16 v[188:191], a[216:219], a[124:127], v[188:191]
buffer_load_dwordx4 a[216:219], v0, s[20:23], s30 offen offset:3072 sc1
s_add_u32 s30, s30, 0x1000
s_barrier
s_waitcnt vmcnt(18)
v_mfma_f32_16x16x32_bf16 v[224:227], a[160:163], a[96:99], v[224:227]
v_mfma_f32_16x16x32_bf16 v[224:227], a[192:195], a[128:131], v[224:227]
v_accvgpr_read_b32 v16, a64
v_accvgpr_read_b32 v17, a65
v_mfma_f32_16x16x32_bf16 a[224:227], a[196:199], a[128:131], a[224:227]
v_xor_b32 v2, 0x2000, v6
ds_read_b128 a[128:131], v2 offset:0
v_mfma_f32_16x16x32_bf16 a[224:227], a[164:167], a[96:99], a[224:227]
v_xor_b32 v1, 0x0, v6
ds_read_b128 a[96:99], v1 offset:0
v_mfma_f32_16x16x32_bf16 a[228:231], a[164:167], a[100:103], a[228:231]
v_accvgpr_read_b32 v18, a66
v_accvgpr_read_b32 v19, a67
v_mfma_f32_16x16x32_bf16 a[228:231], a[196:199], a[132:135], a[228:231]
v_lshlrev_b32 v24, 16, v16
v_and_b32 v25, s33, v16
v_mfma_f32_16x16x32_bf16 v[228:231], a[192:195], a[132:135], v[228:231]
ds_read_b128 a[132:135], v2 offset:1024
v_lshlrev_b32 v26, 16, v17
v_mfma_f32_16x16x32_bf16 v[228:231], a[160:163], a[100:103], v[228:231]
ds_read_b128 a[100:103], v1 offset:1024
v_and_b32 v27, s33, v17
v_mfma_f32_16x16x32_bf16 v[232:235], a[160:163], a[104:107], v[232:235]
v_mul_f32 v24, v24, v160
v_mul_f32 v25, v25, v161
v_mfma_f32_16x16x32_bf16 v[232:235], a[192:195], a[136:139], v[232:235]
v_mul_f32 v26, v26, v162
v_mul_f32 v27, v27, v163
v_mfma_f32_16x16x32_bf16 a[232:235], a[196:199], a[136:139], a[232:235]
ds_read_b128 a[136:139], v2 offset:2048
v_cvt_pk_bf16_f32 v16, v24, v25
v_mfma_f32_16x16x32_bf16 a[232:235], a[164:167], a[104:107], a[232:235]
ds_read_b128 a[104:107], v1 offset:2048
v_cvt_pk_bf16_f32 v17, v26, v27
v_mfma_f32_16x16x32_bf16 a[236:239], a[164:167], a[108:111], a[236:239]
v_lshlrev_b32 v24, 16, v18
v_and_b32 v25, s33, v18
v_mfma_f32_16x16x32_bf16 a[236:239], a[196:199], a[140:143], a[236:239]
v_lshlrev_b32 v26, 16, v19
v_and_b32 v27, s33, v19
v_mfma_f32_16x16x32_bf16 v[236:239], a[192:195], a[140:143], v[236:239]
ds_read_b128 a[140:143], v2 offset:3072
v_mul_f32 v24, v24, v192
v_mfma_f32_16x16x32_bf16 v[236:239], a[160:163], a[108:111], v[236:239]
ds_read_b128 a[108:111], v1 offset:3072
v_mul_f32 v25, v25, v193
v_mfma_f32_16x16x32_bf16 v[240:243], a[160:163], a[112:115], v[240:243]
v_mul_f32 v26, v26, v194
v_mul_f32 v27, v27, v195
v_mfma_f32_16x16x32_bf16 v[240:243], a[192:195], a[144:147], v[240:243]
v_cvt_pk_bf16_f32 v18, v24, v25
v_cvt_pk_bf16_f32 v19, v26, v27
v_mfma_f32_16x16x32_bf16 a[240:243], a[196:199], a[144:147], a[240:243]
ds_read_b128 a[144:147], v2 offset:4096
ds_write_b128 v7, v[16:19] offset:0
v_mfma_f32_16x16x32_bf16 a[240:243], a[164:167], a[112:115], a[240:243]
ds_read_b128 a[112:115], v1 offset:4096
buffer_store_dwordx4 v[16:19], v7, s[20:23], s52 offen offset:0 sc1
v_mfma_f32_16x16x32_bf16 a[244:247], a[164:167], a[116:119], a[244:247]
v_accvgpr_read_b32 v20, a68
v_accvgpr_read_b32 v21, a69
v_mfma_f32_16x16x32_bf16 a[244:247], a[196:199], a[148:151], a[244:247]
v_accvgpr_read_b32 v22, a70
v_accvgpr_read_b32 v23, a71
v_mfma_f32_16x16x32_bf16 v[244:247], a[192:195], a[148:151], v[244:247]
ds_read_b128 a[148:151], v2 offset:5120
v_lshlrev_b32 v24, 16, v20
v_mfma_f32_16x16x32_bf16 v[244:247], a[160:163], a[116:119], v[244:247]
ds_read_b128 a[116:119], v1 offset:5120
v_and_b32 v25, s33, v20
v_mfma_f32_16x16x32_bf16 v[248:251], a[160:163], a[120:123], v[248:251]
v_lshlrev_b32 v26, 16, v21
v_and_b32 v27, s33, v21
v_mfma_f32_16x16x32_bf16 v[248:251], a[192:195], a[152:155], v[248:251]
v_mul_f32 v24, v24, v164
v_mul_f32 v25, v25, v165
v_mfma_f32_16x16x32_bf16 a[248:251], a[196:199], a[152:155], a[248:251]
ds_read_b128 a[152:155], v2 offset:6144
v_mul_f32 v26, v26, v166
v_mfma_f32_16x16x32_bf16 a[248:251], a[164:167], a[120:123], a[248:251]
ds_read_b128 a[120:123], v1 offset:6144
v_mul_f32 v27, v27, v167
v_mfma_f32_16x16x32_bf16 a[252:255], a[164:167], a[124:127], a[252:255]
buffer_load_dwordx4 a[164:167], v0, s[20:23], s30 offen offset:0 sc1
v_cvt_pk_bf16_f32 v20, v24, v25
v_mfma_f32_16x16x32_bf16 a[252:255], a[196:199], a[156:159], a[252:255]
buffer_load_dwordx4 a[196:199], v0, s[20:23], s30 offen offset:1024 sc1
v_cvt_pk_bf16_f32 v21, v26, v27
v_mfma_f32_16x16x32_bf16 v[252:255], a[192:195], a[156:159], v[252:255]
buffer_load_dwordx4 a[192:195], v0, s[20:23], s30 offen offset:2048 sc1
ds_read_b128 a[156:159], v2 offset:7168
v_mfma_f32_16x16x32_bf16 v[252:255], a[160:163], a[124:127], v[252:255]
buffer_load_dwordx4 a[160:163], v0, s[20:23], s30 offen offset:3072 sc1
s_add_u32 s30, s30, 0x3000
ds_read_b128 a[124:127], v1 offset:7168
L_q4:
s_waitcnt vmcnt(17) lgkmcnt(15)
v_mfma_f32_16x16x32_bf16 v[32:35], a[168:171], a[96:99], v[32:35]
v_lshlrev_b32 v24, 16, v22
v_mfma_f32_16x16x32_bf16 v[32:35], a[200:203], a[128:131], v[32:35]
v_and_b32 v25, s33, v22
v_lshlrev_b32 v26, 16, v23
v_mfma_f32_16x16x32_bf16 v[64:67], a[204:207], a[128:131], v[64:67]
v_and_b32 v27, s33, v23
v_mul_f32 v24, v24, v196
v_mfma_f32_16x16x32_bf16 v[64:67], a[172:175], a[96:99], v[64:67]
v_mul_f32 v25, v25, v197
v_mul_f32 v26, v26, v198
s_waitcnt lgkmcnt(13)
v_mfma_f32_16x16x32_bf16 v[68:71], a[172:175], a[100:103], v[68:71]
v_mul_f32 v27, v27, v199
v_mfma_f32_16x16x32_bf16 v[68:71], a[204:207], a[132:135], v[68:71]
v_cvt_pk_bf16_f32 v22, v24, v25
v_cvt_pk_bf16_f32 v23, v26, v27
v_mfma_f32_16x16x32_bf16 v[36:39], a[200:203], a[132:135], v[36:39]
ds_write_b128 v7, v[20:23] offset:1024
buffer_store_dwordx4 v[20:23], v7, s[20:23], s52 offen offset:1024 sc1
v_mfma_f32_16x16x32_bf16 v[36:39], a[168:171], a[100:103], v[36:39]
v_accvgpr_read_b32 v12, a72
v_accvgpr_read_b32 v13, a73
s_waitcnt lgkmcnt(12)
v_mfma_f32_16x16x32_bf16 v[40:43], a[168:171], a[104:107], v[40:43]
v_accvgpr_read_b32 v14, a74
v_mfma_f32_16x16x32_bf16 v[40:43], a[200:203], a[136:139], v[40:43]
v_accvgpr_read_b32 v15, a75
v_lshlrev_b32 v24, 16, v12
v_mfma_f32_16x16x32_bf16 v[72:75], a[204:207], a[136:139], v[72:75]
v_and_b32 v25, s33, v12
v_lshlrev_b32 v26, 16, v13
v_mfma_f32_16x16x32_bf16 v[72:75], a[172:175], a[104:107], v[72:75]
v_and_b32 v27, s33, v13
v_mul_f32 v24, v24, v168
s_waitcnt lgkmcnt(10)
v_mfma_f32_16x16x32_bf16 v[76:79], a[172:175], a[108:111], v[76:79]
v_mul_f32 v25, v25, v169
v_mfma_f32_16x16x32_bf16 v[76:79], a[204:207], a[140:143], v[76:79]
v_mul_f32 v26, v26, v170
v_mul_f32 v27, v27, v171
v_mfma_f32_16x16x32_bf16 v[44:47], a[200:203], a[140:143], v[44:47]
v_cvt_pk_bf16_f32 v12, v24, v25
v_cvt_pk_bf16_f32 v13, v26, v27
v_mfma_f32_16x16x32_bf16 v[44:47], a[168:171], a[108:111], v[44:47]
v_lshlrev_b32 v24, 16, v14
v_and_b32 v25, s33, v14
s_waitcnt lgkmcnt(7)
v_mfma_f32_16x16x32_bf16 v[48:51], a[168:171], a[112:115], v[48:51]
v_lshlrev_b32 v26, 16, v15
v_mfma_f32_16x16x32_bf16 v[48:51], a[200:203], a[144:147], v[48:51]
v_and_b32 v27, s33, v15
v_mul_f32 v24, v24, v200
v_mfma_f32_16x16x32_bf16 v[80:83], a[204:207], a[144:147], v[80:83]
v_mul_f32 v25, v25, v201
v_mul_f32 v26, v26, v202
v_mfma_f32_16x16x32_bf16 v[80:83], a[172:175], a[112:115], v[80:83]
v_mul_f32 v27, v27, v203
v_cvt_pk_bf16_f32 v14, v24, v25
s_waitcnt lgkmcnt(5)
v_mfma_f32_16x16x32_bf16 v[84:87], a[172:175], a[116:119], v[84:87]
v_cvt_pk_bf16_f32 v15, v26, v27
v_mfma_f32_16x16x32_bf16 v[84:87], a[204:207], a[148:151], v[84:87]
ds_write_b128 v7, v[12:15] offset:2048
buffer_store_dwordx4 v[12:15], v7, s[20:23], s52 offen offset:2048 sc1
v_mfma_f32_16x16x32_bf16 v[52:55], a[200:203], a[148:151], v[52:55]
v_accvgpr_read_b32 v16, a76
v_accvgpr_read_b32 v17, a77
v_mfma_f32_16x16x32_bf16 v[52:55], a[168:171], a[116:119], v[52:55]
v_accvgpr_read_b32 v18, a78
v_accvgpr_read_b32 v19, a79
s_waitcnt lgkmcnt(4)
v_mfma_f32_16x16x32_bf16 v[56:59], a[168:171], a[120:123], v[56:59]
v_lshlrev_b32 v24, 16, v16
v_mfma_f32_16x16x32_bf16 v[56:59], a[200:203], a[152:155], v[56:59]
v_and_b32 v25, s33, v16
v_lshlrev_b32 v26, 16, v17
v_mfma_f32_16x16x32_bf16 v[88:91], a[204:207], a[152:155], v[88:91]
v_and_b32 v27, s33, v17
v_mul_f32 v24, v24, v172
v_mfma_f32_16x16x32_bf16 v[88:91], a[172:175], a[120:123], v[88:91]
v_mul_f32 v25, v25, v173
v_mul_f32 v26, v26, v174
s_waitcnt lgkmcnt(2)
v_mfma_f32_16x16x32_bf16 v[92:95], a[172:175], a[124:127], v[92:95]
buffer_load_dwordx4 a[172:175], v0, s[20:23], s30 offen offset:0 sc1
v_mfma_f32_16x16x32_bf16 v[92:95], a[204:207], a[156:159], v[92:95]
buffer_load_dwordx4 a[204:207], v0, s[20:23], s30 offen offset:1024 sc1
v_mul_f32 v27, v27, v175
v_mfma_f32_16x16x32_bf16 v[60:63], a[200:203], a[156:159], v[60:63]
buffer_load_dwordx4 a[200:203], v0, s[20:23], s30 offen offset:2048 sc1
v_cvt_pk_bf16_f32 v16, v24, v25
v_mfma_f32_16x16x32_bf16 v[60:63], a[168:171], a[124:127], v[60:63]
buffer_load_dwordx4 a[168:171], v0, s[20:23], s30 offen offset:3072 sc1
s_add_u32 s30, s30, 0x1000
s_waitcnt vmcnt(17)
v_mfma_f32_16x16x32_bf16 v[96:99], a[212:215], a[96:99], v[96:99]
v_cvt_pk_bf16_f32 v17, v26, v27
s_add_u32 s96, s92, L_q6-L_pc
s_addc_u32 s97, s93, 0
s_load_dword s98, s[96:97], 0
v_mfma_f32_16x16x32_bf16 v[96:99], a[180:183], a[128:131], v[96:99]
v_mfma_f32_16x16x32_bf16 v[128:131], a[208:211], a[128:131], v[128:131]
v_xor_b32 v4, 0x6000, v6
ds_read_b128 a[128:131], v4 offset:0
v_mfma_f32_16x16x32_bf16 v[128:131], a[176:179], a[96:99], v[128:131]
v_xor_b32 v3, 0x4000, v6
ds_read_b128 a[96:99], v3 offset:0
v_mfma_f32_16x16x32_bf16 v[132:135], a[176:179], a[100:103], v[132:135]
v_lshlrev_b32 v24, 16, v18
v_and_b32 v25, s33, v18
v_mfma_f32_16x16x32_bf16 v[132:135], a[208:211], a[132:135], v[132:135]
v_lshlrev_b32 v26, 16, v19
v_and_b32 v27, s33, v19
v_mfma_f32_16x16x32_bf16 v[100:103], a[180:183], a[132:135], v[100:103]
ds_read_b128 a[132:135], v4 offset:1024
v_mul_f32 v24, v24, v204
v_mfma_f32_16x16x32_bf16 v[100:103], a[212:215], a[100:103], v[100:103]
ds_read_b128 a[100:103], v3 offset:1024
v_mul_f32 v25, v25, v205
v_mfma_f32_16x16x32_bf16 v[104:107], a[212:215], a[104:107], v[104:107]
v_mul_f32 v26, v26, v206
v_mul_f32 v27, v27, v207
v_mfma_f32_16x16x32_bf16 v[104:107], a[180:183], a[136:139], v[104:107]
v_cvt_pk_bf16_f32 v18, v24, v25
v_cvt_pk_bf16_f32 v19, v26, v27
v_mfma_f32_16x16x32_bf16 v[136:139], a[208:211], a[136:139], v[136:139]
ds_read_b128 a[136:139], v4 offset:2048
ds_write_b128 v7, v[16:19] offset:3072
v_mfma_f32_16x16x32_bf16 v[136:139], a[176:179], a[104:107], v[136:139]
ds_read_b128 a[104:107], v3 offset:2048
buffer_store_dwordx4 v[16:19], v7, s[20:23], s52 offen offset:3072 sc1
v_mfma_f32_16x16x32_bf16 v[140:143], a[176:179], a[108:111], v[140:143]
v_accvgpr_read_b32 v20, a80
v_accvgpr_read_b32 v21, a81
v_mfma_f32_16x16x32_bf16 v[140:143], a[208:211], a[140:143], v[140:143]
v_accvgpr_read_b32 v22, a82
v_accvgpr_read_b32 v23, a83
v_mfma_f32_16x16x32_bf16 v[108:111], a[180:183], a[140:143], v[108:111]
ds_read_b128 a[140:143], v4 offset:3072
v_lshlrev_b32 v24, 16, v20
v_mfma_f32_16x16x32_bf16 v[108:111], a[212:215], a[108:111], v[108:111]
ds_read_b128 a[108:111], v3 offset:3072
v_and_b32 v25, s33, v20
v_mfma_f32_16x16x32_bf16 v[112:115], a[212:215], a[112:115], v[112:115]
v_lshlrev_b32 v26, 16, v21
v_and_b32 v27, s33, v21
v_mfma_f32_16x16x32_bf16 v[112:115], a[180:183], a[144:147], v[112:115]
v_mul_f32 v24, v24, v176
v_mul_f32 v25, v25, v177
v_mfma_f32_16x16x32_bf16 v[144:147], a[208:211], a[144:147], v[144:147]
ds_read_b128 a[144:147], v4 offset:4096
v_mul_f32 v26, v26, v178
v_mfma_f32_16x16x32_bf16 v[144:147], a[176:179], a[112:115], v[144:147]
ds_read_b128 a[112:115], v3 offset:4096
v_mul_f32 v27, v27, v179
v_mfma_f32_16x16x32_bf16 v[148:151], a[176:179], a[116:119], v[148:151]
v_cvt_pk_bf16_f32 v20, v24, v25
v_cvt_pk_bf16_f32 v21, v26, v27
v_mfma_f32_16x16x32_bf16 v[148:151], a[208:211], a[148:151], v[148:151]
v_lshlrev_b32 v24, 16, v22
v_and_b32 v25, s33, v22
v_mfma_f32_16x16x32_bf16 v[116:119], a[180:183], a[148:151], v[116:119]
ds_read_b128 a[148:151], v4 offset:5120
v_lshlrev_b32 v26, 16, v23
v_mfma_f32_16x16x32_bf16 v[116:119], a[212:215], a[116:119], v[116:119]
ds_read_b128 a[116:119], v3 offset:5120
v_and_b32 v27, s33, v23
v_mfma_f32_16x16x32_bf16 v[120:123], a[212:215], a[120:123], v[120:123]
v_mul_f32 v24, v24, v208
v_mul_f32 v25, v25, v209
v_mfma_f32_16x16x32_bf16 v[120:123], a[180:183], a[152:155], v[120:123]
v_mul_f32 v26, v26, v210
v_mul_f32 v27, v27, v211
v_mfma_f32_16x16x32_bf16 v[152:155], a[208:211], a[152:155], v[152:155]
ds_read_b128 a[152:155], v4 offset:6144
v_cvt_pk_bf16_f32 v22, v24, v25
v_mfma_f32_16x16x32_bf16 v[152:155], a[176:179], a[120:123], v[152:155]
ds_read_b128 a[120:123], v3 offset:6144
v_cvt_pk_bf16_f32 v23, v26, v27
v_mfma_f32_16x16x32_bf16 v[156:159], a[176:179], a[124:127], v[156:159]
buffer_load_dwordx4 a[176:179], v0, s[20:23], s30 offen offset:0 sc1
ds_write_b128 v7, v[20:23] offset:4096
v_mfma_f32_16x16x32_bf16 v[156:159], a[208:211], a[156:159], v[156:159]
buffer_load_dwordx4 a[208:211], v0, s[20:23], s30 offen offset:1024 sc1
buffer_store_dwordx4 v[20:23], v7, s[20:23], s53 offen offset:0 sc1
v_mfma_f32_16x16x32_bf16 v[124:127], a[180:183], a[156:159], v[124:127]
buffer_load_dwordx4 a[180:183], v0, s[20:23], s30 offen offset:2048 sc1
ds_read_b128 a[156:159], v4 offset:7168
v_mfma_f32_16x16x32_bf16 v[124:127], a[212:215], a[124:127], v[124:127]
buffer_load_dwordx4 a[212:215], v0, s[20:23], s30 offen offset:3072 sc1
s_add_u32 s30, s30, 0x3000
ds_read_b128 a[124:127], v3 offset:7168
s_waitcnt vmcnt(17) lgkmcnt(15)
v_mfma_f32_16x16x32_bf16 v[32:35], a[220:223], a[96:99], v[32:35]
v_accvgpr_read_b32 v12, a84
v_mfma_f32_16x16x32_bf16 v[32:35], a[188:191], a[128:131], v[32:35]
v_accvgpr_read_b32 v13, a85
v_accvgpr_read_b32 v14, a86
v_mfma_f32_16x16x32_bf16 v[64:67], a[216:219], a[128:131], v[64:67]
v_accvgpr_read_b32 v15, a87
v_lshlrev_b32 v24, 16, v12
v_mfma_f32_16x16x32_bf16 v[64:67], a[184:187], a[96:99], v[64:67]
v_and_b32 v25, s33, v12
v_lshlrev_b32 v26, 16, v13
s_waitcnt lgkmcnt(14)
v_mfma_f32_16x16x32_bf16 v[68:71], a[184:187], a[100:103], v[68:71]
v_and_b32 v27, s33, v13
v_mfma_f32_16x16x32_bf16 v[68:71], a[216:219], a[132:135], v[68:71]
v_mul_f32 v24, v24, v180
v_mul_f32 v25, v25, v181
v_mfma_f32_16x16x32_bf16 v[36:39], a[188:191], a[132:135], v[36:39]
v_mul_f32 v26, v26, v182
v_mul_f32 v27, v27, v183
v_mfma_f32_16x16x32_bf16 v[36:39], a[220:223], a[100:103], v[36:39]
v_cvt_pk_bf16_f32 v12, v24, v25
v_cvt_pk_bf16_f32 v13, v26, v27
s_waitcnt lgkmcnt(11)
v_mfma_f32_16x16x32_bf16 v[40:43], a[220:223], a[104:107], v[40:43]
v_lshlrev_b32 v24, 16, v14
v_mfma_f32_16x16x32_bf16 v[40:43], a[188:191], a[136:139], v[40:43]
v_and_b32 v25, s33, v14
v_lshlrev_b32 v26, 16, v15
v_mfma_f32_16x16x32_bf16 v[72:75], a[216:219], a[136:139], v[72:75]
v_and_b32 v27, s33, v15
v_mul_f32 v24, v24, v212
v_mfma_f32_16x16x32_bf16 v[72:75], a[184:187], a[104:107], v[72:75]
v_mul_f32 v25, v25, v213
v_mul_f32 v26, v26, v214
s_waitcnt lgkmcnt(9)
v_mfma_f32_16x16x32_bf16 v[76:79], a[184:187], a[108:111], v[76:79]
v_mul_f32 v27, v27, v215
v_mfma_f32_16x16x32_bf16 v[76:79], a[216:219], a[140:143], v[76:79]
v_cvt_pk_bf16_f32 v14, v24, v25
v_cvt_pk_bf16_f32 v15, v26, v27
v_mfma_f32_16x16x32_bf16 v[44:47], a[188:191], a[140:143], v[44:47]
ds_write_b128 v7, v[12:15] offset:5120
buffer_store_dwordx4 v[12:15], v7, s[20:23], s53 offen offset:1024 sc1
v_mfma_f32_16x16x32_bf16 v[44:47], a[220:223], a[108:111], v[44:47]
v_accvgpr_read_b32 v16, a88
v_accvgpr_read_b32 v17, a89
s_waitcnt lgkmcnt(8)
v_mfma_f32_16x16x32_bf16 v[48:51], a[220:223], a[112:115], v[48:51]
v_accvgpr_read_b32 v18, a90
v_mfma_f32_16x16x32_bf16 v[48:51], a[188:191], a[144:147], v[48:51]
v_accvgpr_read_b32 v19, a91
v_lshlrev_b32 v24, 16, v16
v_mfma_f32_16x16x32_bf16 v[80:83], a[216:219], a[144:147], v[80:83]
v_and_b32 v25, s33, v16
v_lshlrev_b32 v26, 16, v17
v_mfma_f32_16x16x32_bf16 v[80:83], a[184:187], a[112:115], v[80:83]
v_and_b32 v27, s33, v17
ds_read_b128 v[12:15], v8 offset:0
s_waitcnt lgkmcnt(7)
v_mfma_f32_16x16x32_bf16 v[84:87], a[184:187], a[116:119], v[84:87]
v_mul_f32 v24, v24, v184
v_mfma_f32_16x16x32_bf16 v[84:87], a[216:219], a[148:151], v[84:87]
v_mul_f32 v25, v25, v185
v_mul_f32 v26, v26, v186
v_mfma_f32_16x16x32_bf16 v[52:55], a[188:191], a[148:151], v[52:55]
v_mul_f32 v27, v27, v187
v_cvt_pk_bf16_f32 v16, v24, v25
v_mfma_f32_16x16x32_bf16 v[52:55], a[220:223], a[116:119], v[52:55]
v_cvt_pk_bf16_f32 v17, v26, v27
v_lshlrev_b32 v24, 16, v18
s_waitcnt lgkmcnt(5)
v_mfma_f32_16x16x32_bf16 v[56:59], a[220:223], a[120:123], v[56:59]
v_and_b32 v25, s33, v18
v_mfma_f32_16x16x32_bf16 v[56:59], a[188:191], a[152:155], v[56:59]
v_lshlrev_b32 v26, 16, v19
v_and_b32 v27, s33, v19
v_mfma_f32_16x16x32_bf16 v[88:91], a[216:219], a[152:155], v[88:91]
v_mul_f32 v24, v24, v216
v_mul_f32 v25, v25, v217
v_mfma_f32_16x16x32_bf16 v[88:91], a[184:187], a[120:123], v[88:91]
v_mul_f32 v26, v26, v218
v_mul_f32 v27, v27, v219
s_waitcnt lgkmcnt(2)
v_mfma_f32_16x16x32_bf16 v[92:95], a[184:187], a[124:127], v[92:95]
buffer_load_dwordx4 a[184:187], v0, s[20:23], s30 offen offset:0 sc1
v_mfma_f32_16x16x32_bf16 v[92:95], a[216:219], a[156:159], v[92:95]
buffer_load_dwordx4 a[216:219], v0, s[20:23], s30 offen offset:1024 sc1
v_cvt_pk_bf16_f32 v18, v24, v25
v_mfma_f32_16x16x32_bf16 v[60:63], a[188:191], a[156:159], v[60:63]
buffer_load_dwordx4 a[188:191], v0, s[20:23], s30 offen offset:2048 sc1
v_cvt_pk_bf16_f32 v19, v26, v27
v_mfma_f32_16x16x32_bf16 v[60:63], a[220:223], a[124:127], v[60:63]
buffer_load_dwordx4 a[220:223], v0, s[20:23], s30 offen offset:3072 sc1
s_add_u32 s30, s30, 0x1000
s_barrier
s_waitcnt vmcnt(17)
v_mfma_f32_16x16x32_bf16 v[96:99], a[164:167], a[96:99], v[96:99]
v_mfma_f32_16x16x32_bf16 v[96:99], a[196:199], a[128:131], v[96:99]
ds_write_b128 v7, v[16:19] offset:6144
buffer_store_dwordx4 v[16:19], v7, s[20:23], s53 offen offset:2048 sc1
v_mfma_f32_16x16x32_bf16 v[128:131], a[160:163], a[128:131], v[128:131]
ds_read_b128 a[128:131], v2 offset:32768
v_accvgpr_read_b32 v20, a92
v_mfma_f32_16x16x32_bf16 v[128:131], a[192:195], a[96:99], v[128:131]
ds_read_b128 a[96:99], v1 offset:32768
v_accvgpr_read_b32 v21, a93
v_mfma_f32_16x16x32_bf16 v[132:135], a[192:195], a[100:103], v[132:135]
v_accvgpr_read_b32 v22, a94
v_accvgpr_read_b32 v23, a95
v_mfma_f32_16x16x32_bf16 v[132:135], a[160:163], a[132:135], v[132:135]
v_lshlrev_b32 v24, 16, v20
v_and_b32 v25, s33, v20
v_mfma_f32_16x16x32_bf16 v[100:103], a[196:199], a[132:135], v[100:103]
ds_read_b128 a[132:135], v2 offset:33792
v_lshlrev_b32 v26, 16, v21
v_mfma_f32_16x16x32_bf16 v[100:103], a[164:167], a[100:103], v[100:103]
ds_read_b128 a[100:103], v1 offset:33792
v_and_b32 v27, s33, v21
v_mfma_f32_16x16x32_bf16 v[104:107], a[164:167], a[104:107], v[104:107]
ds_read_b128 v[16:19], v8 offset:1024
v_mul_f32 v24, v24, v188
v_mfma_f32_16x16x32_bf16 v[104:107], a[196:199], a[136:139], v[104:107]
v_mul_f32 v25, v25, v189
v_mul_f32 v26, v26, v190
v_mfma_f32_16x16x32_bf16 v[136:139], a[160:163], a[136:139], v[136:139]
ds_read_b128 a[136:139], v2 offset:34816
v_mul_f32 v27, v27, v191
v_mfma_f32_16x16x32_bf16 v[136:139], a[192:195], a[104:107], v[136:139]
ds_read_b128 a[104:107], v1 offset:34816
v_cvt_pk_bf16_f32 v20, v24, v25
v_mfma_f32_16x16x32_bf16 v[140:143], a[192:195], a[108:111], v[140:143]
v_cvt_pk_bf16_f32 v21, v26, v27
v_lshlrev_b32 v24, 16, v22
v_mfma_f32_16x16x32_bf16 v[140:143], a[160:163], a[140:143], v[140:143]
v_and_b32 v25, s33, v22
v_lshlrev_b32 v26, 16, v23
v_mfma_f32_16x16x32_bf16 v[108:111], a[196:199], a[140:143], v[108:111]
ds_read_b128 a[140:143], v2 offset:35840
v_and_b32 v27, s33, v23
v_mfma_f32_16x16x32_bf16 v[108:111], a[164:167], a[108:111], v[108:111]
ds_read_b128 a[108:111], v1 offset:35840
v_mul_f32 v24, v24, v220
v_mfma_f32_16x16x32_bf16 v[112:115], a[164:167], a[112:115], v[112:115]
v_mul_f32 v25, v25, v221
v_mul_f32 v26, v26, v222
v_mfma_f32_16x16x32_bf16 v[112:115], a[196:199], a[144:147], v[112:115]
v_mul_f32 v27, v27, v223
v_cvt_pk_bf16_f32 v22, v24, v25
v_mfma_f32_16x16x32_bf16 v[144:147], a[160:163], a[144:147], v[144:147]
ds_read_b128 a[144:147], v2 offset:36864
v_cvt_pk_bf16_f32 v23, v26, v27
v_mfma_f32_16x16x32_bf16 v[144:147], a[192:195], a[112:115], v[144:147]
ds_read_b128 a[112:115], v1 offset:36864
ds_write_b128 v7, v[20:23] offset:7168
v_mfma_f32_16x16x32_bf16 v[148:151], a[192:195], a[116:119], v[148:151]
buffer_store_dwordx4 v[20:23], v7, s[20:23], s53 offen offset:3072 sc1
s_waitcnt lgkmcnt(13)
v_lshlrev_b32 v24, 16, v12
v_mfma_f32_16x16x32_bf16 v[148:151], a[160:163], a[148:151], v[148:151]
v_and_b32 v25, s33, v12
v_lshlrev_b32 v26, 16, v13
v_mfma_f32_16x16x32_bf16 v[116:119], a[196:199], a[148:151], v[116:119]
ds_read_b128 a[148:151], v2 offset:37888
v_and_b32 v27, s33, v13
v_mfma_f32_16x16x32_bf16 v[116:119], a[164:167], a[116:119], v[116:119]
ds_read_b128 a[116:119], v1 offset:37888
ds_read_b128 v[20:23], v8 offset:2048
v_mfma_f32_16x16x32_bf16 v[120:123], a[164:167], a[120:123], v[120:123]
v_mul_f32 v24, v24, v224
v_mul_f32 v25, v25, v225
v_mfma_f32_16x16x32_bf16 v[120:123], a[196:199], a[152:155], v[120:123]
v_mul_f32 v26, v26, v226
v_mul_f32 v27, v27, v227
v_mfma_f32_16x16x32_bf16 v[152:155], a[160:163], a[152:155], v[152:155]
ds_read_b128 a[152:155], v2 offset:38912
v_cvt_pk_bf16_f32 v12, v24, v25
v_mfma_f32_16x16x32_bf16 v[152:155], a[192:195], a[120:123], v[152:155]
ds_read_b128 a[120:123], v1 offset:38912
v_cvt_pk_bf16_f32 v13, v26, v27
v_mfma_f32_16x16x32_bf16 v[156:159], a[192:195], a[124:127], v[156:159]
buffer_load_dwordx4 a[192:195], v0, s[20:23], s30 offen offset:0 sc1
v_lshlrev_b32 v24, 16, v14
v_mfma_f32_16x16x32_bf16 v[156:159], a[160:163], a[156:159], v[156:159]
buffer_load_dwordx4 a[160:163], v0, s[20:23], s30 offen offset:1024 sc1
v_and_b32 v25, s33, v14
v_mfma_f32_16x16x32_bf16 v[124:127], a[196:199], a[156:159], v[124:127]
buffer_load_dwordx4 a[196:199], v0, s[20:23], s30 offen offset:2048 sc1
ds_read_b128 a[156:159], v2 offset:39936
v_mfma_f32_16x16x32_bf16 v[124:127], a[164:167], a[124:127], v[124:127]
buffer_load_dwordx4 a[164:167], v0, s[20:23], s30 offen offset:3072 sc1
s_add_u32 s30, s30, 0xffff5000
ds_read_b128 a[124:127], v1 offset:39936
s_waitcnt vmcnt(17) lgkmcnt(15)
v_mfma_f32_16x16x32_bf16 v[32:35], a[172:175], a[96:99], v[32:35]
v_lshlrev_b32 v26, 16, v15
v_mfma_f32_16x16x32_bf16 v[32:35], a[204:207], a[128:131], v[32:35]
v_and_b32 v27, s33, v15
v_accvgpr_read_b32 v28, a224
v_mfma_f32_16x16x32_bf16 v[64:67], a[168:171], a[128:131], v[64:67]
v_mul_f32 v24, v24, v28
v_accvgpr_read_b32 v29, a225
v_mfma_f32_16x16x32_bf16 v[64:67], a[200:203], a[96:99], v[64:67]
v_mul_f32 v25, v25, v29
v_accvgpr_read_b32 v30, a226
v_mfma_f32_16x16x32_bf16 v[68:71], a[200:203], a[100:103], v[68:71]
v_mul_f32 v26, v26, v30
v_accvgpr_read_b32 v31, a227
v_mfma_f32_16x16x32_bf16 v[68:71], a[168:171], a[132:135], v[68:71]
v_mul_f32 v27, v27, v31
v_cvt_pk_bf16_f32 v14, v24, v25
v_mfma_f32_16x16x32_bf16 v[36:39], a[204:207], a[132:135], v[36:39]
v_cvt_pk_bf16_f32 v15, v26, v27
ds_write_b128 v7, v[12:15] offset:32768
v_mfma_f32_16x16x32_bf16 v[36:39], a[172:175], a[100:103], v[36:39]
buffer_store_dwordx4 v[12:15], v7, s[20:23], s54 offen offset:0 sc1
s_waitcnt lgkmcnt(15)
v_lshlrev_b32 v24, 16, v16
s_waitcnt lgkmcnt(13)
v_mfma_f32_16x16x32_bf16 v[40:43], a[172:175], a[104:107], v[40:43]
v_and_b32 v25, s33, v16
v_mfma_f32_16x16x32_bf16 v[40:43], a[204:207], a[136:139], v[40:43]
v_lshlrev_b32 v26, 16, v17
v_and_b32 v27, s33, v17
v_mfma_f32_16x16x32_bf16 v[72:75], a[168:171], a[136:139], v[72:75]
ds_read_b128 v[12:15], v8 offset:3072
v_mul_f32 v24, v24, v228
v_mfma_f32_16x16x32_bf16 v[72:75], a[200:203], a[104:107], v[72:75]
v_mul_f32 v25, v25, v229
v_mul_f32 v26, v26, v230
s_waitcnt lgkmcnt(12)
v_mfma_f32_16x16x32_bf16 v[76:79], a[200:203], a[108:111], v[76:79]
v_mul_f32 v27, v27, v231
v_mfma_f32_16x16x32_bf16 v[76:79], a[168:171], a[140:143], v[76:79]
v_cvt_pk_bf16_f32 v16, v24, v25
v_cvt_pk_bf16_f32 v17, v26, v27
v_mfma_f32_16x16x32_bf16 v[44:47], a[204:207], a[140:143], v[44:47]
v_lshlrev_b32 v24, 16, v18
v_and_b32 v25, s33, v18
v_mfma_f32_16x16x32_bf16 v[44:47], a[172:175], a[108:111], v[44:47]
v_lshlrev_b32 v26, 16, v19
v_and_b32 v27, s33, v19
s_waitcnt lgkmcnt(10)
v_mfma_f32_16x16x32_bf16 v[48:51], a[172:175], a[112:115], v[48:51]
v_accvgpr_read_b32 v28, a228
v_mfma_f32_16x16x32_bf16 v[48:51], a[204:207], a[144:147], v[48:51]
v_mul_f32 v24, v24, v28
v_accvgpr_read_b32 v29, a229
v_mfma_f32_16x16x32_bf16 v[80:83], a[168:171], a[144:147], v[80:83]
v_mul_f32 v25, v25, v29
v_accvgpr_read_b32 v30, a230
v_mfma_f32_16x16x32_bf16 v[80:83], a[200:203], a[112:115], v[80:83]
v_mul_f32 v26, v26, v30
v_accvgpr_read_b32 v31, a231
s_waitcnt lgkmcnt(7)
v_mfma_f32_16x16x32_bf16 v[84:87], a[200:203], a[116:119], v[84:87]
v_mul_f32 v27, v27, v31
v_mfma_f32_16x16x32_bf16 v[84:87], a[168:171], a[148:151], v[84:87]
v_cvt_pk_bf16_f32 v18, v24, v25
v_cvt_pk_bf16_f32 v19, v26, v27
v_mfma_f32_16x16x32_bf16 v[52:55], a[204:207], a[148:151], v[52:55]
ds_write_b128 v7, v[16:19] offset:33792
buffer_store_dwordx4 v[16:19], v7, s[20:23], s54 offen offset:1024 sc1
v_mfma_f32_16x16x32_bf16 v[52:55], a[172:175], a[116:119], v[52:55]
s_waitcnt lgkmcnt(7)
v_lshlrev_b32 v24, 16, v20
v_and_b32 v25, s33, v20
s_waitcnt lgkmcnt(5)
v_mfma_f32_16x16x32_bf16 v[56:59], a[172:175], a[120:123], v[56:59]
v_lshlrev_b32 v26, 16, v21
v_mfma_f32_16x16x32_bf16 v[56:59], a[204:207], a[152:155], v[56:59]
v_and_b32 v27, s33, v21
ds_read_b128 v[16:19], v8 offset:4096
v_mfma_f32_16x16x32_bf16 v[88:91], a[168:171], a[152:155], v[88:91]
v_mul_f32 v24, v24, v232
v_mul_f32 v25, v25, v233
v_mfma_f32_16x16x32_bf16 v[88:91], a[200:203], a[120:123], v[88:91]
v_mul_f32 v26, v26, v234
v_mul_f32 v27, v27, v235
s_waitcnt lgkmcnt(4)
v_mfma_f32_16x16x32_bf16 v[92:95], a[200:203], a[124:127], v[92:95]
buffer_load_dwordx4 a[200:203], v0, s[20:23], s30 offen offset:0 sc1
v_mfma_f32_16x16x32_bf16 v[92:95], a[168:171], a[156:159], v[92:95]
buffer_load_dwordx4 a[168:171], v0, s[20:23], s30 offen offset:1024 sc1
v_cvt_pk_bf16_f32 v20, v24, v25
v_mfma_f32_16x16x32_bf16 v[60:63], a[204:207], a[156:159], v[60:63]
buffer_load_dwordx4 a[204:207], v0, s[20:23], s30 offen offset:2048 sc1
v_cvt_pk_bf16_f32 v21, v26, v27
v_mfma_f32_16x16x32_bf16 v[60:63], a[172:175], a[124:127], v[60:63]
buffer_load_dwordx4 a[172:175], v0, s[20:23], s30 offen offset:3072 sc1
s_add_u32 s30, s30, 0x1000
s_waitcnt vmcnt(17)
v_mfma_f32_16x16x32_bf16 v[96:99], a[176:179], a[96:99], v[96:99]
v_lshlrev_b32 v24, 16, v22
v_mfma_f32_16x16x32_bf16 v[96:99], a[208:211], a[128:131], v[96:99]
v_and_b32 v25, s33, v22
v_lshlrev_b32 v26, 16, v23
v_mfma_f32_16x16x32_bf16 v[128:131], a[212:215], a[128:131], v[128:131]
ds_read_b128 a[128:131], v4 offset:32768
v_and_b32 v27, s33, v23
v_mfma_f32_16x16x32_bf16 v[128:131], a[180:183], a[96:99], v[128:131]
ds_read_b128 a[96:99], v3 offset:32768
v_accvgpr_read_b32 v28, a232
v_mfma_f32_16x16x32_bf16 v[132:135], a[180:183], a[100:103], v[132:135]
v_mul_f32 v24, v24, v28
v_accvgpr_read_b32 v29, a233
v_mfma_f32_16x16x32_bf16 v[132:135], a[212:215], a[132:135], v[132:135]
v_mul_f32 v25, v25, v29
v_accvgpr_read_b32 v30, a234
v_mfma_f32_16x16x32_bf16 v[100:103], a[208:211], a[132:135], v[100:103]
ds_read_b128 a[132:135], v4 offset:33792
v_mul_f32 v26, v26, v30
v_mfma_f32_16x16x32_bf16 v[100:103], a[176:179], a[100:103], v[100:103]
ds_read_b128 a[100:103], v3 offset:33792
v_accvgpr_read_b32 v31, a235
v_mfma_f32_16x16x32_bf16 v[104:107], a[176:179], a[104:107], v[104:107]
v_mul_f32 v27, v27, v31
v_cvt_pk_bf16_f32 v22, v24, v25
v_mfma_f32_16x16x32_bf16 v[104:107], a[208:211], a[136:139], v[104:107]
v_cvt_pk_bf16_f32 v23, v26, v27
ds_write_b128 v7, v[20:23] offset:34816
v_mfma_f32_16x16x32_bf16 v[136:139], a[212:215], a[136:139], v[136:139]
ds_read_b128 a[136:139], v4 offset:34816
buffer_store_dwordx4 v[20:23], v7, s[20:23], s54 offen offset:2048 sc1
v_mfma_f32_16x16x32_bf16 v[136:139], a[180:183], a[104:107], v[136:139]
ds_read_b128 a[104:107], v3 offset:34816
s_waitcnt lgkmcnt(9)
v_lshlrev_b32 v24, 16, v12
v_mfma_f32_16x16x32_bf16 v[140:143], a[180:183], a[108:111], v[140:143]
v_and_b32 v25, s33, v12
v_lshlrev_b32 v26, 16, v13
v_mfma_f32_16x16x32_bf16 v[140:143], a[212:215], a[140:143], v[140:143]
v_and_b32 v27, s33, v13
ds_read_b128 v[20:23], v8 offset:5120
v_mfma_f32_16x16x32_bf16 v[108:111], a[208:211], a[140:143], v[108:111]
ds_read_b128 a[140:143], v4 offset:35840
v_mul_f32 v24, v24, v236
v_mfma_f32_16x16x32_bf16 v[108:111], a[176:179], a[108:111], v[108:111]
ds_read_b128 a[108:111], v3 offset:35840
v_mul_f32 v25, v25, v237
v_mfma_f32_16x16x32_bf16 v[112:115], a[176:179], a[112:115], v[112:115]
v_mul_f32 v26, v26, v238
v_mul_f32 v27, v27, v239
v_mfma_f32_16x16x32_bf16 v[112:115], a[208:211], a[144:147], v[112:115]
v_cvt_pk_bf16_f32 v12, v24, v25
v_cvt_pk_bf16_f32 v13, v26, v27
v_mfma_f32_16x16x32_bf16 v[144:147], a[212:215], a[144:147], v[144:147]
ds_read_b128 a[144:147], v4 offset:36864
v_lshlrev_b32 v24, 16, v14
v_mfma_f32_16x16x32_bf16 v[144:147], a[180:183], a[112:115], v[144:147]
ds_read_b128 a[112:115], v3 offset:36864
v_and_b32 v25, s33, v14
v_mfma_f32_16x16x32_bf16 v[148:151], a[180:183], a[116:119], v[148:151]
v_lshlrev_b32 v26, 16, v15
v_and_b32 v27, s33, v15
v_mfma_f32_16x16x32_bf16 v[148:151], a[212:215], a[148:151], v[148:151]
v_accvgpr_read_b32 v28, a236
v_mul_f32 v24, v24, v28
v_mfma_f32_16x16x32_bf16 v[116:119], a[208:211], a[148:151], v[116:119]
ds_read_b128 a[148:151], v4 offset:37888
v_accvgpr_read_b32 v29, a237
v_mfma_f32_16x16x32_bf16 v[116:119], a[176:179], a[116:119], v[116:119]
ds_read_b128 a[116:119], v3 offset:37888
v_mul_f32 v25, v25, v29
v_mfma_f32_16x16x32_bf16 v[120:123], a[176:179], a[120:123], v[120:123]
v_accvgpr_read_b32 v30, a238
v_mul_f32 v26, v26, v30
v_mfma_f32_16x16x32_bf16 v[120:123], a[208:211], a[152:155], v[120:123]
v_accvgpr_read_b32 v31, a239
v_mul_f32 v27, v27, v31
v_mfma_f32_16x16x32_bf16 v[152:155], a[212:215], a[152:155], v[152:155]
ds_read_b128 a[152:155], v4 offset:38912
v_cvt_pk_bf16_f32 v14, v24, v25
v_mfma_f32_16x16x32_bf16 v[152:155], a[180:183], a[120:123], v[152:155]
ds_read_b128 a[120:123], v3 offset:38912
v_cvt_pk_bf16_f32 v15, v26, v27
v_mfma_f32_16x16x32_bf16 v[156:159], a[180:183], a[124:127], v[156:159]
buffer_load_dwordx4 a[180:183], v0, s[20:23], s30 offen offset:0 sc1
ds_write_b128 v7, v[12:15] offset:35840
v_mfma_f32_16x16x32_bf16 v[156:159], a[212:215], a[156:159], v[156:159]
buffer_load_dwordx4 a[212:215], v0, s[20:23], s30 offen offset:1024 sc1
buffer_store_dwordx4 v[12:15], v7, s[20:23], s54 offen offset:3072 sc1
v_mfma_f32_16x16x32_bf16 v[124:127], a[208:211], a[156:159], v[124:127]
buffer_load_dwordx4 a[208:211], v0, s[20:23], s30 offen offset:2048 sc1
ds_read_b128 a[156:159], v4 offset:39936
v_mfma_f32_16x16x32_bf16 v[124:127], a[176:179], a[124:127], v[124:127]
buffer_load_dwordx4 a[176:179], v0, s[20:23], s30 offen offset:3072 sc1
s_add_u32 s30, s30, 0x3000
ds_read_b128 a[124:127], v3 offset:39936
s_waitcnt vmcnt(18) lgkmcnt(15)
v_mfma_f32_16x16x32_bf16 v[32:35], a[184:187], a[96:99], v[32:35]
v_lshlrev_b32 v24, 16, v16
v_mfma_f32_16x16x32_bf16 v[32:35], a[216:219], a[128:131], v[32:35]
v_and_b32 v25, s33, v16
v_lshlrev_b32 v26, 16, v17
v_mfma_f32_16x16x32_bf16 v[64:67], a[220:223], a[128:131], v[64:67]
v_and_b32 v27, s33, v17
ds_read_b128 v[12:15], v8 offset:6144
v_mfma_f32_16x16x32_bf16 v[64:67], a[188:191], a[96:99], v[64:67]
v_mul_f32 v24, v24, v240
v_mul_f32 v25, v25, v241
v_mfma_f32_16x16x32_bf16 v[68:71], a[188:191], a[100:103], v[68:71]
v_mul_f32 v26, v26, v242
v_mul_f32 v27, v27, v243
v_mfma_f32_16x16x32_bf16 v[68:71], a[220:223], a[132:135], v[68:71]
v_cvt_pk_bf16_f32 v16, v24, v25
v_cvt_pk_bf16_f32 v17, v26, v27
v_mfma_f32_16x16x32_bf16 v[36:39], a[216:219], a[132:135], v[36:39]
v_lshlrev_b32 v24, 16, v18
v_and_b32 v25, s33, v18
v_mfma_f32_16x16x32_bf16 v[36:39], a[184:187], a[100:103], v[36:39]
v_lshlrev_b32 v26, 16, v19
v_and_b32 v27, s33, v19
s_waitcnt lgkmcnt(13)
v_mfma_f32_16x16x32_bf16 v[40:43], a[184:187], a[104:107], v[40:43]
v_accvgpr_read_b32 v28, a240
v_mfma_f32_16x16x32_bf16 v[40:43], a[216:219], a[136:139], v[40:43]
v_mul_f32 v24, v24, v28
v_accvgpr_read_b32 v29, a241
v_mfma_f32_16x16x32_bf16 v[72:75], a[220:223], a[136:139], v[72:75]
v_mul_f32 v25, v25, v29
v_accvgpr_read_b32 v30, a242
v_mfma_f32_16x16x32_bf16 v[72:75], a[188:191], a[104:107], v[72:75]
v_mul_f32 v26, v26, v30
v_accvgpr_read_b32 v31, a243
s_waitcnt lgkmcnt(10)
v_mfma_f32_16x16x32_bf16 v[76:79], a[188:191], a[108:111], v[76:79]
v_mul_f32 v27, v27, v31
v_mfma_f32_16x16x32_bf16 v[76:79], a[220:223], a[140:143], v[76:79]
v_cvt_pk_bf16_f32 v18, v24, v25
v_cvt_pk_bf16_f32 v19, v26, v27
v_mfma_f32_16x16x32_bf16 v[44:47], a[216:219], a[140:143], v[44:47]
ds_write_b128 v7, v[16:19] offset:36864
buffer_store_dwordx4 v[16:19], v7, s[20:23], s55 offen offset:0 sc1
v_mfma_f32_16x16x32_bf16 v[44:47], a[184:187], a[108:111], v[44:47]
v_lshlrev_b32 v24, 16, v20
v_and_b32 v25, s33, v20
s_waitcnt lgkmcnt(9)
v_mfma_f32_16x16x32_bf16 v[48:51], a[184:187], a[112:115], v[48:51]
v_lshlrev_b32 v26, 16, v21
v_mfma_f32_16x16x32_bf16 v[48:51], a[216:219], a[144:147], v[48:51]
v_and_b32 v27, s33, v21
ds_read_b128 v[16:19], v8 offset:7168
v_mfma_f32_16x16x32_bf16 v[80:83], a[220:223], a[144:147], v[80:83]
v_mul_f32 v24, v24, v244
v_mul_f32 v25, v25, v245
v_mfma_f32_16x16x32_bf16 v[80:83], a[188:191], a[112:115], v[80:83]
v_mul_f32 v26, v26, v246
v_mul_f32 v27, v27, v247
s_waitcnt lgkmcnt(8)
v_mfma_f32_16x16x32_bf16 v[84:87], a[188:191], a[116:119], v[84:87]
v_cvt_pk_bf16_f32 v20, v24, v25
v_mfma_f32_16x16x32_bf16 v[84:87], a[220:223], a[148:151], v[84:87]
v_cvt_pk_bf16_f32 v21, v26, v27
v_lshlrev_b32 v24, 16, v22
v_mfma_f32_16x16x32_bf16 v[52:55], a[216:219], a[148:151], v[52:55]
v_and_b32 v25, s33, v22
v_lshlrev_b32 v26, 16, v23
v_mfma_f32_16x16x32_bf16 v[52:55], a[184:187], a[116:119], v[52:55]
v_and_b32 v27, s33, v23
v_accvgpr_read_b32 v28, a244
s_waitcnt lgkmcnt(6)
v_mfma_f32_16x16x32_bf16 v[56:59], a[184:187], a[120:123], v[56:59]
v_mul_f32 v24, v24, v28
v_mfma_f32_16x16x32_bf16 v[56:59], a[216:219], a[152:155], v[56:59]
v_accvgpr_read_b32 v29, a245
v_mul_f32 v25, v25, v29
v_mfma_f32_16x16x32_bf16 v[88:91], a[220:223], a[152:155], v[88:91]
v_accvgpr_read_b32 v30, a246
v_mul_f32 v26, v26, v30
v_mfma_f32_16x16x32_bf16 v[88:91], a[188:191], a[120:123], v[88:91]
v_accvgpr_read_b32 v31, a247
v_mul_f32 v27, v27, v31
s_waitcnt lgkmcnt(3)
v_mfma_f32_16x16x32_bf16 v[92:95], a[188:191], a[124:127], v[92:95]
buffer_load_dwordx4 a[188:191], v0, s[20:23], s30 offen offset:0 sc1
v_mfma_f32_16x16x32_bf16 v[92:95], a[220:223], a[156:159], v[92:95]
buffer_load_dwordx4 a[220:223], v0, s[20:23], s30 offen offset:1024 sc1
v_cvt_pk_bf16_f32 v22, v24, v25
v_mfma_f32_16x16x32_bf16 v[60:63], a[216:219], a[156:159], v[60:63]
buffer_load_dwordx4 a[216:219], v0, s[20:23], s30 offen offset:2048 sc1
v_cvt_pk_bf16_f32 v23, v26, v27
v_mfma_f32_16x16x32_bf16 v[60:63], a[184:187], a[124:127], v[60:63]
buffer_load_dwordx4 a[184:187], v0, s[20:23], s30 offen offset:3072 sc1
s_add_u32 s30, s30, 0x1000
s_waitcnt vmcnt(17)
v_mfma_f32_16x16x32_bf16 v[96:99], a[192:195], a[96:99], v[96:99]
ds_write_b128 v7, v[20:23] offset:37888
v_mfma_f32_16x16x32_bf16 v[96:99], a[160:163], a[128:131], v[96:99]
buffer_store_dwordx4 v[20:23], v7, s[20:23], s55 offen offset:1024 sc1
s_waitcnt lgkmcnt(3)
v_lshlrev_b32 v24, 16, v12
v_mfma_f32_16x16x32_bf16 v[128:131], a[164:167], a[128:131], v[128:131]
ds_read_b128 a[128:131], v2 offset:0
v_and_b32 v25, s33, v12
v_mfma_f32_16x16x32_bf16 v[128:131], a[196:199], a[96:99], v[128:131]
ds_read_b128 a[96:99], v1 offset:0
v_lshlrev_b32 v26, 16, v13
v_mfma_f32_16x16x32_bf16 v[132:135], a[196:199], a[100:103], v[132:135]
v_and_b32 v27, s33, v13
v_mul_f32 v24, v24, v248
v_mfma_f32_16x16x32_bf16 v[132:135], a[164:167], a[132:135], v[132:135]
v_mul_f32 v25, v25, v249
v_mul_f32 v26, v26, v250
v_mfma_f32_16x16x32_bf16 v[100:103], a[160:163], a[132:135], v[100:103]
ds_read_b128 a[132:135], v2 offset:1024
v_mul_f32 v27, v27, v251
v_mfma_f32_16x16x32_bf16 v[100:103], a[192:195], a[100:103], v[100:103]
ds_read_b128 a[100:103], v1 offset:1024
v_cvt_pk_bf16_f32 v12, v24, v25
v_mfma_f32_16x16x32_bf16 v[104:107], a[192:195], a[104:107], v[104:107]
v_cvt_pk_bf16_f32 v13, v26, v27
v_lshlrev_b32 v24, 16, v14
v_mfma_f32_16x16x32_bf16 v[104:107], a[160:163], a[136:139], v[104:107]
v_and_b32 v25, s33, v14
v_lshlrev_b32 v26, 16, v15
v_mfma_f32_16x16x32_bf16 v[136:139], a[164:167], a[136:139], v[136:139]
ds_read_b128 a[136:139], v2 offset:2048
v_and_b32 v27, s33, v15
v_mfma_f32_16x16x32_bf16 v[136:139], a[196:199], a[104:107], v[136:139]
ds_read_b128 a[104:107], v1 offset:2048
v_accvgpr_read_b32 v28, a248
v_mfma_f32_16x16x32_bf16 v[140:143], a[196:199], a[108:111], v[140:143]
v_mul_f32 v24, v24, v28
v_accvgpr_read_b32 v29, a249
v_mfma_f32_16x16x32_bf16 v[140:143], a[164:167], a[140:143], v[140:143]
v_mul_f32 v25, v25, v29
v_accvgpr_read_b32 v30, a250
v_mfma_f32_16x16x32_bf16 v[108:111], a[160:163], a[140:143], v[108:111]
ds_read_b128 a[140:143], v2 offset:3072
v_mul_f32 v26, v26, v30
v_mfma_f32_16x16x32_bf16 v[108:111], a[192:195], a[108:111], v[108:111]
ds_read_b128 a[108:111], v1 offset:3072
v_accvgpr_read_b32 v31, a251
v_mfma_f32_16x16x32_bf16 v[112:115], a[192:195], a[112:115], v[112:115]
v_mul_f32 v27, v27, v31
v_cvt_pk_bf16_f32 v14, v24, v25
v_mfma_f32_16x16x32_bf16 v[112:115], a[160:163], a[144:147], v[112:115]
v_cvt_pk_bf16_f32 v15, v26, v27
ds_write_b128 v7, v[12:15] offset:38912
v_mfma_f32_16x16x32_bf16 v[144:147], a[164:167], a[144:147], v[144:147]
ds_read_b128 a[144:147], v2 offset:4096
buffer_store_dwordx4 v[12:15], v7, s[20:23], s55 offen offset:2048 sc1
v_mfma_f32_16x16x32_bf16 v[144:147], a[196:199], a[112:115], v[144:147]
ds_read_b128 a[112:115], v1 offset:4096
s_waitcnt lgkmcnt(12)
v_lshlrev_b32 v24, 16, v16
v_mfma_f32_16x16x32_bf16 v[148:151], a[196:199], a[116:119], v[148:151]
v_and_b32 v25, s33, v16
v_lshlrev_b32 v26, 16, v17
v_mfma_f32_16x16x32_bf16 v[148:151], a[164:167], a[148:151], v[148:151]
v_and_b32 v27, s33, v17
v_mul_f32 v24, v24, v252
v_mfma_f32_16x16x32_bf16 v[116:119], a[160:163], a[148:151], v[116:119]
ds_read_b128 a[148:151], v2 offset:5120
v_mul_f32 v25, v25, v253
v_mfma_f32_16x16x32_bf16 v[116:119], a[192:195], a[116:119], v[116:119]
ds_read_b128 a[116:119], v1 offset:5120
v_mul_f32 v26, v26, v254
v_mfma_f32_16x16x32_bf16 v[120:123], a[192:195], a[120:123], v[120:123]
v_mul_f32 v27, v27, v255
v_cvt_pk_bf16_f32 v16, v24, v25
v_mfma_f32_16x16x32_bf16 v[120:123], a[160:163], a[152:155], v[120:123]
v_cvt_pk_bf16_f32 v17, v26, v27
v_lshlrev_b32 v24, 16, v18
v_mfma_f32_16x16x32_bf16 v[152:155], a[164:167], a[152:155], v[152:155]
ds_read_b128 a[152:155], v2 offset:6144
v_and_b32 v25, s33, v18
v_mfma_f32_16x16x32_bf16 v[152:155], a[196:199], a[120:123], v[152:155]
ds_read_b128 a[120:123], v1 offset:6144
v_lshlrev_b32 v26, 16, v19
v_mfma_f32_16x16x32_bf16 v[156:159], a[196:199], a[124:127], v[156:159]
buffer_load_dwordx4 a[196:199], v0, s[20:23], s30 offen offset:0 sc1
v_and_b32 v27, s33, v19
v_mfma_f32_16x16x32_bf16 v[156:159], a[164:167], a[156:159], v[156:159]
buffer_load_dwordx4 a[164:167], v0, s[20:23], s30 offen offset:1024 sc1
v_accvgpr_read_b32 v28, a252
v_mfma_f32_16x16x32_bf16 v[124:127], a[160:163], a[156:159], v[124:127]
buffer_load_dwordx4 a[160:163], v0, s[20:23], s30 offen offset:2048 sc1
ds_read_b128 a[156:159], v2 offset:7168
v_mfma_f32_16x16x32_bf16 v[124:127], a[192:195], a[124:127], v[124:127]
buffer_load_dwordx4 a[192:195], v0, s[20:23], s30 offen offset:3072 sc1
s_add_u32 s30, s30, 0x3000
ds_read_b128 a[124:127], v1 offset:7168
s_waitcnt vmcnt(17) lgkmcnt(15)
v_mfma_f32_16x16x32_bf16 v[160:163], a[200:203], a[96:99], v[160:163]
v_mul_f32 v24, v24, v28
v_mfma_f32_16x16x32_bf16 v[160:163], a[168:171], a[128:131], v[160:163]
v_accvgpr_read_b32 v29, a253
v_mul_f32 v25, v25, v29
v_mfma_f32_16x16x32_bf16 v[192:195], a[172:175], a[128:131], v[192:195]
v_accvgpr_read_b32 v30, a254
v_mul_f32 v26, v26, v30
v_mfma_f32_16x16x32_bf16 v[192:195], a[204:207], a[96:99], v[192:195]
v_accvgpr_read_b32 v31, a255
v_mul_f32 v27, v27, v31
s_waitcnt lgkmcnt(13)
v_mfma_f32_16x16x32_bf16 v[196:199], a[204:207], a[100:103], v[196:199]
v_cvt_pk_bf16_f32 v18, v24, v25
v_mfma_f32_16x16x32_bf16 v[196:199], a[172:175], a[132:135], v[196:199]
v_cvt_pk_bf16_f32 v19, v26, v27
ds_write_b128 v7, v[16:19] offset:39936
v_mfma_f32_16x16x32_bf16 v[164:167], a[168:171], a[132:135], v[164:167]
buffer_store_dwordx4 v[16:19], v7, s[20:23], s55 offen offset:3072 sc1
v_mfma_f32_16x16x32_bf16 v[164:167], a[200:203], a[100:103], v[164:167]
s_waitcnt lgkmcnt(12)
v_mfma_f32_16x16x32_bf16 v[168:171], a[200:203], a[104:107], v[168:171]
v_mfma_f32_16x16x32_bf16 v[168:171], a[168:171], a[136:139], v[168:171]
v_mfma_f32_16x16x32_bf16 v[200:203], a[172:175], a[136:139], v[200:203]
v_mfma_f32_16x16x32_bf16 v[200:203], a[204:207], a[104:107], v[200:203]
s_waitcnt lgkmcnt(10)
v_mfma_f32_16x16x32_bf16 v[204:207], a[204:207], a[108:111], v[204:207]
v_mfma_f32_16x16x32_bf16 v[204:207], a[172:175], a[140:143], v[204:207]
v_mfma_f32_16x16x32_bf16 v[172:175], a[168:171], a[140:143], v[172:175]
v_mfma_f32_16x16x32_bf16 v[172:175], a[200:203], a[108:111], v[172:175]
s_waitcnt lgkmcnt(7)
v_mfma_f32_16x16x32_bf16 v[176:179], a[200:203], a[112:115], v[176:179]
v_mfma_f32_16x16x32_bf16 v[176:179], a[168:171], a[144:147], v[176:179]
v_mfma_f32_16x16x32_bf16 v[208:211], a[172:175], a[144:147], v[208:211]
v_mfma_f32_16x16x32_bf16 v[208:211], a[204:207], a[112:115], v[208:211]
s_waitcnt lgkmcnt(5)
v_mfma_f32_16x16x32_bf16 v[212:215], a[204:207], a[116:119], v[212:215]
v_mfma_f32_16x16x32_bf16 v[212:215], a[172:175], a[148:151], v[212:215]
v_mfma_f32_16x16x32_bf16 v[180:183], a[168:171], a[148:151], v[180:183]
v_mfma_f32_16x16x32_bf16 v[180:183], a[200:203], a[116:119], v[180:183]
s_waitcnt lgkmcnt(3)
v_mfma_f32_16x16x32_bf16 v[184:187], a[200:203], a[120:123], v[184:187]
v_mfma_f32_16x16x32_bf16 v[184:187], a[168:171], a[152:155], v[184:187]
v_mfma_f32_16x16x32_bf16 v[216:219], a[172:175], a[152:155], v[216:219]
v_mfma_f32_16x16x32_bf16 v[216:219], a[204:207], a[120:123], v[216:219]
s_waitcnt lgkmcnt(1)
v_mfma_f32_16x16x32_bf16 v[220:223], a[204:207], a[124:127], v[220:223]
buffer_load_dwordx4 a[204:207], v0, s[20:23], s30 offen offset:0 sc1
v_mfma_f32_16x16x32_bf16 v[220:223], a[172:175], a[156:159], v[220:223]
buffer_load_dwordx4 a[172:175], v0, s[20:23], s30 offen offset:1024 sc1
v_mfma_f32_16x16x32_bf16 v[188:191], a[168:171], a[156:159], v[188:191]
buffer_load_dwordx4 a[168:171], v0, s[20:23], s30 offen offset:2048 sc1
v_mfma_f32_16x16x32_bf16 v[188:191], a[200:203], a[124:127], v[188:191]
buffer_load_dwordx4 a[200:203], v0, s[20:23], s30 offen offset:3072 sc1
s_add_u32 s30, s30, 0x1000
s_barrier
s_waitcnt vmcnt(16)
v_mfma_f32_16x16x32_bf16 v[224:227], a[180:183], a[96:99], v[224:227]
s_cmp_lg_u32 s28, 0
s_cbranch_scc1 L_nf2
s_add_u32 s34, s8, 2
v_mov_b32 v10, s34
v_mov_b32 v11, s9
s_mov_b64 exec, 1
buffer_store_dwordx2 v[10:11], off, s[20:23], s35 sc1
s_mov_b64 exec, -1
L_nf2:
v_mfma_f32_16x16x32_bf16 v[224:227], a[212:215], a[128:131], v[224:227]
v_mfma_f32_16x16x32_bf16 a[224:227], a[176:179], a[128:131], a[224:227]
ds_read_b128 a[128:131], v4 offset:0
v_mfma_f32_16x16x32_bf16 a[224:227], a[208:211], a[96:99], a[224:227]
ds_read_b128 a[96:99], v3 offset:0
v_mfma_f32_16x16x32_bf16 a[228:231], a[208:211], a[100:103], a[228:231]
v_mfma_f32_16x16x32_bf16 a[228:231], a[176:179], a[132:135], a[228:231]
v_mfma_f32_16x16x32_bf16 v[228:231], a[212:215], a[132:135], v[228:231]
ds_read_b128 a[132:135], v4 offset:1024
v_mfma_f32_16x16x32_bf16 v[228:231], a[180:183], a[100:103], v[228:231]
ds_read_b128 a[100:103], v3 offset:1024
v_mfma_f32_16x16x32_bf16 v[232:235], a[180:183], a[104:107], v[232:235]
v_mfma_f32_16x16x32_bf16 v[232:235], a[212:215], a[136:139], v[232:235]
v_mfma_f32_16x16x32_bf16 a[232:235], a[176:179], a[136:139], a[232:235]
ds_read_b128 a[136:139], v4 offset:2048
v_mfma_f32_16x16x32_bf16 a[232:235], a[208:211], a[104:107], a[232:235]
ds_read_b128 a[104:107], v3 offset:2048
v_mfma_f32_16x16x32_bf16 a[236:239], a[208:211], a[108:111], a[236:239]
v_mfma_f32_16x16x32_bf16 a[236:239], a[176:179], a[140:143], a[236:239]
v_mfma_f32_16x16x32_bf16 v[236:239], a[212:215], a[140:143], v[236:239]
ds_read_b128 a[140:143], v4 offset:3072
v_mfma_f32_16x16x32_bf16 v[236:239], a[180:183], a[108:111], v[236:239]
ds_read_b128 a[108:111], v3 offset:3072
v_mfma_f32_16x16x32_bf16 v[240:243], a[180:183], a[112:115], v[240:243]
v_mfma_f32_16x16x32_bf16 v[240:243], a[212:215], a[144:147], v[240:243]
v_mfma_f32_16x16x32_bf16 a[240:243], a[176:179], a[144:147], a[240:243]
ds_read_b128 a[144:147], v4 offset:4096
v_mfma_f32_16x16x32_bf16 a[240:243], a[208:211], a[112:115], a[240:243]
ds_read_b128 a[112:115], v3 offset:4096
v_mfma_f32_16x16x32_bf16 a[244:247], a[208:211], a[116:119], a[244:247]
v_mfma_f32_16x16x32_bf16 a[244:247], a[176:179], a[148:151], a[244:247]
v_mfma_f32_16x16x32_bf16 v[244:247], a[212:215], a[148:151], v[244:247]
ds_read_b128 a[148:151], v4 offset:5120
v_mfma_f32_16x16x32_bf16 v[244:247], a[180:183], a[116:119], v[244:247]
ds_read_b128 a[116:119], v3 offset:5120
v_mfma_f32_16x16x32_bf16 v[248:251], a[180:183], a[120:123], v[248:251]
v_mfma_f32_16x16x32_bf16 v[248:251], a[212:215], a[152:155], v[248:251]
v_mfma_f32_16x16x32_bf16 a[248:251], a[176:179], a[152:155], a[248:251]
ds_read_b128 a[152:155], v4 offset:6144
v_mfma_f32_16x16x32_bf16 a[248:251], a[208:211], a[120:123], a[248:251]
ds_read_b128 a[120:123], v3 offset:6144
v_mfma_f32_16x16x32_bf16 a[252:255], a[208:211], a[124:127], a[252:255]
buffer_load_dwordx4 a[208:211], v0, s[20:23], s30 offen offset:0 sc1
v_mfma_f32_16x16x32_bf16 a[252:255], a[176:179], a[156:159], a[252:255]
buffer_load_dwordx4 a[176:179], v0, s[20:23], s30 offen offset:1024 sc1
v_mfma_f32_16x16x32_bf16 v[252:255], a[212:215], a[156:159], v[252:255]
buffer_load_dwordx4 a[212:215], v0, s[20:23], s30 offen offset:2048 sc1
ds_read_b128 a[156:159], v4 offset:7168
v_mfma_f32_16x16x32_bf16 v[252:255], a[180:183], a[124:127], v[252:255]
buffer_load_dwordx4 a[180:183], v0, s[20:23], s30 offen offset:3072 sc1
s_add_u32 s30, s30, 0x3000
ds_read_b128 a[124:127], v3 offset:7168
s_waitcnt vmcnt(15) lgkmcnt(14)
v_mfma_f32_16x16x32_bf16 v[160:163], a[188:191], a[96:99], v[160:163]
v_mfma_f32_16x16x32_bf16 v[160:163], a[220:223], a[128:131], v[160:163]
v_mfma_f32_16x16x32_bf16 v[192:195], a[184:187], a[128:131], v[192:195]
v_mfma_f32_16x16x32_bf16 v[192:195], a[216:219], a[96:99], v[192:195]
s_waitcnt lgkmcnt(12)
v_mfma_f32_16x16x32_bf16 v[196:199], a[216:219], a[100:103], v[196:199]
buffer_load_dwordx4 v[12:15], v9, s[24:27], s37 offen offset:2048
v_mfma_f32_16x16x32_bf16 v[196:199], a[184:187], a[132:135], v[196:199]
v_mfma_f32_16x16x32_bf16 v[164:167], a[220:223], a[132:135], v[164:167]
v_mfma_f32_16x16x32_bf16 v[164:167], a[188:191], a[100:103], v[164:167]
s_waitcnt lgkmcnt(10)
v_mfma_f32_16x16x32_bf16 v[168:171], a[188:191], a[104:107], v[168:171]
buffer_load_dwordx4 v[16:19], v9, s[24:27], s37 offen offset:2112
v_mfma_f32_16x16x32_bf16 v[168:171], a[220:223], a[136:139], v[168:171]
v_mfma_f32_16x16x32_bf16 v[200:203], a[184:187], a[136:139], v[200:203]
v_mfma_f32_16x16x32_bf16 v[200:203], a[216:219], a[104:107], v[200:203]
s_waitcnt lgkmcnt(8)
v_mfma_f32_16x16x32_bf16 v[204:207], a[216:219], a[108:111], v[204:207]
v_mfma_f32_16x16x32_bf16 v[204:207], a[184:187], a[140:143], v[204:207]
v_mfma_f32_16x16x32_bf16 v[172:175], a[220:223], a[140:143], v[172:175]
v_mfma_f32_16x16x32_bf16 v[172:175], a[188:191], a[108:111], v[172:175]
s_waitcnt lgkmcnt(6)
v_mfma_f32_16x16x32_bf16 v[176:179], a[188:191], a[112:115], v[176:179]
v_mfma_f32_16x16x32_bf16 v[176:179], a[220:223], a[144:147], v[176:179]
v_mfma_f32_16x16x32_bf16 v[208:211], a[184:187], a[144:147], v[208:211]
v_mfma_f32_16x16x32_bf16 v[208:211], a[216:219], a[112:115], v[208:211]
s_waitcnt lgkmcnt(4)
v_mfma_f32_16x16x32_bf16 v[212:215], a[216:219], a[116:119], v[212:215]
v_mfma_f32_16x16x32_bf16 v[212:215], a[184:187], a[148:151], v[212:215]
v_mfma_f32_16x16x32_bf16 v[180:183], a[220:223], a[148:151], v[180:183]
v_mfma_f32_16x16x32_bf16 v[180:183], a[188:191], a[116:119], v[180:183]
s_waitcnt lgkmcnt(2)
v_mfma_f32_16x16x32_bf16 v[184:187], a[188:191], a[120:123], v[184:187]
v_mfma_f32_16x16x32_bf16 v[184:187], a[220:223], a[152:155], v[184:187]
v_mfma_f32_16x16x32_bf16 v[216:219], a[184:187], a[152:155], v[216:219]
v_mfma_f32_16x16x32_bf16 v[216:219], a[216:219], a[120:123], v[216:219]
s_waitcnt lgkmcnt(0)
v_mfma_f32_16x16x32_bf16 v[220:223], a[216:219], a[124:127], v[220:223]
buffer_load_dwordx4 a[216:219], v0, s[20:23], s30 offen offset:0 sc1
v_mfma_f32_16x16x32_bf16 v[220:223], a[184:187], a[156:159], v[220:223]
buffer_load_dwordx4 a[184:187], v0, s[20:23], s30 offen offset:1024 sc1
v_mfma_f32_16x16x32_bf16 v[188:191], a[220:223], a[156:159], v[188:191]
buffer_load_dwordx4 a[220:223], v0, s[20:23], s30 offen offset:2048 sc1
v_mfma_f32_16x16x32_bf16 v[188:191], a[188:191], a[124:127], v[188:191]
buffer_load_dwordx4 a[188:191], v0, s[20:23], s30 offen offset:3072 sc1
s_add_u32 s30, s30, 0x1000
s_waitcnt vmcnt(15)
v_mfma_f32_16x16x32_bf16 v[224:227], a[196:199], a[96:99], v[224:227]
v_mfma_f32_16x16x32_bf16 v[224:227], a[164:167], a[128:131], v[224:227]
v_mfma_f32_16x16x32_bf16 a[224:227], a[192:195], a[128:131], a[224:227]
ds_read_b128 a[128:131], v2 offset:32768
v_mfma_f32_16x16x32_bf16 a[224:227], a[160:163], a[96:99], a[224:227]
ds_read_b128 a[96:99], v1 offset:32768
v_mfma_f32_16x16x32_bf16 a[228:231], a[160:163], a[100:103], a[228:231]
v_mfma_f32_16x16x32_bf16 a[228:231], a[192:195], a[132:135], a[228:231]
v_mfma_f32_16x16x32_bf16 v[228:231], a[164:167], a[132:135], v[228:231]
ds_read_b128 a[132:135], v2 offset:33792
v_mfma_f32_16x16x32_bf16 v[228:231], a[196:199], a[100:103], v[228:231]
ds_read_b128 a[100:103], v1 offset:33792
v_mfma_f32_16x16x32_bf16 v[232:235], a[196:199], a[104:107], v[232:235]
v_mfma_f32_16x16x32_bf16 v[232:235], a[164:167], a[136:139], v[232:235]
v_mfma_f32_16x16x32_bf16 a[232:235], a[192:195], a[136:139], a[232:235]
ds_read_b128 a[136:139], v2 offset:34816
v_mfma_f32_16x16x32_bf16 a[232:235], a[160:163], a[104:107], a[232:235]
ds_read_b128 a[104:107], v1 offset:34816
v_mfma_f32_16x16x32_bf16 a[236:239], a[160:163], a[108:111], a[236:239]
v_mfma_f32_16x16x32_bf16 a[236:239], a[192:195], a[140:143], a[236:239]
v_mfma_f32_16x16x32_bf16 v[236:239], a[164:167], a[140:143], v[236:239]
ds_read_b128 a[140:143], v2 offset:35840
v_mfma_f32_16x16x32_bf16 v[236:239], a[196:199], a[108:111], v[236:239]
ds_read_b128 a[108:111], v1 offset:35840
v_mfma_f32_16x16x32_bf16 v[240:243], a[196:199], a[112:115], v[240:243]
v_mfma_f32_16x16x32_bf16 v[240:243], a[164:167], a[144:147], v[240:243]
v_mfma_f32_16x16x32_bf16 a[240:243], a[192:195], a[144:147], a[240:243]
ds_read_b128 a[144:147], v2 offset:36864
v_mfma_f32_16x16x32_bf16 a[240:243], a[160:163], a[112:115], a[240:243]
ds_read_b128 a[112:115], v1 offset:36864
v_mfma_f32_16x16x32_bf16 a[244:247], a[160:163], a[116:119], a[244:247]
v_mfma_f32_16x16x32_bf16 a[244:247], a[192:195], a[148:151], a[244:247]
v_mfma_f32_16x16x32_bf16 v[244:247], a[164:167], a[148:151], v[244:247]
ds_read_b128 a[148:151], v2 offset:37888
v_mfma_f32_16x16x32_bf16 v[244:247], a[196:199], a[116:119], v[244:247]
ds_read_b128 a[116:119], v1 offset:37888
v_mfma_f32_16x16x32_bf16 v[248:251], a[196:199], a[120:123], v[248:251]
v_mfma_f32_16x16x32_bf16 v[248:251], a[164:167], a[152:155], v[248:251]
v_mfma_f32_16x16x32_bf16 a[248:251], a[192:195], a[152:155], a[248:251]
ds_read_b128 a[152:155], v2 offset:38912
v_mfma_f32_16x16x32_bf16 a[248:251], a[160:163], a[120:123], a[248:251]
ds_read_b128 a[120:123], v1 offset:38912
v_mfma_f32_16x16x32_bf16 a[252:255], a[160:163], a[124:127], a[252:255]
buffer_load_dwordx4 a[160:163], v0, s[20:23], s30 offen offset:0 sc1
v_mfma_f32_16x16x32_bf16 a[252:255], a[192:195], a[156:159], a[252:255]
buffer_load_dwordx4 a[192:195], v0, s[20:23], s30 offen offset:1024 sc1
v_mfma_f32_16x16x32_bf16 v[252:255], a[164:167], a[156:159], v[252:255]
buffer_load_dwordx4 a[164:167], v0, s[20:23], s30 offen offset:2048 sc1
ds_read_b128 a[156:159], v2 offset:39936
v_mfma_f32_16x16x32_bf16 v[252:255], a[196:199], a[124:127], v[252:255]
buffer_load_dwordx4 a[196:199], v0, s[20:23], s30 offen offset:3072 sc1
s_add_u32 s30, s30, 0x1000
ds_read_b128 a[124:127], v1 offset:39936
s_waitcnt vmcnt(14) lgkmcnt(14)
v_mfma_f32_16x16x32_bf16 v[160:163], a[204:207], a[96:99], v[160:163]
v_mfma_f32_16x16x32_bf16 v[160:163], a[172:175], a[128:131], v[160:163]
v_mfma_f32_16x16x32_bf16 v[192:195], a[200:203], a[128:131], v[192:195]
v_mfma_f32_16x16x32_bf16 v[192:195], a[168:171], a[96:99], v[192:195]
s_waitcnt lgkmcnt(12)
v_mfma_f32_16x16x32_bf16 v[196:199], a[168:171], a[100:103], v[196:199]
v_mfma_f32_16x16x32_bf16 v[196:199], a[200:203], a[132:135], v[196:199]
v_mfma_f32_16x16x32_bf16 v[164:167], a[172:175], a[132:135], v[164:167]
v_mfma_f32_16x16x32_bf16 v[164:167], a[204:207], a[100:103], v[164:167]
s_waitcnt lgkmcnt(10)
v_mfma_f32_16x16x32_bf16 v[168:171], a[204:207], a[104:107], v[168:171]
v_mfma_f32_16x16x32_bf16 v[168:171], a[172:175], a[136:139], v[168:171]
v_mfma_f32_16x16x32_bf16 v[200:203], a[200:203], a[136:139], v[200:203]
v_mfma_f32_16x16x32_bf16 v[200:203], a[168:171], a[104:107], v[200:203]
s_waitcnt lgkmcnt(8)
v_mfma_f32_16x16x32_bf16 v[204:207], a[168:171], a[108:111], v[204:207]
v_mfma_f32_16x16x32_bf16 v[204:207], a[200:203], a[140:143], v[204:207]
v_mfma_f32_16x16x32_bf16 v[172:175], a[172:175], a[140:143], v[172:175]
v_mfma_f32_16x16x32_bf16 v[172:175], a[204:207], a[108:111], v[172:175]
s_waitcnt lgkmcnt(6)
v_mfma_f32_16x16x32_bf16 v[176:179], a[204:207], a[112:115], v[176:179]
v_mfma_f32_16x16x32_bf16 v[176:179], a[172:175], a[144:147], v[176:179]
v_mfma_f32_16x16x32_bf16 v[208:211], a[200:203], a[144:147], v[208:211]
v_mfma_f32_16x16x32_bf16 v[208:211], a[168:171], a[112:115], v[208:211]
s_waitcnt lgkmcnt(4)
v_mfma_f32_16x16x32_bf16 v[212:215], a[168:171], a[116:119], v[212:215]
v_mfma_f32_16x16x32_bf16 v[212:215], a[200:203], a[148:151], v[212:215]
v_mfma_f32_16x16x32_bf16 v[180:183], a[172:175], a[148:151], v[180:183]
v_mfma_f32_16x16x32_bf16 v[180:183], a[204:207], a[116:119], v[180:183]
s_waitcnt lgkmcnt(2)
v_mfma_f32_16x16x32_bf16 v[184:187], a[204:207], a[120:123], v[184:187]
v_mfma_f32_16x16x32_bf16 v[184:187], a[172:175], a[152:155], v[184:187]
v_mfma_f32_16x16x32_bf16 v[216:219], a[200:203], a[152:155], v[216:219]
v_mfma_f32_16x16x32_bf16 v[216:219], a[168:171], a[120:123], v[216:219]
s_waitcnt lgkmcnt(0)
v_mfma_f32_16x16x32_bf16 v[220:223], a[168:171], a[124:127], v[220:223]
buffer_load_dwordx4 a[168:171], v0, s[20:23], s30 offen offset:0 sc1
v_mfma_f32_16x16x32_bf16 v[220:223], a[200:203], a[156:159], v[220:223]
buffer_load_dwordx4 a[200:203], v0, s[20:23], s30 offen offset:1024 sc1
v_mfma_f32_16x16x32_bf16 v[188:191], a[172:175], a[156:159], v[188:191]
buffer_load_dwordx4 a[172:175], v0, s[20:23], s30 offen offset:2048 sc1
v_mfma_f32_16x16x32_bf16 v[188:191], a[204:207], a[124:127], v[188:191]
buffer_load_dwordx4 a[204:207], v0, s[20:23], s30 offen offset:3072 sc1
s_add_u32 s30, s30, 0x1000
s_waitcnt vmcnt(14)
v_mfma_f32_16x16x32_bf16 v[224:227], a[208:211], a[96:99], v[224:227]
v_mfma_f32_16x16x32_bf16 v[224:227], a[176:179], a[128:131], v[224:227]
v_mfma_f32_16x16x32_bf16 a[224:227], a[180:183], a[128:131], a[224:227]
ds_read_b128 a[128:131], v4 offset:32768
v_mfma_f32_16x16x32_bf16 a[224:227], a[212:215], a[96:99], a[224:227]
ds_read_b128 a[96:99], v3 offset:32768
v_mfma_f32_16x16x32_bf16 a[228:231], a[212:215], a[100:103], a[228:231]
s_waitcnt vmcnt(13)
v_lshlrev_b32 v28, 16, v12
v_and_b32 v29, s33, v12
v_mfma_f32_16x16x32_bf16 a[228:231], a[180:183], a[132:135], a[228:231]
v_lshlrev_b32 v30, 16, v13
v_and_b32 v31, s33, v13
v_mfma_f32_16x16x32_bf16 v[228:231], a[176:179], a[132:135], v[228:231]
ds_read_b128 a[132:135], v4 offset:33792
v_add_f32 v32, v32, v28
v_mfma_f32_16x16x32_bf16 v[228:231], a[208:211], a[100:103], v[228:231]
ds_read_b128 a[100:103], v3 offset:33792
v_add_f32 v33, v33, v29
v_mfma_f32_16x16x32_bf16 v[232:235], a[208:211], a[104:107], v[232:235]
v_add_f32 v34, v34, v30
v_add_f32 v35, v35, v31
v_mfma_f32_16x16x32_bf16 v[232:235], a[176:179], a[136:139], v[232:235]
v_add_f32 v36, v36, v28
v_add_f32 v37, v37, v29
v_mfma_f32_16x16x32_bf16 a[232:235], a[180:183], a[136:139], a[232:235]
ds_read_b128 a[136:139], v4 offset:34816
v_add_f32 v38, v38, v30
v_mfma_f32_16x16x32_bf16 a[232:235], a[212:215], a[104:107], a[232:235]
ds_read_b128 a[104:107], v3 offset:34816
v_add_f32 v39, v39, v31
v_mfma_f32_16x16x32_bf16 a[236:239], a[212:215], a[108:111], a[236:239]
v_add_f32 v40, v40, v28
v_add_f32 v41, v41, v29
v_mfma_f32_16x16x32_bf16 a[236:239], a[180:183], a[140:143], a[236:239]
v_add_f32 v42, v42, v30
v_add_f32 v43, v43, v31
v_mfma_f32_16x16x32_bf16 v[236:239], a[176:179], a[140:143], v[236:239]
ds_read_b128 a[140:143], v4 offset:35840
v_add_f32 v44, v44, v28
v_mfma_f32_16x16x32_bf16 v[236:239], a[208:211], a[108:111], v[236:239]
ds_read_b128 a[108:111], v3 offset:35840
v_add_f32 v45, v45, v29
v_mfma_f32_16x16x32_bf16 v[240:243], a[208:211], a[112:115], v[240:243]
v_add_f32 v46, v46, v30
v_add_f32 v47, v47, v31
v_mfma_f32_16x16x32_bf16 v[240:243], a[176:179], a[144:147], v[240:243]
v_add_f32 v48, v48, v28
v_add_f32 v49, v49, v29
v_mfma_f32_16x16x32_bf16 a[240:243], a[180:183], a[144:147], a[240:243]
ds_read_b128 a[144:147], v4 offset:36864
v_add_f32 v50, v50, v30
v_mfma_f32_16x16x32_bf16 a[240:243], a[212:215], a[112:115], a[240:243]
ds_read_b128 a[112:115], v3 offset:36864
v_add_f32 v51, v51, v31
v_mfma_f32_16x16x32_bf16 a[244:247], a[212:215], a[116:119], a[244:247]
v_add_f32 v52, v52, v28
v_add_f32 v53, v53, v29
v_mfma_f32_16x16x32_bf16 a[244:247], a[180:183], a[148:151], a[244:247]
v_add_f32 v54, v54, v30
v_add_f32 v55, v55, v31
v_mfma_f32_16x16x32_bf16 v[244:247], a[176:179], a[148:151], v[244:247]
ds_read_b128 a[148:151], v4 offset:37888
v_add_f32 v56, v56, v28
v_mfma_f32_16x16x32_bf16 v[244:247], a[208:211], a[116:119], v[244:247]
ds_read_b128 a[116:119], v3 offset:37888
v_add_f32 v57, v57, v29
v_mfma_f32_16x16x32_bf16 v[248:251], a[208:211], a[120:123], v[248:251]
v_add_f32 v58, v58, v30
v_add_f32 v59, v59, v31
v_mfma_f32_16x16x32_bf16 v[248:251], a[176:179], a[152:155], v[248:251]
v_add_f32 v60, v60, v28
v_add_f32 v61, v61, v29
v_mfma_f32_16x16x32_bf16 a[248:251], a[180:183], a[152:155], a[248:251]
ds_read_b128 a[152:155], v4 offset:38912
v_add_f32 v62, v62, v30
v_mfma_f32_16x16x32_bf16 a[248:251], a[212:215], a[120:123], a[248:251]
ds_read_b128 a[120:123], v3 offset:38912
v_add_f32 v63, v63, v31
v_mfma_f32_16x16x32_bf16 a[252:255], a[212:215], a[124:127], a[252:255]
buffer_load_dwordx4 a[212:215], v0, s[20:23], s30 offen offset:0 sc1
v_lshlrev_b32 v28, 16, v14
v_mfma_f32_16x16x32_bf16 a[252:255], a[180:183], a[156:159], a[252:255]
buffer_load_dwordx4 a[180:183], v0, s[20:23], s30 offen offset:1024 sc1
v_and_b32 v29, s33, v14
v_mfma_f32_16x16x32_bf16 v[252:255], a[176:179], a[156:159], v[252:255]
buffer_load_dwordx4 a[176:179], v0, s[20:23], s30 offen offset:2048 sc1
ds_read_b128 a[156:159], v4 offset:39936
v_mfma_f32_16x16x32_bf16 v[252:255], a[208:211], a[124:127], v[252:255]
buffer_load_dwordx4 a[208:211], v0, s[20:23], s30 offen offset:3072 sc1
s_add_u32 s30, s30, 0x1000
ds_read_b128 a[124:127], v3 offset:39936
s_waitcnt vmcnt(12) lgkmcnt(14)
v_mfma_f32_16x16x32_bf16 v[160:163], a[216:219], a[96:99], v[160:163]
v_lshlrev_b32 v30, 16, v15
v_mfma_f32_16x16x32_bf16 v[160:163], a[184:187], a[128:131], v[160:163]
v_and_b32 v31, s33, v15
v_add_f32 v64, v64, v28
v_mfma_f32_16x16x32_bf16 v[192:195], a[188:191], a[128:131], v[192:195]
v_add_f32 v65, v65, v29
v_add_f32 v66, v66, v30
v_mfma_f32_16x16x32_bf16 v[192:195], a[220:223], a[96:99], v[192:195]
v_add_f32 v67, v67, v31
v_add_f32 v68, v68, v28
s_waitcnt lgkmcnt(12)
v_mfma_f32_16x16x32_bf16 v[196:199], a[220:223], a[100:103], v[196:199]
v_add_f32 v69, v69, v29
v_mfma_f32_16x16x32_bf16 v[196:199], a[188:191], a[132:135], v[196:199]
v_add_f32 v70, v70, v30
v_add_f32 v71, v71, v31
v_mfma_f32_16x16x32_bf16 v[164:167], a[184:187], a[132:135], v[164:167]
v_add_f32 v72, v72, v28
v_add_f32 v73, v73, v29
v_mfma_f32_16x16x32_bf16 v[164:167], a[216:219], a[100:103], v[164:167]
v_add_f32 v74, v74, v30
v_add_f32 v75, v75, v31
s_waitcnt lgkmcnt(10)
v_mfma_f32_16x16x32_bf16 v[168:171], a[216:219], a[104:107], v[168:171]
v_add_f32 v76, v76, v28
v_mfma_f32_16x16x32_bf16 v[168:171], a[184:187], a[136:139], v[168:171]
v_add_f32 v77, v77, v29
v_add_f32 v78, v78, v30
v_mfma_f32_16x16x32_bf16 v[200:203], a[188:191], a[136:139], v[200:203]
v_add_f32 v79, v79, v31
v_add_f32 v80, v80, v28
v_mfma_f32_16x16x32_bf16 v[200:203], a[220:223], a[104:107], v[200:203]
v_add_f32 v81, v81, v29
v_add_f32 v82, v82, v30
s_waitcnt lgkmcnt(8)
v_mfma_f32_16x16x32_bf16 v[204:207], a[220:223], a[108:111], v[204:207]
v_add_f32 v83, v83, v31
v_mfma_f32_16x16x32_bf16 v[204:207], a[188:191], a[140:143], v[204:207]
v_add_f32 v84, v84, v28
v_add_f32 v85, v85, v29
v_mfma_f32_16x16x32_bf16 v[172:175], a[184:187], a[140:143], v[172:175]
v_add_f32 v86, v86, v30
v_add_f32 v87, v87, v31
v_mfma_f32_16x16x32_bf16 v[172:175], a[216:219], a[108:111], v[172:175]
v_add_f32 v88, v88, v28
v_add_f32 v89, v89, v29
s_waitcnt lgkmcnt(6)
v_mfma_f32_16x16x32_bf16 v[176:179], a[216:219], a[112:115], v[176:179]
v_add_f32 v90, v90, v30
v_mfma_f32_16x16x32_bf16 v[176:179], a[184:187], a[144:147], v[176:179]
v_add_f32 v91, v91, v31
v_add_f32 v92, v92, v28
v_mfma_f32_16x16x32_bf16 v[208:211], a[188:191], a[144:147], v[208:211]
v_add_f32 v93, v93, v29
v_add_f32 v94, v94, v30
v_mfma_f32_16x16x32_bf16 v[208:211], a[220:223], a[112:115], v[208:211]
v_add_f32 v95, v95, v31
v_lshlrev_b32 v28, 16, v16
s_waitcnt lgkmcnt(4)
v_mfma_f32_16x16x32_bf16 v[212:215], a[220:223], a[116:119], v[212:215]
v_and_b32 v29, s33, v16
v_mfma_f32_16x16x32_bf16 v[212:215], a[188:191], a[148:151], v[212:215]
v_lshlrev_b32 v30, 16, v17
v_and_b32 v31, s33, v17
v_mfma_f32_16x16x32_bf16 v[180:183], a[184:187], a[148:151], v[180:183]
v_add_f32 v96, v96, v28
v_add_f32 v97, v97, v29
v_mfma_f32_16x16x32_bf16 v[180:183], a[216:219], a[116:119], v[180:183]
v_add_f32 v98, v98, v30
v_add_f32 v99, v99, v31
s_waitcnt lgkmcnt(2)
v_mfma_f32_16x16x32_bf16 v[184:187], a[216:219], a[120:123], v[184:187]
v_add_f32 v100, v100, v28
v_mfma_f32_16x16x32_bf16 v[184:187], a[184:187], a[152:155], v[184:187]
v_add_f32 v101, v101, v29
v_add_f32 v102, v102, v30
v_mfma_f32_16x16x32_bf16 v[216:219], a[188:191], a[152:155], v[216:219]
v_add_f32 v103, v103, v31
v_add_f32 v104, v104, v28
v_mfma_f32_16x16x32_bf16 v[216:219], a[220:223], a[120:123], v[216:219]
v_add_f32 v105, v105, v29
v_add_f32 v106, v106, v30
s_waitcnt lgkmcnt(0)
v_mfma_f32_16x16x32_bf16 v[220:223], a[220:223], a[124:127], v[220:223]
buffer_load_dwordx4 a[220:223], v0, s[20:23], s30 offen offset:0 sc1
v_mfma_f32_16x16x32_bf16 v[220:223], a[188:191], a[156:159], v[220:223]
buffer_load_dwordx4 a[188:191], v0, s[20:23], s30 offen offset:1024 sc1
v_add_f32 v107, v107, v31
v_mfma_f32_16x16x32_bf16 v[188:191], a[184:187], a[156:159], v[188:191]
buffer_load_dwordx4 a[184:187], v0, s[20:23], s30 offen offset:2048 sc1
v_add_f32 v108, v108, v28
v_mfma_f32_16x16x32_bf16 v[188:191], a[216:219], a[124:127], v[188:191]
buffer_load_dwordx4 a[216:219], v0, s[20:23], s30 offen offset:3072 sc1
s_add_u32 s30, s30, 0x1000
s_barrier
s_waitcnt vmcnt(12)
v_mfma_f32_16x16x32_bf16 v[224:227], a[160:163], a[96:99], v[224:227]
s_cmp_lg_u32 s28, 0
s_cbranch_scc1 L_nf3
s_add_u32 s34, s8, 3
v_mov_b32 v10, s34
v_mov_b32 v11, s9
s_mov_b64 exec, 1
buffer_store_dwordx2 v[10:11], off, s[20:23], s35 sc1
s_mov_b64 exec, -1
L_nf3:
v_mfma_f32_16x16x32_bf16 v[224:227], a[192:195], a[128:131], v[224:227]
v_add_f32 v109, v109, v29
v_add_f32 v110, v110, v30
v_mfma_f32_16x16x32_bf16 a[224:227], a[196:199], a[128:131], a[224:227]
v_xor_b32 v2, 0x12000, v6
ds_read_b128 a[128:131], v2 offset:0
v_mfma_f32_16x16x32_bf16 a[224:227], a[164:167], a[96:99], a[224:227]
v_xor_b32 v1, 0x10000, v6
ds_read_b128 a[96:99], v1 offset:0
v_mfma_f32_16x16x32_bf16 a[228:231], a[164:167], a[100:103], a[228:231]
v_add_f32 v111, v111, v31
v_add_f32 v112, v112, v28
v_mfma_f32_16x16x32_bf16 a[228:231], a[196:199], a[132:135], a[228:231]
v_add_f32 v113, v113, v29
v_add_f32 v114, v114, v30
v_mfma_f32_16x16x32_bf16 v[228:231], a[192:195], a[132:135], v[228:231]
ds_read_b128 a[132:135], v2 offset:1024
v_add_f32 v115, v115, v31
v_mfma_f32_16x16x32_bf16 v[228:231], a[160:163], a[100:103], v[228:231]
ds_read_b128 a[100:103], v1 offset:1024
v_add_f32 v116, v116, v28
v_mfma_f32_16x16x32_bf16 v[232:235], a[160:163], a[104:107], v[232:235]
buffer_load_dwordx2 v[10:11], off, s[20:23], s36 sc1
v_add_f32 v117, v117, v29
v_mfma_f32_16x16x32_bf16 v[232:235], a[192:195], a[136:139], v[232:235]
v_add_f32 v118, v118, v30
v_add_f32 v119, v119, v31
v_mfma_f32_16x16x32_bf16 a[232:235], a[196:199], a[136:139], a[232:235]
ds_read_b128 a[136:139], v2 offset:2048
v_add_f32 v120, v120, v28
v_mfma_f32_16x16x32_bf16 a[232:235], a[164:167], a[104:107], a[232:235]
ds_read_b128 a[104:107], v1 offset:2048
v_add_f32 v121, v121, v29
v_mfma_f32_16x16x32_bf16 a[236:239], a[164:167], a[108:111], a[236:239]
v_add_f32 v122, v122, v30
v_add_f32 v123, v123, v31
v_mfma_f32_16x16x32_bf16 a[236:239], a[196:199], a[140:143], a[236:239]
v_add_f32 v124, v124, v28
v_add_f32 v125, v125, v29
v_mfma_f32_16x16x32_bf16 v[236:239], a[192:195], a[140:143], v[236:239]
ds_read_b128 a[140:143], v2 offset:3072
v_add_f32 v126, v126, v30
v_mfma_f32_16x16x32_bf16 v[236:239], a[160:163], a[108:111], v[236:239]
ds_read_b128 a[108:111], v1 offset:3072
v_add_f32 v127, v127, v31
v_mfma_f32_16x16x32_bf16 v[240:243], a[160:163], a[112:115], v[240:243]
v_lshlrev_b32 v28, 16, v18
v_and_b32 v29, s33, v18
v_mfma_f32_16x16x32_bf16 v[240:243], a[192:195], a[144:147], v[240:243]
v_lshlrev_b32 v30, 16, v19
v_and_b32 v31, s33, v19
v_mfma_f32_16x16x32_bf16 a[240:243], a[196:199], a[144:147], a[240:243]
ds_read_b128 a[144:147], v2 offset:4096
v_add_f32 v128, v128, v28
v_mfma_f32_16x16x32_bf16 a[240:243], a[164:167], a[112:115], a[240:243]
ds_read_b128 a[112:115], v1 offset:4096
v_add_f32 v129, v129, v29
v_mfma_f32_16x16x32_bf16 a[244:247], a[164:167], a[116:119], a[244:247]
v_add_f32 v130, v130, v30
v_add_f32 v131, v131, v31
v_mfma_f32_16x16x32_bf16 a[244:247], a[196:199], a[148:151], a[244:247]
v_add_f32 v132, v132, v28
v_add_f32 v133, v133, v29
v_mfma_f32_16x16x32_bf16 v[244:247], a[192:195], a[148:151], v[244:247]
ds_read_b128 a[148:151], v2 offset:5120
v_add_f32 v134, v134, v30
v_mfma_f32_16x16x32_bf16 v[244:247], a[160:163], a[116:119], v[244:247]
ds_read_b128 a[116:119], v1 offset:5120
v_add_f32 v135, v135, v31
v_mfma_f32_16x16x32_bf16 v[248:251], a[160:163], a[120:123], v[248:251]
v_add_f32 v136, v136, v28
v_add_f32 v137, v137, v29
v_mfma_f32_16x16x32_bf16 v[248:251], a[192:195], a[152:155], v[248:251]
v_add_f32 v138, v138, v30
v_add_f32 v139, v139, v31
v_mfma_f32_16x16x32_bf16 a[248:251], a[196:199], a[152:155], a[248:251]
ds_read_b128 a[152:155], v2 offset:6144
v_add_f32 v140, v140, v28
v_mfma_f32_16x16x32_bf16 a[248:251], a[164:167], a[120:123], a[248:251]
ds_read_b128 a[120:123], v1 offset:6144
v_add_f32 v141, v141, v29
v_mfma_f32_16x16x32_bf16 a[252:255], a[164:167], a[124:127], a[252:255]
buffer_load_dwordx4 a[164:167], v0, s[20:23], s30 offen offset:0 sc1
v_add_f32 v142, v142, v30
v_mfma_f32_16x16x32_bf16 a[252:255], a[196:199], a[156:159], a[252:255]
buffer_load_dwordx4 a[196:199], v0, s[20:23], s30 offen offset:1024 sc1
v_add_f32 v143, v143, v31
v_mfma_f32_16x16x32_bf16 v[252:255], a[192:195], a[156:159], v[252:255]
buffer_load_dwordx4 a[192:195], v0, s[20:23], s30 offen offset:2048 sc1
ds_read_b128 a[156:159], v2 offset:7168
v_mfma_f32_16x16x32_bf16 v[252:255], a[160:163], a[124:127], v[252:255]
buffer_load_dwordx4 a[160:163], v0, s[20:23], s30 offen offset:3072 sc1
s_add_u32 s30, s30, 0x1000
ds_read_b128 a[124:127], v1 offset:7168
L_q5:
s_waitcnt vmcnt(13) lgkmcnt(14)
v_mfma_f32_16x16x32_bf16 v[32:35], a[168:171], a[96:99], v[32:35]
v_add_f32 v144, v144, v28
v_mfma_f32_16x16x32_bf16 v[32:35], a[200:203], a[128:131], v[32:35]
v_add_f32 v145, v145, v29
v_add_f32 v146, v146, v30
v_mfma_f32_16x16x32_bf16 v[64:67], a[204:207], a[128:131], v[64:67]
v_add_f32 v147, v147, v31
v_add_f32 v148, v148, v28
v_mfma_f32_16x16x32_bf16 v[64:67], a[172:175], a[96:99], v[64:67]
v_add_f32 v149, v149, v29
v_add_f32 v150, v150, v30
s_waitcnt lgkmcnt(12)
v_mfma_f32_16x16x32_bf16 v[68:71], a[172:175], a[100:103], v[68:71]
v_add_f32 v151, v151, v31
v_mfma_f32_16x16x32_bf16 v[68:71], a[204:207], a[132:135], v[68:71]
v_add_f32 v152, v152, v28
v_add_f32 v153, v153, v29
v_mfma_f32_16x16x32_bf16 v[36:39], a[200:203], a[132:135], v[36:39]
v_add_f32 v154, v154, v30
v_add_f32 v155, v155, v31
v_mfma_f32_16x16x32_bf16 v[36:39], a[168:171], a[100:103], v[36:39]
v_add_f32 v156, v156, v28
v_add_f32 v157, v157, v29
s_waitcnt lgkmcnt(10)
v_mfma_f32_16x16x32_bf16 v[40:43], a[168:171], a[104:107], v[40:43]
v_add_f32 v158, v158, v30
v_mfma_f32_16x16x32_bf16 v[40:43], a[200:203], a[136:139], v[40:43]
v_add_f32 v159, v159, v31
v_mfma_f32_16x16x32_bf16 v[72:75], a[204:207], a[136:139], v[72:75]
v_mfma_f32_16x16x32_bf16 v[72:75], a[172:175], a[104:107], v[72:75]
s_waitcnt lgkmcnt(8)
v_mfma_f32_16x16x32_bf16 v[76:79], a[172:175], a[108:111], v[76:79]
v_mfma_f32_16x16x32_bf16 v[76:79], a[204:207], a[140:143], v[76:79]
v_mfma_f32_16x16x32_bf16 v[44:47], a[200:203], a[140:143], v[44:47]
v_mfma_f32_16x16x32_bf16 v[44:47], a[168:171], a[108:111], v[44:47]
s_waitcnt lgkmcnt(6)
v_mfma_f32_16x16x32_bf16 v[48:51], a[168:171], a[112:115], v[48:51]
v_mfma_f32_16x16x32_bf16 v[48:51], a[200:203], a[144:147], v[48:51]
v_mfma_f32_16x16x32_bf16 v[80:83], a[204:207], a[144:147], v[80:83]
v_mfma_f32_16x16x32_bf16 v[80:83], a[172:175], a[112:115], v[80:83]
s_waitcnt lgkmcnt(4)
v_mfma_f32_16x16x32_bf16 v[84:87], a[172:175], a[116:119], v[84:87]
v_mfma_f32_16x16x32_bf16 v[84:87], a[204:207], a[148:151], v[84:87]
v_mfma_f32_16x16x32_bf16 v[52:55], a[200:203], a[148:151], v[52:55]
v_mfma_f32_16x16x32_bf16 v[52:55], a[168:171], a[116:119], v[52:55]
s_waitcnt lgkmcnt(2)
v_mfma_f32_16x16x32_bf16 v[56:59], a[168:171], a[120:123], v[56:59]
v_mfma_f32_16x16x32_bf16 v[56:59], a[200:203], a[152:155], v[56:59]
v_mfma_f32_16x16x32_bf16 v[88:91], a[204:207], a[152:155], v[88:91]
v_mfma_f32_16x16x32_bf16 v[88:91], a[172:175], a[120:123], v[88:91]
s_waitcnt lgkmcnt(0)
v_mfma_f32_16x16x32_bf16 v[92:95], a[172:175], a[124:127], v[92:95]
buffer_load_dwordx4 a[172:175], v0, s[20:23], s30 offen offset:0 sc1
v_mfma_f32_16x16x32_bf16 v[92:95], a[204:207], a[156:159], v[92:95]
buffer_load_dwordx4 a[204:207], v0, s[20:23], s30 offen offset:1024 sc1
v_mfma_f32_16x16x32_bf16 v[60:63], a[200:203], a[156:159], v[60:63]
buffer_load_dwordx4 a[200:203], v0, s[20:23], s30 offen offset:2048 sc1
v_mfma_f32_16x16x32_bf16 v[60:63], a[168:171], a[124:127], v[60:63]
buffer_load_dwordx4 a[168:171], v0, s[20:23], s30 offen offset:3072 sc1
s_add_u32 s30, s30, 0x1000
s_waitcnt vmcnt(13)
v_mfma_f32_16x16x32_bf16 v[96:99], a[212:215], a[96:99], v[96:99]
s_add_u32 s96, s92, L_q7-L_pc
s_addc_u32 s97, s93, 0
s_load_dword s98, s[96:97], 0
v_mfma_f32_16x16x32_bf16 v[96:99], a[180:183], a[128:131], v[96:99]
v_mfma_f32_16x16x32_bf16 v[128:131], a[208:211], a[128:131], v[128:131]
v_mfma_f32_16x16x32_bf16 v[128:131], a[176:179], a[96:99], v[128:131]
v_mfma_f32_16x16x32_bf16 v[132:135], a[176:179], a[100:103], v[132:135]
v_mfma_f32_16x16x32_bf16 v[132:135], a[208:211], a[132:135], v[132:135]
v_mfma_f32_16x16x32_bf16 v[100:103], a[180:183], a[132:135], v[100:103]
v_mfma_f32_16x16x32_bf16 v[100:103], a[212:215], a[100:103], v[100:103]
v_mfma_f32_16x16x32_bf16 v[104:107], a[212:215], a[104:107], v[104:107]
s_waitcnt vmcnt(8)
v_readfirstlane_b32 s34, v10
v_readfirstlane_b32 s11, v11
s_xor_b32 s34, s34, s8
s_sub_u32 s34, s34, 2
s_cmp_lg_u32 s11, s9
s_cbranch_scc1 L_spin2
s_cmp_gt_u32 s34, 13
s_cbranch_scc1 L_spin2
L_back2:
s_add_u32 m0, s32, 0
s_add_u32 s39, s56, 0
v_mfma_f32_16x16x32_bf16 v[104:107], a[180:183], a[136:139], v[104:107]
buffer_load_dwordx4 v0, s[20:23], s39 offen offset:0 sc1 lds
v_mfma_f32_16x16x32_bf16 v[136:139], a[208:211], a[136:139], v[136:139]
v_mfma_f32_16x16x32_bf16 v[136:139], a[176:179], a[104:107], v[136:139]
v_mfma_f32_16x16x32_bf16 v[140:143], a[176:179], a[108:111], v[140:143]
v_mfma_f32_16x16x32_bf16 v[140:143], a[208:211], a[140:143], v[140:143]
v_mfma_f32_16x16x32_bf16 v[108:111], a[180:183], a[140:143], v[108:111]
v_mfma_f32_16x16x32_bf16 v[108:111], a[212:215], a[108:111], v[108:111]
v_mfma_f32_16x16x32_bf16 v[112:115], a[212:215], a[112:115], v[112:115]
v_mfma_f32_16x16x32_bf16 v[112:115], a[180:183], a[144:147], v[112:115]
v_mfma_f32_16x16x32_bf16 v[144:147], a[208:211], a[144:147], v[144:147]
v_mfma_f32_16x16x32_bf16 v[144:147], a[176:179], a[112:115], v[144:147]
v_mfma_f32_16x16x32_bf16 v[148:151], a[176:179], a[116:119], v[148:151]
v_mfma_f32_16x16x32_bf16 v[148:151], a[208:211], a[148:151], v[148:151]
v_mfma_f32_16x16x32_bf16 v[116:119], a[180:183], a[148:151], v[116:119]
v_mfma_f32_16x16x32_bf16 v[116:119], a[212:215], a[116:119], v[116:119]
v_mfma_f32_16x16x32_bf16 v[120:123], a[212:215], a[120:123], v[120:123]
v_mfma_f32_16x16x32_bf16 v[120:123], a[180:183], a[152:155], v[120:123]
v_mfma_f32_16x16x32_bf16 v[152:155], a[208:211], a[152:155], v[152:155]
v_mfma_f32_16x16x32_bf16 v[152:155], a[176:179], a[120:123], v[152:155]
v_mfma_f32_16x16x32_bf16 v[156:159], a[176:179], a[124:127], v[156:159]
buffer_load_dwordx4 a[176:179], v0, s[20:23], s30 offen offset:0 sc1
v_mfma_f32_16x16x32_bf16 v[156:159], a[208:211], a[156:159], v[156:159]
buffer_load_dwordx4 a[208:211], v0, s[20:23], s30 offen offset:1024 sc1
v_mfma_f32_16x16x32_bf16 v[124:127], a[180:183], a[156:159], v[124:127]
buffer_load_dwordx4 a[180:183], v0, s[20:23], s30 offen offset:2048 sc1
v_mfma_f32_16x16x32_bf16 v[124:127], a[212:215], a[124:127], v[124:127]
buffer_load_dwordx4 a[212:215], v0, s[20:23], s30 offen offset:3072 sc1
s_add_u32 s30, s30, 0x1000
v_mfma_f32_16x16x32_bf16 v[160:163], a[220:223], a[96:99], v[160:163]
v_mfma_f32_16x16x32_bf16 v[160:163], a[188:191], a[128:131], v[160:163]
v_mfma_f32_16x16x32_bf16 v[192:195], a[216:219], a[128:131], v[192:195]
v_mfma_f32_16x16x32_bf16 v[192:195], a[184:187], a[96:99], v[192:195]
v_mfma_f32_16x16x32_bf16 v[196:199], a[184:187], a[100:103], v[196:199]
v_mfma_f32_16x16x32_bf16 v[196:199], a[216:219], a[132:135], v[196:199]
v_mfma_f32_16x16x32_bf16 v[164:167], a[188:191], a[132:135], v[164:167]
v_mfma_f32_16x16x32_bf16 v[164:167], a[220:223], a[100:103], v[164:167]
buffer_load_dwordx4 v0, s[20:23], s39 offen offset:1024 sc1 lds
v_mfma_f32_16x16x32_bf16 v[168:171], a[220:223], a[104:107], v[168:171]
v_mfma_f32_16x16x32_bf16 v[168:171], a[188:191], a[136:139], v[168:171]
v_mfma_f32_16x16x32_bf16 v[200:203], a[216:219], a[136:139], v[200:203]
v_mfma_f32_16x16x32_bf16 v[200:203], a[184:187], a[104:107], v[200:203]
v_mfma_f32_16x16x32_bf16 v[204:207], a[184:187], a[108:111], v[204:207]
v_mfma_f32_16x16x32_bf16 v[204:207], a[216:219], a[140:143], v[204:207]
v_mfma_f32_16x16x32_bf16 v[172:175], a[188:191], a[140:143], v[172:175]
v_mfma_f32_16x16x32_bf16 v[172:175], a[220:223], a[108:111], v[172:175]
v_mfma_f32_16x16x32_bf16 v[176:179], a[220:223], a[112:115], v[176:179]
v_mfma_f32_16x16x32_bf16 v[176:179], a[188:191], a[144:147], v[176:179]
v_mfma_f32_16x16x32_bf16 v[208:211], a[216:219], a[144:147], v[208:211]
v_mfma_f32_16x16x32_bf16 v[208:211], a[184:187], a[112:115], v[208:211]
v_mfma_f32_16x16x32_bf16 v[212:215], a[184:187], a[116:119], v[212:215]
v_mfma_f32_16x16x32_bf16 v[212:215], a[216:219], a[148:151], v[212:215]
v_mfma_f32_16x16x32_bf16 v[180:183], a[188:191], a[148:151], v[180:183]
v_mfma_f32_16x16x32_bf16 v[180:183], a[220:223], a[116:119], v[180:183]
v_mfma_f32_16x16x32_bf16 v[184:187], a[220:223], a[120:123], v[184:187]
v_mfma_f32_16x16x32_bf16 v[184:187], a[188:191], a[152:155], v[184:187]
v_mfma_f32_16x16x32_bf16 v[216:219], a[216:219], a[152:155], v[216:219]
v_mfma_f32_16x16x32_bf16 v[216:219], a[184:187], a[120:123], v[216:219]
v_mfma_f32_16x16x32_bf16 v[220:223], a[184:187], a[124:127], v[220:223]
buffer_load_dwordx4 a[184:187], v0, s[20:23], s30 offen offset:0 sc1
v_mfma_f32_16x16x32_bf16 v[220:223], a[216:219], a[156:159], v[220:223]
buffer_load_dwordx4 a[216:219], v0, s[20:23], s30 offen offset:1024 sc1
v_mfma_f32_16x16x32_bf16 v[188:191], a[188:191], a[156:159], v[188:191]
buffer_load_dwordx4 a[188:191], v0, s[20:23], s30 offen offset:2048 sc1
v_mfma_f32_16x16x32_bf16 v[188:191], a[220:223], a[124:127], v[188:191]
buffer_load_dwordx4 a[220:223], v0, s[20:23], s30 offen offset:3072 sc1
s_add_u32 s30, s30, 0x1000
s_waitcnt vmcnt(14)
v_mfma_f32_16x16x32_bf16 v[224:227], a[164:167], a[96:99], v[224:227]
v_mfma_f32_16x16x32_bf16 v[224:227], a[196:199], a[128:131], v[224:227]
v_mfma_f32_16x16x32_bf16 a[224:227], a[160:163], a[128:131], a[224:227]
v_xor_b32 v4, 0x16000, v6
ds_read_b128 a[128:131], v4 offset:0
v_mfma_f32_16x16x32_bf16 a[224:227], a[192:195], a[96:99], a[224:227]
v_xor_b32 v3, 0x14000, v6
ds_read_b128 a[96:99], v3 offset:0
v_mfma_f32_16x16x32_bf16 a[228:231], a[192:195], a[100:103], a[228:231]
v_mfma_f32_16x16x32_bf16 a[228:231], a[160:163], a[132:135], a[228:231]
buffer_load_dwordx4 v0, s[20:23], s39 offen offset:2048 sc1 lds
v_mfma_f32_16x16x32_bf16 v[228:231], a[196:199], a[132:135], v[228:231]
ds_read_b128 a[132:135], v4 offset:1024
v_mfma_f32_16x16x32_bf16 v[228:231], a[164:167], a[100:103], v[228:231]
ds_read_b128 a[100:103], v3 offset:1024
v_mfma_f32_16x16x32_bf16 v[232:235], a[164:167], a[104:107], v[232:235]
v_mfma_f32_16x16x32_bf16 v[232:235], a[196:199], a[136:139], v[232:235]
v_mfma_f32_16x16x32_bf16 a[232:235], a[160:163], a[136:139], a[232:235]
ds_read_b128 a[136:139], v4 offset:2048
v_mfma_f32_16x16x32_bf16 a[232:235], a[192:195], a[104:107], a[232:235]
ds_read_b128 a[104:107], v3 offset:2048
v_mfma_f32_16x16x32_bf16 a[236:239], a[192:195], a[108:111], a[236:239]
v_mfma_f32_16x16x32_bf16 a[236:239], a[160:163], a[140:143], a[236:239]
v_mfma_f32_16x16x32_bf16 v[236:239], a[196:199], a[140:143], v[236:239]
ds_read_b128 a[140:143], v4 offset:3072
v_mfma_f32_16x16x32_bf16 v[236:239], a[164:167], a[108:111], v[236:239]
ds_read_b128 a[108:111], v3 offset:3072
v_mfma_f32_16x16x32_bf16 v[240:243], a[164:167], a[112:115], v[240:243]
v_mfma_f32_16x16x32_bf16 v[240:243], a[196:199], a[144:147], v[240:243]
v_mfma_f32_16x16x32_bf16 a[240:243], a[160:163], a[144:147], a[240:243]
ds_read_b128 a[144:147], v4 offset:4096
v_mfma_f32_16x16x32_bf16 a[240:243], a[192:195], a[112:115], a[240:243]
ds_read_b128 a[112:115], v3 offset:4096
v_mfma_f32_16x16x32_bf16 a[244:247], a[192:195], a[116:119], a[244:247]
v_mfma_f32_16x16x32_bf16 a[244:247], a[160:163], a[148:151], a[244:247]
v_mfma_f32_16x16x32_bf16 v[244:247], a[196:199], a[148:151], v[244:247]
ds_read_b128 a[148:151], v4 offset:5120
v_mfma_f32_16x16x32_bf16 v[244:247], a[164:167], a[116:119], v[244:247]
ds_read_b128 a[116:119], v3 offset:5120
v_mfma_f32_16x16x32_bf16 v[248:251], a[164:167], a[120:123], v[248:251]
v_mfma_f32_16x16x32_bf16 v[248:251], a[196:199], a[152:155], v[248:251]
v_mfma_f32_16x16x32_bf16 a[248:251], a[160:163], a[152:155], a[248:251]
ds_read_b128 a[152:155], v4 offset:6144
v_mfma_f32_16x16x32_bf16 a[248:251], a[192:195], a[120:123], a[248:251]
ds_read_b128 a[120:123], v3 offset:6144
v_mfma_f32_16x16x32_bf16 a[252:255], a[192:195], a[124:127], a[252:255]
buffer_load_dwordx4 a[192:195], v0, s[20:23], s30 offen offset:0 sc1
v_mfma_f32_16x16x32_bf16 a[252:255], a[160:163], a[156:159], a[252:255]
buffer_load_dwordx4 a[160:163], v0, s[20:23], s30 offen offset:1024 sc1
v_mfma_f32_16x16x32_bf16 v[252:255], a[196:199], a[156:159], v[252:255]
buffer_load_dwordx4 a[196:199], v0, s[20:23], s30 offen offset:2048 sc1
ds_read_b128 a[156:159], v4 offset:7168
v_mfma_f32_16x16x32_bf16 v[252:255], a[164:167], a[124:127], v[252:255]
buffer_load_dwordx4 a[164:167], v0, s[20:23], s30 offen offset:3072 sc1
s_add_u32 s30, s30, 0x1000
ds_read_b128 a[124:127], v3 offset:7168
s_waitcnt vmcnt(15) lgkmcnt(14)
v_mfma_f32_16x16x32_bf16 v[32:35], a[172:175], a[96:99], v[32:35]
v_mfma_f32_16x16x32_bf16 v[32:35], a[204:207], a[128:131], v[32:35]
v_mfma_f32_16x16x32_bf16 v[64:67], a[168:171], a[128:131], v[64:67]
v_mfma_f32_16x16x32_bf16 v[64:67], a[200:203], a[96:99], v[64:67]
buffer_load_dwordx4 v0, s[20:23], s39 offen offset:3072 sc1 lds
s_waitcnt lgkmcnt(12)
v_mfma_f32_16x16x32_bf16 v[68:71], a[200:203], a[100:103], v[68:71]
v_mfma_f32_16x16x32_bf16 v[68:71], a[168:171], a[132:135], v[68:71]
v_mfma_f32_16x16x32_bf16 v[36:39], a[204:207], a[132:135], v[36:39]
v_mfma_f32_16x16x32_bf16 v[36:39], a[172:175], a[100:103], v[36:39]
s_waitcnt lgkmcnt(10)
v_mfma_f32_16x16x32_bf16 v[40:43], a[172:175], a[104:107], v[40:43]
v_mfma_f32_16x16x32_bf16 v[40:43], a[204:207], a[136:139], v[40:43]
v_mfma_f32_16x16x32_bf16 v[72:75], a[168:171], a[136:139], v[72:75]
v_mfma_f32_16x16x32_bf16 v[72:75], a[200:203], a[104:107], v[72:75]
s_waitcnt lgkmcnt(8)
v_mfma_f32_16x16x32_bf16 v[76:79], a[200:203], a[108:111], v[76:79]
v_mfma_f32_16x16x32_bf16 v[76:79], a[168:171], a[140:143], v[76:79]
v_mfma_f32_16x16x32_bf16 v[44:47], a[204:207], a[140:143], v[44:47]
v_mfma_f32_16x16x32_bf16 v[44:47], a[172:175], a[108:111], v[44:47]
s_waitcnt lgkmcnt(6)
v_mfma_f32_16x16x32_bf16 v[48:51], a[172:175], a[112:115], v[48:51]
v_mfma_f32_16x16x32_bf16 v[48:51], a[204:207], a[144:147], v[48:51]
v_mfma_f32_16x16x32_bf16 v[80:83], a[168:171], a[144:147], v[80:83]
v_mfma_f32_16x16x32_bf16 v[80:83], a[200:203], a[112:115], v[80:83]
s_waitcnt lgkmcnt(4)
v_mfma_f32_16x16x32_bf16 v[84:87], a[200:203], a[116:119], v[84:87]
v_mfma_f32_16x16x32_bf16 v[84:87], a[168:171], a[148:151], v[84:87]
v_mfma_f32_16x16x32_bf16 v[52:55], a[204:207], a[148:151], v[52:55]
v_mfma_f32_16x16x32_bf16 v[52:55], a[172:175], a[116:119], v[52:55]
s_waitcnt lgkmcnt(2)
v_mfma_f32_16x16x32_bf16 v[56:59], a[172:175], a[120:123], v[56:59]
v_mfma_f32_16x16x32_bf16 v[56:59], a[204:207], a[152:155], v[56:59]
v_mfma_f32_16x16x32_bf16 v[88:91], a[168:171], a[152:155], v[88:91]
v_mfma_f32_16x16x32_bf16 v[88:91], a[200:203], a[120:123], v[88:91]
s_waitcnt lgkmcnt(0)
v_mfma_f32_16x16x32_bf16 v[92:95], a[200:203], a[124:127], v[92:95]
buffer_load_dwordx4 a[200:203], v0, s[20:23], s30 offen offset:0 sc1
v_mfma_f32_16x16x32_bf16 v[92:95], a[168:171], a[156:159], v[92:95]
buffer_load_dwordx4 a[168:171], v0, s[20:23], s30 offen offset:1024 sc1
v_mfma_f32_16x16x32_bf16 v[60:63], a[204:207], a[156:159], v[60:63]
buffer_load_dwordx4 a[204:207], v0, s[20:23], s30 offen offset:2048 sc1
v_mfma_f32_16x16x32_bf16 v[60:63], a[172:175], a[124:127], v[60:63]
buffer_load_dwordx4 a[172:175], v0, s[20:23], s30 offen offset:3072 sc1
s_add_u32 s30, s30, 0x1000
s_waitcnt vmcnt(15)
v_mfma_f32_16x16x32_bf16 v[96:99], a[176:179], a[96:99], v[96:99]
s_add_u32 m0, s32, 4096
s_add_u32 s39, s56, 4096
v_mfma_f32_16x16x32_bf16 v[96:99], a[208:211], a[128:131], v[96:99]
buffer_load_dwordx4 v0, s[20:23], s39 offen offset:0 sc1 lds
v_mfma_f32_16x16x32_bf16 v[128:131], a[212:215], a[128:131], v[128:131]
v_mfma_f32_16x16x32_bf16 v[128:131], a[180:183], a[96:99], v[128:131]
v_mfma_f32_16x16x32_bf16 v[132:135], a[180:183], a[100:103], v[132:135]
v_mfma_f32_16x16x32_bf16 v[132:135], a[212:215], a[132:135], v[132:135]
v_mfma_f32_16x16x32_bf16 v[100:103], a[208:211], a[132:135], v[100:103]
v_mfma_f32_16x16x32_bf16 v[100:103], a[176:179], a[100:103], v[100:103]
v_mfma_f32_16x16x32_bf16 v[104:107], a[176:179], a[104:107], v[104:107]
v_mfma_f32_16x16x32_bf16 v[104:107], a[208:211], a[136:139], v[104:107]
v_mfma_f32_16x16x32_bf16 v[136:139], a[212:215], a[136:139], v[136:139]
v_mfma_f32_16x16x32_bf16 v[136:139], a[180:183], a[104:107], v[136:139]
v_mfma_f32_16x16x32_bf16 v[140:143], a[180:183], a[108:111], v[140:143]
v_mfma_f32_16x16x32_bf16 v[140:143], a[212:215], a[140:143], v[140:143]
v_mfma_f32_16x16x32_bf16 v[108:111], a[208:211], a[140:143], v[108:111]
v_mfma_f32_16x16x32_bf16 v[108:111], a[176:179], a[108:111], v[108:111]
v_mfma_f32_16x16x32_bf16 v[112:115], a[176:179], a[112:115], v[112:115]
v_mfma_f32_16x16x32_bf16 v[112:115], a[208:211], a[144:147], v[112:115]
v_mfma_f32_16x16x32_bf16 v[144:147], a[212:215], a[144:147], v[144:147]
v_mfma_f32_16x16x32_bf16 v[144:147], a[180:183], a[112:115], v[144:147]
v_mfma_f32_16x16x32_bf16 v[148:151], a[180:183], a[116:119], v[148:151]
v_mfma_f32_16x16x32_bf16 v[148:151], a[212:215], a[148:151], v[148:151]
v_mfma_f32_16x16x32_bf16 v[116:119], a[208:211], a[148:151], v[116:119]
v_mfma_f32_16x16x32_bf16 v[116:119], a[176:179], a[116:119], v[116:119]
v_mfma_f32_16x16x32_bf16 v[120:123], a[176:179], a[120:123], v[120:123]
v_mfma_f32_16x16x32_bf16 v[120:123], a[208:211], a[152:155], v[120:123]
v_mfma_f32_16x16x32_bf16 v[152:155], a[212:215], a[152:155], v[152:155]
v_mfma_f32_16x16x32_bf16 v[152:155], a[180:183], a[120:123], v[152:155]
v_mfma_f32_16x16x32_bf16 v[156:159], a[180:183], a[124:127], v[156:159]
buffer_load_dwordx4 a[180:183], v0, s[20:23], s30 offen offset:0 sc1
v_mfma_f32_16x16x32_bf16 v[156:159], a[212:215], a[156:159], v[156:159]
buffer_load_dwordx4 a[212:215], v0, s[20:23], s30 offen offset:1024 sc1
v_mfma_f32_16x16x32_bf16 v[124:127], a[208:211], a[156:159], v[124:127]
buffer_load_dwordx4 a[208:211], v0, s[20:23], s30 offen offset:2048 sc1
v_mfma_f32_16x16x32_bf16 v[124:127], a[176:179], a[124:127], v[124:127]
buffer_load_dwordx4 a[176:179], v0, s[20:23], s30 offen offset:3072 sc1
s_add_u32 s30, s30, 0x1000
buffer_load_dwordx4 v0, s[20:23], s39 offen offset:1024 sc1 lds
s_waitcnt vmcnt(16)
v_mfma_f32_16x16x32_bf16 v[160:163], a[184:187], a[96:99], v[160:163]
v_mfma_f32_16x16x32_bf16 v[160:163], a[216:219], a[128:131], v[160:163]
v_mfma_f32_16x16x32_bf16 v[192:195], a[220:223], a[128:131], v[192:195]
v_mfma_f32_16x16x32_bf16 v[192:195], a[188:191], a[96:99], v[192:195]
v_mfma_f32_16x16x32_bf16 v[196:199], a[188:191], a[100:103], v[196:199]
v_mfma_f32_16x16x32_bf16 v[196:199], a[220:223], a[132:135], v[196:199]
v_mfma_f32_16x16x32_bf16 v[164:167], a[216:219], a[132:135], v[164:167]
v_mfma_f32_16x16x32_bf16 v[164:167], a[184:187], a[100:103], v[164:167]
v_mfma_f32_16x16x32_bf16 v[168:171], a[184:187], a[104:107], v[168:171]
v_mfma_f32_16x16x32_bf16 v[168:171], a[216:219], a[136:139], v[168:171]
v_mfma_f32_16x16x32_bf16 v[200:203], a[220:223], a[136:139], v[200:203]
v_mfma_f32_16x16x32_bf16 v[200:203], a[188:191], a[104:107], v[200:203]
v_mfma_f32_16x16x32_bf16 v[204:207], a[188:191], a[108:111], v[204:207]
v_mfma_f32_16x16x32_bf16 v[204:207], a[220:223], a[140:143], v[204:207]
v_mfma_f32_16x16x32_bf16 v[172:175], a[216:219], a[140:143], v[172:175]
v_mfma_f32_16x16x32_bf16 v[172:175], a[184:187], a[108:111], v[172:175]
v_mfma_f32_16x16x32_bf16 v[176:179], a[184:187], a[112:115], v[176:179]
v_mfma_f32_16x16x32_bf16 v[176:179], a[216:219], a[144:147], v[176:179]
v_mfma_f32_16x16x32_bf16 v[208:211], a[220:223], a[144:147], v[208:211]
v_mfma_f32_16x16x32_bf16 v[208:211], a[188:191], a[112:115], v[208:211]
v_mfma_f32_16x16x32_bf16 v[212:215], a[188:191], a[116:119], v[212:215]
v_mfma_f32_16x16x32_bf16 v[212:215], a[220:223], a[148:151], v[212:215]
v_mfma_f32_16x16x32_bf16 v[180:183], a[216:219], a[148:151], v[180:183]
v_mfma_f32_16x16x32_bf16 v[180:183], a[184:187], a[116:119], v[180:183]
v_mfma_f32_16x16x32_bf16 v[184:187], a[184:187], a[120:123], v[184:187]
v_mfma_f32_16x16x32_bf16 v[184:187], a[216:219], a[152:155], v[184:187]
v_mfma_f32_16x16x32_bf16 v[216:219], a[220:223], a[152:155], v[216:219]
v_mfma_f32_16x16x32_bf16 v[216:219], a[188:191], a[120:123], v[216:219]
v_mfma_f32_16x16x32_bf16 v[220:223], a[188:191], a[124:127], v[220:223]
buffer_load_dwordx4 a[188:191], v0, s[20:23], s30 offen offset:0 sc1
v_mfma_f32_16x16x32_bf16 v[220:223], a[220:223], a[156:159], v[220:223]
buffer_load_dwordx4 a[220:223], v0, s[20:23], s30 offen offset:1024 sc1
buffer_load_dwordx4 v0, s[20:23], s39 offen offset:2048 sc1 lds
v_mfma_f32_16x16x32_bf16 v[188:191], a[216:219], a[156:159], v[188:191]
buffer_load_dwordx4 a[216:219], v0, s[20:23], s30 offen offset:2048 sc1
v_mfma_f32_16x16x32_bf16 v[188:191], a[184:187], a[124:127], v[188:191]
buffer_load_dwordx4 a[184:187], v0, s[20:23], s30 offen offset:3072 sc1
s_add_u32 s30, s30, 0x1000
s_barrier
s_waitcnt vmcnt(16)
v_mfma_f32_16x16x32_bf16 v[224:227], a[192:195], a[96:99], v[224:227]
v_mfma_f32_16x16x32_bf16 v[224:227], a[160:163], a[128:131], v[224:227]
v_mfma_f32_16x16x32_bf16 a[224:227], a[164:167], a[128:131], a[224:227]
ds_read_b128 a[128:131], v2 offset:32768
v_mfma_f32_16x16x32_bf16 a[224:227], a[196:199], a[96:99], a[224:227]
ds_read_b128 a[96:99], v1 offset:32768
v_mfma_f32_16x16x32_bf16 a[228:231], a[196:199], a[100:103], a[228:231]
v_mfma_f32_16x16x32_bf16 a[228:231], a[164:167], a[132:135], a[228:231]
v_mfma_f32_16x16x32_bf16 v[228:231], a[160:163], a[132:135], v[228:231]
ds_read_b128 a[132:135], v2 offset:33792
v_mfma_f32_16x16x32_bf16 v[228:231], a[192:195], a[100:103], v[228:231]
ds_read_b128 a[100:103], v1 offset:33792
v_mfma_f32_16x16x32_bf16 v[232:235], a[192:195], a[104:107], v[232:235]
v_mfma_f32_16x16x32_bf16 v[232:235], a[160:163], a[136:139], v[232:235]
v_mfma_f32_16x16x32_bf16 a[232:235], a[164:167], a[136:139], a[232:235]
ds_read_b128 a[136:139], v2 offset:34816
v_mfma_f32_16x16x32_bf16 a[232:235], a[196:199], a[104:107], a[232:235]
ds_read_b128 a[104:107], v1 offset:34816
v_mfma_f32_16x16x32_bf16 a[236:239], a[196:199], a[108:111], a[236:239]
v_mfma_f32_16x16x32_bf16 a[236:239], a[164:167], a[140:143], a[236:239]
v_mfma_f32_16x16x32_bf16 v[236:239], a[160:163], a[140:143], v[236:239]
ds_read_b128 a[140:143], v2 offset:35840
v_mfma_f32_16x16x32_bf16 v[236:239], a[192:195], a[108:111], v[236:239]
ds_read_b128 a[108:111], v1 offset:35840
v_mfma_f32_16x16x32_bf16 v[240:243], a[192:195], a[112:115], v[240:243]
v_mfma_f32_16x16x32_bf16 v[240:243], a[160:163], a[144:147], v[240:243]
v_mfma_f32_16x16x32_bf16 a[240:243], a[164:167], a[144:147], a[240:243]
ds_read_b128 a[144:147], v2 offset:36864
v_mfma_f32_16x16x32_bf16 a[240:243], a[196:199], a[112:115], a[240:243]
ds_read_b128 a[112:115], v1 offset:36864
v_mfma_f32_16x16x32_bf16 a[244:247], a[196:199], a[116:119], a[244:247]
v_mfma_f32_16x16x32_bf16 a[244:247], a[164:167], a[148:151], a[244:247]
v_mfma_f32_16x16x32_bf16 v[244:247], a[160:163], a[148:151], v[244:247]
ds_read_b128 a[148:151], v2 offset:37888
v_mfma_f32_16x16x32_bf16 v[244:247], a[192:195], a[116:119], v[244:247]
ds_read_b128 a[116:119], v1 offset:37888
v_mfma_f32_16x16x32_bf16 v[248:251], a[192:195], a[120:123], v[248:251]
v_mfma_f32_16x16x32_bf16 v[248:251], a[160:163], a[152:155], v[248:251]
v_mfma_f32_16x16x32_bf16 a[248:251], a[164:167], a[152:155], a[248:251]
ds_read_b128 a[152:155], v2 offset:38912
v_mfma_f32_16x16x32_bf16 a[248:251], a[196:199], a[120:123], a[248:251]
ds_read_b128 a[120:123], v1 offset:38912
buffer_load_dwordx4 v0, s[20:23], s39 offen offset:3072 sc1 lds
v_mfma_f32_16x16x32_bf16 a[252:255], a[196:199], a[124:127], a[252:255]
buffer_load_dwordx4 a[196:199], v0, s[20:23], s30 offen offset:0 sc1
v_mfma_f32_16x16x32_bf16 a[252:255], a[164:167], a[156:159], a[252:255]
buffer_load_dwordx4 a[164:167], v0, s[20:23], s30 offen offset:1024 sc1
v_mfma_f32_16x16x32_bf16 v[252:255], a[160:163], a[156:159], v[252:255]
buffer_load_dwordx4 a[160:163], v0, s[20:23], s30 offen offset:2048 sc1
ds_read_b128 a[156:159], v2 offset:39936
v_mfma_f32_16x16x32_bf16 v[252:255], a[192:195], a[124:127], v[252:255]
buffer_load_dwordx4 a[192:195], v0, s[20:23], s30 offen offset:3072 sc1
s_add_u32 s30, s30, 0x1000
ds_read_b128 a[124:127], v1 offset:39936
s_waitcnt vmcnt(16) lgkmcnt(14)
v_mfma_f32_16x16x32_bf16 v[32:35], a[200:203], a[96:99], v[32:35]
v_mfma_f32_16x16x32_bf16 v[32:35], a[168:171], a[128:131], v[32:35]
v_mfma_f32_16x16x32_bf16 v[64:67], a[172:175], a[128:131], v[64:67]
v_mfma_f32_16x16x32_bf16 v[64:67], a[204:207], a[96:99], v[64:67]
s_waitcnt lgkmcnt(12)
v_mfma_f32_16x16x32_bf16 v[68:71], a[204:207], a[100:103], v[68:71]
v_mfma_f32_16x16x32_bf16 v[68:71], a[172:175], a[132:135], v[68:71]
v_mfma_f32_16x16x32_bf16 v[36:39], a[168:171], a[132:135], v[36:39]
v_mfma_f32_16x16x32_bf16 v[36:39], a[200:203], a[100:103], v[36:39]
s_waitcnt lgkmcnt(10)
v_mfma_f32_16x16x32_bf16 v[40:43], a[200:203], a[104:107], v[40:43]
v_mfma_f32_16x16x32_bf16 v[40:43], a[168:171], a[136:139], v[40:43]
v_mfma_f32_16x16x32_bf16 v[72:75], a[172:175], a[136:139], v[72:75]
v_mfma_f32_16x16x32_bf16 v[72:75], a[204:207], a[104:107], v[72:75]
s_waitcnt lgkmcnt(8)
v_mfma_f32_16x16x32_bf16 v[76:79], a[204:207], a[108:111], v[76:79]
v_mfma_f32_16x16x32_bf16 v[76:79], a[172:175], a[140:143], v[76:79]
v_mfma_f32_16x16x32_bf16 v[44:47], a[168:171], a[140:143], v[44:47]
v_mfma_f32_16x16x32_bf16 v[44:47], a[200:203], a[108:111], v[44:47]
s_waitcnt lgkmcnt(6)
v_mfma_f32_16x16x32_bf16 v[48:51], a[200:203], a[112:115], v[48:51]
v_mfma_f32_16x16x32_bf16 v[48:51], a[168:171], a[144:147], v[48:51]
v_mfma_f32_16x16x32_bf16 v[80:83], a[172:175], a[144:147], v[80:83]
v_mfma_f32_16x16x32_bf16 v[80:83], a[204:207], a[112:115], v[80:83]
s_waitcnt lgkmcnt(4)
v_mfma_f32_16x16x32_bf16 v[84:87], a[204:207], a[116:119], v[84:87]
v_mfma_f32_16x16x32_bf16 v[84:87], a[172:175], a[148:151], v[84:87]
v_mfma_f32_16x16x32_bf16 v[52:55], a[168:171], a[148:151], v[52:55]
v_mfma_f32_16x16x32_bf16 v[52:55], a[200:203], a[116:119], v[52:55]
s_waitcnt lgkmcnt(2)
v_mfma_f32_16x16x32_bf16 v[56:59], a[200:203], a[120:123], v[56:59]
s_add_u32 m0, s32, 32768
s_add_u32 s39, s56, 32768
v_mfma_f32_16x16x32_bf16 v[56:59], a[168:171], a[152:155], v[56:59]
buffer_load_dwordx4 v0, s[20:23], s39 offen offset:0 sc1 lds
v_mfma_f32_16x16x32_bf16 v[88:91], a[172:175], a[152:155], v[88:91]
v_mfma_f32_16x16x32_bf16 v[88:91], a[204:207], a[120:123], v[88:91]
s_waitcnt lgkmcnt(0)
v_mfma_f32_16x16x32_bf16 v[92:95], a[204:207], a[124:127], v[92:95]
buffer_load_dwordx4 a[204:207], v0, s[20:23], s30 offen offset:0 sc1
v_mfma_f32_16x16x32_bf16 v[92:95], a[172:175], a[156:159], v[92:95]
buffer_load_dwordx4 a[172:175], v0, s[20:23], s30 offen offset:1024 sc1
v_mfma_f32_16x16x32_bf16 v[60:63], a[168:171], a[156:159], v[60:63]
buffer_load_dwordx4 a[168:171], v0, s[20:23], s30 offen offset:2048 sc1
v_mfma_f32_16x16x32_bf16 v[60:63], a[200:203], a[124:127], v[60:63]
buffer_load_dwordx4 a[200:203], v0, s[20:23], s30 offen offset:3072 sc1
s_add_u32 s30, s30, 0x1000
s_waitcnt vmcnt(16)
v_mfma_f32_16x16x32_bf16 v[96:99], a[180:183], a[96:99], v[96:99]
v_mfma_f32_16x16x32_bf16 v[96:99], a[212:215], a[128:131], v[96:99]
v_mfma_f32_16x16x32_bf16 v[128:131], a[176:179], a[128:131], v[128:131]
v_mfma_f32_16x16x32_bf16 v[128:131], a[208:211], a[96:99], v[128:131]
v_mfma_f32_16x16x32_bf16 v[132:135], a[208:211], a[100:103], v[132:135]
v_mfma_f32_16x16x32_bf16 v[132:135], a[176:179], a[132:135], v[132:135]
v_mfma_f32_16x16x32_bf16 v[100:103], a[212:215], a[132:135], v[100:103]
v_mfma_f32_16x16x32_bf16 v[100:103], a[180:183], a[100:103], v[100:103]
v_mfma_f32_16x16x32_bf16 v[104:107], a[180:183], a[104:107], v[104:107]
v_mfma_f32_16x16x32_bf16 v[104:107], a[212:215], a[136:139], v[104:107]
v_mfma_f32_16x16x32_bf16 v[136:139], a[176:179], a[136:139], v[136:139]
v_mfma_f32_16x16x32_bf16 v[136:139], a[208:211], a[104:107], v[136:139]
v_mfma_f32_16x16x32_bf16 v[140:143], a[208:211], a[108:111], v[140:143]
v_mfma_f32_16x16x32_bf16 v[140:143], a[176:179], a[140:143], v[140:143]
v_mfma_f32_16x16x32_bf16 v[108:111], a[212:215], a[140:143], v[108:111]
v_mfma_f32_16x16x32_bf16 v[108:111], a[180:183], a[108:111], v[108:111]
v_mfma_f32_16x16x32_bf16 v[112:115], a[180:183], a[112:115], v[112:115]
v_mfma_f32_16x16x32_bf16 v[112:115], a[212:215], a[144:147], v[112:115]
v_mfma_f32_16x16x32_bf16 v[144:147], a[176:179], a[144:147], v[144:147]
v_mfma_f32_16x16x32_bf16 v[144:147], a[208:211], a[112:115], v[144:147]
v_mfma_f32_16x16x32_bf16 v[148:151], a[208:211], a[116:119], v[148:151]
v_mfma_f32_16x16x32_bf16 v[148:151], a[176:179], a[148:151], v[148:151]
v_mfma_f32_16x16x32_bf16 v[116:119], a[212:215], a[148:151], v[116:119]
v_mfma_f32_16x16x32_bf16 v[116:119], a[180:183], a[116:119], v[116:119]
buffer_load_dwordx4 v0, s[20:23], s39 offen offset:1024 sc1 lds
v_mfma_f32_16x16x32_bf16 v[120:123], a[180:183], a[120:123], v[120:123]
v_mfma_f32_16x16x32_bf16 v[120:123], a[212:215], a[152:155], v[120:123]
v_mfma_f32_16x16x32_bf16 v[152:155], a[176:179], a[152:155], v[152:155]
v_mfma_f32_16x16x32_bf16 v[152:155], a[208:211], a[120:123], v[152:155]
v_mfma_f32_16x16x32_bf16 v[156:159], a[208:211], a[124:127], v[156:159]
buffer_load_dwordx4 a[208:211], v0, s[20:23], s30 offen offset:0 sc1
v_mfma_f32_16x16x32_bf16 v[156:159], a[176:179], a[156:159], v[156:159]
buffer_load_dwordx4 a[176:179], v0, s[20:23], s30 offen offset:1024 sc1
v_mfma_f32_16x16x32_bf16 v[124:127], a[212:215], a[156:159], v[124:127]
buffer_load_dwordx4 a[212:215], v0, s[20:23], s30 offen offset:2048 sc1
v_mfma_f32_16x16x32_bf16 v[124:127], a[180:183], a[124:127], v[124:127]
buffer_load_dwordx4 a[180:183], v0, s[20:23], s30 offen offset:3072 sc1
s_add_u32 s30, s30, 0x1000
s_waitcnt vmcnt(15)
v_mfma_f32_16x16x32_bf16 v[160:163], a[188:191], a[96:99], v[160:163]
v_mfma_f32_16x16x32_bf16 v[160:163], a[220:223], a[128:131], v[160:163]
v_mfma_f32_16x16x32_bf16 v[192:195], a[184:187], a[128:131], v[192:195]
v_mfma_f32_16x16x32_bf16 v[192:195], a[216:219], a[96:99], v[192:195]
v_mfma_f32_16x16x32_bf16 v[196:199], a[216:219], a[100:103], v[196:199]
v_mfma_f32_16x16x32_bf16 v[196:199], a[184:187], a[132:135], v[196:199]
v_mfma_f32_16x16x32_bf16 v[164:167], a[220:223], a[132:135], v[164:167]
v_mfma_f32_16x16x32_bf16 v[164:167], a[188:191], a[100:103], v[164:167]
v_mfma_f32_16x16x32_bf16 v[168:171], a[188:191], a[104:107], v[168:171]
v_mfma_f32_16x16x32_bf16 v[168:171], a[220:223], a[136:139], v[168:171]
v_mfma_f32_16x16x32_bf16 v[200:203], a[184:187], a[136:139], v[200:203]
v_mfma_f32_16x16x32_bf16 v[200:203], a[216:219], a[104:107], v[200:203]
v_mfma_f32_16x16x32_bf16 v[204:207], a[216:219], a[108:111], v[204:207]
v_mfma_f32_16x16x32_bf16 v[204:207], a[184:187], a[140:143], v[204:207]
v_mfma_f32_16x16x32_bf16 v[172:175], a[220:223], a[140:143], v[172:175]
v_mfma_f32_16x16x32_bf16 v[172:175], a[188:191], a[108:111], v[172:175]
v_mfma_f32_16x16x32_bf16 v[176:179], a[188:191], a[112:115], v[176:179]
v_mfma_f32_16x16x32_bf16 v[176:179], a[220:223], a[144:147], v[176:179]
v_mfma_f32_16x16x32_bf16 v[208:211], a[184:187], a[144:147], v[208:211]
v_mfma_f32_16x16x32_bf16 v[208:211], a[216:219], a[112:115], v[208:211]
v_mfma_f32_16x16x32_bf16 v[212:215], a[216:219], a[116:119], v[212:215]
v_mfma_f32_16x16x32_bf16 v[212:215], a[184:187], a[148:151], v[212:215]
buffer_load_dwordx4 v0, s[20:23], s39 offen offset:2048 sc1 lds
v_mfma_f32_16x16x32_bf16 v[180:183], a[220:223], a[148:151], v[180:183]
v_mfma_f32_16x16x32_bf16 v[180:183], a[188:191], a[116:119], v[180:183]
v_mfma_f32_16x16x32_bf16 v[184:187], a[188:191], a[120:123], v[184:187]
v_mfma_f32_16x16x32_bf16 v[184:187], a[220:223], a[152:155], v[184:187]
v_mfma_f32_16x16x32_bf16 v[216:219], a[184:187], a[152:155], v[216:219]
v_mfma_f32_16x16x32_bf16 v[216:219], a[216:219], a[120:123], v[216:219]
v_mfma_f32_16x16x32_bf16 v[220:223], a[216:219], a[124:127], v[220:223]
buffer_load_dwordx4 a[216:219], v0, s[20:23], s30 offen offset:0 sc1
v_mfma_f32_16x16x32_bf16 v[220:223], a[184:187], a[156:159], v[220:223]
buffer_load_dwordx4 a[184:187], v0, s[20:23], s30 offen offset:1024 sc1
v_mfma_f32_16x16x32_bf16 v[188:191], a[220:223], a[156:159], v[188:191]
buffer_load_dwordx4 a[220:223], v0, s[20:23], s30 offen offset:2048 sc1
v_mfma_f32_16x16x32_bf16 v[188:191], a[188:191], a[124:127], v[188:191]
buffer_load_dwordx4 a[188:191], v0, s[20:23], s30 offen offset:3072 sc1
s_add_u32 s30, s30, 0x1000
s_waitcnt vmcnt(15)
v_mfma_f32_16x16x32_bf16 v[224:227], a[196:199], a[96:99], v[224:227]
v_mfma_f32_16x16x32_bf16 v[224:227], a[164:167], a[128:131], v[224:227]
v_mfma_f32_16x16x32_bf16 a[224:227], a[192:195], a[128:131], a[224:227]
ds_read_b128 a[128:131], v4 offset:32768
v_mfma_f32_16x16x32_bf16 a[224:227], a[160:163], a[96:99], a[224:227]
ds_read_b128 a[96:99], v3 offset:32768
v_mfma_f32_16x16x32_bf16 a[228:231], a[160:163], a[100:103], a[228:231]
v_mfma_f32_16x16x32_bf16 a[228:231], a[192:195], a[132:135], a[228:231]
v_mfma_f32_16x16x32_bf16 v[228:231], a[164:167], a[132:135], v[228:231]
ds_read_b128 a[132:135], v4 offset:33792
v_mfma_f32_16x16x32_bf16 v[228:231], a[196:199], a[100:103], v[228:231]
ds_read_b128 a[100:103], v3 offset:33792
v_mfma_f32_16x16x32_bf16 v[232:235], a[196:199], a[104:107], v[232:235]
v_mfma_f32_16x16x32_bf16 v[232:235], a[164:167], a[136:139], v[232:235]
v_mfma_f32_16x16x32_bf16 a[232:235], a[192:195], a[136:139], a[232:235]
ds_read_b128 a[136:139], v4 offset:34816
v_mfma_f32_16x16x32_bf16 a[232:235], a[160:163], a[104:107], a[232:235]
ds_read_b128 a[104:107], v3 offset:34816
v_mfma_f32_16x16x32_bf16 a[236:239], a[160:163], a[108:111], a[236:239]
v_mfma_f32_16x16x32_bf16 a[236:239], a[192:195], a[140:143], a[236:239]
v_mfma_f32_16x16x32_bf16 v[236:239], a[164:167], a[140:143], v[236:239]
ds_read_b128 a[140:143], v4 offset:35840
v_mfma_f32_16x16x32_bf16 v[236:239], a[196:199], a[108:111], v[236:239]
ds_read_b128 a[108:111], v3 offset:35840
v_mfma_f32_16x16x32_bf16 v[240:243], a[196:199], a[112:115], v[240:243]
v_mfma_f32_16x16x32_bf16 v[240:243], a[164:167], a[144:147], v[240:243]
v_mfma_f32_16x16x32_bf16 a[240:243], a[192:195], a[144:147], a[240:243]
ds_read_b128 a[144:147], v4 offset:36864
v_mfma_f32_16x16x32_bf16 a[240:243], a[160:163], a[112:115], a[240:243]
ds_read_b128 a[112:115], v3 offset:36864
buffer_load_dwordx4 v0, s[20:23], s39 offen offset:3072 sc1 lds
v_mfma_f32_16x16x32_bf16 a[244:247], a[160:163], a[116:119], a[244:247]
v_mfma_f32_16x16x32_bf16 a[244:247], a[192:195], a[148:151], a[244:247]
v_mfma_f32_16x16x32_bf16 v[244:247], a[164:167], a[148:151], v[244:247]
ds_read_b128 a[148:151], v4 offset:37888
v_mfma_f32_16x16x32_bf16 v[244:247], a[196:199], a[116:119], v[244:247]
ds_read_b128 a[116:119], v3 offset:37888
v_mfma_f32_16x16x32_bf16 v[248:251], a[196:199], a[120:123], v[248:251]
v_mfma_f32_16x16x32_bf16 v[248:251], a[164:167], a[152:155], v[248:251]
v_mfma_f32_16x16x32_bf16 a[248:251], a[192:195], a[152:155], a[248:251]
ds_read_b128 a[152:155], v4 offset:38912
v_mfma_f32_16x16x32_bf16 a[248:251], a[160:163], a[120:123], a[248:251]
ds_read_b128 a[120:123], v3 offset:38912
v_mfma_f32_16x16x32_bf16 a[252:255], a[160:163], a[124:127], a[252:255]
buffer_load_dwordx4 a[160:163], v0, s[20:23], s30 offen offset:0 sc1
v_mfma_f32_16x16x32_bf16 a[252:255], a[192:195], a[156:159], a[252:255]
buffer_load_dwordx4 a[192:195], v0, s[20:23], s30 offen offset:1024 sc1
v_mfma_f32_16x16x32_bf16 v[252:255], a[164:167], a[156:159], v[252:255]
buffer_load_dwordx4 a[164:167], v0, s[20:23], s30 offen offset:2048 sc1
ds_read_b128 a[156:159], v4 offset:39936
v_mfma_f32_16x16x32_bf16 v[252:255], a[196:199], a[124:127], v[252:255]
buffer_load_dwordx4 a[196:199], v0, s[20:23], s30 offen offset:3072 sc1
s_add_u32 s30, s30, 0x1000
ds_read_b128 a[124:127], v3 offset:39936
s_waitcnt vmcnt(15) lgkmcnt(14)
v_mfma_f32_16x16x32_bf16 v[32:35], a[204:207], a[96:99], v[32:35]
v_mfma_f32_16x16x32_bf16 v[32:35], a[172:175], a[128:131], v[32:35]
v_mfma_f32_16x16x32_bf16 v[64:67], a[200:203], a[128:131], v[64:67]
v_mfma_f32_16x16x32_bf16 v[64:67], a[168:171], a[96:99], v[64:67]
s_waitcnt lgkmcnt(12)
v_mfma_f32_16x16x32_bf16 v[68:71], a[168:171], a[100:103], v[68:71]
v_mfma_f32_16x16x32_bf16 v[68:71], a[200:203], a[132:135], v[68:71]
v_mfma_f32_16x16x32_bf16 v[36:39], a[172:175], a[132:135], v[36:39]
v_mfma_f32_16x16x32_bf16 v[36:39], a[204:207], a[100:103], v[36:39]
s_waitcnt lgkmcnt(10)
v_mfma_f32_16x16x32_bf16 v[40:43], a[204:207], a[104:107], v[40:43]
v_mfma_f32_16x16x32_bf16 v[40:43], a[172:175], a[136:139], v[40:43]
v_mfma_f32_16x16x32_bf16 v[72:75], a[200:203], a[136:139], v[72:75]
v_mfma_f32_16x16x32_bf16 v[72:75], a[168:171], a[104:107], v[72:75]
s_waitcnt lgkmcnt(8)
v_mfma_f32_16x16x32_bf16 v[76:79], a[168:171], a[108:111], v[76:79]
v_mfma_f32_16x16x32_bf16 v[76:79], a[200:203], a[140:143], v[76:79]
v_mfma_f32_16x16x32_bf16 v[44:47], a[172:175], a[140:143], v[44:47]
v_mfma_f32_16x16x32_bf16 v[44:47], a[204:207], a[108:111], v[44:47]
s_waitcnt lgkmcnt(6)
v_mfma_f32_16x16x32_bf16 v[48:51], a[204:207], a[112:115], v[48:51]
s_add_u32 m0, s32, 36864
s_add_u32 s39, s56, 36864
v_mfma_f32_16x16x32_bf16 v[48:51], a[172:175], a[144:147], v[48:51]
buffer_load_dwordx4 v0, s[20:23], s39 offen offset:0 sc1 lds
v_mfma_f32_16x16x32_bf16 v[80:83], a[200:203], a[144:147], v[80:83]
v_mfma_f32_16x16x32_bf16 v[80:83], a[168:171], a[112:115], v[80:83]
s_waitcnt lgkmcnt(4)
v_mfma_f32_16x16x32_bf16 v[84:87], a[168:171], a[116:119], v[84:87]
v_mfma_f32_16x16x32_bf16 v[84:87], a[200:203], a[148:151], v[84:87]
v_mfma_f32_16x16x32_bf16 v[52:55], a[172:175], a[148:151], v[52:55]
v_mfma_f32_16x16x32_bf16 v[52:55], a[204:207], a[116:119], v[52:55]
s_waitcnt lgkmcnt(2)
v_mfma_f32_16x16x32_bf16 v[56:59], a[204:207], a[120:123], v[56:59]
v_mfma_f32_16x16x32_bf16 v[56:59], a[172:175], a[152:155], v[56:59]
v_mfma_f32_16x16x32_bf16 v[88:91], a[200:203], a[152:155], v[88:91]
v_mfma_f32_16x16x32_bf16 v[88:91], a[168:171], a[120:123], v[88:91]
s_waitcnt lgkmcnt(0)
v_mfma_f32_16x16x32_bf16 v[92:95], a[168:171], a[124:127], v[92:95]
buffer_load_dwordx4 a[168:171], v0, s[20:23], s30 offen offset:0 sc1
v_mfma_f32_16x16x32_bf16 v[92:95], a[200:203], a[156:159], v[92:95]
buffer_load_dwordx4 a[200:203], v0, s[20:23], s30 offen offset:1024 sc1
v_mfma_f32_16x16x32_bf16 v[60:63], a[172:175], a[156:159], v[60:63]
buffer_load_dwordx4 a[172:175], v0, s[20:23], s30 offen offset:2048 sc1
v_mfma_f32_16x16x32_bf16 v[60:63], a[204:207], a[124:127], v[60:63]
buffer_load_dwordx4 a[204:207], v0, s[20:23], s30 offen offset:3072 sc1
s_add_u32 s30, s30, 0x1000
s_waitcnt vmcnt(15)
v_mfma_f32_16x16x32_bf16 v[96:99], a[208:211], a[96:99], v[96:99]
v_mfma_f32_16x16x32_bf16 v[96:99], a[176:179], a[128:131], v[96:99]
v_mfma_f32_16x16x32_bf16 v[128:131], a[180:183], a[128:131], v[128:131]
v_mfma_f32_16x16x32_bf16 v[128:131], a[212:215], a[96:99], v[128:131]
v_mfma_f32_16x16x32_bf16 v[132:135], a[212:215], a[100:103], v[132:135]
v_mfma_f32_16x16x32_bf16 v[132:135], a[180:183], a[132:135], v[132:135]
v_mfma_f32_16x16x32_bf16 v[100:103], a[176:179], a[132:135], v[100:103]
v_mfma_f32_16x16x32_bf16 v[100:103], a[208:211], a[100:103], v[100:103]
v_mfma_f32_16x16x32_bf16 v[104:107], a[208:211], a[104:107], v[104:107]
v_mfma_f32_16x16x32_bf16 v[104:107], a[176:179], a[136:139], v[104:107]
v_mfma_f32_16x16x32_bf16 v[136:139], a[180:183], a[136:139], v[136:139]
v_mfma_f32_16x16x32_bf16 v[136:139], a[212:215], a[104:107], v[136:139]
v_mfma_f32_16x16x32_bf16 v[140:143], a[212:215], a[108:111], v[140:143]
v_mfma_f32_16x16x32_bf16 v[140:143], a[180:183], a[140:143], v[140:143]
v_mfma_f32_16x16x32_bf16 v[108:111], a[176:179], a[140:143], v[108:111]
v_mfma_f32_16x16x32_bf16 v[108:111], a[208:211], a[108:111], v[108:111]
buffer_load_dwordx4 v0, s[20:23], s39 offen offset:1024 sc1 lds
v_mfma_f32_16x16x32_bf16 v[112:115], a[208:211], a[112:115], v[112:115]
v_mfma_f32_16x16x32_bf16 v[112:115], a[176:179], a[144:147], v[112:115]
v_mfma_f32_16x16x32_bf16 v[144:147], a[180:183], a[144:147], v[144:147]
v_mfma_f32_16x16x32_bf16 v[144:147], a[212:215], a[112:115], v[144:147]
v_mfma_f32_16x16x32_bf16 v[148:151], a[212:215], a[116:119], v[148:151]
v_mfma_f32_16x16x32_bf16 v[148:151], a[180:183], a[148:151], v[148:151]
v_mfma_f32_16x16x32_bf16 v[116:119], a[176:179], a[148:151], v[116:119]
v_mfma_f32_16x16x32_bf16 v[116:119], a[208:211], a[116:119], v[116:119]
v_mfma_f32_16x16x32_bf16 v[120:123], a[208:211], a[120:123], v[120:123]
v_mfma_f32_16x16x32_bf16 v[120:123], a[176:179], a[152:155], v[120:123]
v_mfma_f32_16x16x32_bf16 v[152:155], a[180:183], a[152:155], v[152:155]
v_mfma_f32_16x16x32_bf16 v[152:155], a[212:215], a[120:123], v[152:155]
v_mfma_f32_16x16x32_bf16 v[156:159], a[212:215], a[124:127], v[156:159]
buffer_load_dwordx4 a[212:215], v0, s[20:23], s30 offen offset:0 sc1
v_mfma_f32_16x16x32_bf16 v[156:159], a[180:183], a[156:159], v[156:159]
buffer_load_dwordx4 a[180:183], v0, s[20:23], s30 offen offset:1024 sc1
v_mfma_f32_16x16x32_bf16 v[124:127], a[176:179], a[156:159], v[124:127]
buffer_load_dwordx4 a[176:179], v0, s[20:23], s30 offen offset:2048 sc1
v_mfma_f32_16x16x32_bf16 v[124:127], a[208:211], a[124:127], v[124:127]
buffer_load_dwordx4 a[208:211], v0, s[20:23], s30 offen offset:3072 sc1
s_add_u32 s30, s30, 0x1000
s_waitcnt vmcnt(15)
v_mfma_f32_16x16x32_bf16 v[160:163], a[216:219], a[96:99], v[160:163]
v_mfma_f32_16x16x32_bf16 v[160:163], a[184:187], a[128:131], v[160:163]
v_mfma_f32_16x16x32_bf16 v[192:195], a[188:191], a[128:131], v[192:195]
v_mfma_f32_16x16x32_bf16 v[192:195], a[220:223], a[96:99], v[192:195]
v_mfma_f32_16x16x32_bf16 v[196:199], a[220:223], a[100:103], v[196:199]
v_mfma_f32_16x16x32_bf16 v[196:199], a[188:191], a[132:135], v[196:199]
v_mfma_f32_16x16x32_bf16 v[164:167], a[184:187], a[132:135], v[164:167]
v_mfma_f32_16x16x32_bf16 v[164:167], a[216:219], a[100:103], v[164:167]
v_mfma_f32_16x16x32_bf16 v[168:171], a[216:219], a[104:107], v[168:171]
v_mfma_f32_16x16x32_bf16 v[168:171], a[184:187], a[136:139], v[168:171]
v_mfma_f32_16x16x32_bf16 v[200:203], a[188:191], a[136:139], v[200:203]
v_mfma_f32_16x16x32_bf16 v[200:203], a[220:223], a[104:107], v[200:203]
buffer_load_dwordx2 v[10:11], off, s[20:23], s36 sc1
v_mfma_f32_16x16x32_bf16 v[204:207], a[220:223], a[108:111], v[204:207]
v_mfma_f32_16x16x32_bf16 v[204:207], a[188:191], a[140:143], v[204:207]
buffer_load_dwordx4 v0, s[20:23], s39 offen offset:2048 sc1 lds
v_mfma_f32_16x16x32_bf16 v[172:175], a[184:187], a[140:143], v[172:175]
v_mfma_f32_16x16x32_bf16 v[172:175], a[216:219], a[108:111], v[172:175]
v_mfma_f32_16x16x32_bf16 v[176:179], a[216:219], a[112:115], v[176:179]
v_mfma_f32_16x16x32_bf16 v[176:179], a[184:187], a[144:147], v[176:179]
v_mfma_f32_16x16x32_bf16 v[208:211], a[188:191], a[144:147], v[208:211]
v_mfma_f32_16x16x32_bf16 v[208:211], a[220:223], a[112:115], v[208:211]
v_mfma_f32_16x16x32_bf16 v[212:215], a[220:223], a[116:119], v[212:215]
v_mfma_f32_16x16x32_bf16 v[212:215], a[188:191], a[148:151], v[212:215]
v_mfma_f32_16x16x32_bf16 v[180:183], a[184:187], a[148:151], v[180:183]
v_mfma_f32_16x16x32_bf16 v[180:183], a[216:219], a[116:119], v[180:183]
v_mfma_f32_16x16x32_bf16 v[184:187], a[216:219], a[120:123], v[184:187]
v_mfma_f32_16x16x32_bf16 v[184:187], a[184:187], a[152:155], v[184:187]
v_mfma_f32_16x16x32_bf16 v[216:219], a[188:191], a[152:155], v[216:219]
v_mfma_f32_16x16x32_bf16 v[216:219], a[220:223], a[120:123], v[216:219]
v_mfma_f32_16x16x32_bf16 v[220:223], a[220:223], a[124:127], v[220:223]
buffer_load_dwordx4 a[220:223], v0, s[20:23], s30 offen offset:0 sc1
v_mfma_f32_16x16x32_bf16 v[220:223], a[188:191], a[156:159], v[220:223]
buffer_load_dwordx4 a[188:191], v0, s[20:23], s30 offen offset:1024 sc1
v_mfma_f32_16x16x32_bf16 v[188:191], a[184:187], a[156:159], v[188:191]
buffer_load_dwordx4 a[184:187], v0, s[20:23], s30 offen offset:2048 sc1
v_mfma_f32_16x16x32_bf16 v[188:191], a[216:219], a[124:127], v[188:191]
buffer_load_dwordx4 a[216:219], v0, s[20:23], s30 offen offset:3072 sc1
s_add_u32 s30, s30, 0x1000
s_barrier
s_waitcnt vmcnt(16)
v_mfma_f32_16x16x32_bf16 v[224:227], a[160:163], a[96:99], v[224:227]
v_mfma_f32_16x16x32_bf16 v[224:227], a[192:195], a[128:131], v[224:227]
v_mfma_f32_16x16x32_bf16 a[224:227], a[196:199], a[128:131], a[224:227]
v_xor_b32 v2, 0x2000, v6
ds_read_b128 a[128:131], v2 offset:0
v_mfma_f32_16x16x32_bf16 a[224:227], a[164:167], a[96:99], a[224:227]
v_xor_b32 v1, 0x0, v6
ds_read_b128 a[96:99], v1 offset:0
v_mfma_f32_16x16x32_bf16 a[228:231], a[164:167], a[100:103], a[228:231]
v_mfma_f32_16x16x32_bf16 a[228:231], a[196:199], a[132:135], a[228:231]
v_mfma_f32_16x16x32_bf16 v[228:231], a[192:195], a[132:135], v[228:231]
ds_read_b128 a[132:135], v2 offset:1024
v_mfma_f32_16x16x32_bf16 v[228:231], a[160:163], a[100:103], v[228:231]
ds_read_b128 a[100:103], v1 offset:1024
v_mfma_f32_16x16x32_bf16 v[232:235], a[160:163], a[104:107], v[232:235]
v_mfma_f32_16x16x32_bf16 v[232:235], a[192:195], a[136:139], v[232:235]
v_mfma_f32_16x16x32_bf16 a[232:235], a[196:199], a[136:139], a[232:235]
ds_read_b128 a[136:139], v2 offset:2048
v_mfma_f32_16x16x32_bf16 a[232:235], a[164:167], a[104:107], a[232:235]
ds_read_b128 a[104:107], v1 offset:2048
buffer_load_dwordx4 v0, s[20:23], s39 offen offset:3072 sc1 lds
v_mfma_f32_16x16x32_bf16 a[236:239], a[164:167], a[108:111], a[236:239]
v_mfma_f32_16x16x32_bf16 a[236:239], a[196:199], a[140:143], a[236:239]
v_mfma_f32_16x16x32_bf16 v[236:239], a[192:195], a[140:143], v[236:239]
ds_read_b128 a[140:143], v2 offset:3072
v_mfma_f32_16x16x32_bf16 v[236:239], a[160:163], a[108:111], v[236:239]
ds_read_b128 a[108:111], v1 offset:3072
v_mfma_f32_16x16x32_bf16 v[240:243], a[160:163], a[112:115], v[240:243]
v_mfma_f32_16x16x32_bf16 v[240:243], a[192:195], a[144:147], v[240:243]
v_mfma_f32_16x16x32_bf16 a[240:243], a[196:199], a[144:147], a[240:243]
ds_read_b128 a[144:147], v2 offset:4096
v_mfma_f32_16x16x32_bf16 a[240:243], a[164:167], a[112:115], a[240:243]
ds_read_b128 a[112:115], v1 offset:4096
v_mfma_f32_16x16x32_bf16 a[244:247], a[164:167], a[116:119], a[244:247]
v_mfma_f32_16x16x32_bf16 a[244:247], a[196:199], a[148:151], a[244:247]
v_mfma_f32_16x16x32_bf16 v[244:247], a[192:195], a[148:151], v[244:247]
ds_read_b128 a[148:151], v2 offset:5120
v_mfma_f32_16x16x32_bf16 v[244:247], a[160:163], a[116:119], v[244:247]
ds_read_b128 a[116:119], v1 offset:5120
v_mfma_f32_16x16x32_bf16 v[248:251], a[160:163], a[120:123], v[248:251]
v_mfma_f32_16x16x32_bf16 v[248:251], a[192:195], a[152:155], v[248:251]
v_mfma_f32_16x16x32_bf16 a[248:251], a[196:199], a[152:155], a[248:251]
ds_read_b128 a[152:155], v2 offset:6144
v_mfma_f32_16x16x32_bf16 a[248:251], a[164:167], a[120:123], a[248:251]
ds_read_b128 a[120:123], v1 offset:6144
v_mfma_f32_16x16x32_bf16 a[252:255], a[164:167], a[124:127], a[252:255]
buffer_load_dwordx4 a[164:167], v0, s[20:23], s30 offen offset:0 sc1
v_mfma_f32_16x16x32_bf16 a[252:255], a[196:199], a[156:159], a[252:255]
buffer_load_dwordx4 a[196:199], v0, s[20:23], s30 offen offset:1024 sc1
v_mfma_f32_16x16x32_bf16 v[252:255], a[192:195], a[156:159], v[252:255]
buffer_load_dwordx4 a[192:195], v0, s[20:23], s30 offen offset:2048 sc1
ds_read_b128 a[156:159], v2 offset:7168
v_mfma_f32_16x16x32_bf16 v[252:255], a[160:163], a[124:127], v[252:255]
buffer_load_dwordx4 a[160:163], v0, s[20:23], s30 offen offset:3072 sc1
s_add_u32 s30, s30, 0x1000
ds_read_b128 a[124:127], v1 offset:7168
L_q6:
s_waitcnt vmcnt(16) lgkmcnt(14)
v_mfma_f32_16x16x32_bf16 v[32:35], a[168:171], a[96:99], v[32:35]
v_mfma_f32_16x16x32_bf16 v[32:35], a[200:203], a[128:131], v[32:35]
v_mfma_f32_16x16x32_bf16 v[64:67], a[204:207], a[128:131], v[64:67]
v_mfma_f32_16x16x32_bf16 v[64:67], a[172:175], a[96:99], v[64:67]
s_waitcnt lgkmcnt(12)
v_mfma_f32_16x16x32_bf16 v[68:71], a[172:175], a[100:103], v[68:71]
v_mfma_f32_16x16x32_bf16 v[68:71], a[204:207], a[132:135], v[68:71]
v_mfma_f32_16x16x32_bf16 v[36:39], a[200:203], a[132:135], v[36:39]
v_mfma_f32_16x16x32_bf16 v[36:39], a[168:171], a[100:103], v[36:39]
s_waitcnt lgkmcnt(10)
v_mfma_f32_16x16x32_bf16 v[40:43], a[168:171], a[104:107], v[40:43]
v_mfma_f32_16x16x32_bf16 v[40:43], a[200:203], a[136:139], v[40:43]
v_mfma_f32_16x16x32_bf16 v[72:75], a[204:207], a[136:139], v[72:75]
v_mfma_f32_16x16x32_bf16 v[72:75], a[172:175], a[104:107], v[72:75]
s_waitcnt vmcnt(10)
v_readfirstlane_b32 s34, v10
v_readfirstlane_b32 s11, v11
s_xor_b32 s34, s34, s8
s_sub_u32 s34, s34, 3
s_cmp_lg_u32 s11, s9
s_cbranch_scc1 L_spin3
s_cmp_gt_u32 s34, 12
s_cbranch_scc1 L_spin3
L_back3:
s_add_u32 m0, s32, 65536
s_add_u32 s39, s56, 65536
s_waitcnt lgkmcnt(8)
v_mfma_f32_16x16x32_bf16 v[76:79], a[172:175], a[108:111], v[76:79]
buffer_load_dwordx4 v0, s[20:23], s39 offen offset:0 sc1 lds
v_mfma_f32_16x16x32_bf16 v[76:79], a[204:207], a[140:143], v[76:79]
v_mfma_f32_16x16x32_bf16 v[44:47], a[200:203], a[140:143], v[44:47]
v_mfma_f32_16x16x32_bf16 v[44:47], a[168:171], a[108:111], v[44:47]
s_waitcnt lgkmcnt(6)
v_mfma_f32_16x16x32_bf16 v[48:51], a[168:171], a[112:115], v[48:51]
v_mfma_f32_16x16x32_bf16 v[48:51], a[200:203], a[144:147], v[48:51]
v_mfma_f32_16x16x32_bf16 v[80:83], a[204:207], a[144:147], v[80:83]
v_mfma_f32_16x16x32_bf16 v[80:83], a[172:175], a[112:115], v[80:83]
s_waitcnt lgkmcnt(4)
v_mfma_f32_16x16x32_bf16 v[84:87], a[172:175], a[116:119], v[84:87]
v_mfma_f32_16x16x32_bf16 v[84:87], a[204:207], a[148:151], v[84:87]
v_mfma_f32_16x16x32_bf16 v[52:55], a[200:203], a[148:151], v[52:55]
v_mfma_f32_16x16x32_bf16 v[52:55], a[168:171], a[116:119], v[52:55]
s_waitcnt lgkmcnt(2)
v_mfma_f32_16x16x32_bf16 v[56:59], a[168:171], a[120:123], v[56:59]
v_mfma_f32_16x16x32_bf16 v[56:59], a[200:203], a[152:155], v[56:59]
v_mfma_f32_16x16x32_bf16 v[88:91], a[204:207], a[152:155], v[88:91]
v_mfma_f32_16x16x32_bf16 v[88:91], a[172:175], a[120:123], v[88:91]
s_waitcnt lgkmcnt(0)
v_mfma_f32_16x16x32_bf16 v[92:95], a[172:175], a[124:127], v[92:95]
buffer_load_dwordx4 a[172:175], v0, s[20:23], s30 offen offset:0 sc1
v_mfma_f32_16x16x32_bf16 v[92:95], a[204:207], a[156:159], v[92:95]
buffer_load_dwordx4 a[204:207], v0, s[20:23], s30 offen offset:1024 sc1
v_mfma_f32_16x16x32_bf16 v[60:63], a[200:203], a[156:159], v[60:63]
buffer_load_dwordx4 a[200:203], v0, s[20:23], s30 offen offset:2048 sc1
v_mfma_f32_16x16x32_bf16 v[60:63], a[168:171], a[124:127], v[60:63]
buffer_load_dwordx4 a[168:171], v0, s[20:23], s30 offen offset:3072 sc1
s_add_u32 s30, s30, 0x1000
v_mfma_f32_16x16x32_bf16 v[96:99], a[212:215], a[96:99], v[96:99]
s_add_u32 s96, s92, L_q8-L_pc
s_addc_u32 s97, s93, 0
s_load_dword s98, s[96:97], 0
v_mfma_f32_16x16x32_bf16 v[96:99], a[180:183], a[128:131], v[96:99]
v_mfma_f32_16x16x32_bf16 v[128:131], a[208:211], a[128:131], v[128:131]
v_mfma_f32_16x16x32_bf16 v[128:131], a[176:179], a[96:99], v[128:131]
v_mfma_f32_16x16x32_bf16 v[132:135], a[176:179], a[100:103], v[132:135]
v_mfma_f32_16x16x32_bf16 v[132:135], a[208:211], a[132:135], v[132:135]
v_mfma_f32_16x16x32_bf16 v[100:103], a[180:183], a[132:135], v[100:103]
v_mfma_f32_16x16x32_bf16 v[100:103], a[212:215], a[100:103], v[100:103]
v_mfma_f32_16x16x32_bf16 v[104:107], a[212:215], a[104:107], v[104:107]
v_mfma_f32_16x16x32_bf16 v[104:107], a[180:183], a[136:139], v[104:107]
v_mfma_f32_16x16x32_bf16 v[136:139], a[208:211], a[136:139], v[136:139]
buffer_load_dwordx4 v0, s[20:23], s39 offen offset:1024 sc1 lds
v_mfma_f32_16x16x32_bf16 v[136:139], a[176:179], a[104:107], v[136:139]
v_mfma_f32_16x16x32_bf16 v[140:143], a[176:179], a[108:111], v[140:143]
v_mfma_f32_16x16x32_bf16 v[140:143], a[208:211], a[140:143], v[140:143]
v_mfma_f32_16x16x32_bf16 v[108:111], a[180:183], a[140:143], v[108:111]
v_mfma_f32_16x16x32_bf16 v[108:111], a[212:215], a[108:111], v[108:111]
v_mfma_f32_16x16x32_bf16 v[112:115], a[212:215], a[112:115], v[112:115]
v_mfma_f32_16x16x32_bf16 v[112:115], a[180:183], a[144:147], v[112:115]
v_mfma_f32_16x16x32_bf16 v[144:147], a[208:211], a[144:147], v[144:147]
v_mfma_f32_16x16x32_bf16 v[144:147], a[176:179], a[112:115], v[144:147]
v_mfma_f32_16x16x32_bf16 v[148:151], a[176:179], a[116:119], v[148:151]
v_mfma_f32_16x16x32_bf16 v[148:151], a[208:211], a[148:151], v[148:151]
v_mfma_f32_16x16x32_bf16 v[116:119], a[180:183], a[148:151], v[116:119]
v_mfma_f32_16x16x32_bf16 v[116:119], a[212:215], a[116:119], v[116:119]
v_mfma_f32_16x16x32_bf16 v[120:123], a[212:215], a[120:123], v[120:123]
v_mfma_f32_16x16x32_bf16 v[120:123], a[180:183], a[152:155], v[120:123]
v_mfma_f32_16x16x32_bf16 v[152:155], a[208:211], a[152:155], v[152:155]
v_mfma_f32_16x16x32_bf16 v[152:155], a[176:179], a[120:123], v[152:155]
v_mfma_f32_16x16x32_bf16 v[156:159], a[176:179], a[124:127], v[156:159]
buffer_load_dwordx4 a[176:179], v0, s[20:23], s30 offen offset:0 sc1
v_mfma_f32_16x16x32_bf16 v[156:159], a[208:211], a[156:159], v[156:159]
buffer_load_dwordx4 a[208:211], v0, s[20:23], s30 offen offset:1024 sc1
v_mfma_f32_16x16x32_bf16 v[124:127], a[180:183], a[156:159], v[124:127]
buffer_load_dwordx4 a[180:183], v0, s[20:23], s30 offen offset:2048 sc1
v_mfma_f32_16x16x32_bf16 v[124:127], a[212:215], a[124:127], v[124:127]
buffer_load_dwordx4 a[212:215], v0, s[20:23], s30 offen offset:3072 sc1
s_add_u32 s30, s30, 0x1000
s_waitcnt vmcnt(15)
v_mfma_f32_16x16x32_bf16 v[160:163], a[220:223], a[96:99], v[160:163]
v_mfma_f32_16x16x32_bf16 v[160:163], a[188:191], a[128:131], v[160:163]
v_mfma_f32_16x16x32_bf16 v[192:195], a[216:219], a[128:131], v[192:195]
v_mfma_f32_16x16x32_bf16 v[192:195], a[184:187], a[96:99], v[192:195]
v_mfma_f32_16x16x32_bf16 v[196:199], a[184:187], a[100:103], v[196:199]
v_mfma_f32_16x16x32_bf16 v[196:199], a[216:219], a[132:135], v[196:199]
v_mfma_f32_16x16x32_bf16 v[164:167], a[188:191], a[132:135], v[164:167]
v_mfma_f32_16x16x32_bf16 v[164:167], a[220:223], a[100:103], v[164:167]
v_mfma_f32_16x16x32_bf16 v[168:171], a[220:223], a[104:107], v[168:171]
buffer_load_dwordx4 v0, s[20:23], s39 offen offset:2048 sc1 lds
v_mfma_f32_16x16x32_bf16 v[168:171], a[188:191], a[136:139], v[168:171]
v_mfma_f32_16x16x32_bf16 v[200:203], a[216:219], a[136:139], v[200:203]
v_mfma_f32_16x16x32_bf16 v[200:203], a[184:187], a[104:107], v[200:203]
v_mfma_f32_16x16x32_bf16 v[204:207], a[184:187], a[108:111], v[204:207]
v_mfma_f32_16x16x32_bf16 v[204:207], a[216:219], a[140:143], v[204:207]
v_mfma_f32_16x16x32_bf16 v[172:175], a[188:191], a[140:143], v[172:175]
v_mfma_f32_16x16x32_bf16 v[172:175], a[220:223], a[108:111], v[172:175]
v_mfma_f32_16x16x32_bf16 v[176:179], a[220:223], a[112:115], v[176:179]
v_mfma_f32_16x16x32_bf16 v[176:179], a[188:191], a[144:147], v[176:179]
v_mfma_f32_16x16x32_bf16 v[208:211], a[216:219], a[144:147], v[208:211]
v_mfma_f32_16x16x32_bf16 v[208:211], a[184:187], a[112:115], v[208:211]
v_mfma_f32_16x16x32_bf16 v[212:215], a[184:187], a[116:119], v[212:215]
v_mfma_f32_16x16x32_bf16 v[212:215], a[216:219], a[148:151], v[212:215]
v_mfma_f32_16x16x32_bf16 v[180:183], a[188:191], a[148:151], v[180:183]
v_mfma_f32_16x16x32_bf16 v[180:183], a[220:223], a[116:119], v[180:183]
v_mfma_f32_16x16x32_bf16 v[184:187], a[220:223], a[120:123], v[184:187]
v_mfma_f32_16x16x32_bf16 v[184:187], a[188:191], a[152:155], v[184:187]
v_mfma_f32_16x16x32_bf16 v[216:219], a[216:219], a[152:155], v[216:219]
v_mfma_f32_16x16x32_bf16 v[216:219], a[184:187], a[120:123], v[216:219]
v_mfma_f32_16x16x32_bf16 v[220:223], a[184:187], a[124:127], v[220:223]
buffer_load_dwordx4 a[184:187], v0, s[20:23], s30 offen offset:0 sc1
v_mfma_f32_16x16x32_bf16 v[220:223], a[216:219], a[156:159], v[220:223]
buffer_load_dwordx4 a[216:219], v0, s[20:23], s30 offen offset:1024 sc1
v_mfma_f32_16x16x32_bf16 v[188:191], a[188:191], a[156:159], v[188:191]
buffer_load_dwordx4 a[188:191], v0, s[20:23], s30 offen offset:2048 sc1
v_mfma_f32_16x16x32_bf16 v[188:191], a[220:223], a[124:127], v[188:191]
buffer_load_dwordx4 a[220:223], v0, s[20:23], s30 offen offset:3072 sc1
s_add_u32 s30, s30, 0x1000
s_waitcnt vmcnt(15)
v_mfma_f32_16x16x32_bf16 v[224:227], a[164:167], a[96:99], v[224:227]
v_mfma_f32_16x16x32_bf16 v[224:227], a[196:199], a[128:131], v[224:227]
v_mfma_f32_16x16x32_bf16 a[224:227], a[160:163], a[128:131], a[224:227]
v_xor_b32 v4, 0x6000, v6
ds_read_b128 a[128:131], v4 offset:0
v_mfma_f32_16x16x32_bf16 a[224:227], a[192:195], a[96:99], a[224:227]
v_xor_b32 v3, 0x4000, v6
ds_read_b128 a[96:99], v3 offset:0
v_mfma_f32_16x16x32_bf16 a[228:231], a[192:195], a[100:103], a[228:231]
v_mfma_f32_16x16x32_bf16 a[228:231], a[160:163], a[132:135], a[228:231]
v_mfma_f32_16x16x32_bf16 v[228:231], a[196:199], a[132:135], v[228:231]
ds_read_b128 a[132:135], v4 offset:1024
buffer_load_dwordx4 v0, s[20:23], s39 offen offset:3072 sc1 lds
v_mfma_f32_16x16x32_bf16 v[228:231], a[164:167], a[100:103], v[228:231]
ds_read_b128 a[100:103], v3 offset:1024
v_mfma_f32_16x16x32_bf16 v[232:235], a[164:167], a[104:107], v[232:235]
v_mfma_f32_16x16x32_bf16 v[232:235], a[196:199], a[136:139], v[232:235]
v_mfma_f32_16x16x32_bf16 a[232:235], a[160:163], a[136:139], a[232:235]
ds_read_b128 a[136:139], v4 offset:2048
v_mfma_f32_16x16x32_bf16 a[232:235], a[192:195], a[104:107], a[232:235]
ds_read_b128 a[104:107], v3 offset:2048
v_mfma_f32_16x16x32_bf16 a[236:239], a[192:195], a[108:111], a[236:239]
v_mfma_f32_16x16x32_bf16 a[236:239], a[160:163], a[140:143], a[236:239]
v_mfma_f32_16x16x32_bf16 v[236:239], a[196:199], a[140:143], v[236:239]
ds_read_b128 a[140:143], v4 offset:3072
v_mfma_f32_16x16x32_bf16 v[236:239], a[164:167], a[108:111], v[236:239]
ds_read_b128 a[108:111], v3 offset:3072
v_mfma_f32_16x16x32_bf16 v[240:243], a[164:167], a[112:115], v[240:243]
v_mfma_f32_16x16x32_bf16 v[240:243], a[196:199], a[144:147], v[240:243]
v_mfma_f32_16x16x32_bf16 a[240:243], a[160:163], a[144:147], a[240:243]
ds_read_b128 a[144:147], v4 offset:4096
v_mfma_f32_16x16x32_bf16 a[240:243], a[192:195], a[112:115], a[240:243]
ds_read_b128 a[112:115], v3 offset:4096
v_mfma_f32_16x16x32_bf16 a[244:247], a[192:195], a[116:119], a[244:247]
v_mfma_f32_16x16x32_bf16 a[244:247], a[160:163], a[148:151], a[244:247]
v_mfma_f32_16x16x32_bf16 v[244:247], a[196:199], a[148:151], v[244:247]
ds_read_b128 a[148:151], v4 offset:5120
v_mfma_f32_16x16x32_bf16 v[244:247], a[164:167], a[116:119], v[244:247]
ds_read_b128 a[116:119], v3 offset:5120
v_mfma_f32_16x16x32_bf16 v[248:251], a[164:167], a[120:123], v[248:251]
v_mfma_f32_16x16x32_bf16 v[248:251], a[196:199], a[152:155], v[248:251]
v_mfma_f32_16x16x32_bf16 a[248:251], a[160:163], a[152:155], a[248:251]
ds_read_b128 a[152:155], v4 offset:6144
v_mfma_f32_16x16x32_bf16 a[248:251], a[192:195], a[120:123], a[248:251]
ds_read_b128 a[120:123], v3 offset:6144
v_mfma_f32_16x16x32_bf16 a[252:255], a[192:195], a[124:127], a[252:255]
buffer_load_dwordx4 a[192:195], v0, s[20:23], s30 offen offset:0 sc1
v_mfma_f32_16x16x32_bf16 a[252:255], a[160:163], a[156:159], a[252:255]
buffer_load_dwordx4 a[160:163], v0, s[20:23], s30 offen offset:1024 sc1
v_mfma_f32_16x16x32_bf16 v[252:255], a[196:199], a[156:159], v[252:255]
buffer_load_dwordx4 a[196:199], v0, s[20:23], s30 offen offset:2048 sc1
ds_read_b128 a[156:159], v4 offset:7168
v_mfma_f32_16x16x32_bf16 v[252:255], a[164:167], a[124:127], v[252:255]
buffer_load_dwordx4 a[164:167], v0, s[20:23], s30 offen offset:3072 sc1
s_add_u32 s30, s30, 0x1000
ds_read_b128 a[124:127], v3 offset:7168
s_waitcnt vmcnt(15) lgkmcnt(14)
v_mfma_f32_16x16x32_bf16 v[32:35], a[172:175], a[96:99], v[32:35]
v_mfma_f32_16x16x32_bf16 v[32:35], a[204:207], a[128:131], v[32:35]
v_mfma_f32_16x16x32_bf16 v[64:67], a[168:171], a[128:131], v[64:67]
v_mfma_f32_16x16x32_bf16 v[64:67], a[200:203], a[96:99], v[64:67]
s_add_u32 m0, s32, 69632
s_add_u32 s39, s56, 69632
s_waitcnt lgkmcnt(12)
v_mfma_f32_16x16x32_bf16 v[68:71], a[200:203], a[100:103], v[68:71]
buffer_load_dwordx4 v0, s[20:23], s39 offen offset:0 sc1 lds
v_mfma_f32_16x16x32_bf16 v[68:71], a[168:171], a[132:135], v[68:71]
v_mfma_f32_16x16x32_bf16 v[36:39], a[204:207], a[132:135], v[36:39]
v_mfma_f32_16x16x32_bf16 v[36:39], a[172:175], a[100:103], v[36:39]
s_waitcnt lgkmcnt(10)
v_mfma_f32_16x16x32_bf16 v[40:43], a[172:175], a[104:107], v[40:43]
v_mfma_f32_16x16x32_bf16 v[40:43], a[204:207], a[136:139], v[40:43]
v_mfma_f32_16x16x32_bf16 v[72:75], a[168:171], a[136:139], v[72:75]
v_mfma_f32_16x16x32_bf16 v[72:75], a[200:203], a[104:107], v[72:75]
s_waitcnt lgkmcnt(8)
v_mfma_f32_16x16x32_bf16 v[76:79], a[200:203], a[108:111], v[76:79]
v_mfma_f32_16x16x32_bf16 v[76:79], a[168:171], a[140:143], v[76:79]
v_mfma_f32_16x16x32_bf16 v[44:47], a[204:207], a[140:143], v[44:47]
v_mfma_f32_16x16x32_bf16 v[44:47], a[172:175], a[108:111], v[44:47]
s_waitcnt lgkmcnt(6)
v_mfma_f32_16x16x32_bf16 v[48:51], a[172:175], a[112:115], v[48:51]
v_mfma_f32_16x16x32_bf16 v[48:51], a[204:207], a[144:147], v[48:51]
v_mfma_f32_16x16x32_bf16 v[80:83], a[168:171], a[144:147], v[80:83]
v_mfma_f32_16x16x32_bf16 v[80:83], a[200:203], a[112:115], v[80:83]
s_waitcnt lgkmcnt(4)
v_mfma_f32_16x16x32_bf16 v[84:87], a[200:203], a[116:119], v[84:87]
v_mfma_f32_16x16x32_bf16 v[84:87], a[168:171], a[148:151], v[84:87]
v_mfma_f32_16x16x32_bf16 v[52:55], a[204:207], a[148:151], v[52:55]
v_mfma_f32_16x16x32_bf16 v[52:55], a[172:175], a[116:119], v[52:55]
s_waitcnt lgkmcnt(2)
v_mfma_f32_16x16x32_bf16 v[56:59], a[172:175], a[120:123], v[56:59]
v_mfma_f32_16x16x32_bf16 v[56:59], a[204:207], a[152:155], v[56:59]
v_mfma_f32_16x16x32_bf16 v[88:91], a[168:171], a[152:155], v[88:91]
v_mfma_f32_16x16x32_bf16 v[88:91], a[200:203], a[120:123], v[88:91]
s_waitcnt lgkmcnt(0)
v_mfma_f32_16x16x32_bf16 v[92:95], a[200:203], a[124:127], v[92:95]
buffer_load_dwordx4 a[200:203], v0, s[20:23], s30 offen offset:0 sc1
v_mfma_f32_16x16x32_bf16 v[92:95], a[168:171], a[156:159], v[92:95]
buffer_load_dwordx4 a[168:171], v0, s[20:23], s30 offen offset:1024 sc1
v_mfma_f32_16x16x32_bf16 v[60:63], a[204:207], a[156:159], v[60:63]
buffer_load_dwordx4 a[204:207], v0, s[20:23], s30 offen offset:2048 sc1
v_mfma_f32_16x16x32_bf16 v[60:63], a[172:175], a[124:127], v[60:63]
buffer_load_dwordx4 a[172:175], v0, s[20:23], s30 offen offset:3072 sc1
s_add_u32 s30, s30, 0x1000
s_waitcnt vmcnt(15)
v_mfma_f32_16x16x32_bf16 v[96:99], a[176:179], a[96:99], v[96:99]
s_add_u32 s52, s52, 33816576
s_add_u32 s53, s53, 33816576
s_add_u32 s54, s54, 33816576
s_add_u32 s55, s55, 33816576
v_mfma_f32_16x16x32_bf16 v[96:99], a[208:211], a[128:131], v[96:99]
v_mfma_f32_16x16x32_bf16 v[128:131], a[212:215], a[128:131], v[128:131]
buffer_load_dwordx4 v0, s[20:23], s39 offen offset:1024 sc1 lds
v_mfma_f32_16x16x32_bf16 v[128:131], a[180:183], a[96:99], v[128:131]
v_mfma_f32_16x16x32_bf16 v[132:135], a[180:183], a[100:103], v[132:135]
v_mfma_f32_16x16x32_bf16 v[132:135], a[212:215], a[132:135], v[132:135]
v_mfma_f32_16x16x32_bf16 v[100:103], a[208:211], a[132:135], v[100:103]
v_mfma_f32_16x16x32_bf16 v[100:103], a[176:179], a[100:103], v[100:103]
v_mfma_f32_16x16x32_bf16 v[104:107], a[176:179], a[104:107], v[104:107]
v_mfma_f32_16x16x32_bf16 v[104:107], a[208:211], a[136:139], v[104:107]
v_mfma_f32_16x16x32_bf16 v[136:139], a[212:215], a[136:139], v[136:139]
v_mfma_f32_16x16x32_bf16 v[136:139], a[180:183], a[104:107], v[136:139]
v_mfma_f32_16x16x32_bf16 v[140:143], a[180:183], a[108:111], v[140:143]
v_mfma_f32_16x16x32_bf16 v[140:143], a[212:215], a[140:143], v[140:143]
v_mfma_f32_16x16x32_bf16 v[108:111], a[208:211], a[140:143], v[108:111]
v_mfma_f32_16x16x32_bf16 v[108:111], a[176:179], a[108:111], v[108:111]
v_mfma_f32_16x16x32_bf16 v[112:115], a[176:179], a[112:115], v[112:115]
v_mfma_f32_16x16x32_bf16 v[112:115], a[208:211], a[144:147], v[112:115]
v_mfma_f32_16x16x32_bf16 v[144:147], a[212:215], a[144:147], v[144:147]
v_mfma_f32_16x16x32_bf16 v[144:147], a[180:183], a[112:115], v[144:147]
v_mfma_f32_16x16x32_bf16 v[148:151], a[180:183], a[116:119], v[148:151]
v_mfma_f32_16x16x32_bf16 v[148:151], a[212:215], a[148:151], v[148:151]
v_mfma_f32_16x16x32_bf16 v[116:119], a[208:211], a[148:151], v[116:119]
v_mfma_f32_16x16x32_bf16 v[116:119], a[176:179], a[116:119], v[116:119]
v_mfma_f32_16x16x32_bf16 v[120:123], a[176:179], a[120:123], v[120:123]
v_mfma_f32_16x16x32_bf16 v[120:123], a[208:211], a[152:155], v[120:123]
v_mfma_f32_16x16x32_bf16 v[152:155], a[212:215], a[152:155], v[152:155]
v_mfma_f32_16x16x32_bf16 v[152:155], a[180:183], a[120:123], v[152:155]
v_mfma_f32_16x16x32_bf16 v[156:159], a[180:183], a[124:127], v[156:159]
buffer_load_dwordx4 a[180:183], v0, s[20:23], s30 offen offset:0 sc1
v_mfma_f32_16x16x32_bf16 v[156:159], a[212:215], a[156:159], v[156:159]
buffer_load_dwordx4 a[212:215], v0, s[20:23], s30 offen offset:1024 sc1
v_mfma_f32_16x16x32_bf16 v[124:127], a[208:211], a[156:159], v[124:127]
buffer_load_dwordx4 a[208:211], v0, s[20:23], s30 offen offset:2048 sc1
v_mfma_f32_16x16x32_bf16 v[124:127], a[176:179], a[124:127], v[124:127]
buffer_load_dwordx4 a[176:179], v0, s[20:23], s30 offen offset:3072 sc1
s_add_u32 s30, s30, 0x1000
s_waitcnt vmcnt(15)
v_mfma_f32_16x16x32_bf16 v[160:163], a[184:187], a[96:99], v[160:163]
buffer_load_dwordx4 v0, s[20:23], s39 offen offset:2048 sc1 lds
v_mfma_f32_16x16x32_bf16 v[160:163], a[216:219], a[128:131], v[160:163]
v_mfma_f32_16x16x32_bf16 v[192:195], a[220:223], a[128:131], v[192:195]
v_mfma_f32_16x16x32_bf16 v[192:195], a[188:191], a[96:99], v[192:195]
v_mfma_f32_16x16x32_bf16 v[196:199], a[188:191], a[100:103], v[196:199]
v_mfma_f32_16x16x32_bf16 v[196:199], a[220:223], a[132:135], v[196:199]
v_mfma_f32_16x16x32_bf16 v[164:167], a[216:219], a[132:135], v[164:167]
v_mfma_f32_16x16x32_bf16 v[164:167], a[184:187], a[100:103], v[164:167]
v_mfma_f32_16x16x32_bf16 v[168:171], a[184:187], a[104:107], v[168:171]
v_mfma_f32_16x16x32_bf16 v[168:171], a[216:219], a[136:139], v[168:171]
v_mfma_f32_16x16x32_bf16 v[200:203], a[220:223], a[136:139], v[200:203]
v_mfma_f32_16x16x32_bf16 v[200:203], a[188:191], a[104:107], v[200:203]
v_mfma_f32_16x16x32_bf16 v[204:207], a[188:191], a[108:111], v[204:207]
v_mfma_f32_16x16x32_bf16 v[204:207], a[220:223], a[140:143], v[204:207]
v_mfma_f32_16x16x32_bf16 v[172:175], a[216:219], a[140:143], v[172:175]
v_mfma_f32_16x16x32_bf16 v[172:175], a[184:187], a[108:111], v[172:175]
v_mfma_f32_16x16x32_bf16 v[176:179], a[184:187], a[112:115], v[176:179]
v_mfma_f32_16x16x32_bf16 v[176:179], a[216:219], a[144:147], v[176:179]
v_mfma_f32_16x16x32_bf16 v[208:211], a[220:223], a[144:147], v[208:211]
v_mfma_f32_16x16x32_bf16 v[208:211], a[188:191], a[112:115], v[208:211]
v_mfma_f32_16x16x32_bf16 v[212:215], a[188:191], a[116:119], v[212:215]
v_mfma_f32_16x16x32_bf16 v[212:215], a[220:223], a[148:151], v[212:215]
v_mfma_f32_16x16x32_bf16 v[180:183], a[216:219], a[148:151], v[180:183]
v_mfma_f32_16x16x32_bf16 v[180:183], a[184:187], a[116:119], v[180:183]
v_mfma_f32_16x16x32_bf16 v[184:187], a[184:187], a[120:123], v[184:187]
v_mfma_f32_16x16x32_bf16 v[184:187], a[216:219], a[152:155], v[184:187]
v_mfma_f32_16x16x32_bf16 v[216:219], a[220:223], a[152:155], v[216:219]
v_mfma_f32_16x16x32_bf16 v[216:219], a[188:191], a[120:123], v[216:219]
v_mfma_f32_16x16x32_bf16 v[220:223], a[188:191], a[124:127], v[220:223]
buffer_load_dwordx4 a[188:191], v0, s[20:23], s30 offen offset:0 sc1
v_mfma_f32_16x16x32_bf16 v[220:223], a[220:223], a[156:159], v[220:223]
buffer_load_dwordx4 a[220:223], v0, s[20:23], s30 offen offset:1024 sc1
v_mfma_f32_16x16x32_bf16 v[188:191], a[216:219], a[156:159], v[188:191]
buffer_load_dwordx4 a[216:219], v0, s[20:23], s30 offen offset:2048 sc1
buffer_load_dwordx4 v0, s[20:23], s39 offen offset:3072 sc1 lds
v_mfma_f32_16x16x32_bf16 v[188:191], a[184:187], a[124:127], v[188:191]
buffer_load_dwordx4 a[184:187], v0, s[20:23], s30 offen offset:3072 sc1
s_add_u32 s30, s30, 0x1000
s_barrier
s_waitcnt vmcnt(16)
v_mfma_f32_16x16x32_bf16 v[224:227], a[192:195], a[96:99], v[224:227]
v_mfma_f32_16x16x32_bf16 v[224:227], a[160:163], a[128:131], v[224:227]
v_mfma_f32_16x16x32_bf16 a[224:227], a[164:167], a[128:131], a[224:227]
ds_read_b128 a[128:131], v2 offset:32768
v_mfma_f32_16x16x32_bf16 a[224:227], a[196:199], a[96:99], a[224:227]
ds_read_b128 a[96:99], v1 offset:32768
v_mfma_f32_16x16x32_bf16 a[228:231], a[196:199], a[100:103], a[228:231]
v_mfma_f32_16x16x32_bf16 a[228:231], a[164:167], a[132:135], a[228:231]
v_mfma_f32_16x16x32_bf16 v[228:231], a[160:163], a[132:135], v[228:231]
ds_read_b128 a[132:135], v2 offset:33792
v_mfma_f32_16x16x32_bf16 v[228:231], a[192:195], a[100:103], v[228:231]
ds_read_b128 a[100:103], v1 offset:33792
v_mfma_f32_16x16x32_bf16 v[232:235], a[192:195], a[104:107], v[232:235]
v_mfma_f32_16x16x32_bf16 v[232:235], a[160:163], a[136:139], v[232:235]
v_mfma_f32_16x16x32_bf16 a[232:235], a[164:167], a[136:139], a[232:235]
ds_read_b128 a[136:139], v2 offset:34816
v_mfma_f32_16x16x32_bf16 a[232:235], a[196:199], a[104:107], a[232:235]
ds_read_b128 a[104:107], v1 offset:34816
v_mfma_f32_16x16x32_bf16 a[236:239], a[196:199], a[108:111], a[236:239]
v_mfma_f32_16x16x32_bf16 a[236:239], a[164:167], a[140:143], a[236:239]
v_mfma_f32_16x16x32_bf16 v[236:239], a[160:163], a[140:143], v[236:239]
ds_read_b128 a[140:143], v2 offset:35840
v_mfma_f32_16x16x32_bf16 v[236:239], a[192:195], a[108:111], v[236:239]
ds_read_b128 a[108:111], v1 offset:35840
v_mfma_f32_16x16x32_bf16 v[240:243], a[192:195], a[112:115], v[240:243]
v_mfma_f32_16x16x32_bf16 v[240:243], a[160:163], a[144:147], v[240:243]
v_mfma_f32_16x16x32_bf16 a[240:243], a[164:167], a[144:147], a[240:243]
ds_read_b128 a[144:147], v2 offset:36864
v_mfma_f32_16x16x32_bf16 a[240:243], a[196:199], a[112:115], a[240:243]
ds_read_b128 a[112:115], v1 offset:36864
v_mfma_f32_16x16x32_bf16 a[244:247], a[196:199], a[116:119], a[244:247]
v_mfma_f32_16x16x32_bf16 a[244:247], a[164:167], a[148:151], a[244:247]
v_mfma_f32_16x16x32_bf16 v[244:247], a[160:163], a[148:151], v[244:247]
ds_read_b128 a[148:151], v2 offset:37888
v_mfma_f32_16x16x32_bf16 v[244:247], a[192:195], a[116:119], v[244:247]
ds_read_b128 a[116:119], v1 offset:37888
v_mfma_f32_16x16x32_bf16 v[248:251], a[192:195], a[120:123], v[248:251]
v_mfma_f32_16x16x32_bf16 v[248:251], a[160:163], a[152:155], v[248:251]
v_mfma_f32_16x16x32_bf16 a[248:251], a[164:167], a[152:155], a[248:251]
ds_read_b128 a[152:155], v2 offset:38912
v_mfma_f32_16x16x32_bf16 a[248:251], a[196:199], a[120:123], a[248:251]
ds_read_b128 a[120:123], v1 offset:38912
s_add_u32 m0, s32, 98304
s_add_u32 s39, s56, 98304
v_mfma_f32_16x16x32_bf16 a[252:255], a[196:199], a[124:127], a[252:255]
buffer_load_dwordx4 a[196:199], v0, s[20:23], s30 offen offset:0 sc1
buffer_load_dwordx4 v0, s[20:23], s39 offen offset:0 sc1 lds
v_mfma_f32_16x16x32_bf16 a[252:255], a[164:167], a[156:159], a[252:255]
buffer_load_dwordx4 a[164:167], v0, s[20:23], s30 offen offset:1024 sc1
v_mfma_f32_16x16x32_bf16 v[252:255], a[160:163], a[156:159], v[252:255]
buffer_load_dwordx4 a[160:163], v0, s[20:23], s30 offen offset:2048 sc1
ds_read_b128 a[156:159], v2 offset:39936
v_mfma_f32_16x16x32_bf16 v[252:255], a[192:195], a[124:127], v[252:255]
buffer_load_dwordx4 a[192:195], v0, s[20:23], s30 offen offset:3072 sc1
s_add_u32 s30, s30, 0x1000
ds_read_b128 a[124:127], v1 offset:39936
s_waitcnt vmcnt(16) lgkmcnt(14)
v_mfma_f32_16x16x32_bf16 v[32:35], a[200:203], a[96:99], v[32:35]
v_mfma_f32_16x16x32_bf16 v[32:35], a[168:171], a[128:131], v[32:35]
v_mfma_f32_16x16x32_bf16 v[64:67], a[172:175], a[128:131], v[64:67]
v_mfma_f32_16x16x32_bf16 v[64:67], a[204:207], a[96:99], v[64:67]
s_waitcnt lgkmcnt(12)
v_mfma_f32_16x16x32_bf16 v[68:71], a[204:207], a[100:103], v[68:71]
v_mfma_f32_16x16x32_bf16 v[68:71], a[172:175], a[132:135], v[68:71]
v_mfma_f32_16x16x32_bf16 v[36:39], a[168:171], a[132:135], v[36:39]
v_mfma_f32_16x16x32_bf16 v[36:39], a[200:203], a[100:103], v[36:39]
s_waitcnt lgkmcnt(10)
v_mfma_f32_16x16x32_bf16 v[40:43], a[200:203], a[104:107], v[40:43]
v_mfma_f32_16x16x32_bf16 v[40:43], a[168:171], a[136:139], v[40:43]
v_mfma_f32_16x16x32_bf16 v[72:75], a[172:175], a[136:139], v[72:75]
v_mfma_f32_16x16x32_bf16 v[72:75], a[204:207], a[104:107], v[72:75]
s_waitcnt lgkmcnt(8)
v_mfma_f32_16x16x32_bf16 v[76:79], a[204:207], a[108:111], v[76:79]
v_mfma_f32_16x16x32_bf16 v[76:79], a[172:175], a[140:143], v[76:79]
v_mfma_f32_16x16x32_bf16 v[44:47], a[168:171], a[140:143], v[44:47]
v_mfma_f32_16x16x32_bf16 v[44:47], a[200:203], a[108:111], v[44:47]
s_waitcnt lgkmcnt(6)
v_mfma_f32_16x16x32_bf16 v[48:51], a[200:203], a[112:115], v[48:51]
v_mfma_f32_16x16x32_bf16 v[48:51], a[168:171], a[144:147], v[48:51]
v_mfma_f32_16x16x32_bf16 v[80:83], a[172:175], a[144:147], v[80:83]
v_mfma_f32_16x16x32_bf16 v[80:83], a[204:207], a[112:115], v[80:83]
s_waitcnt lgkmcnt(4)
v_mfma_f32_16x16x32_bf16 v[84:87], a[204:207], a[116:119], v[84:87]
v_mfma_f32_16x16x32_bf16 v[84:87], a[172:175], a[148:151], v[84:87]
v_mfma_f32_16x16x32_bf16 v[52:55], a[168:171], a[148:151], v[52:55]
v_mfma_f32_16x16x32_bf16 v[52:55], a[200:203], a[116:119], v[52:55]
s_waitcnt lgkmcnt(2)
v_mfma_f32_16x16x32_bf16 v[56:59], a[200:203], a[120:123], v[56:59]
v_mfma_f32_16x16x32_bf16 v[56:59], a[168:171], a[152:155], v[56:59]
v_mfma_f32_16x16x32_bf16 v[88:91], a[172:175], a[152:155], v[88:91]
buffer_load_dwordx4 v0, s[20:23], s39 offen offset:1024 sc1 lds
v_mfma_f32_16x16x32_bf16 v[88:91], a[204:207], a[120:123], v[88:91]
s_waitcnt lgkmcnt(0)
v_mfma_f32_16x16x32_bf16 v[92:95], a[204:207], a[124:127], v[92:95]
buffer_load_dwordx4 a[204:207], v0, s[20:23], s30 offen offset:0 sc1
v_mfma_f32_16x16x32_bf16 v[92:95], a[172:175], a[156:159], v[92:95]
buffer_load_dwordx4 a[172:175], v0, s[20:23], s30 offen offset:1024 sc1
v_mfma_f32_16x16x32_bf16 v[60:63], a[168:171], a[156:159], v[60:63]
buffer_load_dwordx4 a[168:171], v0, s[20:23], s30 offen offset:2048 sc1
v_mfma_f32_16x16x32_bf16 v[60:63], a[200:203], a[124:127], v[60:63]
buffer_load_dwordx4 a[200:203], v0, s[20:23], s30 offen offset:3072 sc1
s_add_u32 s30, s30, 0x1000
s_waitcnt vmcnt(16)
v_mfma_f32_16x16x32_bf16 v[96:99], a[180:183], a[96:99], v[96:99]
v_mfma_f32_16x16x32_bf16 v[96:99], a[212:215], a[128:131], v[96:99]
v_mfma_f32_16x16x32_bf16 v[128:131], a[176:179], a[128:131], v[128:131]
v_mfma_f32_16x16x32_bf16 v[128:131], a[208:211], a[96:99], v[128:131]
v_mfma_f32_16x16x32_bf16 v[132:135], a[208:211], a[100:103], v[132:135]
v_mfma_f32_16x16x32_bf16 v[132:135], a[176:179], a[132:135], v[132:135]
v_mfma_f32_16x16x32_bf16 v[100:103], a[212:215], a[132:135], v[100:103]
v_mfma_f32_16x16x32_bf16 v[100:103], a[180:183], a[100:103], v[100:103]
v_mfma_f32_16x16x32_bf16 v[104:107], a[180:183], a[104:107], v[104:107]
v_mfma_f32_16x16x32_bf16 v[104:107], a[212:215], a[136:139], v[104:107]
v_mfma_f32_16x16x32_bf16 v[136:139], a[176:179], a[136:139], v[136:139]
v_mfma_f32_16x16x32_bf16 v[136:139], a[208:211], a[104:107], v[136:139]
v_mfma_f32_16x16x32_bf16 v[140:143], a[208:211], a[108:111], v[140:143]
v_mfma_f32_16x16x32_bf16 v[140:143], a[176:179], a[140:143], v[140:143]
v_mfma_f32_16x16x32_bf16 v[108:111], a[212:215], a[140:143], v[108:111]
v_mfma_f32_16x16x32_bf16 v[108:111], a[180:183], a[108:111], v[108:111]
v_mfma_f32_16x16x32_bf16 v[112:115], a[180:183], a[112:115], v[112:115]
v_mfma_f32_16x16x32_bf16 v[112:115], a[212:215], a[144:147], v[112:115]
v_mfma_f32_16x16x32_bf16 v[144:147], a[176:179], a[144:147], v[144:147]
v_mfma_f32_16x16x32_bf16 v[144:147], a[208:211], a[112:115], v[144:147]
v_mfma_f32_16x16x32_bf16 v[148:151], a[208:211], a[116:119], v[148:151]
v_mfma_f32_16x16x32_bf16 v[148:151], a[176:179], a[148:151], v[148:151]
v_mfma_f32_16x16x32_bf16 v[116:119], a[212:215], a[148:151], v[116:119]
v_mfma_f32_16x16x32_bf16 v[116:119], a[180:183], a[116:119], v[116:119]
v_mfma_f32_16x16x32_bf16 v[120:123], a[180:183], a[120:123], v[120:123]
buffer_load_dwordx4 v0, s[20:23], s39 offen offset:2048 sc1 lds
v_mfma_f32_16x16x32_bf16 v[120:123], a[212:215], a[152:155], v[120:123]
v_mfma_f32_16x16x32_bf16 v[152:155], a[176:179], a[152:155], v[152:155]
v_mfma_f32_16x16x32_bf16 v[152:155], a[208:211], a[120:123], v[152:155]
v_mfma_f32_16x16x32_bf16 v[156:159], a[208:211], a[124:127], v[156:159]
buffer_load_dwordx4 a[208:211], v0, s[20:23], s30 offen offset:0 sc1
v_mfma_f32_16x16x32_bf16 v[156:159], a[176:179], a[156:159], v[156:159]
buffer_load_dwordx4 a[176:179], v0, s[20:23], s30 offen offset:1024 sc1
v_mfma_f32_16x16x32_bf16 v[124:127], a[212:215], a[156:159], v[124:127]
buffer_load_dwordx4 a[212:215], v0, s[20:23], s30 offen offset:2048 sc1
v_mfma_f32_16x16x32_bf16 v[124:127], a[180:183], a[124:127], v[124:127]
buffer_load_dwordx4 a[180:183], v0, s[20:23], s30 offen offset:3072 sc1
s_add_u32 s30, s30, 0x1000
s_waitcnt vmcnt(15)
v_mfma_f32_16x16x32_bf16 v[160:163], a[188:191], a[96:99], v[160:163]
v_mfma_f32_16x16x32_bf16 v[160:163], a[220:223], a[128:131], v[160:163]
v_mfma_f32_16x16x32_bf16 v[192:195], a[184:187], a[128:131], v[192:195]
v_mfma_f32_16x16x32_bf16 v[192:195], a[216:219], a[96:99], v[192:195]
v_mfma_f32_16x16x32_bf16 v[196:199], a[216:219], a[100:103], v[196:199]
v_mfma_f32_16x16x32_bf16 v[196:199], a[184:187], a[132:135], v[196:199]
v_mfma_f32_16x16x32_bf16 v[164:167], a[220:223], a[132:135], v[164:167]
v_mfma_f32_16x16x32_bf16 v[164:167], a[188:191], a[100:103], v[164:167]
v_mfma_f32_16x16x32_bf16 v[168:171], a[188:191], a[104:107], v[168:171]
v_mfma_f32_16x16x32_bf16 v[168:171], a[220:223], a[136:139], v[168:171]
v_mfma_f32_16x16x32_bf16 v[200:203], a[184:187], a[136:139], v[200:203]
v_mfma_f32_16x16x32_bf16 v[200:203], a[216:219], a[104:107], v[200:203]
v_mfma_f32_16x16x32_bf16 v[204:207], a[216:219], a[108:111], v[204:207]
v_mfma_f32_16x16x32_bf16 v[204:207], a[184:187], a[140:143], v[204:207]
v_mfma_f32_16x16x32_bf16 v[172:175], a[220:223], a[140:143], v[172:175]
v_mfma_f32_16x16x32_bf16 v[172:175], a[188:191], a[108:111], v[172:175]
v_mfma_f32_16x16x32_bf16 v[176:179], a[188:191], a[112:115], v[176:179]
v_mfma_f32_16x16x32_bf16 v[176:179], a[220:223], a[144:147], v[176:179]
v_mfma_f32_16x16x32_bf16 v[208:211], a[184:187], a[144:147], v[208:211]
v_mfma_f32_16x16x32_bf16 v[208:211], a[216:219], a[112:115], v[208:211]
v_mfma_f32_16x16x32_bf16 v[212:215], a[216:219], a[116:119], v[212:215]
v_mfma_f32_16x16x32_bf16 v[212:215], a[184:187], a[148:151], v[212:215]
v_mfma_f32_16x16x32_bf16 v[180:183], a[220:223], a[148:151], v[180:183]
buffer_load_dwordx4 v0, s[20:23], s39 offen offset:3072 sc1 lds
v_mfma_f32_16x16x32_bf16 v[180:183], a[188:191], a[116:119], v[180:183]
v_mfma_f32_16x16x32_bf16 v[184:187], a[188:191], a[120:123], v[184:187]
v_mfma_f32_16x16x32_bf16 v[184:187], a[220:223], a[152:155], v[184:187]
v_mfma_f32_16x16x32_bf16 v[216:219], a[184:187], a[152:155], v[216:219]
v_mfma_f32_16x16x32_bf16 v[216:219], a[216:219], a[120:123], v[216:219]
v_mfma_f32_16x16x32_bf16 v[220:223], a[216:219], a[124:127], v[220:223]
buffer_load_dwordx4 a[216:219], v0, s[20:23], s30 offen offset:0 sc1
v_mfma_f32_16x16x32_bf16 v[220:223], a[184:187], a[156:159], v[220:223]
buffer_load_dwordx4 a[184:187], v0, s[20:23], s30 offen offset:1024 sc1
v_mfma_f32_16x16x32_bf16 v[188:191], a[220:223], a[156:159], v[188:191]
buffer_load_dwordx4 a[220:223], v0, s[20:23], s30 offen offset:2048 sc1
v_mfma_f32_16x16x32_bf16 v[188:191], a[188:191], a[124:127], v[188:191]
buffer_load_dwordx4 a[188:191], v0, s[20:23], s30 offen offset:3072 sc1
s_add_u32 s30, s30, 0x1000
s_waitcnt vmcnt(15)
v_mfma_f32_16x16x32_bf16 v[224:227], a[196:199], a[96:99], v[224:227]
v_mfma_f32_16x16x32_bf16 v[224:227], a[164:167], a[128:131], v[224:227]
v_mfma_f32_16x16x32_bf16 a[224:227], a[192:195], a[128:131], a[224:227]
ds_read_b128 a[128:131], v4 offset:32768
v_mfma_f32_16x16x32_bf16 a[224:227], a[160:163], a[96:99], a[224:227]
ds_read_b128 a[96:99], v3 offset:32768
v_mfma_f32_16x16x32_bf16 a[228:231], a[160:163], a[100:103], a[228:231]
v_mfma_f32_16x16x32_bf16 a[228:231], a[192:195], a[132:135], a[228:231]
v_mfma_f32_16x16x32_bf16 v[228:231], a[164:167], a[132:135], v[228:231]
ds_read_b128 a[132:135], v4 offset:33792
v_mfma_f32_16x16x32_bf16 v[228:231], a[196:199], a[100:103], v[228:231]
ds_read_b128 a[100:103], v3 offset:33792
v_mfma_f32_16x16x32_bf16 v[232:235], a[196:199], a[104:107], v[232:235]
v_mfma_f32_16x16x32_bf16 v[232:235], a[164:167], a[136:139], v[232:235]
v_mfma_f32_16x16x32_bf16 a[232:235], a[192:195], a[136:139], a[232:235]
ds_read_b128 a[136:139], v4 offset:34816
v_mfma_f32_16x16x32_bf16 a[232:235], a[160:163], a[104:107], a[232:235]
ds_read_b128 a[104:107], v3 offset:34816
v_mfma_f32_16x16x32_bf16 a[236:239], a[160:163], a[108:111], a[236:239]
v_mfma_f32_16x16x32_bf16 a[236:239], a[192:195], a[140:143], a[236:239]
v_mfma_f32_16x16x32_bf16 v[236:239], a[164:167], a[140:143], v[236:239]
ds_read_b128 a[140:143], v4 offset:35840
v_mfma_f32_16x16x32_bf16 v[236:239], a[196:199], a[108:111], v[236:239]
ds_read_b128 a[108:111], v3 offset:35840
v_mfma_f32_16x16x32_bf16 v[240:243], a[196:199], a[112:115], v[240:243]
v_mfma_f32_16x16x32_bf16 v[240:243], a[164:167], a[144:147], v[240:243]
v_mfma_f32_16x16x32_bf16 a[240:243], a[192:195], a[144:147], a[240:243]
ds_read_b128 a[144:147], v4 offset:36864
v_mfma_f32_16x16x32_bf16 a[240:243], a[160:163], a[112:115], a[240:243]
ds_read_b128 a[112:115], v3 offset:36864
s_add_u32 m0, s32, 102400
s_add_u32 s39, s56, 102400
v_mfma_f32_16x16x32_bf16 a[244:247], a[160:163], a[116:119], a[244:247]
buffer_load_dwordx4 v0, s[20:23], s39 offen offset:0 sc1 lds
v_mfma_f32_16x16x32_bf16 a[244:247], a[192:195], a[148:151], a[244:247]
v_mfma_f32_16x16x32_bf16 v[244:247], a[164:167], a[148:151], v[244:247]
ds_read_b128 a[148:151], v4 offset:37888
v_mfma_f32_16x16x32_bf16 v[244:247], a[196:199], a[116:119], v[244:247]
ds_read_b128 a[116:119], v3 offset:37888
v_mfma_f32_16x16x32_bf16 v[248:251], a[196:199], a[120:123], v[248:251]
v_mfma_f32_16x16x32_bf16 v[248:251], a[164:167], a[152:155], v[248:251]
v_mfma_f32_16x16x32_bf16 a[248:251], a[192:195], a[152:155], a[248:251]
ds_read_b128 a[152:155], v4 offset:38912
v_mfma_f32_16x16x32_bf16 a[248:251], a[160:163], a[120:123], a[248:251]
ds_read_b128 a[120:123], v3 offset:38912
v_mfma_f32_16x16x32_bf16 a[252:255], a[160:163], a[124:127], a[252:255]
buffer_load_dwordx4 a[160:163], v0, s[20:23], s30 offen offset:0 sc1
v_mfma_f32_16x16x32_bf16 a[252:255], a[192:195], a[156:159], a[252:255]
buffer_load_dwordx4 a[192:195], v0, s[20:23], s30 offen offset:1024 sc1
v_mfma_f32_16x16x32_bf16 v[252:255], a[164:167], a[156:159], v[252:255]
buffer_load_dwordx4 a[164:167], v0, s[20:23], s30 offen offset:2048 sc1
ds_read_b128 a[156:159], v4 offset:39936
v_mfma_f32_16x16x32_bf16 v[252:255], a[196:199], a[124:127], v[252:255]
buffer_load_dwordx4 a[196:199], v0, s[20:23], s30 offen offset:3072 sc1
s_add_u32 s30, s30, 0x1000
ds_read_b128 a[124:127], v3 offset:39936
s_waitcnt vmcnt(15) lgkmcnt(14)
v_mfma_f32_16x16x32_bf16 v[32:35], a[204:207], a[96:99], v[32:35]
v_mfma_f32_16x16x32_bf16 v[32:35], a[172:175], a[128:131], v[32:35]
v_mfma_f32_16x16x32_bf16 v[64:67], a[200:203], a[128:131], v[64:67]
v_mfma_f32_16x16x32_bf16 v[64:67], a[168:171], a[96:99], v[64:67]
s_waitcnt lgkmcnt(12)
v_mfma_f32_16x16x32_bf16 v[68:71], a[168:171], a[100:103], v[68:71]
buffer_load_dwordx4 v[20:23], v9, s[24:27], s37 offen offset:2176
v_mfma_f32_16x16x32_bf16 v[68:71], a[200:203], a[132:135], v[68:71]
v_mfma_f32_16x16x32_bf16 v[36:39], a[172:175], a[132:135], v[36:39]
v_mfma_f32_16x16x32_bf16 v[36:39], a[204:207], a[100:103], v[36:39]
s_waitcnt lgkmcnt(10)
v_mfma_f32_16x16x32_bf16 v[40:43], a[204:207], a[104:107], v[40:43]
buffer_load_dwordx4 v[24:27], v9, s[24:27], s37 offen offset:2240
v_mfma_f32_16x16x32_bf16 v[40:43], a[172:175], a[136:139], v[40:43]
v_mfma_f32_16x16x32_bf16 v[72:75], a[200:203], a[136:139], v[72:75]
v_mfma_f32_16x16x32_bf16 v[72:75], a[168:171], a[104:107], v[72:75]
s_waitcnt lgkmcnt(8)
v_mfma_f32_16x16x32_bf16 v[76:79], a[168:171], a[108:111], v[76:79]
v_mfma_f32_16x16x32_bf16 v[76:79], a[200:203], a[140:143], v[76:79]
v_mfma_f32_16x16x32_bf16 v[44:47], a[172:175], a[140:143], v[44:47]
v_mfma_f32_16x16x32_bf16 v[44:47], a[204:207], a[108:111], v[44:47]
s_waitcnt lgkmcnt(6)
v_mfma_f32_16x16x32_bf16 v[48:51], a[204:207], a[112:115], v[48:51]
v_mfma_f32_16x16x32_bf16 v[48:51], a[172:175], a[144:147], v[48:51]
v_mfma_f32_16x16x32_bf16 v[80:83], a[200:203], a[144:147], v[80:83]
buffer_load_dwordx4 v0, s[20:23], s39 offen offset:1024 sc1 lds
v_mfma_f32_16x16x32_bf16 v[80:83], a[168:171], a[112:115], v[80:83]
s_waitcnt lgkmcnt(4)
v_mfma_f32_16x16x32_bf16 v[84:87], a[168:171], a[116:119], v[84:87]
v_mfma_f32_16x16x32_bf16 v[84:87], a[200:203], a[148:151], v[84:87]
v_mfma_f32_16x16x32_bf16 v[52:55], a[172:175], a[148:151], v[52:55]
v_mfma_f32_16x16x32_bf16 v[52:55], a[204:207], a[116:119], v[52:55]
s_waitcnt lgkmcnt(2)
v_mfma_f32_16x16x32_bf16 v[56:59], a[204:207], a[120:123], v[56:59]
v_mfma_f32_16x16x32_bf16 v[56:59], a[172:175], a[152:155], v[56:59]
v_mfma_f32_16x16x32_bf16 v[88:91], a[200:203], a[152:155], v[88:91]
v_mfma_f32_16x16x32_bf16 v[88:91], a[168:171], a[120:123], v[88:91]
s_waitcnt lgkmcnt(0)
v_mfma_f32_16x16x32_bf16 v[92:95], a[168:171], a[124:127], v[92:95]
buffer_load_dwordx4 a[168:171], v0, s[20:23], s30 offen offset:0 sc1
v_mfma_f32_16x16x32_bf16 v[92:95], a[200:203], a[156:159], v[92:95]
buffer_load_dwordx4 a[200:203], v0, s[20:23], s30 offen offset:1024 sc1
v_mfma_f32_16x16x32_bf16 v[60:63], a[172:175], a[156:159], v[60:63]
buffer_load_dwordx4 a[172:175], v0, s[20:23], s30 offen offset:2048 sc1
v_mfma_f32_16x16x32_bf16 v[60:63], a[204:207], a[124:127], v[60:63]
buffer_load_dwordx4 a[204:207], v0, s[20:23], s30 offen offset:3072 sc1
s_add_u32 s30, s30, 0x1000
s_waitcnt vmcnt(17)
v_mfma_f32_16x16x32_bf16 v[96:99], a[208:211], a[96:99], v[96:99]
v_mfma_f32_16x16x32_bf16 v[96:99], a[176:179], a[128:131], v[96:99]
v_mfma_f32_16x16x32_bf16 v[128:131], a[180:183], a[128:131], v[128:131]
v_mfma_f32_16x16x32_bf16 v[128:131], a[212:215], a[96:99], v[128:131]
v_mfma_f32_16x16x32_bf16 v[132:135], a[212:215], a[100:103], v[132:135]
v_mfma_f32_16x16x32_bf16 v[132:135], a[180:183], a[132:135], v[132:135]
v_mfma_f32_16x16x32_bf16 v[100:103], a[176:179], a[132:135], v[100:103]
v_mfma_f32_16x16x32_bf16 v[100:103], a[208:211], a[100:103], v[100:103]
v_mfma_f32_16x16x32_bf16 v[104:107], a[208:211], a[104:107], v[104:107]
v_mfma_f32_16x16x32_bf16 v[104:107], a[176:179], a[136:139], v[104:107]
v_mfma_f32_16x16x32_bf16 v[136:139], a[180:183], a[136:139], v[136:139]
v_mfma_f32_16x16x32_bf16 v[136:139], a[212:215], a[104:107], v[136:139]
v_mfma_f32_16x16x32_bf16 v[140:143], a[212:215], a[108:111], v[140:143]
v_mfma_f32_16x16x32_bf16 v[140:143], a[180:183], a[140:143], v[140:143]
v_mfma_f32_16x16x32_bf16 v[108:111], a[176:179], a[140:143], v[108:111]
v_mfma_f32_16x16x32_bf16 v[108:111], a[208:211], a[108:111], v[108:111]
v_mfma_f32_16x16x32_bf16 v[112:115], a[208:211], a[112:115], v[112:115]
buffer_load_dwordx4 v0, s[20:23], s39 offen offset:2048 sc1 lds
v_mfma_f32_16x16x32_bf16 v[112:115], a[176:179], a[144:147], v[112:115]
v_mfma_f32_16x16x32_bf16 v[144:147], a[180:183], a[144:147], v[144:147]
v_mfma_f32_16x16x32_bf16 v[144:147], a[212:215], a[112:115], v[144:147]
v_mfma_f32_16x16x32_bf16 v[148:151], a[212:215], a[116:119], v[148:151]
v_mfma_f32_16x16x32_bf16 v[148:151], a[180:183], a[148:151], v[148:151]
v_mfma_f32_16x16x32_bf16 v[116:119], a[176:179], a[148:151], v[116:119]
v_mfma_f32_16x16x32_bf16 v[116:119], a[208:211], a[116:119], v[116:119]
v_mfma_f32_16x16x32_bf16 v[120:123], a[208:211], a[120:123], v[120:123]
v_mfma_f32_16x16x32_bf16 v[120:123], a[176:179], a[152:155], v[120:123]
v_mfma_f32_16x16x32_bf16 v[152:155], a[180:183], a[152:155], v[152:155]
v_mfma_f32_16x16x32_bf16 v[152:155], a[212:215], a[120:123], v[152:155]
v_mfma_f32_16x16x32_bf16 v[156:159], a[212:215], a[124:127], v[156:159]
buffer_load_dwordx4 a[212:215], v0, s[20:23], s30 offen offset:0 sc1
v_mfma_f32_16x16x32_bf16 v[156:159], a[180:183], a[156:159], v[156:159]
buffer_load_dwordx4 a[180:183], v0, s[20:23], s30 offen offset:1024 sc1
v_mfma_f32_16x16x32_bf16 v[124:127], a[176:179], a[156:159], v[124:127]
buffer_load_dwordx4 a[176:179], v0, s[20:23], s30 offen offset:2048 sc1
v_mfma_f32_16x16x32_bf16 v[124:127], a[208:211], a[124:127], v[124:127]
buffer_load_dwordx4 a[208:211], v0, s[20:23], s30 offen offset:3072 sc1
s_add_u32 s30, s30, 0x3000
s_waitcnt vmcnt(17)
v_mfma_f32_16x16x32_bf16 v[160:163], a[216:219], a[96:99], v[160:163]
v_mfma_f32_16x16x32_bf16 v[160:163], a[184:187], a[128:131], v[160:163]
v_mfma_f32_16x16x32_bf16 v[192:195], a[188:191], a[128:131], v[192:195]
v_mfma_f32_16x16x32_bf16 v[192:195], a[220:223], a[96:99], v[192:195]
v_mfma_f32_16x16x32_bf16 v[196:199], a[220:223], a[100:103], v[196:199]
v_mfma_f32_16x16x32_bf16 v[196:199], a[188:191], a[132:135], v[196:199]
v_mfma_f32_16x16x32_bf16 v[164:167], a[184:187], a[132:135], v[164:167]
v_mfma_f32_16x16x32_bf16 v[164:167], a[216:219], a[100:103], v[164:167]
v_mfma_f32_16x16x32_bf16 v[168:171], a[216:219], a[104:107], v[168:171]
v_mfma_f32_16x16x32_bf16 v[168:171], a[184:187], a[136:139], v[168:171]
v_mfma_f32_16x16x32_bf16 v[200:203], a[188:191], a[136:139], v[200:203]
v_mfma_f32_16x16x32_bf16 v[200:203], a[220:223], a[104:107], v[200:203]
v_mfma_f32_16x16x32_bf16 v[204:207], a[220:223], a[108:111], v[204:207]
v_mfma_f32_16x16x32_bf16 v[204:207], a[188:191], a[140:143], v[204:207]
v_mfma_f32_16x16x32_bf16 v[172:175], a[184:187], a[140:143], v[172:175]
buffer_load_dwordx4 v0, s[20:23], s39 offen offset:3072 sc1 lds
v_mfma_f32_16x16x32_bf16 v[172:175], a[216:219], a[108:111], v[172:175]
v_mfma_f32_16x16x32_bf16 v[176:179], a[216:219], a[112:115], v[176:179]
v_mfma_f32_16x16x32_bf16 v[176:179], a[184:187], a[144:147], v[176:179]
v_mfma_f32_16x16x32_bf16 v[208:211], a[188:191], a[144:147], v[208:211]
v_mfma_f32_16x16x32_bf16 v[208:211], a[220:223], a[112:115], v[208:211]
v_mfma_f32_16x16x32_bf16 v[212:215], a[220:223], a[116:119], v[212:215]
v_mfma_f32_16x16x32_bf16 v[212:215], a[188:191], a[148:151], v[212:215]
v_mfma_f32_16x16x32_bf16 v[180:183], a[184:187], a[148:151], v[180:183]
v_mfma_f32_16x16x32_bf16 v[180:183], a[216:219], a[116:119], v[180:183]
v_mfma_f32_16x16x32_bf16 v[184:187], a[216:219], a[120:123], v[184:187]
v_mfma_f32_16x16x32_bf16 v[184:187], a[184:187], a[152:155], v[184:187]
v_mfma_f32_16x16x32_bf16 v[216:219], a[188:191], a[152:155], v[216:219]
v_mfma_f32_16x16x32_bf16 v[216:219], a[220:223], a[120:123], v[216:219]
v_mfma_f32_16x16x32_bf16 v[220:223], a[220:223], a[124:127], v[220:223]
buffer_load_dwordx4 a[220:223], v0, s[20:23], s30 offen offset:0 sc1
v_mfma_f32_16x16x32_bf16 v[220:223], a[188:191], a[156:159], v[220:223]
buffer_load_dwordx4 a[188:191], v0, s[20:23], s30 offen offset:1024 sc1
v_mfma_f32_16x16x32_bf16 v[188:191], a[184:187], a[156:159], v[188:191]
buffer_load_dwordx4 a[184:187], v0, s[20:23], s30 offen offset:2048 sc1
v_mfma_f32_16x16x32_bf16 v[188:191], a[216:219], a[124:127], v[188:191]
buffer_load_dwordx4 a[216:219], v0, s[20:23], s30 offen offset:3072 sc1
s_add_u32 s30, s30, 0x1000
s_barrier
s_waitcnt vmcnt(17)
v_mfma_f32_16x16x32_bf16 v[224:227], a[160:163], a[96:99], v[224:227]
v_mfma_f32_16x16x32_bf16 v[224:227], a[192:195], a[128:131], v[224:227]
v_mfma_f32_16x16x32_bf16 a[224:227], a[196:199], a[128:131], a[224:227]
v_xor_b32 v2, 0x12000, v6
ds_read_b128 a[128:131], v2 offset:0
v_mfma_f32_16x16x32_bf16 a[224:227], a[164:167], a[96:99], a[224:227]
v_xor_b32 v1, 0x10000, v6
ds_read_b128 a[96:99], v1 offset:0
v_mfma_f32_16x16x32_bf16 a[228:231], a[164:167], a[100:103], a[228:231]
s_waitcnt vmcnt(16)
v_lshlrev_b32 v28, 16, v20
v_and_b32 v29, s33, v20
v_mfma_f32_16x16x32_bf16 a[228:231], a[196:199], a[132:135], a[228:231]
v_lshlrev_b32 v30, 16, v21
v_and_b32 v31, s33, v21
v_mfma_f32_16x16x32_bf16 v[228:231], a[192:195], a[132:135], v[228:231]
ds_read_b128 a[132:135], v2 offset:1024
v_add_f32 v160, v160, v28
v_mfma_f32_16x16x32_bf16 v[228:231], a[160:163], a[100:103], v[228:231]
ds_read_b128 a[100:103], v1 offset:1024
v_add_f32 v161, v161, v29
v_mfma_f32_16x16x32_bf16 v[232:235], a[160:163], a[104:107], v[232:235]
v_add_f32 v162, v162, v30
v_add_f32 v163, v163, v31
v_mfma_f32_16x16x32_bf16 v[232:235], a[192:195], a[136:139], v[232:235]
v_add_f32 v164, v164, v28
v_add_f32 v165, v165, v29
v_mfma_f32_16x16x32_bf16 a[232:235], a[196:199], a[136:139], a[232:235]
ds_read_b128 a[136:139], v2 offset:2048
v_add_f32 v166, v166, v30
v_mfma_f32_16x16x32_bf16 a[232:235], a[164:167], a[104:107], a[232:235]
ds_read_b128 a[104:107], v1 offset:2048
v_add_f32 v167, v167, v31
v_mfma_f32_16x16x32_bf16 a[236:239], a[164:167], a[108:111], a[236:239]
v_add_f32 v168, v168, v28
v_add_f32 v169, v169, v29
v_mfma_f32_16x16x32_bf16 a[236:239], a[196:199], a[140:143], a[236:239]
v_add_f32 v170, v170, v30
v_add_f32 v171, v171, v31
v_mfma_f32_16x16x32_bf16 v[236:239], a[192:195], a[140:143], v[236:239]
ds_read_b128 a[140:143], v2 offset:3072
v_add_f32 v172, v172, v28
v_mfma_f32_16x16x32_bf16 v[236:239], a[160:163], a[108:111], v[236:239]
ds_read_b128 a[108:111], v1 offset:3072
v_add_f32 v173, v173, v29
v_mfma_f32_16x16x32_bf16 v[240:243], a[160:163], a[112:115], v[240:243]
v_add_f32 v174, v174, v30
v_add_f32 v175, v175, v31
v_mfma_f32_16x16x32_bf16 v[240:243], a[192:195], a[144:147], v[240:243]
v_add_f32 v176, v176, v28
v_add_f32 v177, v177, v29
v_mfma_f32_16x16x32_bf16 a[240:243], a[196:199], a[144:147], a[240:243]
ds_read_b128 a[144:147], v2 offset:4096
v_add_f32 v178, v178, v30
v_mfma_f32_16x16x32_bf16 a[240:243], a[164:167], a[112:115], a[240:243]
ds_read_b128 a[112:115], v1 offset:4096
v_add_f32 v179, v179, v31
v_mfma_f32_16x16x32_bf16 a[244:247], a[164:167], a[116:119], a[244:247]
v_add_f32 v180, v180, v28
v_add_f32 v181, v181, v29
v_mfma_f32_16x16x32_bf16 a[244:247], a[196:199], a[148:151], a[244:247]
v_add_f32 v182, v182, v30
v_add_f32 v183, v183, v31
v_mfma_f32_16x16x32_bf16 v[244:247], a[192:195], a[148:151], v[244:247]
ds_read_b128 a[148:151], v2 offset:5120
v_add_f32 v184, v184, v28
v_mfma_f32_16x16x32_bf16 v[244:247], a[160:163], a[116:119], v[244:247]
ds_read_b128 a[116:119], v1 offset:5120
v_add_f32 v185, v185, v29
v_mfma_f32_16x16x32_bf16 v[248:251], a[160:163], a[120:123], v[248:251]
v_add_f32 v186, v186, v30
v_add_f32 v187, v187, v31
v_mfma_f32_16x16x32_bf16 v[248:251], a[192:195], a[152:155], v[248:251]
v_add_f32 v188, v188, v28
v_add_f32 v189, v189, v29
v_mfma_f32_16x16x32_bf16 a[248:251], a[196:199], a[152:155], a[248:251]
ds_read_b128 a[152:155], v2 offset:6144
v_add_f32 v190, v190, v30
v_mfma_f32_16x16x32_bf16 a[248:251], a[164:167], a[120:123], a[248:251]
ds_read_b128 a[120:123], v1 offset:6144
v_add_f32 v191, v191, v31
v_mfma_f32_16x16x32_bf16 a[252:255], a[164:167], a[124:127], a[252:255]
buffer_load_dwordx4 a[164:167], v0, s[20:23], s30 offen offset:0 sc1
v_lshlrev_b32 v28, 16, v22
v_mfma_f32_16x16x32_bf16 a[252:255], a[196:199], a[156:159], a[252:255]
buffer_load_dwordx4 a[196:199], v0, s[20:23], s30 offen offset:1024 sc1
v_and_b32 v29, s33, v22
v_mfma_f32_16x16x32_bf16 v[252:255], a[192:195], a[156:159], v[252:255]
buffer_load_dwordx4 a[192:195], v0, s[20:23], s30 offen offset:2048 sc1
ds_read_b128 a[156:159], v2 offset:7168
v_mfma_f32_16x16x32_bf16 v[252:255], a[160:163], a[124:127], v[252:255]
buffer_load_dwordx4 a[160:163], v0, s[20:23], s30 offen offset:3072 sc1
s_add_u32 s30, s30, 0x3000
ds_read_b128 a[124:127], v1 offset:7168
L_q7:
s_waitcnt vmcnt(14) lgkmcnt(14)
v_mfma_f32_16x16x32_bf16 v[32:35], a[168:171], a[96:99], v[32:35]
v_lshlrev_b32 v30, 16, v23
v_mfma_f32_16x16x32_bf16 v[32:35], a[200:203], a[128:131], v[32:35]
v_and_b32 v31, s33, v23
v_add_f32 v192, v192, v28
v_mfma_f32_16x16x32_bf16 v[64:67], a[204:207], a[128:131], v[64:67]
v_add_f32 v193, v193, v29
v_add_f32 v194, v194, v30
v_mfma_f32_16x16x32_bf16 v[64:67], a[172:175], a[96:99], v[64:67]
v_add_f32 v195, v195, v31
v_add_f32 v196, v196, v28
s_waitcnt lgkmcnt(12)
v_mfma_f32_16x16x32_bf16 v[68:71], a[172:175], a[100:103], v[68:71]
v_add_f32 v197, v197, v29
v_mfma_f32_16x16x32_bf16 v[68:71], a[204:207], a[132:135], v[68:71]
v_add_f32 v198, v198, v30
v_add_f32 v199, v199, v31
v_mfma_f32_16x16x32_bf16 v[36:39], a[200:203], a[132:135], v[36:39]
v_add_f32 v200, v200, v28
v_add_f32 v201, v201, v29
v_mfma_f32_16x16x32_bf16 v[36:39], a[168:171], a[100:103], v[36:39]
v_add_f32 v202, v202, v30
v_add_f32 v203, v203, v31
s_waitcnt lgkmcnt(10)
v_mfma_f32_16x16x32_bf16 v[40:43], a[168:171], a[104:107], v[40:43]
v_add_f32 v204, v204, v28
v_mfma_f32_16x16x32_bf16 v[40:43], a[200:203], a[136:139], v[40:43]
v_add_f32 v205, v205, v29
v_add_f32 v206, v206, v30
v_mfma_f32_16x16x32_bf16 v[72:75], a[204:207], a[136:139], v[72:75]
v_add_f32 v207, v207, v31
v_add_f32 v208, v208, v28
v_mfma_f32_16x16x32_bf16 v[72:75], a[172:175], a[104:107], v[72:75]
v_add_f32 v209, v209, v29
v_add_f32 v210, v210, v30
s_waitcnt lgkmcnt(8)
v_mfma_f32_16x16x32_bf16 v[76:79], a[172:175], a[108:111], v[76:79]
v_add_f32 v211, v211, v31
v_mfma_f32_16x16x32_bf16 v[76:79], a[204:207], a[140:143], v[76:79]
v_add_f32 v212, v212, v28
v_add_f32 v213, v213, v29
v_mfma_f32_16x16x32_bf16 v[44:47], a[200:203], a[140:143], v[44:47]
v_add_f32 v214, v214, v30
v_add_f32 v215, v215, v31
v_mfma_f32_16x16x32_bf16 v[44:47], a[168:171], a[108:111], v[44:47]
v_add_f32 v216, v216, v28
v_add_f32 v217, v217, v29
s_waitcnt lgkmcnt(6)
v_mfma_f32_16x16x32_bf16 v[48:51], a[168:171], a[112:115], v[48:51]
v_add_f32 v218, v218, v30
v_mfma_f32_16x16x32_bf16 v[48:51], a[200:203], a[144:147], v[48:51]
v_add_f32 v219, v219, v31
v_add_f32 v220, v220, v28
v_mfma_f32_16x16x32_bf16 v[80:83], a[204:207], a[144:147], v[80:83]
v_add_f32 v221, v221, v29
v_add_f32 v222, v222, v30
v_mfma_f32_16x16x32_bf16 v[80:83], a[172:175], a[112:115], v[80:83]
v_add_f32 v223, v223, v31
v_lshlrev_b32 v28, 16, v24
s_waitcnt lgkmcnt(4)
v_mfma_f32_16x16x32_bf16 v[84:87], a[172:175], a[116:119], v[84:87]
v_and_b32 v29, s33, v24
v_mfma_f32_16x16x32_bf16 v[84:87], a[204:207], a[148:151], v[84:87]
v_lshlrev_b32 v30, 16, v25
v_and_b32 v31, s33, v25
v_mfma_f32_16x16x32_bf16 v[52:55], a[200:203], a[148:151], v[52:55]
v_add_f32 v224, v224, v28
v_add_f32 v225, v225, v29
v_mfma_f32_16x16x32_bf16 v[52:55], a[168:171], a[116:119], v[52:55]
v_add_f32 v226, v226, v30
v_add_f32 v227, v227, v31
s_waitcnt lgkmcnt(2)
v_mfma_f32_16x16x32_bf16 v[56:59], a[168:171], a[120:123], v[56:59]
v_add_f32 v228, v228, v28
v_mfma_f32_16x16x32_bf16 v[56:59], a[200:203], a[152:155], v[56:59]
v_add_f32 v229, v229, v29
v_add_f32 v230, v230, v30
v_mfma_f32_16x16x32_bf16 v[88:91], a[204:207], a[152:155], v[88:91]
v_add_f32 v231, v231, v31
v_add_f32 v232, v232, v28
v_mfma_f32_16x16x32_bf16 v[88:91], a[172:175], a[120:123], v[88:91]
v_add_f32 v233, v233, v29
v_add_f32 v234, v234, v30
s_waitcnt lgkmcnt(0)
v_mfma_f32_16x16x32_bf16 v[92:95], a[172:175], a[124:127], v[92:95]
buffer_load_dwordx4 a[172:175], v0, s[20:23], s30 offen offset:0 sc1
v_mfma_f32_16x16x32_bf16 v[92:95], a[204:207], a[156:159], v[92:95]
buffer_load_dwordx4 a[204:207], v0, s[20:23], s30 offen offset:1024 sc1
v_add_f32 v235, v235, v31
v_mfma_f32_16x16x32_bf16 v[60:63], a[200:203], a[156:159], v[60:63]
buffer_load_dwordx4 a[200:203], v0, s[20:23], s30 offen offset:2048 sc1
v_add_f32 v236, v236, v28
v_mfma_f32_16x16x32_bf16 v[60:63], a[168:171], a[124:127], v[60:63]
buffer_load_dwordx4 a[168:171], v0, s[20:23], s30 offen offset:3072 sc1
s_add_u32 s30, s30, 0x1000
s_waitcnt vmcnt(13)
v_mfma_f32_16x16x32_bf16 v[96:99], a[212:215], a[96:99], v[96:99]
v_add_f32 v237, v237, v29
s_add_u32 s96, s92, L_q9-L_pc
s_addc_u32 s97, s93, 0
s_load_dword s98, s[96:97], 0
v_mfma_f32_16x16x32_bf16 v[96:99], a[180:183], a[128:131], v[96:99]
v_mfma_f32_16x16x32_bf16 v[128:131], a[208:211], a[128:131], v[128:131]
v_xor_b32 v4, 0x16000, v6
ds_read_b128 a[128:131], v4 offset:0
v_mfma_f32_16x16x32_bf16 v[128:131], a[176:179], a[96:99], v[128:131]
v_xor_b32 v3, 0x14000, v6
ds_read_b128 a[96:99], v3 offset:0
v_mfma_f32_16x16x32_bf16 v[132:135], a[176:179], a[100:103], v[132:135]
v_add_f32 v238, v238, v30
v_add_f32 v239, v239, v31
v_mfma_f32_16x16x32_bf16 v[132:135], a[208:211], a[132:135], v[132:135]
v_add_f32 v240, v240, v28
v_add_f32 v241, v241, v29
v_mfma_f32_16x16x32_bf16 v[100:103], a[180:183], a[132:135], v[100:103]
ds_read_b128 a[132:135], v4 offset:1024
v_add_f32 v242, v242, v30
v_mfma_f32_16x16x32_bf16 v[100:103], a[212:215], a[100:103], v[100:103]
ds_read_b128 a[100:103], v3 offset:1024
v_add_f32 v243, v243, v31
v_mfma_f32_16x16x32_bf16 v[104:107], a[212:215], a[104:107], v[104:107]
v_add_f32 v244, v244, v28
v_add_f32 v245, v245, v29
v_mfma_f32_16x16x32_bf16 v[104:107], a[180:183], a[136:139], v[104:107]
v_add_f32 v246, v246, v30
v_add_f32 v247, v247, v31
v_mfma_f32_16x16x32_bf16 v[136:139], a[208:211], a[136:139], v[136:139]
ds_read_b128 a[136:139], v4 offset:2048
v_add_f32 v248, v248, v28
v_mfma_f32_16x16x32_bf16 v[136:139], a[176:179], a[104:107], v[136:139]
ds_read_b128 a[104:107], v3 offset:2048
v_add_f32 v249, v249, v29
v_mfma_f32_16x16x32_bf16 v[140:143], a[176:179], a[108:111], v[140:143]
v_add_f32 v250, v250, v30
v_add_f32 v251, v251, v31
v_mfma_f32_16x16x32_bf16 v[140:143], a[208:211], a[140:143], v[140:143]
v_add_f32 v252, v252, v28
v_add_f32 v253, v253, v29
v_mfma_f32_16x16x32_bf16 v[108:111], a[180:183], a[140:143], v[108:111]
ds_read_b128 a[140:143], v4 offset:3072
v_add_f32 v254, v254, v30
v_mfma_f32_16x16x32_bf16 v[108:111], a[212:215], a[108:111], v[108:111]
ds_read_b128 a[108:111], v3 offset:3072
v_add_f32 v255, v255, v31
v_mfma_f32_16x16x32_bf16 v[112:115], a[212:215], a[112:115], v[112:115]
v_lshlrev_b32 v28, 16, v26
v_and_b32 v29, s33, v26
v_mfma_f32_16x16x32_bf16 v[112:115], a[180:183], a[144:147], v[112:115]
v_lshlrev_b32 v30, 16, v27
v_and_b32 v31, s33, v27
v_mfma_f32_16x16x32_bf16 v[144:147], a[208:211], a[144:147], v[144:147]
ds_read_b128 a[144:147], v4 offset:4096
v_accvgpr_read_b32 v12, a224
v_mfma_f32_16x16x32_bf16 v[144:147], a[176:179], a[112:115], v[144:147]
ds_read_b128 a[112:115], v3 offset:4096
v_accvgpr_read_b32 v13, a225
v_mfma_f32_16x16x32_bf16 v[148:151], a[176:179], a[116:119], v[148:151]
v_accvgpr_read_b32 v14, a226
v_accvgpr_read_b32 v15, a227
v_mfma_f32_16x16x32_bf16 v[148:151], a[208:211], a[148:151], v[148:151]
v_add_f32 v12, v12, v28
v_add_f32 v13, v13, v29
v_mfma_f32_16x16x32_bf16 v[116:119], a[180:183], a[148:151], v[116:119]
ds_read_b128 a[148:151], v4 offset:5120
v_add_f32 v14, v14, v30
v_mfma_f32_16x16x32_bf16 v[116:119], a[212:215], a[116:119], v[116:119]
ds_read_b128 a[116:119], v3 offset:5120
v_add_f32 v15, v15, v31
v_mfma_f32_16x16x32_bf16 v[120:123], a[212:215], a[120:123], v[120:123]
v_accvgpr_write_b32 a224, v12
v_accvgpr_write_b32 a225, v13
v_mfma_f32_16x16x32_bf16 v[120:123], a[180:183], a[152:155], v[120:123]
v_accvgpr_write_b32 a226, v14
v_accvgpr_write_b32 a227, v15
v_mfma_f32_16x16x32_bf16 v[152:155], a[208:211], a[152:155], v[152:155]
ds_read_b128 a[152:155], v4 offset:6144
v_accvgpr_read_b32 v12, a228
v_mfma_f32_16x16x32_bf16 v[152:155], a[176:179], a[120:123], v[152:155]
ds_read_b128 a[120:123], v3 offset:6144
v_accvgpr_read_b32 v13, a229
v_mfma_f32_16x16x32_bf16 v[156:159], a[176:179], a[124:127], v[156:159]
buffer_load_dwordx4 a[176:179], v0, s[20:23], s30 offen offset:0 sc1
v_accvgpr_read_b32 v14, a230
v_mfma_f32_16x16x32_bf16 v[156:159], a[208:211], a[156:159], v[156:159]
buffer_load_dwordx4 a[208:211], v0, s[20:23], s30 offen offset:1024 sc1
v_accvgpr_read_b32 v15, a231
v_mfma_f32_16x16x32_bf16 v[124:127], a[180:183], a[156:159], v[124:127]
buffer_load_dwordx4 a[180:183], v0, s[20:23], s30 offen offset:2048 sc1
ds_read_b128 a[156:159], v4 offset:7168
v_mfma_f32_16x16x32_bf16 v[124:127], a[212:215], a[124:127], v[124:127]
buffer_load_dwordx4 a[212:215], v0, s[20:23], s30 offen offset:3072 sc1
s_add_u32 s30, s30, 0x3000
ds_read_b128 a[124:127], v3 offset:7168
s_waitcnt vmcnt(12) lgkmcnt(14)
v_mfma_f32_16x16x32_bf16 v[32:35], a[220:223], a[96:99], v[32:35]
v_add_f32 v12, v12, v28
v_mfma_f32_16x16x32_bf16 v[32:35], a[188:191], a[128:131], v[32:35]
v_add_f32 v13, v13, v29
v_add_f32 v14, v14, v30
v_mfma_f32_16x16x32_bf16 v[64:67], a[216:219], a[128:131], v[64:67]
v_add_f32 v15, v15, v31
v_accvgpr_write_b32 a228, v12
v_mfma_f32_16x16x32_bf16 v[64:67], a[184:187], a[96:99], v[64:67]
v_accvgpr_write_b32 a229, v13
v_accvgpr_write_b32 a230, v14
s_waitcnt lgkmcnt(12)
v_mfma_f32_16x16x32_bf16 v[68:71], a[184:187], a[100:103], v[68:71]
v_accvgpr_write_b32 a231, v15
v_mfma_f32_16x16x32_bf16 v[68:71], a[216:219], a[132:135], v[68:71]
v_accvgpr_read_b32 v12, a232
v_accvgpr_read_b32 v13, a233
v_mfma_f32_16x16x32_bf16 v[36:39], a[188:191], a[132:135], v[36:39]
v_accvgpr_read_b32 v14, a234
v_accvgpr_read_b32 v15, a235
v_mfma_f32_16x16x32_bf16 v[36:39], a[220:223], a[100:103], v[36:39]
v_add_f32 v12, v12, v28
v_add_f32 v13, v13, v29
s_waitcnt lgkmcnt(10)
v_mfma_f32_16x16x32_bf16 v[40:43], a[220:223], a[104:107], v[40:43]
v_add_f32 v14, v14, v30
v_mfma_f32_16x16x32_bf16 v[40:43], a[188:191], a[136:139], v[40:43]
v_add_f32 v15, v15, v31
v_accvgpr_write_b32 a232, v12
v_mfma_f32_16x16x32_bf16 v[72:75], a[216:219], a[136:139], v[72:75]
v_accvgpr_write_b32 a233, v13
v_accvgpr_write_b32 a234, v14
v_mfma_f32_16x16x32_bf16 v[72:75], a[184:187], a[104:107], v[72:75]
v_accvgpr_write_b32 a235, v15
v_accvgpr_read_b32 v12, a236
s_waitcnt lgkmcnt(8)
v_mfma_f32_16x16x32_bf16 v[76:79], a[184:187], a[108:111], v[76:79]
v_accvgpr_read_b32 v13, a237
v_mfma_f32_16x16x32_bf16 v[76:79], a[216:219], a[140:143], v[76:79]
v_accvgpr_read_b32 v14, a238
v_accvgpr_read_b32 v15, a239
v_mfma_f32_16x16x32_bf16 v[44:47], a[188:191], a[140:143], v[44:47]
v_add_f32 v12, v12, v28
v_add_f32 v13, v13, v29
v_mfma_f32_16x16x32_bf16 v[44:47], a[220:223], a[108:111], v[44:47]
v_add_f32 v14, v14, v30
v_add_f32 v15, v15, v31
s_waitcnt lgkmcnt(6)
v_mfma_f32_16x16x32_bf16 v[48:51], a[220:223], a[112:115], v[48:51]
v_accvgpr_write_b32 a236, v12
v_mfma_f32_16x16x32_bf16 v[48:51], a[188:191], a[144:147], v[48:51]
v_accvgpr_write_b32 a237, v13
v_accvgpr_write_b32 a238, v14
v_mfma_f32_16x16x32_bf16 v[80:83], a[216:219], a[144:147], v[80:83]
v_accvgpr_write_b32 a239, v15
v_accvgpr_read_b32 v12, a240
v_mfma_f32_16x16x32_bf16 v[80:83], a[184:187], a[112:115], v[80:83]
v_accvgpr_read_b32 v13, a241
v_accvgpr_read_b32 v14, a242
s_waitcnt lgkmcnt(4)
v_mfma_f32_16x16x32_bf16 v[84:87], a[184:187], a[116:119], v[84:87]
v_accvgpr_read_b32 v15, a243
v_mfma_f32_16x16x32_bf16 v[84:87], a[216:219], a[148:151], v[84:87]
v_add_f32 v12, v12, v28
v_add_f32 v13, v13, v29
v_mfma_f32_16x16x32_bf16 v[52:55], a[188:191], a[148:151], v[52:55]
v_add_f32 v14, v14, v30
v_add_f32 v15, v15, v31
v_mfma_f32_16x16x32_bf16 v[52:55], a[220:223], a[116:119], v[52:55]
v_accvgpr_write_b32 a240, v12
v_accvgpr_write_b32 a241, v13
s_waitcnt lgkmcnt(2)
v_mfma_f32_16x16x32_bf16 v[56:59], a[220:223], a[120:123], v[56:59]
v_accvgpr_write_b32 a242, v14
v_mfma_f32_16x16x32_bf16 v[56:59], a[188:191], a[152:155], v[56:59]
v_accvgpr_write_b32 a243, v15
v_accvgpr_read_b32 v12, a244
v_mfma_f32_16x16x32_bf16 v[88:91], a[216:219], a[152:155], v[88:91]
v_accvgpr_read_b32 v13, a245
v_accvgpr_read_b32 v14, a246
v_mfma_f32_16x16x32_bf16 v[88:91], a[184:187], a[120:123], v[88:91]
v_accvgpr_read_b32 v15, a247
v_add_f32 v12, v12, v28
s_waitcnt lgkmcnt(0)
v_mfma_f32_16x16x32_bf16 v[92:95], a[184:187], a[124:127], v[92:95]
buffer_load_dwordx4 a[184:187], v0, s[20:23], s30 offen offset:0 sc1
v_mfma_f32_16x16x32_bf16 v[92:95], a[216:219], a[156:159], v[92:95]
buffer_load_dwordx4 a[216:219], v0, s[20:23], s30 offen offset:1024 sc1
v_add_f32 v13, v13, v29
v_mfma_f32_16x16x32_bf16 v[60:63], a[188:191], a[156:159], v[60:63]
buffer_load_dwordx4 a[188:191], v0, s[20:23], s30 offen offset:2048 sc1
v_add_f32 v14, v14, v30
v_mfma_f32_16x16x32_bf16 v[60:63], a[220:223], a[124:127], v[60:63]
buffer_load_dwordx4 a[220:223], v0, s[20:23], s30 offen offset:3072 sc1
s_add_u32 s30, s30, 0x1000
s_barrier
s_waitcnt vmcnt(12)
v_mfma_f32_16x16x32_bf16 v[96:99], a[164:167], a[96:99], v[96:99]
v_mfma_f32_16x16x32_bf16 v[96:99], a[196:199], a[128:131], v[96:99]
v_add_f32 v15, v15, v31
v_accvgpr_write_b32 a244, v12
v_mfma_f32_16x16x32_bf16 v[128:131], a[160:163], a[128:131], v[128:131]
ds_read_b128 a[128:131], v2 offset:32768
v_accvgpr_write_b32 a245, v13
v_mfma_f32_16x16x32_bf16 v[128:131], a[192:195], a[96:99], v[128:131]
ds_read_b128 a[96:99], v1 offset:32768
v_accvgpr_write_b32 a246, v14
v_mfma_f32_16x16x32_bf16 v[132:135], a[192:195], a[100:103], v[132:135]
v_accvgpr_write_b32 a247, v15
v_accvgpr_read_b32 v12, a248
v_mfma_f32_16x16x32_bf16 v[132:135], a[160:163], a[132:135], v[132:135]
v_accvgpr_read_b32 v13, a249
v_accvgpr_read_b32 v14, a250
v_mfma_f32_16x16x32_bf16 v[100:103], a[196:199], a[132:135], v[100:103]
ds_read_b128 a[132:135], v2 offset:33792
v_accvgpr_read_b32 v15, a251
v_mfma_f32_16x16x32_bf16 v[100:103], a[164:167], a[100:103], v[100:103]
ds_read_b128 a[100:103], v1 offset:33792
v_add_f32 v12, v12, v28
v_mfma_f32_16x16x32_bf16 v[104:107], a[164:167], a[104:107], v[104:107]
v_add_f32 v13, v13, v29
v_add_f32 v14, v14, v30
v_mfma_f32_16x16x32_bf16 v[104:107], a[196:199], a[136:139], v[104:107]
v_add_f32 v15, v15, v31
v_accvgpr_write_b32 a248, v12
v_mfma_f32_16x16x32_bf16 v[136:139], a[160:163], a[136:139], v[136:139]
ds_read_b128 a[136:139], v2 offset:34816
v_accvgpr_write_b32 a249, v13
v_mfma_f32_16x16x32_bf16 v[136:139], a[192:195], a[104:107], v[136:139]
ds_read_b128 a[104:107], v1 offset:34816
v_accvgpr_write_b32 a250, v14
v_mfma_f32_16x16x32_bf16 v[140:143], a[192:195], a[108:111], v[140:143]
v_accvgpr_write_b32 a251, v15
v_accvgpr_read_b32 v12, a252
v_mfma_f32_16x16x32_bf16 v[140:143], a[160:163], a[140:143], v[140:143]
v_accvgpr_read_b32 v13, a253
v_accvgpr_read_b32 v14, a254
v_mfma_f32_16x16x32_bf16 v[108:111], a[196:199], a[140:143], v[108:111]
ds_read_b128 a[140:143], v2 offset:35840
v_accvgpr_read_b32 v15, a255
v_mfma_f32_16x16x32_bf16 v[108:111], a[164:167], a[108:111], v[108:111]
ds_read_b128 a[108:111], v1 offset:35840
v_add_f32 v12, v12, v28
v_mfma_f32_16x16x32_bf16 v[112:115], a[164:167], a[112:115], v[112:115]
v_add_f32 v13, v13, v29
v_add_f32 v14, v14, v30
v_mfma_f32_16x16x32_bf16 v[112:115], a[196:199], a[144:147], v[112:115]
v_add_f32 v15, v15, v31
v_accvgpr_write_b32 a252, v12
v_mfma_f32_16x16x32_bf16 v[144:147], a[160:163], a[144:147], v[144:147]
ds_read_b128 a[144:147], v2 offset:36864
v_accvgpr_write_b32 a253, v13
v_mfma_f32_16x16x32_bf16 v[144:147], a[192:195], a[112:115], v[144:147]
ds_read_b128 a[112:115], v1 offset:36864
v_accvgpr_write_b32 a254, v14
v_mfma_f32_16x16x32_bf16 v[148:151], a[192:195], a[116:119], v[148:151]
v_accvgpr_write_b32 a255, v15
v_mfma_f32_16x16x32_bf16 v[148:151], a[160:163], a[148:151], v[148:151]
v_mfma_f32_16x16x32_bf16 v[116:119], a[196:199], a[148:151], v[116:119]
ds_read_b128 a[148:151], v2 offset:37888
v_mfma_f32_16x16x32_bf16 v[116:119], a[164:167], a[116:119], v[116:119]
ds_read_b128 a[116:119], v1 offset:37888
v_mfma_f32_16x16x32_bf16 v[120:123], a[164:167], a[120:123], v[120:123]
v_mfma_f32_16x16x32_bf16 v[120:123], a[196:199], a[152:155], v[120:123]
v_mfma_f32_16x16x32_bf16 v[152:155], a[160:163], a[152:155], v[152:155]
ds_read_b128 a[152:155], v2 offset:38912
v_mfma_f32_16x16x32_bf16 v[152:155], a[192:195], a[120:123], v[152:155]
ds_read_b128 a[120:123], v1 offset:38912
v_mfma_f32_16x16x32_bf16 v[156:159], a[192:195], a[124:127], v[156:159]
buffer_load_dwordx4 a[192:195], v0, s[20:23], s30 offen offset:0 sc1
v_mfma_f32_16x16x32_bf16 v[156:159], a[160:163], a[156:159], v[156:159]
buffer_load_dwordx4 a[160:163], v0, s[20:23], s30 offen offset:1024 sc1
v_mfma_f32_16x16x32_bf16 v[124:127], a[196:199], a[156:159], v[124:127]
buffer_load_dwordx4 a[196:199], v0, s[20:23], s30 offen offset:2048 sc1
ds_read_b128 a[156:159], v2 offset:39936
v_mfma_f32_16x16x32_bf16 v[124:127], a[164:167], a[124:127], v[124:127]
buffer_load_dwordx4 a[164:167], v0, s[20:23], s30 offen offset:3072 sc1
s_add_u32 s30, s30, 0xffff5000
ds_read_b128 a[124:127], v1 offset:39936
s_waitcnt vmcnt(12) lgkmcnt(14)
v_mfma_f32_16x16x32_bf16 v[32:35], a[172:175], a[96:99], v[32:35]
v_mfma_f32_16x16x32_bf16 v[32:35], a[204:207], a[128:131], v[32:35]
v_mfma_f32_16x16x32_bf16 v[64:67], a[168:171], a[128:131], v[64:67]
v_mfma_f32_16x16x32_bf16 v[64:67], a[200:203], a[96:99], v[64:67]
s_waitcnt lgkmcnt(12)
v_mfma_f32_16x16x32_bf16 v[68:71], a[200:203], a[100:103], v[68:71]
v_mfma_f32_16x16x32_bf16 v[68:71], a[168:171], a[132:135], v[68:71]
v_mfma_f32_16x16x32_bf16 v[36:39], a[204:207], a[132:135], v[36:39]
v_mfma_f32_16x16x32_bf16 v[36:39], a[172:175], a[100:103], v[36:39]
s_waitcnt lgkmcnt(10)
v_mfma_f32_16x16x32_bf16 v[40:43], a[172:175], a[104:107], v[40:43]
v_mfma_f32_16x16x32_bf16 v[40:43], a[204:207], a[136:139], v[40:43]
v_mfma_f32_16x16x32_bf16 v[72:75], a[168:171], a[136:139], v[72:75]
v_mfma_f32_16x16x32_bf16 v[72:75], a[200:203], a[104:107], v[72:75]
s_waitcnt lgkmcnt(8)
v_mfma_f32_16x16x32_bf16 v[76:79], a[200:203], a[108:111], v[76:79]
v_mfma_f32_16x16x32_bf16 v[76:79], a[168:171], a[140:143], v[76:79]
v_mfma_f32_16x16x32_bf16 v[44:47], a[204:207], a[140:143], v[44:47]
v_mfma_f32_16x16x32_bf16 v[44:47], a[172:175], a[108:111], v[44:47]
s_waitcnt lgkmcnt(6)
v_mfma_f32_16x16x32_bf16 v[48:51], a[172:175], a[112:115], v[48:51]
v_mfma_f32_16x16x32_bf16 v[48:51], a[204:207], a[144:147], v[48:51]
v_mfma_f32_16x16x32_bf16 v[80:83], a[168:171], a[144:147], v[80:83]
v_mfma_f32_16x16x32_bf16 v[80:83], a[200:203], a[112:115], v[80:83]
s_waitcnt lgkmcnt(4)
v_mfma_f32_16x16x32_bf16 v[84:87], a[200:203], a[116:119], v[84:87]
v_mfma_f32_16x16x32_bf16 v[84:87], a[168:171], a[148:151], v[84:87]
v_mfma_f32_16x16x32_bf16 v[52:55], a[204:207], a[148:151], v[52:55]
v_mfma_f32_16x16x32_bf16 v[52:55], a[172:175], a[116:119], v[52:55]
s_waitcnt lgkmcnt(2)
v_mfma_f32_16x16x32_bf16 v[56:59], a[172:175], a[120:123], v[56:59]
v_mfma_f32_16x16x32_bf16 v[56:59], a[204:207], a[152:155], v[56:59]
v_mfma_f32_16x16x32_bf16 v[88:91], a[168:171], a[152:155], v[88:91]
v_mfma_f32_16x16x32_bf16 v[88:91], a[200:203], a[120:123], v[88:91]
s_waitcnt lgkmcnt(0)
v_mfma_f32_16x16x32_bf16 v[92:95], a[200:203], a[124:127], v[92:95]
buffer_load_dwordx4 a[200:203], v0, s[20:23], s30 offen offset:0 sc1
v_mfma_f32_16x16x32_bf16 v[92:95], a[168:171], a[156:159], v[92:95]
buffer_load_dwordx4 a[168:171], v0, s[20:23], s30 offen offset:1024 sc1
v_mfma_f32_16x16x32_bf16 v[60:63], a[204:207], a[156:159], v[60:63]
buffer_load_dwordx4 a[204:207], v0, s[20:23], s30 offen offset:2048 sc1
v_mfma_f32_16x16x32_bf16 v[60:63], a[172:175], a[124:127], v[60:63]
buffer_load_dwordx4 a[172:175], v0, s[20:23], s30 offen offset:3072 sc1
s_add_u32 s30, s30, 0x1000
s_waitcnt vmcnt(12)
v_mfma_f32_16x16x32_bf16 v[96:99], a[176:179], a[96:99], v[96:99]
v_mfma_f32_16x16x32_bf16 v[96:99], a[208:211], a[128:131], v[96:99]
v_mfma_f32_16x16x32_bf16 v[128:131], a[212:215], a[128:131], v[128:131]
ds_read_b128 a[128:131], v4 offset:32768
v_mfma_f32_16x16x32_bf16 v[128:131], a[180:183], a[96:99], v[128:131]
ds_read_b128 a[96:99], v3 offset:32768
v_mfma_f32_16x16x32_bf16 v[132:135], a[180:183], a[100:103], v[132:135]
v_mfma_f32_16x16x32_bf16 v[132:135], a[212:215], a[132:135], v[132:135]
v_mfma_f32_16x16x32_bf16 v[100:103], a[208:211], a[132:135], v[100:103]
ds_read_b128 a[132:135], v4 offset:33792
v_mfma_f32_16x16x32_bf16 v[100:103], a[176:179], a[100:103], v[100:103]
ds_read_b128 a[100:103], v3 offset:33792
v_mfma_f32_16x16x32_bf16 v[104:107], a[176:179], a[104:107], v[104:107]
v_mfma_f32_16x16x32_bf16 v[104:107], a[208:211], a[136:139], v[104:107]
v_mfma_f32_16x16x32_bf16 v[136:139], a[212:215], a[136:139], v[136:139]
ds_read_b128 a[136:139], v4 offset:34816
v_mfma_f32_16x16x32_bf16 v[136:139], a[180:183], a[104:107], v[136:139]
ds_read_b128 a[104:107], v3 offset:34816
v_mfma_f32_16x16x32_bf16 v[140:143], a[180:183], a[108:111], v[140:143]
v_mfma_f32_16x16x32_bf16 v[140:143], a[212:215], a[140:143], v[140:143]
v_mfma_f32_16x16x32_bf16 v[108:111], a[208:211], a[140:143], v[108:111]
ds_read_b128 a[140:143], v4 offset:35840
v_mfma_f32_16x16x32_bf16 v[108:111], a[176:179], a[108:111], v[108:111]
ds_read_b128 a[108:111], v3 offset:35840
v_mfma_f32_16x16x32_bf16 v[112:115], a[176:179], a[112:115], v[112:115]
v_mfma_f32_16x16x32_bf16 v[112:115], a[208:211], a[144:147], v[112:115]
v_mfma_f32_16x16x32_bf16 v[144:147], a[212:215], a[144:147], v[144:147]
ds_read_b128 a[144:147], v4 offset:36864
v_mfma_f32_16x16x32_bf16 v[144:147], a[180:183], a[112:115], v[144:147]
ds_read_b128 a[112:115], v3 offset:36864
v_mfma_f32_16x16x32_bf16 v[148:151], a[180:183], a[116:119], v[148:151]
v_mfma_f32_16x16x32_bf16 v[148:151], a[212:215], a[148:151], v[148:151]
v_mfma_f32_16x16x32_bf16 v[116:119], a[208:211], a[148:151], v[116:119]
ds_read_b128 a[148:151], v4 offset:37888
v_mfma_f32_16x16x32_bf16 v[116:119], a[176:179], a[116:119], v[116:119]
ds_read_b128 a[116:119], v3 offset:37888
v_mfma_f32_16x16x32_bf16 v[120:123], a[176:179], a[120:123], v[120:123]
v_mfma_f32_16x16x32_bf16 v[120:123], a[208:211], a[152:155], v[120:123]
v_mfma_f32_16x16x32_bf16 v[152:155], a[212:215], a[152:155], v[152:155]
ds_read_b128 a[152:155], v4 offset:38912
v_mfma_f32_16x16x32_bf16 v[152:155], a[180:183], a[120:123], v[152:155]
ds_read_b128 a[120:123], v3 offset:38912
v_mfma_f32_16x16x32_bf16 v[156:159], a[180:183], a[124:127], v[156:159]
buffer_load_dwordx4 a[180:183], v0, s[20:23], s30 offen offset:0 sc1
v_mfma_f32_16x16x32_bf16 v[156:159], a[212:215], a[156:159], v[156:159]
buffer_load_dwordx4 a[212:215], v0, s[20:23], s30 offen offset:1024 sc1
v_mfma_f32_16x16x32_bf16 v[124:127], a[208:211], a[156:159], v[124:127]
buffer_load_dwordx4 a[208:211], v0, s[20:23], s30 offen offset:2048 sc1
ds_read_b128 a[156:159], v4 offset:39936
v_mfma_f32_16x16x32_bf16 v[124:127], a[176:179], a[124:127], v[124:127]
buffer_load_dwordx4 a[176:179], v0, s[20:23], s30 offen offset:3072 sc1
s_add_u32 s30, s30, 0x3000
ds_read_b128 a[124:127], v3 offset:39936
s_waitcnt vmcnt(12) lgkmcnt(14)
v_mfma_f32_16x16x32_bf16 v[32:35], a[184:187], a[96:99], v[32:35]
v_mfma_f32_16x16x32_bf16 v[32:35], a[216:219], a[128:131], v[32:35]
v_mfma_f32_16x16x32_bf16 v[64:67], a[220:223], a[128:131], v[64:67]
v_mfma_f32_16x16x32_bf16 v[64:67], a[188:191], a[96:99], v[64:67]
s_waitcnt lgkmcnt(12)
v_mfma_f32_16x16x32_bf16 v[68:71], a[188:191], a[100:103], v[68:71]
v_mfma_f32_16x16x32_bf16 v[68:71], a[220:223], a[132:135], v[68:71]
v_mfma_f32_16x16x32_bf16 v[36:39], a[216:219], a[132:135], v[36:39]
v_mfma_f32_16x16x32_bf16 v[36:39], a[184:187], a[100:103], v[36:39]
s_waitcnt lgkmcnt(10)
v_mfma_f32_16x16x32_bf16 v[40:43], a[184:187], a[104:107], v[40:43]
v_accvgpr_read_b32 v12, a0
v_mfma_f32_16x16x32_bf16 v[40:43], a[216:219], a[136:139], v[40:43]
v_accvgpr_read_b32 v13, a1
v_accvgpr_read_b32 v14, a2
v_mfma_f32_16x16x32_bf16 v[72:75], a[220:223], a[136:139], v[72:75]
v_accvgpr_read_b32 v15, a3
v_lshlrev_b32 v24, 16, v12
v_mfma_f32_16x16x32_bf16 v[72:75], a[188:191], a[104:107], v[72:75]
v_and_b32 v25, s33, v12
v_lshlrev_b32 v26, 16, v13
s_waitcnt lgkmcnt(8)
v_mfma_f32_16x16x32_bf16 v[76:79], a[188:191], a[108:111], v[76:79]
v_and_b32 v27, s33, v13
v_mfma_f32_16x16x32_bf16 v[76:79], a[220:223], a[140:143], v[76:79]
v_mul_f32 v24, v24, v32
v_mul_f32 v25, v25, v33
v_mfma_f32_16x16x32_bf16 v[44:47], a[216:219], a[140:143], v[44:47]
v_mul_f32 v26, v26, v34
v_mul_f32 v27, v27, v35
v_mfma_f32_16x16x32_bf16 v[44:47], a[184:187], a[108:111], v[44:47]
v_cvt_pk_bf16_f32 v12, v24, v25
v_cvt_pk_bf16_f32 v13, v26, v27
s_waitcnt lgkmcnt(6)
v_mfma_f32_16x16x32_bf16 v[48:51], a[184:187], a[112:115], v[48:51]
v_lshlrev_b32 v24, 16, v14
v_mfma_f32_16x16x32_bf16 v[48:51], a[216:219], a[144:147], v[48:51]
v_and_b32 v25, s33, v14
v_lshlrev_b32 v26, 16, v15
v_mfma_f32_16x16x32_bf16 v[80:83], a[220:223], a[144:147], v[80:83]
v_and_b32 v27, s33, v15
v_mul_f32 v24, v24, v64
v_mfma_f32_16x16x32_bf16 v[80:83], a[188:191], a[112:115], v[80:83]
v_mul_f32 v25, v25, v65
v_mul_f32 v26, v26, v66
s_waitcnt lgkmcnt(4)
v_mfma_f32_16x16x32_bf16 v[84:87], a[188:191], a[116:119], v[84:87]
v_mul_f32 v27, v27, v67
v_mfma_f32_16x16x32_bf16 v[84:87], a[220:223], a[148:151], v[84:87]
v_cvt_pk_bf16_f32 v14, v24, v25
v_cvt_pk_bf16_f32 v15, v26, v27
v_mfma_f32_16x16x32_bf16 v[52:55], a[216:219], a[148:151], v[52:55]
ds_write_b128 v6, v[12:15] offset:0
buffer_store_dwordx4 v[12:15], v6, s[20:23], s52 offen offset:0 sc1
v_mfma_f32_16x16x32_bf16 v[52:55], a[184:187], a[116:119], v[52:55]
v_accvgpr_read_b32 v16, a4
v_accvgpr_read_b32 v17, a5
s_waitcnt lgkmcnt(3)
v_mfma_f32_16x16x32_bf16 v[56:59], a[184:187], a[120:123], v[56:59]
v_accvgpr_read_b32 v18, a6
v_mfma_f32_16x16x32_bf16 v[56:59], a[216:219], a[152:155], v[56:59]
v_accvgpr_read_b32 v19, a7
v_lshlrev_b32 v24, 16, v16
v_mfma_f32_16x16x32_bf16 v[88:91], a[220:223], a[152:155], v[88:91]
v_and_b32 v25, s33, v16
v_lshlrev_b32 v26, 16, v17
v_mfma_f32_16x16x32_bf16 v[88:91], a[188:191], a[120:123], v[88:91]
v_and_b32 v27, s33, v17
v_mul_f32 v24, v24, v36
s_waitcnt lgkmcnt(1)
v_mfma_f32_16x16x32_bf16 v[92:95], a[188:191], a[124:127], v[92:95]
buffer_load_dwordx4 a[188:191], v0, s[20:23], s30 offen offset:0 sc1
v_mfma_f32_16x16x32_bf16 v[92:95], a[220:223], a[156:159], v[92:95]
buffer_load_dwordx4 a[220:223], v0, s[20:23], s30 offen offset:1024 sc1
v_mul_f32 v25, v25, v37
v_mfma_f32_16x16x32_bf16 v[60:63], a[216:219], a[156:159], v[60:63]
buffer_load_dwordx4 a[216:219], v0, s[20:23], s30 offen offset:2048 sc1
v_mul_f32 v26, v26, v38
v_mfma_f32_16x16x32_bf16 v[60:63], a[184:187], a[124:127], v[60:63]
buffer_load_dwordx4 a[184:187], v0, s[20:23], s30 offen offset:3072 sc1
s_add_u32 s30, s30, 0x1000
s_waitcnt vmcnt(13)
v_mfma_f32_16x16x32_bf16 v[96:99], a[192:195], a[96:99], v[96:99]
v_mul_f32 v27, v27, v39
v_mfma_f32_16x16x32_bf16 v[96:99], a[160:163], a[128:131], v[96:99]
v_cvt_pk_bf16_f32 v16, v24, v25
v_cvt_pk_bf16_f32 v17, v26, v27
v_mfma_f32_16x16x32_bf16 v[128:131], a[164:167], a[128:131], v[128:131]
ds_read_b128 a[128:131], v2 offset:0
v_lshlrev_b32 v24, 16, v18
v_mfma_f32_16x16x32_bf16 v[128:131], a[196:199], a[96:99], v[128:131]
ds_read_b128 a[96:99], v1 offset:0
v_and_b32 v25, s33, v18
v_mfma_f32_16x16x32_bf16 v[132:135], a[196:199], a[100:103], v[132:135]
v_lshlrev_b32 v26, 16, v19
v_and_b32 v27, s33, v19
v_mfma_f32_16x16x32_bf16 v[132:135], a[164:167], a[132:135], v[132:135]
v_mul_f32 v24, v24, v68
v_mul_f32 v25, v25, v69
v_mfma_f32_16x16x32_bf16 v[100:103], a[160:163], a[132:135], v[100:103]
ds_read_b128 a[132:135], v2 offset:1024
v_mul_f32 v26, v26, v70
v_mfma_f32_16x16x32_bf16 v[100:103], a[192:195], a[100:103], v[100:103]
ds_read_b128 a[100:103], v1 offset:1024
v_mul_f32 v27, v27, v71
v_mfma_f32_16x16x32_bf16 v[104:107], a[192:195], a[104:107], v[104:107]
v_cvt_pk_bf16_f32 v18, v24, v25
v_cvt_pk_bf16_f32 v19, v26, v27
v_mfma_f32_16x16x32_bf16 v[104:107], a[160:163], a[136:139], v[104:107]
ds_write_b128 v6, v[16:19] offset:1024
buffer_store_dwordx4 v[16:19], v6, s[20:23], s52 offen offset:1024 sc1
v_mfma_f32_16x16x32_bf16 v[136:139], a[164:167], a[136:139], v[136:139]
ds_read_b128 a[136:139], v2 offset:2048
v_accvgpr_read_b32 v20, a8
v_mfma_f32_16x16x32_bf16 v[136:139], a[196:199], a[104:107], v[136:139]
ds_read_b128 a[104:107], v1 offset:2048
v_accvgpr_read_b32 v21, a9
v_mfma_f32_16x16x32_bf16 v[140:143], a[196:199], a[108:111], v[140:143]
v_accvgpr_read_b32 v22, a10
v_accvgpr_read_b32 v23, a11
v_mfma_f32_16x16x32_bf16 v[140:143], a[164:167], a[140:143], v[140:143]
v_lshlrev_b32 v24, 16, v20
v_and_b32 v25, s33, v20
v_mfma_f32_16x16x32_bf16 v[108:111], a[160:163], a[140:143], v[108:111]
ds_read_b128 a[140:143], v2 offset:3072
v_lshlrev_b32 v26, 16, v21
v_mfma_f32_16x16x32_bf16 v[108:111], a[192:195], a[108:111], v[108:111]
ds_read_b128 a[108:111], v1 offset:3072
v_and_b32 v27, s33, v21
v_mfma_f32_16x16x32_bf16 v[112:115], a[192:195], a[112:115], v[112:115]
v_mul_f32 v24, v24, v40
v_mul_f32 v25, v25, v41
v_mfma_f32_16x16x32_bf16 v[112:115], a[160:163], a[144:147], v[112:115]
v_mul_f32 v26, v26, v42
v_mul_f32 v27, v27, v43
v_mfma_f32_16x16x32_bf16 v[144:147], a[164:167], a[144:147], v[144:147]
ds_read_b128 a[144:147], v2 offset:4096
v_cvt_pk_bf16_f32 v20, v24, v25
v_mfma_f32_16x16x32_bf16 v[144:147], a[196:199], a[112:115], v[144:147]
ds_read_b128 a[112:115], v1 offset:4096
v_cvt_pk_bf16_f32 v21, v26, v27
v_mfma_f32_16x16x32_bf16 v[148:151], a[196:199], a[116:119], v[148:151]
v_lshlrev_b32 v24, 16, v22
v_and_b32 v25, s33, v22
v_mfma_f32_16x16x32_bf16 v[148:151], a[164:167], a[148:151], v[148:151]
v_lshlrev_b32 v26, 16, v23
v_and_b32 v27, s33, v23
v_mfma_f32_16x16x32_bf16 v[116:119], a[160:163], a[148:151], v[116:119]
ds_read_b128 a[148:151], v2 offset:5120
v_mul_f32 v24, v24, v72
v_mfma_f32_16x16x32_bf16 v[116:119], a[192:195], a[116:119], v[116:119]
ds_read_b128 a[116:119], v1 offset:5120
v_mul_f32 v25, v25, v73
v_mfma_f32_16x16x32_bf16 v[120:123], a[192:195], a[120:123], v[120:123]
v_mul_f32 v26, v26, v74
v_mul_f32 v27, v27, v75
v_mfma_f32_16x16x32_bf16 v[120:123], a[160:163], a[152:155], v[120:123]
v_cvt_pk_bf16_f32 v22, v24, v25
v_cvt_pk_bf16_f32 v23, v26, v27
v_mfma_f32_16x16x32_bf16 v[152:155], a[164:167], a[152:155], v[152:155]
ds_read_b128 a[152:155], v2 offset:6144
ds_write_b128 v6, v[20:23] offset:2048
v_mfma_f32_16x16x32_bf16 v[152:155], a[196:199], a[120:123], v[152:155]
ds_read_b128 a[120:123], v1 offset:6144
buffer_store_dwordx4 v[20:23], v6, s[20:23], s52 offen offset:2048 sc1
v_mfma_f32_16x16x32_bf16 v[156:159], a[196:199], a[124:127], v[156:159]
buffer_load_dwordx4 a[196:199], v0, s[20:23], s30 offen offset:0 sc1
v_accvgpr_read_b32 v12, a12
v_mfma_f32_16x16x32_bf16 v[156:159], a[164:167], a[156:159], v[156:159]
buffer_load_dwordx4 a[164:167], v0, s[20:23], s30 offen offset:1024 sc1
v_accvgpr_read_b32 v13, a13
v_mfma_f32_16x16x32_bf16 v[124:127], a[160:163], a[156:159], v[124:127]
buffer_load_dwordx4 a[160:163], v0, s[20:23], s30 offen offset:2048 sc1
ds_read_b128 a[156:159], v2 offset:7168
v_mfma_f32_16x16x32_bf16 v[124:127], a[192:195], a[124:127], v[124:127]
buffer_load_dwordx4 a[192:195], v0, s[20:23], s30 offen offset:3072 sc1
s_add_u32 s30, s30, 0x3000
ds_read_b128 a[124:127], v1 offset:7168
s_waitcnt vmcnt(15) lgkmcnt(15)
v_mfma_f32_16x16x32_bf16 v[160:163], a[200:203], a[96:99], v[160:163]
v_accvgpr_read_b32 v14, a14
v_mfma_f32_16x16x32_bf16 v[160:163], a[168:171], a[128:131], v[160:163]
v_accvgpr_read_b32 v15, a15
v_lshlrev_b32 v24, 16, v12
v_mfma_f32_16x16x32_bf16 v[192:195], a[172:175], a[128:131], v[192:195]
v_and_b32 v25, s33, v12
v_lshlrev_b32 v26, 16, v13
v_mfma_f32_16x16x32_bf16 v[192:195], a[204:207], a[96:99], v[192:195]
v_and_b32 v27, s33, v13
v_mul_f32 v24, v24, v44
s_waitcnt lgkmcnt(14)
v_mfma_f32_16x16x32_bf16 v[196:199], a[204:207], a[100:103], v[196:199]
v_mul_f32 v25, v25, v45
v_mfma_f32_16x16x32_bf16 v[196:199], a[172:175], a[132:135], v[196:199]
v_mul_f32 v26, v26, v46
v_mul_f32 v27, v27, v47
v_mfma_f32_16x16x32_bf16 v[164:167], a[168:171], a[132:135], v[164:167]
v_cvt_pk_bf16_f32 v12, v24, v25
v_cvt_pk_bf16_f32 v13, v26, v27
v_mfma_f32_16x16x32_bf16 v[164:167], a[200:203], a[100:103], v[164:167]
v_lshlrev_b32 v24, 16, v14
v_and_b32 v25, s33, v14
s_waitcnt lgkmcnt(11)
v_mfma_f32_16x16x32_bf16 v[168:171], a[200:203], a[104:107], v[168:171]
v_lshlrev_b32 v26, 16, v15
v_mfma_f32_16x16x32_bf16 v[168:171], a[168:171], a[136:139], v[168:171]
v_and_b32 v27, s33, v15
v_mul_f32 v24, v24, v76
v_mfma_f32_16x16x32_bf16 v[200:203], a[172:175], a[136:139], v[200:203]
v_mul_f32 v25, v25, v77
v_mul_f32 v26, v26, v78
v_mfma_f32_16x16x32_bf16 v[200:203], a[204:207], a[104:107], v[200:203]
v_mul_f32 v27, v27, v79
v_cvt_pk_bf16_f32 v14, v24, v25
s_waitcnt lgkmcnt(9)
v_mfma_f32_16x16x32_bf16 v[204:207], a[204:207], a[108:111], v[204:207]
v_cvt_pk_bf16_f32 v15, v26, v27
v_mfma_f32_16x16x32_bf16 v[204:207], a[172:175], a[140:143], v[204:207]
ds_write_b128 v6, v[12:15] offset:3072
buffer_store_dwordx4 v[12:15], v6, s[20:23], s52 offen offset:3072 sc1
v_mfma_f32_16x16x32_bf16 v[172:175], a[168:171], a[140:143], v[172:175]
v_accvgpr_read_b32 v16, a16
v_accvgpr_read_b32 v17, a17
v_mfma_f32_16x16x32_bf16 v[172:175], a[200:203], a[108:111], v[172:175]
v_accvgpr_read_b32 v18, a18
v_accvgpr_read_b32 v19, a19
s_waitcnt lgkmcnt(8)
v_mfma_f32_16x16x32_bf16 v[176:179], a[200:203], a[112:115], v[176:179]
v_lshlrev_b32 v24, 16, v16
v_mfma_f32_16x16x32_bf16 v[176:179], a[168:171], a[144:147], v[176:179]
v_and_b32 v25, s33, v16
v_lshlrev_b32 v26, 16, v17
v_mfma_f32_16x16x32_bf16 v[208:211], a[172:175], a[144:147], v[208:211]
v_and_b32 v27, s33, v17
v_mul_f32 v24, v24, v48
v_mfma_f32_16x16x32_bf16 v[208:211], a[204:207], a[112:115], v[208:211]
v_mul_f32 v25, v25, v49
v_mul_f32 v26, v26, v50
s_waitcnt lgkmcnt(6)
v_mfma_f32_16x16x32_bf16 v[212:215], a[204:207], a[116:119], v[212:215]
v_mul_f32 v27, v27, v51
v_mfma_f32_16x16x32_bf16 v[212:215], a[172:175], a[148:151], v[212:215]
v_cvt_pk_bf16_f32 v16, v24, v25
v_cvt_pk_bf16_f32 v17, v26, v27
v_mfma_f32_16x16x32_bf16 v[180:183], a[168:171], a[148:151], v[180:183]
v_lshlrev_b32 v24, 16, v18
v_and_b32 v25, s33, v18
v_mfma_f32_16x16x32_bf16 v[180:183], a[200:203], a[116:119], v[180:183]
v_lshlrev_b32 v26, 16, v19
v_and_b32 v27, s33, v19
s_waitcnt lgkmcnt(3)
v_mfma_f32_16x16x32_bf16 v[184:187], a[200:203], a[120:123], v[184:187]
v_mul_f32 v24, v24, v80
v_mfma_f32_16x16x32_bf16 v[184:187], a[168:171], a[152:155], v[184:187]
v_mul_f32 v25, v25, v81
v_mul_f32 v26, v26, v82
v_mfma_f32_16x16x32_bf16 v[216:219], a[172:175], a[152:155], v[216:219]
v_mul_f32 v27, v27, v83
v_cvt_pk_bf16_f32 v18, v24, v25
v_mfma_f32_16x16x32_bf16 v[216:219], a[204:207], a[120:123], v[216:219]
v_cvt_pk_bf16_f32 v19, v26, v27
ds_write_b128 v6, v[16:19] offset:4096
s_waitcnt lgkmcnt(2)
v_mfma_f32_16x16x32_bf16 v[220:223], a[204:207], a[124:127], v[220:223]
buffer_load_dwordx4 a[204:207], v0, s[20:23], s30 offen offset:0 sc1
v_mfma_f32_16x16x32_bf16 v[220:223], a[172:175], a[156:159], v[220:223]
buffer_load_dwordx4 a[172:175], v0, s[20:23], s30 offen offset:1024 sc1
buffer_store_dwordx4 v[16:19], v6, s[20:23], s53 offen offset:0 sc1
v_mfma_f32_16x16x32_bf16 v[188:191], a[168:171], a[156:159], v[188:191]
buffer_load_dwordx4 a[168:171], v0, s[20:23], s30 offen offset:2048 sc1
v_accvgpr_read_b32 v20, a20
v_mfma_f32_16x16x32_bf16 v[188:191], a[200:203], a[124:127], v[188:191]
buffer_load_dwordx4 a[200:203], v0, s[20:23], s30 offen offset:3072 sc1
s_add_u32 s30, s30, 0x1000
s_waitcnt vmcnt(17)
v_mfma_f32_16x16x32_bf16 v[224:227], a[180:183], a[96:99], v[224:227]
v_accvgpr_read_b32 v21, a21
v_mfma_f32_16x16x32_bf16 v[224:227], a[212:215], a[128:131], v[224:227]
v_accvgpr_read_b32 v22, a22
v_accvgpr_read_b32 v23, a23
v_mfma_f32_16x16x32_bf16 a[224:227], a[176:179], a[128:131], a[224:227]
ds_read_b128 a[128:131], v4 offset:0
v_lshlrev_b32 v24, 16, v20
v_mfma_f32_16x16x32_bf16 a[224:227], a[208:211], a[96:99], a[224:227]
ds_read_b128 a[96:99], v3 offset:0
v_and_b32 v25, s33, v20
v_mfma_f32_16x16x32_bf16 a[228:231], a[208:211], a[100:103], a[228:231]
v_lshlrev_b32 v26, 16, v21
v_and_b32 v27, s33, v21
v_mfma_f32_16x16x32_bf16 a[228:231], a[176:179], a[132:135], a[228:231]
v_mul_f32 v24, v24, v52
v_mul_f32 v25, v25, v53
v_mfma_f32_16x16x32_bf16 v[228:231], a[212:215], a[132:135], v[228:231]
ds_read_b128 a[132:135], v4 offset:1024
v_mul_f32 v26, v26, v54
v_mfma_f32_16x16x32_bf16 v[228:231], a[180:183], a[100:103], v[228:231]
ds_read_b128 a[100:103], v3 offset:1024
v_mul_f32 v27, v27, v55
v_mfma_f32_16x16x32_bf16 v[232:235], a[180:183], a[104:107], v[232:235]
v_cvt_pk_bf16_f32 v20, v24, v25
v_cvt_pk_bf16_f32 v21, v26, v27
v_mfma_f32_16x16x32_bf16 v[232:235], a[212:215], a[136:139], v[232:235]
v_lshlrev_b32 v24, 16, v22
v_and_b32 v25, s33, v22
v_mfma_f32_16x16x32_bf16 a[232:235], a[176:179], a[136:139], a[232:235]
ds_read_b128 a[136:139], v4 offset:2048
v_lshlrev_b32 v26, 16, v23
v_mfma_f32_16x16x32_bf16 a[232:235], a[208:211], a[104:107], a[232:235]
ds_read_b128 a[104:107], v3 offset:2048
v_and_b32 v27, s33, v23
v_mfma_f32_16x16x32_bf16 a[236:239], a[208:211], a[108:111], a[236:239]
v_mul_f32 v24, v24, v84
v_mul_f32 v25, v25, v85
v_mfma_f32_16x16x32_bf16 a[236:239], a[176:179], a[140:143], a[236:239]
v_mul_f32 v26, v26, v86
v_mul_f32 v27, v27, v87
v_mfma_f32_16x16x32_bf16 v[236:239], a[212:215], a[140:143], v[236:239]
ds_read_b128 a[140:143], v4 offset:3072
v_cvt_pk_bf16_f32 v22, v24, v25
v_mfma_f32_16x16x32_bf16 v[236:239], a[180:183], a[108:111], v[236:239]
ds_read_b128 a[108:111], v3 offset:3072
v_cvt_pk_bf16_f32 v23, v26, v27
v_mfma_f32_16x16x32_bf16 v[240:243], a[180:183], a[112:115], v[240:243]
ds_write_b128 v6, v[20:23] offset:5120
buffer_store_dwordx4 v[20:23], v6, s[20:23], s53 offen offset:1024 sc1
v_mfma_f32_16x16x32_bf16 v[240:243], a[212:215], a[144:147], v[240:243]
v_accvgpr_read_b32 v12, a24
v_accvgpr_read_b32 v13, a25
v_mfma_f32_16x16x32_bf16 a[240:243], a[176:179], a[144:147], a[240:243]
ds_read_b128 a[144:147], v4 offset:4096
v_accvgpr_read_b32 v14, a26
v_mfma_f32_16x16x32_bf16 a[240:243], a[208:211], a[112:115], a[240:243]
ds_read_b128 a[112:115], v3 offset:4096
v_accvgpr_read_b32 v15, a27
v_mfma_f32_16x16x32_bf16 a[244:247], a[208:211], a[116:119], a[244:247]
v_lshlrev_b32 v24, 16, v12
v_and_b32 v25, s33, v12
v_mfma_f32_16x16x32_bf16 a[244:247], a[176:179], a[148:151], a[244:247]
v_lshlrev_b32 v26, 16, v13
v_and_b32 v27, s33, v13
v_mfma_f32_16x16x32_bf16 v[244:247], a[212:215], a[148:151], v[244:247]
ds_read_b128 a[148:151], v4 offset:5120
v_mul_f32 v24, v24, v56
v_mfma_f32_16x16x32_bf16 v[244:247], a[180:183], a[116:119], v[244:247]
ds_read_b128 a[116:119], v3 offset:5120
v_mul_f32 v25, v25, v57
v_mfma_f32_16x16x32_bf16 v[248:251], a[180:183], a[120:123], v[248:251]
v_mul_f32 v26, v26, v58
v_mul_f32 v27, v27, v59
v_mfma_f32_16x16x32_bf16 v[248:251], a[212:215], a[152:155], v[248:251]
v_cvt_pk_bf16_f32 v12, v24, v25
v_cvt_pk_bf16_f32 v13, v26, v27
v_mfma_f32_16x16x32_bf16 a[248:251], a[176:179], a[152:155], a[248:251]
ds_read_b128 a[152:155], v4 offset:6144
v_lshlrev_b32 v24, 16, v14
v_mfma_f32_16x16x32_bf16 a[248:251], a[208:211], a[120:123], a[248:251]
ds_read_b128 a[120:123], v3 offset:6144
v_and_b32 v25, s33, v14
v_mfma_f32_16x16x32_bf16 a[252:255], a[208:211], a[124:127], a[252:255]
buffer_load_dwordx4 a[208:211], v0, s[20:23], s30 offen offset:0 sc1
v_lshlrev_b32 v26, 16, v15
v_mfma_f32_16x16x32_bf16 a[252:255], a[176:179], a[156:159], a[252:255]
buffer_load_dwordx4 a[176:179], v0, s[20:23], s30 offen offset:1024 sc1
v_and_b32 v27, s33, v15
v_mfma_f32_16x16x32_bf16 v[252:255], a[212:215], a[156:159], v[252:255]
buffer_load_dwordx4 a[212:215], v0, s[20:23], s30 offen offset:2048 sc1
ds_read_b128 a[156:159], v4 offset:7168
v_mfma_f32_16x16x32_bf16 v[252:255], a[180:183], a[124:127], v[252:255]
buffer_load_dwordx4 a[180:183], v0, s[20:23], s30 offen offset:3072 sc1
s_add_u32 s30, s30, 0x3000
ds_read_b128 a[124:127], v3 offset:7168
s_waitcnt vmcnt(17) lgkmcnt(15)
v_mfma_f32_16x16x32_bf16 v[160:163], a[188:191], a[96:99], v[160:163]
v_mul_f32 v24, v24, v88
v_mfma_f32_16x16x32_bf16 v[160:163], a[220:223], a[128:131], v[160:163]
v_mul_f32 v25, v25, v89
v_mul_f32 v26, v26, v90
v_mfma_f32_16x16x32_bf16 v[192:195], a[184:187], a[128:131], v[192:195]
v_mul_f32 v27, v27, v91
v_cvt_pk_bf16_f32 v14, v24, v25
v_mfma_f32_16x16x32_bf16 v[192:195], a[216:219], a[96:99], v[192:195]
v_cvt_pk_bf16_f32 v15, v26, v27
ds_write_b128 v6, v[12:15] offset:6144
s_waitcnt lgkmcnt(14)
v_mfma_f32_16x16x32_bf16 v[196:199], a[216:219], a[100:103], v[196:199]
buffer_store_dwordx4 v[12:15], v6, s[20:23], s53 offen offset:2048 sc1
v_mfma_f32_16x16x32_bf16 v[196:199], a[184:187], a[132:135], v[196:199]
v_accvgpr_read_b32 v16, a28
v_accvgpr_read_b32 v17, a29
v_mfma_f32_16x16x32_bf16 v[164:167], a[220:223], a[132:135], v[164:167]
v_accvgpr_read_b32 v18, a30
v_accvgpr_read_b32 v19, a31
v_mfma_f32_16x16x32_bf16 v[164:167], a[188:191], a[100:103], v[164:167]
v_lshlrev_b32 v24, 16, v16
v_and_b32 v25, s33, v16
s_waitcnt lgkmcnt(12)
v_mfma_f32_16x16x32_bf16 v[168:171], a[188:191], a[104:107], v[168:171]
v_lshlrev_b32 v26, 16, v17
v_mfma_f32_16x16x32_bf16 v[168:171], a[220:223], a[136:139], v[168:171]
v_and_b32 v27, s33, v17
v_mul_f32 v24, v24, v60
v_mfma_f32_16x16x32_bf16 v[200:203], a[184:187], a[136:139], v[200:203]
v_mul_f32 v25, v25, v61
v_mul_f32 v26, v26, v62
v_mfma_f32_16x16x32_bf16 v[200:203], a[216:219], a[104:107], v[200:203]
v_mul_f32 v27, v27, v63
v_cvt_pk_bf16_f32 v16, v24, v25
s_waitcnt lgkmcnt(10)
v_mfma_f32_16x16x32_bf16 v[204:207], a[216:219], a[108:111], v[204:207]
v_cvt_pk_bf16_f32 v17, v26, v27
v_mfma_f32_16x16x32_bf16 v[204:207], a[184:187], a[140:143], v[204:207]
v_lshlrev_b32 v24, 16, v18
v_and_b32 v25, s33, v18
v_mfma_f32_16x16x32_bf16 v[172:175], a[220:223], a[140:143], v[172:175]
v_lshlrev_b32 v26, 16, v19
v_and_b32 v27, s33, v19
v_mfma_f32_16x16x32_bf16 v[172:175], a[188:191], a[108:111], v[172:175]
v_mul_f32 v24, v24, v92
v_mul_f32 v25, v25, v93
s_waitcnt lgkmcnt(7)
v_mfma_f32_16x16x32_bf16 v[176:179], a[188:191], a[112:115], v[176:179]
v_mul_f32 v26, v26, v94
v_mfma_f32_16x16x32_bf16 v[176:179], a[220:223], a[144:147], v[176:179]
v_mul_f32 v27, v27, v95
v_cvt_pk_bf16_f32 v18, v24, v25
v_mfma_f32_16x16x32_bf16 v[208:211], a[184:187], a[144:147], v[208:211]
v_cvt_pk_bf16_f32 v19, v26, v27
ds_write_b128 v6, v[16:19] offset:7168
v_mfma_f32_16x16x32_bf16 v[208:211], a[216:219], a[112:115], v[208:211]
buffer_store_dwordx4 v[16:19], v6, s[20:23], s53 offen offset:3072 sc1
v_accvgpr_read_b32 v20, a32
s_waitcnt lgkmcnt(6)
v_mfma_f32_16x16x32_bf16 v[212:215], a[216:219], a[116:119], v[212:215]
v_accvgpr_read_b32 v21, a33
v_mfma_f32_16x16x32_bf16 v[212:215], a[184:187], a[148:151], v[212:215]
v_accvgpr_read_b32 v22, a34
v_accvgpr_read_b32 v23, a35
v_mfma_f32_16x16x32_bf16 v[180:183], a[220:223], a[148:151], v[180:183]
v_lshlrev_b32 v24, 16, v20
v_and_b32 v25, s33, v20
v_mfma_f32_16x16x32_bf16 v[180:183], a[188:191], a[116:119], v[180:183]
v_lshlrev_b32 v26, 16, v21
v_and_b32 v27, s33, v21
s_waitcnt lgkmcnt(4)
v_mfma_f32_16x16x32_bf16 v[184:187], a[188:191], a[120:123], v[184:187]
v_mul_f32 v24, v24, v96
v_mfma_f32_16x16x32_bf16 v[184:187], a[220:223], a[152:155], v[184:187]
v_mul_f32 v25, v25, v97
v_mul_f32 v26, v26, v98
v_mfma_f32_16x16x32_bf16 v[216:219], a[184:187], a[152:155], v[216:219]
v_mul_f32 v27, v27, v99
v_cvt_pk_bf16_f32 v20, v24, v25
v_mfma_f32_16x16x32_bf16 v[216:219], a[216:219], a[120:123], v[216:219]
v_cvt_pk_bf16_f32 v21, v26, v27
v_lshlrev_b32 v24, 16, v22
s_waitcnt lgkmcnt(2)
v_mfma_f32_16x16x32_bf16 v[220:223], a[216:219], a[124:127], v[220:223]
buffer_load_dwordx4 a[216:219], v0, s[20:23], s30 offen offset:0 sc1
v_mfma_f32_16x16x32_bf16 v[220:223], a[184:187], a[156:159], v[220:223]
buffer_load_dwordx4 a[184:187], v0, s[20:23], s30 offen offset:1024 sc1
v_and_b32 v25, s33, v22
v_mfma_f32_16x16x32_bf16 v[188:191], a[220:223], a[156:159], v[188:191]
buffer_load_dwordx4 a[220:223], v0, s[20:23], s30 offen offset:2048 sc1
v_lshlrev_b32 v26, 16, v23
v_mfma_f32_16x16x32_bf16 v[188:191], a[188:191], a[124:127], v[188:191]
buffer_load_dwordx4 a[188:191], v0, s[20:23], s30 offen offset:3072 sc1
s_add_u32 s30, s30, 0x1000
s_waitcnt vmcnt(17)
v_mfma_f32_16x16x32_bf16 v[224:227], a[196:199], a[96:99], v[224:227]
v_and_b32 v27, s33, v23
v_mfma_f32_16x16x32_bf16 v[224:227], a[164:167], a[128:131], v[224:227]
v_mul_f32 v24, v24, v128
v_mul_f32 v25, v25, v129
v_mfma_f32_16x16x32_bf16 a[224:227], a[192:195], a[128:131], a[224:227]
ds_read_b128 a[128:131], v2 offset:32768
v_mul_f32 v26, v26, v130
v_mfma_f32_16x16x32_bf16 a[224:227], a[160:163], a[96:99], a[224:227]
ds_read_b128 a[96:99], v1 offset:32768
v_mul_f32 v27, v27, v131
v_mfma_f32_16x16x32_bf16 a[228:231], a[160:163], a[100:103], a[228:231]
v_cvt_pk_bf16_f32 v22, v24, v25
v_cvt_pk_bf16_f32 v23, v26, v27
v_mfma_f32_16x16x32_bf16 a[228:231], a[192:195], a[132:135], a[228:231]
ds_write_b128 v6, v[20:23] offset:32768
buffer_store_dwordx4 v[20:23], v6, s[20:23], s54 offen offset:0 sc1
v_mfma_f32_16x16x32_bf16 v[228:231], a[164:167], a[132:135], v[228:231]
ds_read_b128 a[132:135], v2 offset:33792
v_accvgpr_read_b32 v12, a36
v_mfma_f32_16x16x32_bf16 v[228:231], a[196:199], a[100:103], v[228:231]
ds_read_b128 a[100:103], v1 offset:33792
v_accvgpr_read_b32 v13, a37
v_mfma_f32_16x16x32_bf16 v[232:235], a[196:199], a[104:107], v[232:235]
v_accvgpr_read_b32 v14, a38
v_accvgpr_read_b32 v15, a39
v_mfma_f32_16x16x32_bf16 v[232:235], a[164:167], a[136:139], v[232:235]
v_lshlrev_b32 v24, 16, v12
v_and_b32 v25, s33, v12
v_mfma_f32_16x16x32_bf16 a[232:235], a[192:195], a[136:139], a[232:235]
ds_read_b128 a[136:139], v2 offset:34816
v_lshlrev_b32 v26, 16, v13
v_mfma_f32_16x16x32_bf16 a[232:235], a[160:163], a[104:107], a[232:235]
ds_read_b128 a[104:107], v1 offset:34816
v_and_b32 v27, s33, v13
v_mfma_f32_16x16x32_bf16 a[236:239], a[160:163], a[108:111], a[236:239]
v_mul_f32 v24, v24, v100
v_mul_f32 v25, v25, v101
v_mfma_f32_16x16x32_bf16 a[236:239], a[192:195], a[140:143], a[236:239]
v_mul_f32 v26, v26, v102
v_mul_f32 v27, v27, v103
v_mfma_f32_16x16x32_bf16 v[236:239], a[164:167], a[140:143], v[236:239]
ds_read_b128 a[140:143], v2 offset:35840
v_cvt_pk_bf16_f32 v12, v24, v25
v_mfma_f32_16x16x32_bf16 v[236:239], a[196:199], a[108:111], v[236:239]
ds_read_b128 a[108:111], v1 offset:35840
v_cvt_pk_bf16_f32 v13, v26, v27
v_mfma_f32_16x16x32_bf16 v[240:243], a[196:199], a[112:115], v[240:243]
v_lshlrev_b32 v24, 16, v14
v_and_b32 v25, s33, v14
v_mfma_f32_16x16x32_bf16 v[240:243], a[164:167], a[144:147], v[240:243]
v_lshlrev_b32 v26, 16, v15
v_and_b32 v27, s33, v15
v_mfma_f32_16x16x32_bf16 a[240:243], a[192:195], a[144:147], a[240:243]
ds_read_b128 a[144:147], v2 offset:36864
v_mul_f32 v24, v24, v132
v_mfma_f32_16x16x32_bf16 a[240:243], a[160:163], a[112:115], a[240:243]
ds_read_b128 a[112:115], v1 offset:36864
v_mul_f32 v25, v25, v133
v_mfma_f32_16x16x32_bf16 a[244:247], a[160:163], a[116:119], a[244:247]
v_mul_f32 v26, v26, v134
v_mul_f32 v27, v27, v135
v_mfma_f32_16x16x32_bf16 a[244:247], a[192:195], a[148:151], a[244:247]
v_cvt_pk_bf16_f32 v14, v24, v25
v_cvt_pk_bf16_f32 v15, v26, v27
v_mfma_f32_16x16x32_bf16 v[244:247], a[164:167], a[148:151], v[244:247]
ds_read_b128 a[148:151], v2 offset:37888
ds_write_b128 v6, v[12:15] offset:33792
v_mfma_f32_16x16x32_bf16 v[244:247], a[196:199], a[116:119], v[244:247]
ds_read_b128 a[116:119], v1 offset:37888
buffer_store_dwordx4 v[12:15], v6, s[20:23], s54 offen offset:1024 sc1
v_mfma_f32_16x16x32_bf16 v[248:251], a[196:199], a[120:123], v[248:251]
v_accvgpr_read_b32 v16, a40
v_accvgpr_read_b32 v17, a41
v_mfma_f32_16x16x32_bf16 v[248:251], a[164:167], a[152:155], v[248:251]
v_accvgpr_read_b32 v18, a42
v_accvgpr_read_b32 v19, a43
v_mfma_f32_16x16x32_bf16 a[248:251], a[192:195], a[152:155], a[248:251]
ds_read_b128 a[152:155], v2 offset:38912
v_lshlrev_b32 v24, 16, v16
v_mfma_f32_16x16x32_bf16 a[248:251], a[160:163], a[120:123], a[248:251]
ds_read_b128 a[120:123], v1 offset:38912
v_and_b32 v25, s33, v16
v_mfma_f32_16x16x32_bf16 a[252:255], a[160:163], a[124:127], a[252:255]
buffer_load_dwordx4 a[160:163], v0, s[20:23], s30 offen offset:0 sc1
v_lshlrev_b32 v26, 16, v17
v_mfma_f32_16x16x32_bf16 a[252:255], a[192:195], a[156:159], a[252:255]
buffer_load_dwordx4 a[192:195], v0, s[20:23], s30 offen offset:1024 sc1
v_and_b32 v27, s33, v17
v_mfma_f32_16x16x32_bf16 v[252:255], a[164:167], a[156:159], v[252:255]
buffer_load_dwordx4 a[164:167], v0, s[20:23], s30 offen offset:2048 sc1
ds_read_b128 a[156:159], v2 offset:39936
v_mfma_f32_16x16x32_bf16 v[252:255], a[196:199], a[124:127], v[252:255]
buffer_load_dwordx4 a[196:199], v0, s[20:23], s30 offen offset:3072 sc1
s_add_u32 s30, s30, 0x1000
ds_read_b128 a[124:127], v1 offset:39936
s_waitcnt vmcnt(17) lgkmcnt(15)
v_mfma_f32_16x16x32_bf16 v[160:163], a[204:207], a[96:99], v[160:163]
v_mul_f32 v24, v24, v104
v_mfma_f32_16x16x32_bf16 v[160:163], a[172:175], a[128:131], v[160:163]
v_mul_f32 v25, v25, v105
v_mul_f32 v26, v26, v106
v_mfma_f32_16x16x32_bf16 v[192:195], a[200:203], a[128:131], v[192:195]
v_mul_f32 v27, v27, v107
v_cvt_pk_bf16_f32 v16, v24, v25
v_mfma_f32_16x16x32_bf16 v[192:195], a[168:171], a[96:99], v[192:195]
v_cvt_pk_bf16_f32 v17, v26, v27
v_lshlrev_b32 v24, 16, v18
s_waitcnt lgkmcnt(13)
v_mfma_f32_16x16x32_bf16 v[196:199], a[168:171], a[100:103], v[196:199]
v_and_b32 v25, s33, v18
v_mfma_f32_16x16x32_bf16 v[196:199], a[200:203], a[132:135], v[196:199]
v_lshlrev_b32 v26, 16, v19
v_and_b32 v27, s33, v19
v_mfma_f32_16x16x32_bf16 v[164:167], a[172:175], a[132:135], v[164:167]
v_mul_f32 v24, v24, v136
v_mul_f32 v25, v25, v137
v_mfma_f32_16x16x32_bf16 v[164:167], a[204:207], a[100:103], v[164:167]
v_mul_f32 v26, v26, v138
v_mul_f32 v27, v27, v139
s_waitcnt lgkmcnt(11)
v_mfma_f32_16x16x32_bf16 v[168:171], a[204:207], a[104:107], v[168:171]
v_cvt_pk_bf16_f32 v18, v24, v25
v_mfma_f32_16x16x32_bf16 v[168:171], a[172:175], a[136:139], v[168:171]
v_cvt_pk_bf16_f32 v19, v26, v27
ds_write_b128 v6, v[16:19] offset:34816
v_mfma_f32_16x16x32_bf16 v[200:203], a[200:203], a[136:139], v[200:203]
buffer_store_dwordx4 v[16:19], v6, s[20:23], s54 offen offset:2048 sc1
v_accvgpr_read_b32 v20, a44
v_mfma_f32_16x16x32_bf16 v[200:203], a[168:171], a[104:107], v[200:203]
v_accvgpr_read_b32 v21, a45
v_accvgpr_read_b32 v22, a46
s_waitcnt lgkmcnt(10)
v_mfma_f32_16x16x32_bf16 v[204:207], a[168:171], a[108:111], v[204:207]
v_accvgpr_read_b32 v23, a47
v_mfma_f32_16x16x32_bf16 v[204:207], a[200:203], a[140:143], v[204:207]
v_lshlrev_b32 v24, 16, v20
v_and_b32 v25, s33, v20
v_mfma_f32_16x16x32_bf16 v[172:175], a[172:175], a[140:143], v[172:175]
v_lshlrev_b32 v26, 16, v21
v_and_b32 v27, s33, v21
v_mfma_f32_16x16x32_bf16 v[172:175], a[204:207], a[108:111], v[172:175]
v_mul_f32 v24, v24, v108
v_mul_f32 v25, v25, v109
s_waitcnt lgkmcnt(8)
v_mfma_f32_16x16x32_bf16 v[176:179], a[204:207], a[112:115], v[176:179]
v_mul_f32 v26, v26, v110
v_mfma_f32_16x16x32_bf16 v[176:179], a[172:175], a[144:147], v[176:179]
v_mul_f32 v27, v27, v111
v_cvt_pk_bf16_f32 v20, v24, v25
v_mfma_f32_16x16x32_bf16 v[208:211], a[200:203], a[144:147], v[208:211]
v_cvt_pk_bf16_f32 v21, v26, v27
v_lshlrev_b32 v24, 16, v22
v_mfma_f32_16x16x32_bf16 v[208:211], a[168:171], a[112:115], v[208:211]
v_and_b32 v25, s33, v22
v_lshlrev_b32 v26, 16, v23
s_waitcnt lgkmcnt(5)
v_mfma_f32_16x16x32_bf16 v[212:215], a[168:171], a[116:119], v[212:215]
v_and_b32 v27, s33, v23
v_mfma_f32_16x16x32_bf16 v[212:215], a[200:203], a[148:151], v[212:215]
v_mul_f32 v24, v24, v140
v_mul_f32 v25, v25, v141
v_mfma_f32_16x16x32_bf16 v[180:183], a[172:175], a[148:151], v[180:183]
v_mul_f32 v26, v26, v142
v_mul_f32 v27, v27, v143
v_mfma_f32_16x16x32_bf16 v[180:183], a[204:207], a[116:119], v[180:183]
v_cvt_pk_bf16_f32 v22, v24, v25
v_cvt_pk_bf16_f32 v23, v26, v27
s_waitcnt lgkmcnt(3)
v_mfma_f32_16x16x32_bf16 v[184:187], a[204:207], a[120:123], v[184:187]
ds_write_b128 v6, v[20:23] offset:35840
v_mfma_f32_16x16x32_bf16 v[184:187], a[172:175], a[152:155], v[184:187]
buffer_store_dwordx4 v[20:23], v6, s[20:23], s54 offen offset:3072 sc1
v_accvgpr_read_b32 v12, a48
v_mfma_f32_16x16x32_bf16 v[216:219], a[200:203], a[152:155], v[216:219]
v_accvgpr_read_b32 v13, a49
v_accvgpr_read_b32 v14, a50
v_mfma_f32_16x16x32_bf16 v[216:219], a[168:171], a[120:123], v[216:219]
v_accvgpr_read_b32 v15, a51
v_lshlrev_b32 v24, 16, v12
s_waitcnt lgkmcnt(2)
v_mfma_f32_16x16x32_bf16 v[220:223], a[168:171], a[124:127], v[220:223]
buffer_load_dwordx4 a[168:171], v0, s[20:23], s30 offen offset:0 sc1
v_mfma_f32_16x16x32_bf16 v[220:223], a[200:203], a[156:159], v[220:223]
buffer_load_dwordx4 a[200:203], v0, s[20:23], s30 offen offset:1024 sc1
v_and_b32 v25, s33, v12
v_mfma_f32_16x16x32_bf16 v[188:191], a[172:175], a[156:159], v[188:191]
buffer_load_dwordx4 a[172:175], v0, s[20:23], s30 offen offset:2048 sc1
v_lshlrev_b32 v26, 16, v13
v_mfma_f32_16x16x32_bf16 v[188:191], a[204:207], a[124:127], v[188:191]
buffer_load_dwordx4 a[204:207], v0, s[20:23], s30 offen offset:3072 sc1
s_add_u32 s30, s30, 0x1000
s_waitcnt vmcnt(18)
v_mfma_f32_16x16x32_bf16 v[224:227], a[208:211], a[96:99], v[224:227]
v_and_b32 v27, s33, v13
v_mfma_f32_16x16x32_bf16 v[224:227], a[176:179], a[128:131], v[224:227]
v_mul_f32 v24, v24, v112
v_mul_f32 v25, v25, v113
v_mfma_f32_16x16x32_bf16 a[224:227], a[180:183], a[128:131], a[224:227]
ds_read_b128 a[128:131], v4 offset:32768
v_mul_f32 v26, v26, v114
v_mfma_f32_16x16x32_bf16 a[224:227], a[212:215], a[96:99], a[224:227]
ds_read_b128 a[96:99], v3 offset:32768
v_mul_f32 v27, v27, v115
v_mfma_f32_16x16x32_bf16 a[228:231], a[212:215], a[100:103], a[228:231]
v_cvt_pk_bf16_f32 v12, v24, v25
v_cvt_pk_bf16_f32 v13, v26, v27
v_mfma_f32_16x16x32_bf16 a[228:231], a[180:183], a[132:135], a[228:231]
v_lshlrev_b32 v24, 16, v14
v_and_b32 v25, s33, v14
v_mfma_f32_16x16x32_bf16 v[228:231], a[176:179], a[132:135], v[228:231]
ds_read_b128 a[132:135], v4 offset:33792
v_lshlrev_b32 v26, 16, v15
v_mfma_f32_16x16x32_bf16 v[228:231], a[208:211], a[100:103], v[228:231]
ds_read_b128 a[100:103], v3 offset:33792
v_and_b32 v27, s33, v15
v_mfma_f32_16x16x32_bf16 v[232:235], a[208:211], a[104:107], v[232:235]
v_mul_f32 v24, v24, v144
v_mul_f32 v25, v25, v145
v_mfma_f32_16x16x32_bf16 v[232:235], a[176:179], a[136:139], v[232:235]
v_mul_f32 v26, v26, v146
v_mul_f32 v27, v27, v147
v_mfma_f32_16x16x32_bf16 a[232:235], a[180:183], a[136:139], a[232:235]
ds_read_b128 a[136:139], v4 offset:34816
v_cvt_pk_bf16_f32 v14, v24, v25
v_mfma_f32_16x16x32_bf16 a[232:235], a[212:215], a[104:107], a[232:235]
ds_read_b128 a[104:107], v3 offset:34816
v_cvt_pk_bf16_f32 v15, v26, v27
v_mfma_f32_16x16x32_bf16 a[236:239], a[212:215], a[108:111], a[236:239]
ds_write_b128 v6, v[12:15] offset:36864
buffer_store_dwordx4 v[12:15], v6, s[20:23], s55 offen offset:0 sc1
v_mfma_f32_16x16x32_bf16 a[236:239], a[180:183], a[140:143], a[236:239]
v_accvgpr_read_b32 v16, a52
v_accvgpr_read_b32 v17, a53
v_mfma_f32_16x16x32_bf16 v[236:239], a[176:179], a[140:143], v[236:239]
ds_read_b128 a[140:143], v4 offset:35840
v_accvgpr_read_b32 v18, a54
v_mfma_f32_16x16x32_bf16 v[236:239], a[208:211], a[108:111], v[236:239]
ds_read_b128 a[108:111], v3 offset:35840
v_accvgpr_read_b32 v19, a55
v_mfma_f32_16x16x32_bf16 v[240:243], a[208:211], a[112:115], v[240:243]
v_lshlrev_b32 v24, 16, v16
v_and_b32 v25, s33, v16
v_mfma_f32_16x16x32_bf16 v[240:243], a[176:179], a[144:147], v[240:243]
v_lshlrev_b32 v26, 16, v17
v_and_b32 v27, s33, v17
v_mfma_f32_16x16x32_bf16 a[240:243], a[180:183], a[144:147], a[240:243]
ds_read_b128 a[144:147], v4 offset:36864
v_mul_f32 v24, v24, v116
v_mfma_f32_16x16x32_bf16 a[240:243], a[212:215], a[112:115], a[240:243]
ds_read_b128 a[112:115], v3 offset:36864
v_mul_f32 v25, v25, v117
v_mfma_f32_16x16x32_bf16 a[244:247], a[212:215], a[116:119], a[244:247]
v_mul_f32 v26, v26, v118
v_mul_f32 v27, v27, v119
v_mfma_f32_16x16x32_bf16 a[244:247], a[180:183], a[148:151], a[244:247]
v_cvt_pk_bf16_f32 v16, v24, v25
v_cvt_pk_bf16_f32 v17, v26, v27
v_mfma_f32_16x16x32_bf16 v[244:247], a[176:179], a[148:151], v[244:247]
ds_read_b128 a[148:151], v4 offset:37888
v_lshlrev_b32 v24, 16, v18
v_mfma_f32_16x16x32_bf16 v[244:247], a[208:211], a[116:119], v[244:247]
ds_read_b128 a[116:119], v3 offset:37888
v_and_b32 v25, s33, v18
v_mfma_f32_16x16x32_bf16 v[248:251], a[208:211], a[120:123], v[248:251]
v_lshlrev_b32 v26, 16, v19
v_and_b32 v27, s33, v19
v_mfma_f32_16x16x32_bf16 v[248:251], a[176:179], a[152:155], v[248:251]
v_mul_f32 v24, v24, v148
v_mul_f32 v25, v25, v149
v_mfma_f32_16x16x32_bf16 a[248:251], a[180:183], a[152:155], a[248:251]
ds_read_b128 a[152:155], v4 offset:38912
v_mul_f32 v26, v26, v150
v_mfma_f32_16x16x32_bf16 a[248:251], a[212:215], a[120:123], a[248:251]
ds_read_b128 a[120:123], v3 offset:38912
v_mul_f32 v27, v27, v151
v_mfma_f32_16x16x32_bf16 a[252:255], a[212:215], a[124:127], a[252:255]
buffer_load_dwordx4 a[212:215], v0, s[20:23], s30 offen offset:0 sc1
v_cvt_pk_bf16_f32 v18, v24, v25
v_mfma_f32_16x16x32_bf16 a[252:255], a[180:183], a[156:159], a[252:255]
buffer_load_dwordx4 a[180:183], v0, s[20:23], s30 offen offset:1024 sc1
v_cvt_pk_bf16_f32 v19, v26, v27
v_mfma_f32_16x16x32_bf16 v[252:255], a[176:179], a[156:159], v[252:255]
buffer_load_dwordx4 a[176:179], v0, s[20:23], s30 offen offset:2048 sc1
ds_read_b128 a[156:159], v4 offset:39936
v_mfma_f32_16x16x32_bf16 v[252:255], a[208:211], a[124:127], v[252:255]
buffer_load_dwordx4 a[208:211], v0, s[20:23], s30 offen offset:3072 sc1
s_add_u32 s30, s30, 0x3000
ds_read_b128 a[124:127], v3 offset:39936
s_waitcnt vmcnt(17) lgkmcnt(15)
v_mfma_f32_16x16x32_bf16 v[160:163], a[216:219], a[96:99], v[160:163]
ds_write_b128 v6, v[16:19] offset:37888
v_mfma_f32_16x16x32_bf16 v[160:163], a[184:187], a[128:131], v[160:163]
buffer_store_dwordx4 v[16:19], v6, s[20:23], s55 offen offset:1024 sc1
v_accvgpr_read_b32 v20, a56
v_mfma_f32_16x16x32_bf16 v[192:195], a[188:191], a[128:131], v[192:195]
v_accvgpr_read_b32 v21, a57
v_accvgpr_read_b32 v22, a58
v_mfma_f32_16x16x32_bf16 v[192:195], a[220:223], a[96:99], v[192:195]
v_accvgpr_read_b32 v23, a59
v_lshlrev_b32 v24, 16, v20
s_waitcnt lgkmcnt(14)
v_mfma_f32_16x16x32_bf16 v[196:199], a[220:223], a[100:103], v[196:199]
v_and_b32 v25, s33, v20
v_mfma_f32_16x16x32_bf16 v[196:199], a[188:191], a[132:135], v[196:199]
v_lshlrev_b32 v26, 16, v21
v_and_b32 v27, s33, v21
v_mfma_f32_16x16x32_bf16 v[164:167], a[184:187], a[132:135], v[164:167]
v_mul_f32 v24, v24, v120
v_mul_f32 v25, v25, v121
v_mfma_f32_16x16x32_bf16 v[164:167], a[216:219], a[100:103], v[164:167]
v_mul_f32 v26, v26, v122
v_mul_f32 v27, v27, v123
s_waitcnt lgkmcnt(12)
v_mfma_f32_16x16x32_bf16 v[168:171], a[216:219], a[104:107], v[168:171]
v_cvt_pk_bf16_f32 v20, v24, v25
v_mfma_f32_16x16x32_bf16 v[168:171], a[184:187], a[136:139], v[168:171]
v_cvt_pk_bf16_f32 v21, v26, v27
v_lshlrev_b32 v24, 16, v22
v_mfma_f32_16x16x32_bf16 v[200:203], a[188:191], a[136:139], v[200:203]
v_and_b32 v25, s33, v22
v_lshlrev_b32 v26, 16, v23
v_mfma_f32_16x16x32_bf16 v[200:203], a[220:223], a[104:107], v[200:203]
v_and_b32 v27, s33, v23
v_mul_f32 v24, v24, v152
s_waitcnt lgkmcnt(9)
v_mfma_f32_16x16x32_bf16 v[204:207], a[220:223], a[108:111], v[204:207]
v_mul_f32 v25, v25, v153
v_mfma_f32_16x16x32_bf16 v[204:207], a[188:191], a[140:143], v[204:207]
v_mul_f32 v26, v26, v154
v_mul_f32 v27, v27, v155
v_mfma_f32_16x16x32_bf16 v[172:175], a[184:187], a[140:143], v[172:175]
v_cvt_pk_bf16_f32 v22, v24, v25
v_cvt_pk_bf16_f32 v23, v26, v27
v_mfma_f32_16x16x32_bf16 v[172:175], a[216:219], a[108:111], v[172:175]
ds_write_b128 v6, v[20:23] offset:38912
buffer_store_dwordx4 v[20:23], v6, s[20:23], s55 offen offset:2048 sc1
s_waitcnt lgkmcnt(8)
v_mfma_f32_16x16x32_bf16 v[176:179], a[216:219], a[112:115], v[176:179]
v_accvgpr_read_b32 v12, a60
v_mfma_f32_16x16x32_bf16 v[176:179], a[184:187], a[144:147], v[176:179]
v_accvgpr_read_b32 v13, a61
v_accvgpr_read_b32 v14, a62
v_mfma_f32_16x16x32_bf16 v[208:211], a[188:191], a[144:147], v[208:211]
v_accvgpr_read_b32 v15, a63
v_lshlrev_b32 v24, 16, v12
v_mfma_f32_16x16x32_bf16 v[208:211], a[220:223], a[112:115], v[208:211]
v_and_b32 v25, s33, v12
v_lshlrev_b32 v26, 16, v13
s_waitcnt lgkmcnt(6)
v_mfma_f32_16x16x32_bf16 v[212:215], a[220:223], a[116:119], v[212:215]
v_and_b32 v27, s33, v13
v_mfma_f32_16x16x32_bf16 v[212:215], a[188:191], a[148:151], v[212:215]
v_mul_f32 v24, v24, v124
v_mul_f32 v25, v25, v125
v_mfma_f32_16x16x32_bf16 v[180:183], a[184:187], a[148:151], v[180:183]
v_mul_f32 v26, v26, v126
v_mul_f32 v27, v27, v127
v_mfma_f32_16x16x32_bf16 v[180:183], a[216:219], a[116:119], v[180:183]
v_cvt_pk_bf16_f32 v12, v24, v25
v_cvt_pk_bf16_f32 v13, v26, v27
s_waitcnt lgkmcnt(4)
v_mfma_f32_16x16x32_bf16 v[184:187], a[216:219], a[120:123], v[184:187]
v_lshlrev_b32 v24, 16, v14
v_mfma_f32_16x16x32_bf16 v[184:187], a[184:187], a[152:155], v[184:187]
v_and_b32 v25, s33, v14
v_lshlrev_b32 v26, 16, v15
v_mfma_f32_16x16x32_bf16 v[216:219], a[188:191], a[152:155], v[216:219]
v_and_b32 v27, s33, v15
v_mul_f32 v24, v24, v156
v_mfma_f32_16x16x32_bf16 v[216:219], a[220:223], a[120:123], v[216:219]
v_mul_f32 v25, v25, v157
v_mul_f32 v26, v26, v158
s_waitcnt lgkmcnt(2)
v_mfma_f32_16x16x32_bf16 v[220:223], a[220:223], a[124:127], v[220:223]
buffer_load_dwordx4 a[220:223], v0, s[20:23], s30 offen offset:0 sc1
v_mfma_f32_16x16x32_bf16 v[220:223], a[188:191], a[156:159], v[220:223]
buffer_load_dwordx4 a[188:191], v0, s[20:23], s30 offen offset:1024 sc1
v_mul_f32 v27, v27, v159
v_mfma_f32_16x16x32_bf16 v[188:191], a[184:187], a[156:159], v[188:191]
buffer_load_dwordx4 a[184:187], v0, s[20:23], s30 offen offset:2048 sc1
v_cvt_pk_bf16_f32 v14, v24, v25
v_mfma_f32_16x16x32_bf16 v[188:191], a[216:219], a[124:127], v[188:191]
buffer_load_dwordx4 a[216:219], v0, s[20:23], s30 offen offset:3072 sc1
s_add_u32 s30, s30, 0x1000
s_barrier
s_waitcnt vmcnt(17)
v_mfma_f32_16x16x32_bf16 v[224:227], a[160:163], a[96:99], v[224:227]
v_mfma_f32_16x16x32_bf16 v[224:227], a[192:195], a[128:131], v[224:227]
v_cvt_pk_bf16_f32 v15, v26, v27
ds_write_b128 v6, v[12:15] offset:39936
v_mfma_f32_16x16x32_bf16 a[224:227], a[196:199], a[128:131], a[224:227]
v_xor_b32 v2, 0x2000, v6
ds_read_b128 a[128:131], v2 offset:0
v_mfma_f32_16x16x32_bf16 a[224:227], a[164:167], a[96:99], a[224:227]
v_xor_b32 v1, 0x0, v6
ds_read_b128 a[96:99], v1 offset:0
v_mfma_f32_16x16x32_bf16 a[228:231], a[164:167], a[100:103], a[228:231]
buffer_store_dwordx4 v[12:15], v6, s[20:23], s55 offen offset:3072 sc1
v_accvgpr_read_b32 v16, a64
v_mfma_f32_16x16x32_bf16 a[228:231], a[196:199], a[132:135], a[228:231]
v_accvgpr_read_b32 v17, a65
v_accvgpr_read_b32 v18, a66
v_mfma_f32_16x16x32_bf16 v[228:231], a[192:195], a[132:135], v[228:231]
ds_read_b128 a[132:135], v2 offset:1024
v_accvgpr_read_b32 v19, a67
v_mfma_f32_16x16x32_bf16 v[228:231], a[160:163], a[100:103], v[228:231]
ds_read_b128 a[100:103], v1 offset:1024
v_lshlrev_b32 v24, 16, v16
v_mfma_f32_16x16x32_bf16 v[232:235], a[160:163], a[104:107], v[232:235]
v_and_b32 v25, s33, v16
v_lshlrev_b32 v26, 16, v17
v_mfma_f32_16x16x32_bf16 v[232:235], a[192:195], a[136:139], v[232:235]
v_and_b32 v27, s33, v17
v_mul_f32 v24, v24, v160
v_mfma_f32_16x16x32_bf16 a[232:235], a[196:199], a[136:139], a[232:235]
ds_read_b128 a[136:139], v2 offset:2048
v_mul_f32 v25, v25, v161
v_mfma_f32_16x16x32_bf16 a[232:235], a[164:167], a[104:107], a[232:235]
ds_read_b128 a[104:107], v1 offset:2048
v_mul_f32 v26, v26, v162
v_mfma_f32_16x16x32_bf16 a[236:239], a[164:167], a[108:111], a[236:239]
v_mul_f32 v27, v27, v163
v_cvt_pk_bf16_f32 v16, v24, v25
v_mfma_f32_16x16x32_bf16 a[236:239], a[196:199], a[140:143], a[236:239]
v_cvt_pk_bf16_f32 v17, v26, v27
v_lshlrev_b32 v24, 16, v18
v_mfma_f32_16x16x32_bf16 v[236:239], a[192:195], a[140:143], v[236:239]
ds_read_b128 a[140:143], v2 offset:3072
v_and_b32 v25, s33, v18
v_mfma_f32_16x16x32_bf16 v[236:239], a[160:163], a[108:111], v[236:239]
ds_read_b128 a[108:111], v1 offset:3072
v_lshlrev_b32 v26, 16, v19
v_mfma_f32_16x16x32_bf16 v[240:243], a[160:163], a[112:115], v[240:243]
v_and_b32 v27, s33, v19
v_mul_f32 v24, v24, v192
v_mfma_f32_16x16x32_bf16 v[240:243], a[192:195], a[144:147], v[240:243]
v_mul_f32 v25, v25, v193
v_mul_f32 v26, v26, v194
v_mfma_f32_16x16x32_bf16 a[240:243], a[196:199], a[144:147], a[240:243]
ds_read_b128 a[144:147], v2 offset:4096
v_mul_f32 v27, v27, v195
v_mfma_f32_16x16x32_bf16 a[240:243], a[164:167], a[112:115], a[240:243]
ds_read_b128 a[112:115], v1 offset:4096
v_cvt_pk_bf16_f32 v18, v24, v25
v_mfma_f32_16x16x32_bf16 a[244:247], a[164:167], a[116:119], a[244:247]
v_cvt_pk_bf16_f32 v19, v26, v27
ds_write_b128 v7, v[16:19] offset:0
v_mfma_f32_16x16x32_bf16 a[244:247], a[196:199], a[148:151], a[244:247]
buffer_store_dwordx4 v[16:19], v7, s[20:23], s52 offen offset:0 sc1
v_accvgpr_read_b32 v20, a68
v_mfma_f32_16x16x32_bf16 v[244:247], a[192:195], a[148:151], v[244:247]
ds_read_b128 a[148:151], v2 offset:5120
v_accvgpr_read_b32 v21, a69
v_mfma_f32_16x16x32_bf16 v[244:247], a[160:163], a[116:119], v[244:247]
ds_read_b128 a[116:119], v1 offset:5120
v_accvgpr_read_b32 v22, a70
v_mfma_f32_16x16x32_bf16 v[248:251], a[160:163], a[120:123], v[248:251]
v_accvgpr_read_b32 v23, a71
v_lshlrev_b32 v24, 16, v20
v_mfma_f32_16x16x32_bf16 v[248:251], a[192:195], a[152:155], v[248:251]
v_and_b32 v25, s33, v20
v_lshlrev_b32 v26, 16, v21
v_mfma_f32_16x16x32_bf16 a[248:251], a[196:199], a[152:155], a[248:251]
ds_read_b128 a[152:155], v2 offset:6144
v_and_b32 v27, s33, v21
v_mfma_f32_16x16x32_bf16 a[248:251], a[164:167], a[120:123], a[248:251]
ds_read_b128 a[120:123], v1 offset:6144
v_mul_f32 v24, v24, v164
v_mfma_f32_16x16x32_bf16 a[252:255], a[164:167], a[124:127], a[252:255]
buffer_load_dwordx4 a[164:167], v0, s[20:23], s30 offen offset:0 sc1
v_mul_f32 v25, v25, v165
v_mfma_f32_16x16x32_bf16 a[252:255], a[196:199], a[156:159], a[252:255]
buffer_load_dwordx4 a[196:199], v0, s[20:23], s30 offen offset:1024 sc1
v_mul_f32 v26, v26, v166
v_mfma_f32_16x16x32_bf16 v[252:255], a[192:195], a[156:159], v[252:255]
buffer_load_dwordx4 a[192:195], v0, s[20:23], s30 offen offset:2048 sc1
ds_read_b128 a[156:159], v2 offset:7168
v_mfma_f32_16x16x32_bf16 v[252:255], a[160:163], a[124:127], v[252:255]
buffer_load_dwordx4 a[160:163], v0, s[20:23], s30 offen offset:3072 sc1
s_add_u32 s30, s30, 0x3000
ds_read_b128 a[124:127], v1 offset:7168
L_q8:
s_waitcnt vmcnt(17) lgkmcnt(15)
v_mfma_f32_16x16x32_bf16 v[32:35], a[168:171], a[96:99], v[32:35]
v_mul_f32 v27, v27, v167
v_mfma_f32_16x16x32_bf16 v[32:35], a[200:203], a[128:131], v[32:35]
v_cvt_pk_bf16_f32 v20, v24, v25
v_cvt_pk_bf16_f32 v21, v26, v27
v_mfma_f32_16x16x32_bf16 v[64:67], a[204:207], a[128:131], v[64:67]
v_lshlrev_b32 v24, 16, v22
v_and_b32 v25, s33, v22
v_mfma_f32_16x16x32_bf16 v[64:67], a[172:175], a[96:99], v[64:67]
v_lshlrev_b32 v26, 16, v23
v_and_b32 v27, s33, v23
s_waitcnt lgkmcnt(13)
v_mfma_f32_16x16x32_bf16 v[68:71], a[172:175], a[100:103], v[68:71]
v_mul_f32 v24, v24, v196
v_mfma_f32_16x16x32_bf16 v[68:71], a[204:207], a[132:135], v[68:71]
v_mul_f32 v25, v25, v197
v_mul_f32 v26, v26, v198
v_mfma_f32_16x16x32_bf16 v[36:39], a[200:203], a[132:135], v[36:39]
v_mul_f32 v27, v27, v199
v_cvt_pk_bf16_f32 v22, v24, v25
v_mfma_f32_16x16x32_bf16 v[36:39], a[168:171], a[100:103], v[36:39]
v_cvt_pk_bf16_f32 v23, v26, v27
ds_write_b128 v7, v[20:23] offset:1024
s_waitcnt lgkmcnt(12)
v_mfma_f32_16x16x32_bf16 v[40:43], a[168:171], a[104:107], v[40:43]
buffer_store_dwordx4 v[20:23], v7, s[20:23], s52 offen offset:1024 sc1
v_mfma_f32_16x16x32_bf16 v[40:43], a[200:203], a[136:139], v[40:43]
v_accvgpr_read_b32 v12, a72
v_accvgpr_read_b32 v13, a73
v_mfma_f32_16x16x32_bf16 v[72:75], a[204:207], a[136:139], v[72:75]
v_accvgpr_read_b32 v14, a74
v_accvgpr_read_b32 v15, a75
v_mfma_f32_16x16x32_bf16 v[72:75], a[172:175], a[104:107], v[72:75]
v_lshlrev_b32 v24, 16, v12
v_and_b32 v25, s33, v12
s_waitcnt lgkmcnt(10)
v_mfma_f32_16x16x32_bf16 v[76:79], a[172:175], a[108:111], v[76:79]
v_lshlrev_b32 v26, 16, v13
v_mfma_f32_16x16x32_bf16 v[76:79], a[204:207], a[140:143], v[76:79]
v_and_b32 v27, s33, v13
v_mul_f32 v24, v24, v168
v_mfma_f32_16x16x32_bf16 v[44:47], a[200:203], a[140:143], v[44:47]
v_mul_f32 v25, v25, v169
v_mul_f32 v26, v26, v170
v_mfma_f32_16x16x32_bf16 v[44:47], a[168:171], a[108:111], v[44:47]
v_mul_f32 v27, v27, v171
v_cvt_pk_bf16_f32 v12, v24, v25
s_waitcnt lgkmcnt(8)
v_mfma_f32_16x16x32_bf16 v[48:51], a[168:171], a[112:115], v[48:51]
v_cvt_pk_bf16_f32 v13, v26, v27
v_mfma_f32_16x16x32_bf16 v[48:51], a[200:203], a[144:147], v[48:51]
v_lshlrev_b32 v24, 16, v14
v_and_b32 v25, s33, v14
v_mfma_f32_16x16x32_bf16 v[80:83], a[204:207], a[144:147], v[80:83]
v_lshlrev_b32 v26, 16, v15
v_and_b32 v27, s33, v15
v_mfma_f32_16x16x32_bf16 v[80:83], a[172:175], a[112:115], v[80:83]
v_mul_f32 v24, v24, v200
v_mul_f32 v25, v25, v201
s_waitcnt lgkmcnt(5)
v_mfma_f32_16x16x32_bf16 v[84:87], a[172:175], a[116:119], v[84:87]
v_mul_f32 v26, v26, v202
v_mfma_f32_16x16x32_bf16 v[84:87], a[204:207], a[148:151], v[84:87]
v_mul_f32 v27, v27, v203
v_cvt_pk_bf16_f32 v14, v24, v25
v_mfma_f32_16x16x32_bf16 v[52:55], a[200:203], a[148:151], v[52:55]
v_cvt_pk_bf16_f32 v15, v26, v27
ds_write_b128 v7, v[12:15] offset:2048
v_mfma_f32_16x16x32_bf16 v[52:55], a[168:171], a[116:119], v[52:55]
buffer_store_dwordx4 v[12:15], v7, s[20:23], s52 offen offset:2048 sc1
v_accvgpr_read_b32 v16, a76
s_waitcnt lgkmcnt(4)
v_mfma_f32_16x16x32_bf16 v[56:59], a[168:171], a[120:123], v[56:59]
v_accvgpr_read_b32 v17, a77
v_mfma_f32_16x16x32_bf16 v[56:59], a[200:203], a[152:155], v[56:59]
v_accvgpr_read_b32 v18, a78
v_accvgpr_read_b32 v19, a79
v_mfma_f32_16x16x32_bf16 v[88:91], a[204:207], a[152:155], v[88:91]
v_lshlrev_b32 v24, 16, v16
v_and_b32 v25, s33, v16
v_mfma_f32_16x16x32_bf16 v[88:91], a[172:175], a[120:123], v[88:91]
v_lshlrev_b32 v26, 16, v17
v_and_b32 v27, s33, v17
s_waitcnt lgkmcnt(2)
v_mfma_f32_16x16x32_bf16 v[92:95], a[172:175], a[124:127], v[92:95]
buffer_load_dwordx4 a[172:175], v0, s[20:23], s30 offen offset:0 sc1
v_mfma_f32_16x16x32_bf16 v[92:95], a[204:207], a[156:159], v[92:95]
buffer_load_dwordx4 a[204:207], v0, s[20:23], s30 offen offset:1024 sc1
v_mul_f32 v24, v24, v172
v_mfma_f32_16x16x32_bf16 v[60:63], a[200:203], a[156:159], v[60:63]
buffer_load_dwordx4 a[200:203], v0, s[20:23], s30 offen offset:2048 sc1
v_mul_f32 v25, v25, v173
v_mfma_f32_16x16x32_bf16 v[60:63], a[168:171], a[124:127], v[60:63]
buffer_load_dwordx4 a[168:171], v0, s[20:23], s30 offen offset:3072 sc1
s_add_u32 s30, s30, 0x1000
s_waitcnt vmcnt(18)
v_mfma_f32_16x16x32_bf16 v[96:99], a[212:215], a[96:99], v[96:99]
v_mul_f32 v26, v26, v174
s_add_u32 s96, s92, L_q10-L_pc
s_addc_u32 s97, s93, 0
s_load_dword s98, s[96:97], 0
v_mfma_f32_16x16x32_bf16 v[96:99], a[180:183], a[128:131], v[96:99]
v_mfma_f32_16x16x32_bf16 v[128:131], a[208:211], a[128:131], v[128:131]
v_xor_b32 v4, 0x6000, v6
ds_read_b128 a[128:131], v4 offset:0
v_mfma_f32_16x16x32_bf16 v[128:131], a[176:179], a[96:99], v[128:131]
v_xor_b32 v3, 0x4000, v6
ds_read_b128 a[96:99], v3 offset:0
v_mfma_f32_16x16x32_bf16 v[132:135], a[176:179], a[100:103], v[132:135]
v_mul_f32 v27, v27, v175
v_cvt_pk_bf16_f32 v16, v24, v25
v_mfma_f32_16x16x32_bf16 v[132:135], a[208:211], a[132:135], v[132:135]
v_cvt_pk_bf16_f32 v17, v26, v27
v_lshlrev_b32 v24, 16, v18
v_mfma_f32_16x16x32_bf16 v[100:103], a[180:183], a[132:135], v[100:103]
ds_read_b128 a[132:135], v4 offset:1024
v_and_b32 v25, s33, v18
v_mfma_f32_16x16x32_bf16 v[100:103], a[212:215], a[100:103], v[100:103]
ds_read_b128 a[100:103], v3 offset:1024
v_lshlrev_b32 v26, 16, v19
v_mfma_f32_16x16x32_bf16 v[104:107], a[212:215], a[104:107], v[104:107]
v_and_b32 v27, s33, v19
v_mul_f32 v24, v24, v204
v_mfma_f32_16x16x32_bf16 v[104:107], a[180:183], a[136:139], v[104:107]
v_mul_f32 v25, v25, v205
v_mul_f32 v26, v26, v206
v_mfma_f32_16x16x32_bf16 v[136:139], a[208:211], a[136:139], v[136:139]
ds_read_b128 a[136:139], v4 offset:2048
v_mul_f32 v27, v27, v207
v_mfma_f32_16x16x32_bf16 v[136:139], a[176:179], a[104:107], v[136:139]
ds_read_b128 a[104:107], v3 offset:2048
v_cvt_pk_bf16_f32 v18, v24, v25
v_mfma_f32_16x16x32_bf16 v[140:143], a[176:179], a[108:111], v[140:143]
v_cvt_pk_bf16_f32 v19, v26, v27
ds_write_b128 v7, v[16:19] offset:3072
v_mfma_f32_16x16x32_bf16 v[140:143], a[208:211], a[140:143], v[140:143]
buffer_store_dwordx4 v[16:19], v7, s[20:23], s52 offen offset:3072 sc1
v_accvgpr_read_b32 v20, a80
v_mfma_f32_16x16x32_bf16 v[108:111], a[180:183], a[140:143], v[108:111]
ds_read_b128 a[140:143], v4 offset:3072
v_accvgpr_read_b32 v21, a81
v_mfma_f32_16x16x32_bf16 v[108:111], a[212:215], a[108:111], v[108:111]
ds_read_b128 a[108:111], v3 offset:3072
v_accvgpr_read_b32 v22, a82
v_mfma_f32_16x16x32_bf16 v[112:115], a[212:215], a[112:115], v[112:115]
v_accvgpr_read_b32 v23, a83
v_lshlrev_b32 v24, 16, v20
v_mfma_f32_16x16x32_bf16 v[112:115], a[180:183], a[144:147], v[112:115]
v_and_b32 v25, s33, v20
v_lshlrev_b32 v26, 16, v21
v_mfma_f32_16x16x32_bf16 v[144:147], a[208:211], a[144:147], v[144:147]
ds_read_b128 a[144:147], v4 offset:4096
v_and_b32 v27, s33, v21
v_mfma_f32_16x16x32_bf16 v[144:147], a[176:179], a[112:115], v[144:147]
ds_read_b128 a[112:115], v3 offset:4096
v_mul_f32 v24, v24, v176
v_mfma_f32_16x16x32_bf16 v[148:151], a[176:179], a[116:119], v[148:151]
v_mul_f32 v25, v25, v177
v_mul_f32 v26, v26, v178
v_mfma_f32_16x16x32_bf16 v[148:151], a[208:211], a[148:151], v[148:151]
v_mul_f32 v27, v27, v179
v_cvt_pk_bf16_f32 v20, v24, v25
v_mfma_f32_16x16x32_bf16 v[116:119], a[180:183], a[148:151], v[116:119]
ds_read_b128 a[148:151], v4 offset:5120
v_cvt_pk_bf16_f32 v21, v26, v27
v_mfma_f32_16x16x32_bf16 v[116:119], a[212:215], a[116:119], v[116:119]
ds_read_b128 a[116:119], v3 offset:5120
v_lshlrev_b32 v24, 16, v22
v_mfma_f32_16x16x32_bf16 v[120:123], a[212:215], a[120:123], v[120:123]
v_and_b32 v25, s33, v22
v_lshlrev_b32 v26, 16, v23
v_mfma_f32_16x16x32_bf16 v[120:123], a[180:183], a[152:155], v[120:123]
v_and_b32 v27, s33, v23
v_mul_f32 v24, v24, v208
v_mfma_f32_16x16x32_bf16 v[152:155], a[208:211], a[152:155], v[152:155]
ds_read_b128 a[152:155], v4 offset:6144
v_mul_f32 v25, v25, v209
v_mfma_f32_16x16x32_bf16 v[152:155], a[176:179], a[120:123], v[152:155]
ds_read_b128 a[120:123], v3 offset:6144
v_mul_f32 v26, v26, v210
v_mfma_f32_16x16x32_bf16 v[156:159], a[176:179], a[124:127], v[156:159]
buffer_load_dwordx4 a[176:179], v0, s[20:23], s30 offen offset:0 sc1
v_mul_f32 v27, v27, v211
v_mfma_f32_16x16x32_bf16 v[156:159], a[208:211], a[156:159], v[156:159]
buffer_load_dwordx4 a[208:211], v0, s[20:23], s30 offen offset:1024 sc1
v_cvt_pk_bf16_f32 v22, v24, v25
v_mfma_f32_16x16x32_bf16 v[124:127], a[180:183], a[156:159], v[124:127]
buffer_load_dwordx4 a[180:183], v0, s[20:23], s30 offen offset:2048 sc1
ds_read_b128 a[156:159], v4 offset:7168
v_mfma_f32_16x16x32_bf16 v[124:127], a[212:215], a[124:127], v[124:127]
buffer_load_dwordx4 a[212:215], v0, s[20:23], s30 offen offset:3072 sc1
s_add_u32 s30, s30, 0x3000
ds_read_b128 a[124:127], v3 offset:7168
s_waitcnt vmcnt(17) lgkmcnt(15)
v_mfma_f32_16x16x32_bf16 v[32:35], a[220:223], a[96:99], v[32:35]
v_cvt_pk_bf16_f32 v23, v26, v27
v_mfma_f32_16x16x32_bf16 v[32:35], a[188:191], a[128:131], v[32:35]
ds_write_b128 v7, v[20:23] offset:4096
buffer_store_dwordx4 v[20:23], v7, s[20:23], s53 offen offset:0 sc1
v_mfma_f32_16x16x32_bf16 v[64:67], a[216:219], a[128:131], v[64:67]
v_accvgpr_read_b32 v12, a84
v_accvgpr_read_b32 v13, a85
v_mfma_f32_16x16x32_bf16 v[64:67], a[184:187], a[96:99], v[64:67]
v_accvgpr_read_b32 v14, a86
v_accvgpr_read_b32 v15, a87
s_waitcnt lgkmcnt(14)
v_mfma_f32_16x16x32_bf16 v[68:71], a[184:187], a[100:103], v[68:71]
v_lshlrev_b32 v24, 16, v12
v_mfma_f32_16x16x32_bf16 v[68:71], a[216:219], a[132:135], v[68:71]
v_and_b32 v25, s33, v12
v_lshlrev_b32 v26, 16, v13
v_mfma_f32_16x16x32_bf16 v[36:39], a[188:191], a[132:135], v[36:39]
v_and_b32 v27, s33, v13
v_mul_f32 v24, v24, v180
v_mfma_f32_16x16x32_bf16 v[36:39], a[220:223], a[100:103], v[36:39]
v_mul_f32 v25, v25, v181
v_mul_f32 v26, v26, v182
s_waitcnt lgkmcnt(12)
v_mfma_f32_16x16x32_bf16 v[40:43], a[220:223], a[104:107], v[40:43]
v_mul_f32 v27, v27, v183
v_mfma_f32_16x16x32_bf16 v[40:43], a[188:191], a[136:139], v[40:43]
v_cvt_pk_bf16_f32 v12, v24, v25
v_cvt_pk_bf16_f32 v13, v26, v27
v_mfma_f32_16x16x32_bf16 v[72:75], a[216:219], a[136:139], v[72:75]
v_lshlrev_b32 v24, 16, v14
v_and_b32 v25, s33, v14
v_mfma_f32_16x16x32_bf16 v[72:75], a[184:187], a[104:107], v[72:75]
v_lshlrev_b32 v26, 16, v15
v_and_b32 v27, s33, v15
s_waitcnt lgkmcnt(9)
v_mfma_f32_16x16x32_bf16 v[76:79], a[184:187], a[108:111], v[76:79]
v_mul_f32 v24, v24, v212
v_mfma_f32_16x16x32_bf16 v[76:79], a[216:219], a[140:143], v[76:79]
v_mul_f32 v25, v25, v213
v_mul_f32 v26, v26, v214
v_mfma_f32_16x16x32_bf16 v[44:47], a[188:191], a[140:143], v[44:47]
v_mul_f32 v27, v27, v215
v_cvt_pk_bf16_f32 v14, v24, v25
v_mfma_f32_16x16x32_bf16 v[44:47], a[220:223], a[108:111], v[44:47]
v_cvt_pk_bf16_f32 v15, v26, v27
ds_write_b128 v7, v[12:15] offset:5120
s_waitcnt lgkmcnt(8)
v_mfma_f32_16x16x32_bf16 v[48:51], a[220:223], a[112:115], v[48:51]
buffer_store_dwordx4 v[12:15], v7, s[20:23], s53 offen offset:1024 sc1
v_mfma_f32_16x16x32_bf16 v[48:51], a[188:191], a[144:147], v[48:51]
v_accvgpr_read_b32 v16, a88
v_accvgpr_read_b32 v17, a89
v_mfma_f32_16x16x32_bf16 v[80:83], a[216:219], a[144:147], v[80:83]
v_accvgpr_read_b32 v18, a90
v_accvgpr_read_b32 v19, a91
v_mfma_f32_16x16x32_bf16 v[80:83], a[184:187], a[112:115], v[80:83]
v_lshlrev_b32 v24, 16, v16
v_and_b32 v25, s33, v16
s_waitcnt lgkmcnt(6)
v_mfma_f32_16x16x32_bf16 v[84:87], a[184:187], a[116:119], v[84:87]
v_lshlrev_b32 v26, 16, v17
v_mfma_f32_16x16x32_bf16 v[84:87], a[216:219], a[148:151], v[84:87]
v_and_b32 v27, s33, v17
ds_read_b128 v[12:15], v8 offset:0
v_mfma_f32_16x16x32_bf16 v[52:55], a[188:191], a[148:151], v[52:55]
v_mul_f32 v24, v24, v184
v_mul_f32 v25, v25, v185
v_mfma_f32_16x16x32_bf16 v[52:55], a[220:223], a[116:119], v[52:55]
v_mul_f32 v26, v26, v186
v_mul_f32 v27, v27, v187
s_waitcnt lgkmcnt(5)
v_mfma_f32_16x16x32_bf16 v[56:59], a[220:223], a[120:123], v[56:59]
v_cvt_pk_bf16_f32 v16, v24, v25
v_mfma_f32_16x16x32_bf16 v[56:59], a[188:191], a[152:155], v[56:59]
v_cvt_pk_bf16_f32 v17, v26, v27
v_lshlrev_b32 v24, 16, v18
v_mfma_f32_16x16x32_bf16 v[88:91], a[216:219], a[152:155], v[88:91]
v_and_b32 v25, s33, v18
v_lshlrev_b32 v26, 16, v19
v_mfma_f32_16x16x32_bf16 v[88:91], a[184:187], a[120:123], v[88:91]
v_and_b32 v27, s33, v19
v_mul_f32 v24, v24, v216
s_waitcnt lgkmcnt(3)
v_mfma_f32_16x16x32_bf16 v[92:95], a[184:187], a[124:127], v[92:95]
buffer_load_dwordx4 a[184:187], v0, s[20:23], s30 offen offset:0 sc1
v_mfma_f32_16x16x32_bf16 v[92:95], a[216:219], a[156:159], v[92:95]
buffer_load_dwordx4 a[216:219], v0, s[20:23], s30 offen offset:1024 sc1
v_mul_f32 v25, v25, v217
v_mfma_f32_16x16x32_bf16 v[60:63], a[188:191], a[156:159], v[60:63]
buffer_load_dwordx4 a[188:191], v0, s[20:23], s30 offen offset:2048 sc1
v_mul_f32 v26, v26, v218
v_mfma_f32_16x16x32_bf16 v[60:63], a[220:223], a[124:127], v[60:63]
buffer_load_dwordx4 a[220:223], v0, s[20:23], s30 offen offset:3072 sc1
s_add_u32 s30, s30, 0x1000
s_barrier
s_waitcnt vmcnt(17)
v_mfma_f32_16x16x32_bf16 v[96:99], a[164:167], a[96:99], v[96:99]
v_mfma_f32_16x16x32_bf16 v[96:99], a[196:199], a[128:131], v[96:99]
v_mul_f32 v27, v27, v219
v_cvt_pk_bf16_f32 v18, v24, v25
v_mfma_f32_16x16x32_bf16 v[128:131], a[160:163], a[128:131], v[128:131]
ds_read_b128 a[128:131], v2 offset:32768
v_cvt_pk_bf16_f32 v19, v26, v27
v_mfma_f32_16x16x32_bf16 v[128:131], a[192:195], a[96:99], v[128:131]
ds_read_b128 a[96:99], v1 offset:32768
ds_write_b128 v7, v[16:19] offset:6144
v_mfma_f32_16x16x32_bf16 v[132:135], a[192:195], a[100:103], v[132:135]
buffer_store_dwordx4 v[16:19], v7, s[20:23], s53 offen offset:2048 sc1
v_accvgpr_read_b32 v20, a92
v_mfma_f32_16x16x32_bf16 v[132:135], a[160:163], a[132:135], v[132:135]
v_accvgpr_read_b32 v21, a93
v_accvgpr_read_b32 v22, a94
v_mfma_f32_16x16x32_bf16 v[100:103], a[196:199], a[132:135], v[100:103]
ds_read_b128 a[132:135], v2 offset:33792
v_accvgpr_read_b32 v23, a95
v_mfma_f32_16x16x32_bf16 v[100:103], a[164:167], a[100:103], v[100:103]
ds_read_b128 a[100:103], v1 offset:33792
v_lshlrev_b32 v24, 16, v20
v_mfma_f32_16x16x32_bf16 v[104:107], a[164:167], a[104:107], v[104:107]
v_and_b32 v25, s33, v20
v_lshlrev_b32 v26, 16, v21
v_mfma_f32_16x16x32_bf16 v[104:107], a[196:199], a[136:139], v[104:107]
v_and_b32 v27, s33, v21
ds_read_b128 v[16:19], v8 offset:1024
v_mfma_f32_16x16x32_bf16 v[136:139], a[160:163], a[136:139], v[136:139]
ds_read_b128 a[136:139], v2 offset:34816
v_mul_f32 v24, v24, v188
v_mfma_f32_16x16x32_bf16 v[136:139], a[192:195], a[104:107], v[136:139]
ds_read_b128 a[104:107], v1 offset:34816
v_mul_f32 v25, v25, v189
v_mfma_f32_16x16x32_bf16 v[140:143], a[192:195], a[108:111], v[140:143]
v_mul_f32 v26, v26, v190
v_mul_f32 v27, v27, v191
v_mfma_f32_16x16x32_bf16 v[140:143], a[160:163], a[140:143], v[140:143]
v_cvt_pk_bf16_f32 v20, v24, v25
v_cvt_pk_bf16_f32 v21, v26, v27
v_mfma_f32_16x16x32_bf16 v[108:111], a[196:199], a[140:143], v[108:111]
ds_read_b128 a[140:143], v2 offset:35840
v_lshlrev_b32 v24, 16, v22
v_mfma_f32_16x16x32_bf16 v[108:111], a[164:167], a[108:111], v[108:111]
ds_read_b128 a[108:111], v1 offset:35840
v_and_b32 v25, s33, v22
v_mfma_f32_16x16x32_bf16 v[112:115], a[164:167], a[112:115], v[112:115]
v_lshlrev_b32 v26, 16, v23
v_and_b32 v27, s33, v23
v_mfma_f32_16x16x32_bf16 v[112:115], a[196:199], a[144:147], v[112:115]
v_mul_f32 v24, v24, v220
v_mul_f32 v25, v25, v221
v_mfma_f32_16x16x32_bf16 v[144:147], a[160:163], a[144:147], v[144:147]
ds_read_b128 a[144:147], v2 offset:36864
v_mul_f32 v26, v26, v222
v_mfma_f32_16x16x32_bf16 v[144:147], a[192:195], a[112:115], v[144:147]
ds_read_b128 a[112:115], v1 offset:36864
v_mul_f32 v27, v27, v223
v_mfma_f32_16x16x32_bf16 v[148:151], a[192:195], a[116:119], v[148:151]
v_cvt_pk_bf16_f32 v22, v24, v25
v_cvt_pk_bf16_f32 v23, v26, v27
v_mfma_f32_16x16x32_bf16 v[148:151], a[160:163], a[148:151], v[148:151]
ds_write_b128 v7, v[20:23] offset:7168
buffer_store_dwordx4 v[20:23], v7, s[20:23], s53 offen offset:3072 sc1
v_mfma_f32_16x16x32_bf16 v[116:119], a[196:199], a[148:151], v[116:119]
ds_read_b128 a[148:151], v2 offset:37888
s_waitcnt lgkmcnt(14)
v_lshlrev_b32 v24, 16, v12
v_mfma_f32_16x16x32_bf16 v[116:119], a[164:167], a[116:119], v[116:119]
ds_read_b128 a[116:119], v1 offset:37888
v_and_b32 v25, s33, v12
v_mfma_f32_16x16x32_bf16 v[120:123], a[164:167], a[120:123], v[120:123]
v_lshlrev_b32 v26, 16, v13
v_and_b32 v27, s33, v13
v_mfma_f32_16x16x32_bf16 v[120:123], a[196:199], a[152:155], v[120:123]
ds_read_b128 v[20:23], v8 offset:2048
v_mul_f32 v24, v24, v224
v_mfma_f32_16x16x32_bf16 v[152:155], a[160:163], a[152:155], v[152:155]
ds_read_b128 a[152:155], v2 offset:38912
v_mul_f32 v25, v25, v225
v_mfma_f32_16x16x32_bf16 v[152:155], a[192:195], a[120:123], v[152:155]
ds_read_b128 a[120:123], v1 offset:38912
v_mul_f32 v26, v26, v226
v_mfma_f32_16x16x32_bf16 v[156:159], a[192:195], a[124:127], v[156:159]
buffer_load_dwordx4 a[192:195], v0, s[20:23], s30 offen offset:0 sc1
v_mul_f32 v27, v27, v227
v_mfma_f32_16x16x32_bf16 v[156:159], a[160:163], a[156:159], v[156:159]
buffer_load_dwordx4 a[160:163], v0, s[20:23], s30 offen offset:1024 sc1
v_cvt_pk_bf16_f32 v12, v24, v25
v_mfma_f32_16x16x32_bf16 v[124:127], a[196:199], a[156:159], v[124:127]
buffer_load_dwordx4 a[196:199], v0, s[20:23], s30 offen offset:2048 sc1
ds_read_b128 a[156:159], v2 offset:39936
v_mfma_f32_16x16x32_bf16 v[124:127], a[164:167], a[124:127], v[124:127]
buffer_load_dwordx4 a[164:167], v0, s[20:23], s30 offen offset:3072 sc1
s_add_u32 s30, s30, 0xffff5000
ds_read_b128 a[124:127], v1 offset:39936
s_waitcnt vmcnt(17) lgkmcnt(15)
v_mfma_f32_16x16x32_bf16 v[32:35], a[172:175], a[96:99], v[32:35]
v_cvt_pk_bf16_f32 v13, v26, v27
v_mfma_f32_16x16x32_bf16 v[32:35], a[204:207], a[128:131], v[32:35]
v_lshlrev_b32 v24, 16, v14
v_and_b32 v25, s33, v14
v_mfma_f32_16x16x32_bf16 v[64:67], a[168:171], a[128:131], v[64:67]
v_lshlrev_b32 v26, 16, v15
v_and_b32 v27, s33, v15
v_mfma_f32_16x16x32_bf16 v[64:67], a[200:203], a[96:99], v[64:67]
v_accvgpr_read_b32 v28, a224
v_mul_f32 v24, v24, v28
v_mfma_f32_16x16x32_bf16 v[68:71], a[200:203], a[100:103], v[68:71]
v_accvgpr_read_b32 v29, a225
v_mul_f32 v25, v25, v29
v_mfma_f32_16x16x32_bf16 v[68:71], a[168:171], a[132:135], v[68:71]
v_accvgpr_read_b32 v30, a226
v_mul_f32 v26, v26, v30
v_mfma_f32_16x16x32_bf16 v[36:39], a[204:207], a[132:135], v[36:39]
v_accvgpr_read_b32 v31, a227
v_mul_f32 v27, v27, v31
v_mfma_f32_16x16x32_bf16 v[36:39], a[172:175], a[100:103], v[36:39]
v_cvt_pk_bf16_f32 v14, v24, v25
v_cvt_pk_bf16_f32 v15, v26, v27
s_waitcnt lgkmcnt(12)
v_mfma_f32_16x16x32_bf16 v[40:43], a[172:175], a[104:107], v[40:43]
ds_write_b128 v7, v[12:15] offset:32768
v_mfma_f32_16x16x32_bf16 v[40:43], a[204:207], a[136:139], v[40:43]
buffer_store_dwordx4 v[12:15], v7, s[20:23], s54 offen offset:0 sc1
v_lshlrev_b32 v24, 16, v16
v_mfma_f32_16x16x32_bf16 v[72:75], a[168:171], a[136:139], v[72:75]
v_and_b32 v25, s33, v16
v_lshlrev_b32 v26, 16, v17
v_mfma_f32_16x16x32_bf16 v[72:75], a[200:203], a[104:107], v[72:75]
v_and_b32 v27, s33, v17
ds_read_b128 v[12:15], v8 offset:3072
s_waitcnt lgkmcnt(12)
v_mfma_f32_16x16x32_bf16 v[76:79], a[200:203], a[108:111], v[76:79]
v_mul_f32 v24, v24, v228
v_mfma_f32_16x16x32_bf16 v[76:79], a[168:171], a[140:143], v[76:79]
v_mul_f32 v25, v25, v229
v_mul_f32 v26, v26, v230
v_mfma_f32_16x16x32_bf16 v[44:47], a[204:207], a[140:143], v[44:47]
v_mul_f32 v27, v27, v231
v_cvt_pk_bf16_f32 v16, v24, v25
v_mfma_f32_16x16x32_bf16 v[44:47], a[172:175], a[108:111], v[44:47]
v_cvt_pk_bf16_f32 v17, v26, v27
v_lshlrev_b32 v24, 16, v18
s_waitcnt lgkmcnt(10)
v_mfma_f32_16x16x32_bf16 v[48:51], a[172:175], a[112:115], v[48:51]
v_and_b32 v25, s33, v18
v_mfma_f32_16x16x32_bf16 v[48:51], a[204:207], a[144:147], v[48:51]
v_lshlrev_b32 v26, 16, v19
v_and_b32 v27, s33, v19
v_mfma_f32_16x16x32_bf16 v[80:83], a[168:171], a[144:147], v[80:83]
v_accvgpr_read_b32 v28, a228
v_mul_f32 v24, v24, v28
v_mfma_f32_16x16x32_bf16 v[80:83], a[200:203], a[112:115], v[80:83]
v_accvgpr_read_b32 v29, a229
v_mul_f32 v25, v25, v29
s_waitcnt lgkmcnt(7)
v_mfma_f32_16x16x32_bf16 v[84:87], a[200:203], a[116:119], v[84:87]
v_accvgpr_read_b32 v30, a230
v_mfma_f32_16x16x32_bf16 v[84:87], a[168:171], a[148:151], v[84:87]
v_mul_f32 v26, v26, v30
v_accvgpr_read_b32 v31, a231
v_mfma_f32_16x16x32_bf16 v[52:55], a[204:207], a[148:151], v[52:55]
v_mul_f32 v27, v27, v31
v_cvt_pk_bf16_f32 v18, v24, v25
v_mfma_f32_16x16x32_bf16 v[52:55], a[172:175], a[116:119], v[52:55]
v_cvt_pk_bf16_f32 v19, v26, v27
ds_write_b128 v7, v[16:19] offset:33792
s_waitcnt lgkmcnt(5)
v_mfma_f32_16x16x32_bf16 v[56:59], a[172:175], a[120:123], v[56:59]
buffer_store_dwordx4 v[16:19], v7, s[20:23], s54 offen offset:1024 sc1
v_mfma_f32_16x16x32_bf16 v[56:59], a[204:207], a[152:155], v[56:59]
v_lshlrev_b32 v24, 16, v20
v_and_b32 v25, s33, v20
v_mfma_f32_16x16x32_bf16 v[88:91], a[168:171], a[152:155], v[88:91]
v_lshlrev_b32 v26, 16, v21
v_and_b32 v27, s33, v21
v_mfma_f32_16x16x32_bf16 v[88:91], a[200:203], a[120:123], v[88:91]
ds_read_b128 v[16:19], v8 offset:4096
v_mul_f32 v24, v24, v232
s_waitcnt lgkmcnt(4)
v_mfma_f32_16x16x32_bf16 v[92:95], a[200:203], a[124:127], v[92:95]
buffer_load_dwordx4 a[200:203], v0, s[20:23], s30 offen offset:0 sc1
v_mfma_f32_16x16x32_bf16 v[92:95], a[168:171], a[156:159], v[92:95]
buffer_load_dwordx4 a[168:171], v0, s[20:23], s30 offen offset:1024 sc1
v_mul_f32 v25, v25, v233
v_mfma_f32_16x16x32_bf16 v[60:63], a[204:207], a[156:159], v[60:63]
buffer_load_dwordx4 a[204:207], v0, s[20:23], s30 offen offset:2048 sc1
v_mul_f32 v26, v26, v234
v_mfma_f32_16x16x32_bf16 v[60:63], a[172:175], a[124:127], v[60:63]
buffer_load_dwordx4 a[172:175], v0, s[20:23], s30 offen offset:3072 sc1
s_add_u32 s30, s30, 0x1000
s_waitcnt vmcnt(18)
v_mfma_f32_16x16x32_bf16 v[96:99], a[176:179], a[96:99], v[96:99]
v_mul_f32 v27, v27, v235
v_mfma_f32_16x16x32_bf16 v[96:99], a[208:211], a[128:131], v[96:99]
v_cvt_pk_bf16_f32 v20, v24, v25
v_cvt_pk_bf16_f32 v21, v26, v27
v_mfma_f32_16x16x32_bf16 v[128:131], a[212:215], a[128:131], v[128:131]
ds_read_b128 a[128:131], v4 offset:32768
v_lshlrev_b32 v24, 16, v22
v_mfma_f32_16x16x32_bf16 v[128:131], a[180:183], a[96:99], v[128:131]
ds_read_b128 a[96:99], v3 offset:32768
v_and_b32 v25, s33, v22
v_mfma_f32_16x16x32_bf16 v[132:135], a[180:183], a[100:103], v[132:135]
v_lshlrev_b32 v26, 16, v23
v_and_b32 v27, s33, v23
v_mfma_f32_16x16x32_bf16 v[132:135], a[212:215], a[132:135], v[132:135]
v_accvgpr_read_b32 v28, a232
v_mul_f32 v24, v24, v28
v_mfma_f32_16x16x32_bf16 v[100:103], a[208:211], a[132:135], v[100:103]
ds_read_b128 a[132:135], v4 offset:33792
v_accvgpr_read_b32 v29, a233
v_mfma_f32_16x16x32_bf16 v[100:103], a[176:179], a[100:103], v[100:103]
ds_read_b128 a[100:103], v3 offset:33792
v_mul_f32 v25, v25, v29
v_mfma_f32_16x16x32_bf16 v[104:107], a[176:179], a[104:107], v[104:107]
v_accvgpr_read_b32 v30, a234
v_mul_f32 v26, v26, v30
v_mfma_f32_16x16x32_bf16 v[104:107], a[208:211], a[136:139], v[104:107]
v_accvgpr_read_b32 v31, a235
v_mul_f32 v27, v27, v31
v_mfma_f32_16x16x32_bf16 v[136:139], a[212:215], a[136:139], v[136:139]
ds_read_b128 a[136:139], v4 offset:34816
v_cvt_pk_bf16_f32 v22, v24, v25
v_mfma_f32_16x16x32_bf16 v[136:139], a[180:183], a[104:107], v[136:139]
ds_read_b128 a[104:107], v3 offset:34816
v_cvt_pk_bf16_f32 v23, v26, v27
v_mfma_f32_16x16x32_bf16 v[140:143], a[180:183], a[108:111], v[140:143]
ds_write_b128 v7, v[20:23] offset:34816
buffer_store_dwordx4 v[20:23], v7, s[20:23], s54 offen offset:2048 sc1
v_mfma_f32_16x16x32_bf16 v[140:143], a[212:215], a[140:143], v[140:143]
s_waitcnt lgkmcnt(9)
v_lshlrev_b32 v24, 16, v12
v_and_b32 v25, s33, v12
v_mfma_f32_16x16x32_bf16 v[108:111], a[208:211], a[140:143], v[108:111]
ds_read_b128 a[140:143], v4 offset:35840
v_lshlrev_b32 v26, 16, v13
v_mfma_f32_16x16x32_bf16 v[108:111], a[176:179], a[108:111], v[108:111]
ds_read_b128 a[108:111], v3 offset:35840
v_and_b32 v27, s33, v13
v_mfma_f32_16x16x32_bf16 v[112:115], a[176:179], a[112:115], v[112:115]
ds_read_b128 v[20:23], v8 offset:5120
v_mul_f32 v24, v24, v236
v_mfma_f32_16x16x32_bf16 v[112:115], a[208:211], a[144:147], v[112:115]
v_mul_f32 v25, v25, v237
v_mul_f32 v26, v26, v238
v_mfma_f32_16x16x32_bf16 v[144:147], a[212:215], a[144:147], v[144:147]
ds_read_b128 a[144:147], v4 offset:36864
v_mul_f32 v27, v27, v239
v_mfma_f32_16x16x32_bf16 v[144:147], a[180:183], a[112:115], v[144:147]
ds_read_b128 a[112:115], v3 offset:36864
v_cvt_pk_bf16_f32 v12, v24, v25
v_mfma_f32_16x16x32_bf16 v[148:151], a[180:183], a[116:119], v[148:151]
v_cvt_pk_bf16_f32 v13, v26, v27
v_lshlrev_b32 v24, 16, v14
v_mfma_f32_16x16x32_bf16 v[148:151], a[212:215], a[148:151], v[148:151]
v_and_b32 v25, s33, v14
v_lshlrev_b32 v26, 16, v15
v_mfma_f32_16x16x32_bf16 v[116:119], a[208:211], a[148:151], v[116:119]
ds_read_b128 a[148:151], v4 offset:37888
v_and_b32 v27, s33, v15
v_mfma_f32_16x16x32_bf16 v[116:119], a[176:179], a[116:119], v[116:119]
ds_read_b128 a[116:119], v3 offset:37888
v_accvgpr_read_b32 v28, a236
v_mfma_f32_16x16x32_bf16 v[120:123], a[176:179], a[120:123], v[120:123]
v_mul_f32 v24, v24, v28
v_accvgpr_read_b32 v29, a237
v_mfma_f32_16x16x32_bf16 v[120:123], a[208:211], a[152:155], v[120:123]
v_mul_f32 v25, v25, v29
v_accvgpr_read_b32 v30, a238
v_mfma_f32_16x16x32_bf16 v[152:155], a[212:215], a[152:155], v[152:155]
ds_read_b128 a[152:155], v4 offset:38912
v_mul_f32 v26, v26, v30
v_mfma_f32_16x16x32_bf16 v[152:155], a[180:183], a[120:123], v[152:155]
ds_read_b128 a[120:123], v3 offset:38912
v_accvgpr_read_b32 v31, a239
v_mfma_f32_16x16x32_bf16 v[156:159], a[180:183], a[124:127], v[156:159]
buffer_load_dwordx4 a[180:183], v0, s[20:23], s30 offen offset:0 sc1
v_mul_f32 v27, v27, v31
v_mfma_f32_16x16x32_bf16 v[156:159], a[212:215], a[156:159], v[156:159]
buffer_load_dwordx4 a[212:215], v0, s[20:23], s30 offen offset:1024 sc1
v_cvt_pk_bf16_f32 v14, v24, v25
v_mfma_f32_16x16x32_bf16 v[124:127], a[208:211], a[156:159], v[124:127]
buffer_load_dwordx4 a[208:211], v0, s[20:23], s30 offen offset:2048 sc1
ds_read_b128 a[156:159], v4 offset:39936
v_mfma_f32_16x16x32_bf16 v[124:127], a[176:179], a[124:127], v[124:127]
buffer_load_dwordx4 a[176:179], v0, s[20:23], s30 offen offset:3072 sc1
s_add_u32 s30, s30, 0x3000
ds_read_b128 a[124:127], v3 offset:39936
s_waitcnt vmcnt(17) lgkmcnt(15)
v_mfma_f32_16x16x32_bf16 v[32:35], a[184:187], a[96:99], v[32:35]
v_cvt_pk_bf16_f32 v15, v26, v27
v_mfma_f32_16x16x32_bf16 v[32:35], a[216:219], a[128:131], v[32:35]
ds_write_b128 v7, v[12:15] offset:35840
buffer_store_dwordx4 v[12:15], v7, s[20:23], s54 offen offset:3072 sc1
v_mfma_f32_16x16x32_bf16 v[64:67], a[220:223], a[128:131], v[64:67]
v_lshlrev_b32 v24, 16, v16
v_and_b32 v25, s33, v16
v_mfma_f32_16x16x32_bf16 v[64:67], a[188:191], a[96:99], v[64:67]
v_lshlrev_b32 v26, 16, v17
v_and_b32 v27, s33, v17
s_waitcnt lgkmcnt(15)
v_mfma_f32_16x16x32_bf16 v[68:71], a[188:191], a[100:103], v[68:71]
ds_read_b128 v[12:15], v8 offset:6144
v_mfma_f32_16x16x32_bf16 v[68:71], a[220:223], a[132:135], v[68:71]
v_mul_f32 v24, v24, v240
v_mul_f32 v25, v25, v241
v_mfma_f32_16x16x32_bf16 v[36:39], a[216:219], a[132:135], v[36:39]
v_mul_f32 v26, v26, v242
v_mul_f32 v27, v27, v243
v_mfma_f32_16x16x32_bf16 v[36:39], a[184:187], a[100:103], v[36:39]
v_cvt_pk_bf16_f32 v16, v24, v25
v_cvt_pk_bf16_f32 v17, v26, v27
s_waitcnt lgkmcnt(14)
v_mfma_f32_16x16x32_bf16 v[40:43], a[184:187], a[104:107], v[40:43]
v_lshlrev_b32 v24, 16, v18
v_mfma_f32_16x16x32_bf16 v[40:43], a[216:219], a[136:139], v[40:43]
v_and_b32 v25, s33, v18
v_lshlrev_b32 v26, 16, v19
v_mfma_f32_16x16x32_bf16 v[72:75], a[220:223], a[136:139], v[72:75]
v_and_b32 v27, s33, v19
v_accvgpr_read_b32 v28, a240
v_mfma_f32_16x16x32_bf16 v[72:75], a[188:191], a[104:107], v[72:75]
v_mul_f32 v24, v24, v28
v_accvgpr_read_b32 v29, a241
s_waitcnt lgkmcnt(11)
v_mfma_f32_16x16x32_bf16 v[76:79], a[188:191], a[108:111], v[76:79]
v_mul_f32 v25, v25, v29
v_mfma_f32_16x16x32_bf16 v[76:79], a[220:223], a[140:143], v[76:79]
v_accvgpr_read_b32 v30, a242
v_mul_f32 v26, v26, v30
v_mfma_f32_16x16x32_bf16 v[44:47], a[216:219], a[140:143], v[44:47]
v_accvgpr_read_b32 v31, a243
v_mul_f32 v27, v27, v31
v_mfma_f32_16x16x32_bf16 v[44:47], a[184:187], a[108:111], v[44:47]
v_cvt_pk_bf16_f32 v18, v24, v25
v_cvt_pk_bf16_f32 v19, v26, v27
s_waitcnt lgkmcnt(8)
v_mfma_f32_16x16x32_bf16 v[48:51], a[184:187], a[112:115], v[48:51]
ds_write_b128 v7, v[16:19] offset:36864
v_mfma_f32_16x16x32_bf16 v[48:51], a[216:219], a[144:147], v[48:51]
buffer_store_dwordx4 v[16:19], v7, s[20:23], s55 offen offset:0 sc1
v_lshlrev_b32 v24, 16, v20
v_mfma_f32_16x16x32_bf16 v[80:83], a[220:223], a[144:147], v[80:83]
v_and_b32 v25, s33, v20
v_lshlrev_b32 v26, 16, v21
v_mfma_f32_16x16x32_bf16 v[80:83], a[188:191], a[112:115], v[80:83]
v_and_b32 v27, s33, v21
ds_read_b128 v[16:19], v8 offset:7168
s_waitcnt lgkmcnt(8)
v_mfma_f32_16x16x32_bf16 v[84:87], a[188:191], a[116:119], v[84:87]
v_mul_f32 v24, v24, v244
v_mfma_f32_16x16x32_bf16 v[84:87], a[220:223], a[148:151], v[84:87]
v_mul_f32 v25, v25, v245
v_mul_f32 v26, v26, v246
v_mfma_f32_16x16x32_bf16 v[52:55], a[216:219], a[148:151], v[52:55]
v_mul_f32 v27, v27, v247
v_cvt_pk_bf16_f32 v20, v24, v25
v_mfma_f32_16x16x32_bf16 v[52:55], a[184:187], a[116:119], v[52:55]
v_cvt_pk_bf16_f32 v21, v26, v27
v_lshlrev_b32 v24, 16, v22
s_waitcnt lgkmcnt(6)
v_mfma_f32_16x16x32_bf16 v[56:59], a[184:187], a[120:123], v[56:59]
v_and_b32 v25, s33, v22
v_mfma_f32_16x16x32_bf16 v[56:59], a[216:219], a[152:155], v[56:59]
v_lshlrev_b32 v26, 16, v23
v_and_b32 v27, s33, v23
v_mfma_f32_16x16x32_bf16 v[88:91], a[220:223], a[152:155], v[88:91]
v_accvgpr_read_b32 v28, a244
v_mul_f32 v24, v24, v28
v_mfma_f32_16x16x32_bf16 v[88:91], a[188:191], a[120:123], v[88:91]
v_accvgpr_read_b32 v29, a245
v_mul_f32 v25, v25, v29
s_waitcnt lgkmcnt(4)
v_mfma_f32_16x16x32_bf16 v[92:95], a[188:191], a[124:127], v[92:95]
buffer_load_dwordx4 a[188:191], v0, s[20:23], s30 offen offset:0 sc1
v_mfma_f32_16x16x32_bf16 v[92:95], a[220:223], a[156:159], v[92:95]
buffer_load_dwordx4 a[220:223], v0, s[20:23], s30 offen offset:1024 sc1
v_accvgpr_read_b32 v30, a246
v_mfma_f32_16x16x32_bf16 v[60:63], a[216:219], a[156:159], v[60:63]
buffer_load_dwordx4 a[216:219], v0, s[20:23], s30 offen offset:2048 sc1
v_mul_f32 v26, v26, v30
v_mfma_f32_16x16x32_bf16 v[60:63], a[184:187], a[124:127], v[60:63]
buffer_load_dwordx4 a[184:187], v0, s[20:23], s30 offen offset:3072 sc1
s_add_u32 s30, s30, 0x1000
s_waitcnt vmcnt(17)
v_mfma_f32_16x16x32_bf16 v[96:99], a[192:195], a[96:99], v[96:99]
v_accvgpr_read_b32 v31, a247
v_mfma_f32_16x16x32_bf16 v[96:99], a[160:163], a[128:131], v[96:99]
v_mul_f32 v27, v27, v31
v_cvt_pk_bf16_f32 v22, v24, v25
v_mfma_f32_16x16x32_bf16 v[128:131], a[164:167], a[128:131], v[128:131]
ds_read_b128 a[128:131], v2 offset:0
v_cvt_pk_bf16_f32 v23, v26, v27
v_mfma_f32_16x16x32_bf16 v[128:131], a[196:199], a[96:99], v[128:131]
ds_read_b128 a[96:99], v1 offset:0
ds_write_b128 v7, v[20:23] offset:37888
v_mfma_f32_16x16x32_bf16 v[132:135], a[196:199], a[100:103], v[132:135]
buffer_store_dwordx4 v[20:23], v7, s[20:23], s55 offen offset:1024 sc1
s_waitcnt lgkmcnt(5)
v_lshlrev_b32 v24, 16, v12
v_mfma_f32_16x16x32_bf16 v[132:135], a[164:167], a[132:135], v[132:135]
v_and_b32 v25, s33, v12
v_lshlrev_b32 v26, 16, v13
v_mfma_f32_16x16x32_bf16 v[100:103], a[160:163], a[132:135], v[100:103]
ds_read_b128 a[132:135], v2 offset:1024
v_and_b32 v27, s33, v13
v_mfma_f32_16x16x32_bf16 v[100:103], a[192:195], a[100:103], v[100:103]
ds_read_b128 a[100:103], v1 offset:1024
v_mul_f32 v24, v24, v248
v_mfma_f32_16x16x32_bf16 v[104:107], a[192:195], a[104:107], v[104:107]
v_mul_f32 v25, v25, v249
v_mul_f32 v26, v26, v250
v_mfma_f32_16x16x32_bf16 v[104:107], a[160:163], a[136:139], v[104:107]
v_mul_f32 v27, v27, v251
v_cvt_pk_bf16_f32 v12, v24, v25
v_mfma_f32_16x16x32_bf16 v[136:139], a[164:167], a[136:139], v[136:139]
ds_read_b128 a[136:139], v2 offset:2048
v_cvt_pk_bf16_f32 v13, v26, v27
v_mfma_f32_16x16x32_bf16 v[136:139], a[196:199], a[104:107], v[136:139]
ds_read_b128 a[104:107], v1 offset:2048
v_lshlrev_b32 v24, 16, v14
v_mfma_f32_16x16x32_bf16 v[140:143], a[196:199], a[108:111], v[140:143]
v_and_b32 v25, s33, v14
v_lshlrev_b32 v26, 16, v15
v_mfma_f32_16x16x32_bf16 v[140:143], a[164:167], a[140:143], v[140:143]
v_and_b32 v27, s33, v15
v_accvgpr_read_b32 v28, a248
v_mfma_f32_16x16x32_bf16 v[108:111], a[160:163], a[140:143], v[108:111]
ds_read_b128 a[140:143], v2 offset:3072
v_mul_f32 v24, v24, v28
v_mfma_f32_16x16x32_bf16 v[108:111], a[192:195], a[108:111], v[108:111]
ds_read_b128 a[108:111], v1 offset:3072
v_accvgpr_read_b32 v29, a249
v_mfma_f32_16x16x32_bf16 v[112:115], a[192:195], a[112:115], v[112:115]
v_mul_f32 v25, v25, v29
v_accvgpr_read_b32 v30, a250
v_mfma_f32_16x16x32_bf16 v[112:115], a[160:163], a[144:147], v[112:115]
v_mul_f32 v26, v26, v30
v_accvgpr_read_b32 v31, a251
v_mfma_f32_16x16x32_bf16 v[144:147], a[164:167], a[144:147], v[144:147]
ds_read_b128 a[144:147], v2 offset:4096
v_mul_f32 v27, v27, v31
v_mfma_f32_16x16x32_bf16 v[144:147], a[196:199], a[112:115], v[144:147]
ds_read_b128 a[112:115], v1 offset:4096
v_cvt_pk_bf16_f32 v14, v24, v25
v_mfma_f32_16x16x32_bf16 v[148:151], a[196:199], a[116:119], v[148:151]
v_cvt_pk_bf16_f32 v15, v26, v27
ds_write_b128 v7, v[12:15] offset:38912
v_mfma_f32_16x16x32_bf16 v[148:151], a[164:167], a[148:151], v[148:151]
buffer_store_dwordx4 v[12:15], v7, s[20:23], s55 offen offset:2048 sc1
s_waitcnt lgkmcnt(12)
v_lshlrev_b32 v24, 16, v16
v_mfma_f32_16x16x32_bf16 v[116:119], a[160:163], a[148:151], v[116:119]
ds_read_b128 a[148:151], v2 offset:5120
v_and_b32 v25, s33, v16
v_mfma_f32_16x16x32_bf16 v[116:119], a[192:195], a[116:119], v[116:119]
ds_read_b128 a[116:119], v1 offset:5120
v_lshlrev_b32 v26, 16, v17
v_mfma_f32_16x16x32_bf16 v[120:123], a[192:195], a[120:123], v[120:123]
v_and_b32 v27, s33, v17
v_mul_f32 v24, v24, v252
v_mfma_f32_16x16x32_bf16 v[120:123], a[160:163], a[152:155], v[120:123]
v_mul_f32 v25, v25, v253
v_mul_f32 v26, v26, v254
v_mfma_f32_16x16x32_bf16 v[152:155], a[164:167], a[152:155], v[152:155]
ds_read_b128 a[152:155], v2 offset:6144
v_mul_f32 v27, v27, v255
v_mfma_f32_16x16x32_bf16 v[152:155], a[196:199], a[120:123], v[152:155]
ds_read_b128 a[120:123], v1 offset:6144
v_cvt_pk_bf16_f32 v16, v24, v25
v_mfma_f32_16x16x32_bf16 v[156:159], a[196:199], a[124:127], v[156:159]
buffer_load_dwordx4 a[196:199], v0, s[20:23], s30 offen offset:0 sc1
v_cvt_pk_bf16_f32 v17, v26, v27
v_mfma_f32_16x16x32_bf16 v[156:159], a[164:167], a[156:159], v[156:159]
buffer_load_dwordx4 a[164:167], v0, s[20:23], s30 offen offset:1024 sc1
v_lshlrev_b32 v24, 16, v18
v_mfma_f32_16x16x32_bf16 v[124:127], a[160:163], a[156:159], v[124:127]
buffer_load_dwordx4 a[160:163], v0, s[20:23], s30 offen offset:2048 sc1
ds_read_b128 a[156:159], v2 offset:7168
v_mfma_f32_16x16x32_bf16 v[124:127], a[192:195], a[124:127], v[124:127]
buffer_load_dwordx4 a[192:195], v0, s[20:23], s30 offen offset:3072 sc1
s_add_u32 s30, s30, 0x3000
ds_read_b128 a[124:127], v1 offset:7168
s_waitcnt vmcnt(17) lgkmcnt(15)
v_mfma_f32_16x16x32_bf16 v[160:163], a[200:203], a[96:99], v[160:163]
v_and_b32 v25, s33, v18
v_mfma_f32_16x16x32_bf16 v[160:163], a[168:171], a[128:131], v[160:163]
v_lshlrev_b32 v26, 16, v19
v_and_b32 v27, s33, v19
v_mfma_f32_16x16x32_bf16 v[192:195], a[172:175], a[128:131], v[192:195]
v_accvgpr_read_b32 v28, a252
v_mul_f32 v24, v24, v28
v_mfma_f32_16x16x32_bf16 v[192:195], a[204:207], a[96:99], v[192:195]
v_accvgpr_read_b32 v29, a253
v_mul_f32 v25, v25, v29
s_waitcnt lgkmcnt(13)
v_mfma_f32_16x16x32_bf16 v[196:199], a[204:207], a[100:103], v[196:199]
v_accvgpr_read_b32 v30, a254
v_mfma_f32_16x16x32_bf16 v[196:199], a[172:175], a[132:135], v[196:199]
v_mul_f32 v26, v26, v30
v_accvgpr_read_b32 v31, a255
v_mfma_f32_16x16x32_bf16 v[164:167], a[168:171], a[132:135], v[164:167]
v_mul_f32 v27, v27, v31
v_cvt_pk_bf16_f32 v18, v24, v25
v_mfma_f32_16x16x32_bf16 v[164:167], a[200:203], a[100:103], v[164:167]
v_cvt_pk_bf16_f32 v19, v26, v27
ds_write_b128 v7, v[16:19] offset:39936
s_waitcnt lgkmcnt(12)
v_mfma_f32_16x16x32_bf16 v[168:171], a[200:203], a[104:107], v[168:171]
buffer_store_dwordx4 v[16:19], v7, s[20:23], s55 offen offset:3072 sc1
v_mfma_f32_16x16x32_bf16 v[168:171], a[168:171], a[136:139], v[168:171]
v_mfma_f32_16x16x32_bf16 v[200:203], a[172:175], a[136:139], v[200:203]
v_mfma_f32_16x16x32_bf16 v[200:203], a[204:207], a[104:107], v[200:203]
s_waitcnt lgkmcnt(10)
v_mfma_f32_16x16x32_bf16 v[204:207], a[204:207], a[108:111], v[204:207]
v_mfma_f32_16x16x32_bf16 v[204:207], a[172:175], a[140:143], v[204:207]
v_mfma_f32_16x16x32_bf16 v[172:175], a[168:171], a[140:143], v[172:175]
v_mfma_f32_16x16x32_bf16 v[172:175], a[200:203], a[108:111], v[172:175]
s_waitcnt lgkmcnt(8)
v_mfma_f32_16x16x32_bf16 v[176:179], a[200:203], a[112:115], v[176:179]
v_mfma_f32_16x16x32_bf16 v[176:179], a[168:171], a[144:147], v[176:179]
v_mfma_f32_16x16x32_bf16 v[208:211], a[172:175], a[144:147], v[208:211]
v_mfma_f32_16x16x32_bf16 v[208:211], a[204:207], a[112:115], v[208:211]
s_waitcnt lgkmcnt(5)
v_mfma_f32_16x16x32_bf16 v[212:215], a[204:207], a[116:119], v[212:215]
v_mfma_f32_16x16x32_bf16 v[212:215], a[172:175], a[148:151], v[212:215]
v_mfma_f32_16x16x32_bf16 v[180:183], a[168:171], a[148:151], v[180:183]
v_mfma_f32_16x16x32_bf16 v[180:183], a[200:203], a[116:119], v[180:183]
s_waitcnt lgkmcnt(3)
v_mfma_f32_16x16x32_bf16 v[184:187], a[200:203], a[120:123], v[184:187]
v_mfma_f32_16x16x32_bf16 v[184:187], a[168:171], a[152:155], v[184:187]
v_mfma_f32_16x16x32_bf16 v[216:219], a[172:175], a[152:155], v[216:219]
v_mfma_f32_16x16x32_bf16 v[216:219], a[204:207], a[120:123], v[216:219]
s_waitcnt lgkmcnt(1)
v_mfma_f32_16x16x32_bf16 v[220:223], a[204:207], a[124:127], v[220:223]
buffer_load_dwordx4 a[204:207], v0, s[20:23], s30 offen offset:0 sc1
v_mfma_f32_16x16x32_bf16 v[220:223], a[172:175], a[156:159], v[220:223]
buffer_load_dwordx4 a[172:175], v0, s[20:23], s30 offen offset:1024 sc1
v_mfma_f32_16x16x32_bf16 v[188:191], a[168:171], a[156:159], v[188:191]
buffer_load_dwordx4 a[168:171], v0, s[20:23], s30 offen offset:2048 sc1
v_mfma_f32_16x16x32_bf16 v[188:191], a[200:203], a[124:127], v[188:191]
buffer_load_dwordx4 a[200:203], v0, s[20:23], s30 offen offset:3072 sc1
s_add_u32 s30, s30, 0x1000
s_barrier
s_waitcnt vmcnt(17)
v_mfma_f32_16x16x32_bf16 v[224:227], a[180:183], a[96:99], v[224:227]
s_cmp_lg_u32 s28, 0
s_cbranch_scc1 L_nf4
s_add_u32 s34, s8, 4
v_mov_b32 v10, s34
v_mov_b32 v11, s9
s_mov_b64 exec, 1
buffer_store_dwordx2 v[10:11], off, s[20:23], s35 sc1
s_mov_b64 exec, -1
L_nf4:
v_mfma_f32_16x16x32_bf16 v[224:227], a[212:215], a[128:131], v[224:227]
v_mfma_f32_16x16x32_bf16 a[224:227], a[176:179], a[128:131], a[224:227]
ds_read_b128 a[128:131], v4 offset:0
v_mfma_f32_16x16x32_bf16 a[224:227], a[208:211], a[96:99], a[224:227]
ds_read_b128 a[96:99], v3 offset:0
v_mfma_f32_16x16x32_bf16 a[228:231], a[208:211], a[100:103], a[228:231]
v_mfma_f32_16x16x32_bf16 a[228:231], a[176:179], a[132:135], a[228:231]
v_mfma_f32_16x16x32_bf16 v[228:231], a[212:215], a[132:135], v[228:231]
ds_read_b128 a[132:135], v4 offset:1024
v_mfma_f32_16x16x32_bf16 v[228:231], a[180:183], a[100:103], v[228:231]
ds_read_b128 a[100:103], v3 offset:1024
v_mfma_f32_16x16x32_bf16 v[232:235], a[180:183], a[104:107], v[232:235]
v_mfma_f32_16x16x32_bf16 v[232:235], a[212:215], a[136:139], v[232:235]
v_mfma_f32_16x16x32_bf16 a[232:235], a[176:179], a[136:139], a[232:235]
ds_read_b128 a[136:139], v4 offset:2048
v_mfma_f32_16x16x32_bf16 a[232:235], a[208:211], a[104:107], a[232:235]
ds_read_b128 a[104:107], v3 offset:2048
v_mfma_f32_16x16x32_bf16 a[236:239], a[208:211], a[108:111], a[236:239]
v_mfma_f32_16x16x32_bf16 a[236:239], a[176:179], a[140:143], a[236:239]
v_mfma_f32_16x16x32_bf16 v[236:239], a[212:215], a[140:143], v[236:239]
ds_read_b128 a[140:143], v4 offset:3072
v_mfma_f32_16x16x32_bf16 v[236:239], a[180:183], a[108:111], v[236:239]
ds_read_b128 a[108:111], v3 offset:3072
v_mfma_f32_16x16x32_bf16 v[240:243], a[180:183], a[112:115], v[240:243]
v_mfma_f32_16x16x32_bf16 v[240:243], a[212:215], a[144:147], v[240:243]
v_mfma_f32_16x16x32_bf16 a[240:243], a[176:179], a[144:147], a[240:243]
ds_read_b128 a[144:147], v4 offset:4096
v_mfma_f32_16x16x32_bf16 a[240:243], a[208:211], a[112:115], a[240:243]
ds_read_b128 a[112:115], v3 offset:4096
v_mfma_f32_16x16x32_bf16 a[244:247], a[208:211], a[116:119], a[244:247]
v_mfma_f32_16x16x32_bf16 a[244:247], a[176:179], a[148:151], a[244:247]
v_mfma_f32_16x16x32_bf16 v[244:247], a[212:215], a[148:151], v[244:247]
ds_read_b128 a[148:151], v4 offset:5120
v_mfma_f32_16x16x32_bf16 v[244:247], a[180:183], a[116:119], v[244:247]
ds_read_b128 a[116:119], v3 offset:5120
v_mfma_f32_16x16x32_bf16 v[248:251], a[180:183], a[120:123], v[248:251]
v_mfma_f32_16x16x32_bf16 v[248:251], a[212:215], a[152:155], v[248:251]
v_mfma_f32_16x16x32_bf16 a[248:251], a[176:179], a[152:155], a[248:251]
ds_read_b128 a[152:155], v4 offset:6144
v_mfma_f32_16x16x32_bf16 a[248:251], a[208:211], a[120:123], a[248:251]
ds_read_b128 a[120:123], v3 offset:6144
v_mfma_f32_16x16x32_bf16 a[252:255], a[208:211], a[124:127], a[252:255]
buffer_load_dwordx4 a[208:211], v0, s[20:23], s30 offen offset:0 sc1
v_mfma_f32_16x16x32_bf16 a[252:255], a[176:179], a[156:159], a[252:255]
buffer_load_dwordx4 a[176:179], v0, s[20:23], s30 offen offset:1024 sc1
v_mfma_f32_16x16x32_bf16 v[252:255], a[212:215], a[156:159], v[252:255]
buffer_load_dwordx4 a[212:215], v0, s[20:23], s30 offen offset:2048 sc1
ds_read_b128 a[156:159], v4 offset:7168
v_mfma_f32_16x16x32_bf16 v[252:255], a[180:183], a[124:127], v[252:255]
buffer_load_dwordx4 a[180:183], v0, s[20:23], s30 offen offset:3072 sc1
s_add_u32 s30, s30, 0x3000
ds_read_b128 a[124:127], v3 offset:7168
s_waitcnt vmcnt(15) lgkmcnt(14)
v_mfma_f32_16x16x32_bf16 v[160:163], a[188:191], a[96:99], v[160:163]
v_mfma_f32_16x16x32_bf16 v[160:163], a[220:223], a[128:131], v[160:163]
v_mfma_f32_16x16x32_bf16 v[192:195], a[184:187], a[128:131], v[192:195]
v_mfma_f32_16x16x32_bf16 v[192:195], a[216:219], a[96:99], v[192:195]
s_waitcnt lgkmcnt(12)
v_mfma_f32_16x16x32_bf16 v[196:199], a[216:219], a[100:103], v[196:199]
s_add_u32 s37, s37, 4096
buffer_load_dwordx4 v[12:15], v9, s[24:27], s37 offen offset:0
v_mfma_f32_16x16x32_bf16 v[196:199], a[184:187], a[132:135], v[196:199]
v_mfma_f32_16x16x32_bf16 v[164:167], a[220:223], a[132:135], v[164:167]
v_mfma_f32_16x16x32_bf16 v[164:167], a[188:191], a[100:103], v[164:167]
s_waitcnt lgkmcnt(10)
v_mfma_f32_16x16x32_bf16 v[168:171], a[188:191], a[104:107], v[168:171]
buffer_load_dwordx4 v[16:19], v9, s[24:27], s37 offen offset:64
v_mfma_f32_16x16x32_bf16 v[168:171], a[220:223], a[136:139], v[168:171]
v_mfma_f32_16x16x32_bf16 v[200:203], a[184:187], a[136:139], v[200:203]
v_mfma_f32_16x16x32_bf16 v[200:203], a[216:219], a[104:107], v[200:203]
s_waitcnt lgkmcnt(8)
v_mfma_f32_16x16x32_bf16 v[204:207], a[216:219], a[108:111], v[204:207]
v_mfma_f32_16x16x32_bf16 v[204:207], a[184:187], a[140:143], v[204:207]
v_mfma_f32_16x16x32_bf16 v[172:175], a[220:223], a[140:143], v[172:175]
v_mfma_f32_16x16x32_bf16 v[172:175], a[188:191], a[108:111], v[172:175]
s_waitcnt lgkmcnt(6)
v_mfma_f32_16x16x32_bf16 v[176:179], a[188:191], a[112:115], v[176:179]
v_mfma_f32_16x16x32_bf16 v[176:179], a[220:223], a[144:147], v[176:179]
v_mfma_f32_16x16x32_bf16 v[208:211], a[184:187], a[144:147], v[208:211]
v_mfma_f32_16x16x32_bf16 v[208:211], a[216:219], a[112:115], v[208:211]
s_waitcnt lgkmcnt(4)
v_mfma_f32_16x16x32_bf16 v[212:215], a[216:219], a[116:119], v[212:215]
v_mfma_f32_16x16x32_bf16 v[212:215], a[184:187], a[148:151], v[212:215]
v_mfma_f32_16x16x32_bf16 v[180:183], a[220:223], a[148:151], v[180:183]
v_mfma_f32_16x16x32_bf16 v[180:183], a[188:191], a[116:119], v[180:183]
s_waitcnt lgkmcnt(2)
v_mfma_f32_16x16x32_bf16 v[184:187], a[188:191], a[120:123], v[184:187]
v_mfma_f32_16x16x32_bf16 v[184:187], a[220:223], a[152:155], v[184:187]
v_mfma_f32_16x16x32_bf16 v[216:219], a[184:187], a[152:155], v[216:219]
v_mfma_f32_16x16x32_bf16 v[216:219], a[216:219], a[120:123], v[216:219]
s_waitcnt lgkmcnt(0)
v_mfma_f32_16x16x32_bf16 v[220:223], a[216:219], a[124:127], v[220:223]
buffer_load_dwordx4 a[216:219], v0, s[20:23], s30 offen offset:0 sc1
v_mfma_f32_16x16x32_bf16 v[220:223], a[184:187], a[156:159], v[220:223]
buffer_load_dwordx4 a[184:187], v0, s[20:23], s30 offen offset:1024 sc1
v_mfma_f32_16x16x32_bf16 v[188:191], a[220:223], a[156:159], v[188:191]
buffer_load_dwordx4 a[220:223], v0, s[20:23], s30 offen offset:2048 sc1
v_mfma_f32_16x16x32_bf16 v[188:191], a[188:191], a[124:127], v[188:191]
buffer_load_dwordx4 a[188:191], v0, s[20:23], s30 offen offset:3072 sc1
s_add_u32 s30, s30, 0x1000
s_waitcnt vmcnt(15)
v_mfma_f32_16x16x32_bf16 v[224:227], a[196:199], a[96:99], v[224:227]
v_mfma_f32_16x16x32_bf16 v[224:227], a[164:167], a[128:131], v[224:227]
v_mfma_f32_16x16x32_bf16 a[224:227], a[192:195], a[128:131], a[224:227]
ds_read_b128 a[128:131], v2 offset:32768
v_mfma_f32_16x16x32_bf16 a[224:227], a[160:163], a[96:99], a[224:227]
ds_read_b128 a[96:99], v1 offset:32768
v_mfma_f32_16x16x32_bf16 a[228:231], a[160:163], a[100:103], a[228:231]
v_mfma_f32_16x16x32_bf16 a[228:231], a[192:195], a[132:135], a[228:231]
v_mfma_f32_16x16x32_bf16 v[228:231], a[164:167], a[132:135], v[228:231]
ds_read_b128 a[132:135], v2 offset:33792
v_mfma_f32_16x16x32_bf16 v[228:231], a[196:199], a[100:103], v[228:231]
ds_read_b128 a[100:103], v1 offset:33792
v_mfma_f32_16x16x32_bf16 v[232:235], a[196:199], a[104:107], v[232:235]
v_mfma_f32_16x16x32_bf16 v[232:235], a[164:167], a[136:139], v[232:235]
v_mfma_f32_16x16x32_bf16 a[232:235], a[192:195], a[136:139], a[232:235]
ds_read_b128 a[136:139], v2 offset:34816
v_mfma_f32_16x16x32_bf16 a[232:235], a[160:163], a[104:107], a[232:235]
ds_read_b128 a[104:107], v1 offset:34816
v_mfma_f32_16x16x32_bf16 a[236:239], a[160:163], a[108:111], a[236:239]
v_mfma_f32_16x16x32_bf16 a[236:239], a[192:195], a[140:143], a[236:239]
v_mfma_f32_16x16x32_bf16 v[236:239], a[164:167], a[140:143], v[236:239]
ds_read_b128 a[140:143], v2 offset:35840
v_mfma_f32_16x16x32_bf16 v[236:239], a[196:199], a[108:111], v[236:239]
ds_read_b128 a[108:111], v1 offset:35840
v_mfma_f32_16x16x32_bf16 v[240:243], a[196:199], a[112:115], v[240:243]
v_mfma_f32_16x16x32_bf16 v[240:243], a[164:167], a[144:147], v[240:243]
v_mfma_f32_16x16x32_bf16 a[240:243], a[192:195], a[144:147], a[240:243]
ds_read_b128 a[144:147], v2 offset:36864
v_mfma_f32_16x16x32_bf16 a[240:243], a[160:163], a[112:115], a[240:243]
ds_read_b128 a[112:115], v1 offset:36864
v_mfma_f32_16x16x32_bf16 a[244:247], a[160:163], a[116:119], a[244:247]
v_mfma_f32_16x16x32_bf16 a[244:247], a[192:195], a[148:151], a[244:247]
v_mfma_f32_16x16x32_bf16 v[244:247], a[164:167], a[148:151], v[244:247]
ds_read_b128 a[148:151], v2 offset:37888
v_mfma_f32_16x16x32_bf16 v[244:247], a[196:199], a[116:119], v[244:247]
ds_read_b128 a[116:119], v1 offset:37888
v_mfma_f32_16x16x32_bf16 v[248:251], a[196:199], a[120:123], v[248:251]
v_mfma_f32_16x16x32_bf16 v[248:251], a[164:167], a[152:155], v[248:251]
v_mfma_f32_16x16x32_bf16 a[248:251], a[192:195], a[152:155], a[248:251]
ds_read_b128 a[152:155], v2 offset:38912
v_mfma_f32_16x16x32_bf16 a[248:251], a[160:163], a[120:123], a[248:251]
ds_read_b128 a[120:123], v1 offset:38912
v_mfma_f32_16x16x32_bf16 a[252:255], a[160:163], a[124:127], a[252:255]
buffer_load_dwordx4 a[160:163], v0, s[20:23], s30 offen offset:0 sc1
v_mfma_f32_16x16x32_bf16 a[252:255], a[192:195], a[156:159], a[252:255]
buffer_load_dwordx4 a[192:195], v0, s[20:23], s30 offen offset:1024 sc1
v_mfma_f32_16x16x32_bf16 v[252:255], a[164:167], a[156:159], v[252:255]
buffer_load_dwordx4 a[164:167], v0, s[20:23], s30 offen offset:2048 sc1
ds_read_b128 a[156:159], v2 offset:39936
v_mfma_f32_16x16x32_bf16 v[252:255], a[196:199], a[124:127], v[252:255]
buffer_load_dwordx4 a[196:199], v0, s[20:23], s30 offen offset:3072 sc1
s_add_u32 s30, s30, 0x1000
ds_read_b128 a[124:127], v1 offset:39936
s_waitcnt vmcnt(14) lgkmcnt(14)
v_mfma_f32_16x16x32_bf16 v[160:163], a[204:207], a[96:99], v[160:163]
v_mfma_f32_16x16x32_bf16 v[160:163], a[172:175], a[128:131], v[160:163]
v_mfma_f32_16x16x32_bf16 v[192:195], a[200:203], a[128:131], v[192:195]
v_mfma_f32_16x16x32_bf16 v[192:195], a[168:171], a[96:99], v[192:195]
s_waitcnt lgkmcnt(12)
v_mfma_f32_16x16x32_bf16 v[196:199], a[168:171], a[100:103], v[196:199]
v_mfma_f32_16x16x32_bf16 v[196:199], a[200:203], a[132:135], v[196:199]
v_mfma_f32_16x16x32_bf16 v[164:167], a[172:175], a[132:135], v[164:167]
v_mfma_f32_16x16x32_bf16 v[164:167], a[204:207], a[100:103], v[164:167]
s_waitcnt lgkmcnt(10)
v_mfma_f32_16x16x32_bf16 v[168:171], a[204:207], a[104:107], v[168:171]
v_mfma_f32_16x16x32_bf16 v[168:171], a[172:175], a[136:139], v[168:171]
v_mfma_f32_16x16x32_bf16 v[200:203], a[200:203], a[136:139], v[200:203]
v_mfma_f32_16x16x32_bf16 v[200:203], a[168:171], a[104:107], v[200:203]
s_waitcnt lgkmcnt(8)
v_mfma_f32_16x16x32_bf16 v[204:207], a[168:171], a[108:111], v[204:207]
v_mfma_f32_16x16x32_bf16 v[204:207], a[200:203], a[140:143], v[204:207]
v_mfma_f32_16x16x32_bf16 v[172:175], a[172:175], a[140:143], v[172:175]
v_mfma_f32_16x16x32_bf16 v[172:175], a[204:207], a[108:111], v[172:175]
s_waitcnt lgkmcnt(6)
v_mfma_f32_16x16x32_bf16 v[176:179], a[204:207], a[112:115], v[176:179]
v_mfma_f32_16x16x32_bf16 v[176:179], a[172:175], a[144:147], v[176:179]
v_mfma_f32_16x16x32_bf16 v[208:211], a[200:203], a[144:147], v[208:211]
v_mfma_f32_16x16x32_bf16 v[208:211], a[168:171], a[112:115], v[208:211]
s_waitcnt lgkmcnt(4)
v_mfma_f32_16x16x32_bf16 v[212:215], a[168:171], a[116:119], v[212:215]
v_mfma_f32_16x16x32_bf16 v[212:215], a[200:203], a[148:151], v[212:215]
v_mfma_f32_16x16x32_bf16 v[180:183], a[172:175], a[148:151], v[180:183]
v_mfma_f32_16x16x32_bf16 v[180:183], a[204:207], a[116:119], v[180:183]
s_waitcnt lgkmcnt(2)
v_mfma_f32_16x16x32_bf16 v[184:187], a[204:207], a[120:123], v[184:187]
v_mfma_f32_16x16x32_bf16 v[184:187], a[172:175], a[152:155], v[184:187]
v_mfma_f32_16x16x32_bf16 v[216:219], a[200:203], a[152:155], v[216:219]
v_mfma_f32_16x16x32_bf16 v[216:219], a[168:171], a[120:123], v[216:219]
s_waitcnt lgkmcnt(0)
v_mfma_f32_16x16x32_bf16 v[220:223], a[168:171], a[124:127], v[220:223]
buffer_load_dwordx4 a[168:171], v0, s[20:23], s30 offen offset:0 sc1
v_mfma_f32_16x16x32_bf16 v[220:223], a[200:203], a[156:159], v[220:223]
buffer_load_dwordx4 a[200:203], v0, s[20:23], s30 offen offset:1024 sc1
v_mfma_f32_16x16x32_bf16 v[188:191], a[172:175], a[156:159], v[188:191]
buffer_load_dwordx4 a[172:175], v0, s[20:23], s30 offen offset:2048 sc1
v_mfma_f32_16x16x32_bf16 v[188:191], a[204:207], a[124:127], v[188:191]
buffer_load_dwordx4 a[204:207], v0, s[20:23], s30 offen offset:3072 sc1
s_add_u32 s30, s30, 0x1000
s_waitcnt vmcnt(14)
v_mfma_f32_16x16x32_bf16 v[224:227], a[208:211], a[96:99], v[224:227]
v_mfma_f32_16x16x32_bf16 v[224:227], a[176:179], a[128:131], v[224:227]
v_mfma_f32_16x16x32_bf16 a[224:227], a[180:183], a[128:131], a[224:227]
ds_read_b128 a[128:131], v4 offset:32768
v_mfma_f32_16x16x32_bf16 a[224:227], a[212:215], a[96:99], a[224:227]
ds_read_b128 a[96:99], v3 offset:32768
v_mfma_f32_16x16x32_bf16 a[228:231], a[212:215], a[100:103], a[228:231]
s_waitcnt vmcnt(13)
v_lshlrev_b32 v28, 16, v12
v_and_b32 v29, s33, v12
v_mfma_f32_16x16x32_bf16 a[228:231], a[180:183], a[132:135], a[228:231]
v_lshlrev_b32 v30, 16, v13
v_and_b32 v31, s33, v13
v_mfma_f32_16x16x32_bf16 v[228:231], a[176:179], a[132:135], v[228:231]
ds_read_b128 a[132:135], v4 offset:33792
v_add_f32 v32, v32, v28
v_mfma_f32_16x16x32_bf16 v[228:231], a[208:211], a[100:103], v[228:231]
ds_read_b128 a[100:103], v3 offset:33792
v_add_f32 v33, v33, v29
v_mfma_f32_16x16x32_bf16 v[232:235], a[208:211], a[104:107], v[232:235]
v_add_f32 v34, v34, v30
v_add_f32 v35, v35, v31
v_mfma_f32_16x16x32_bf16 v[232:235], a[176:179], a[136:139], v[232:235]
v_add_f32 v36, v36, v28
v_add_f32 v37, v37, v29
v_mfma_f32_16x16x32_bf16 a[232:235], a[180:183], a[136:139], a[232:235]
ds_read_b128 a[136:139], v4 offset:34816
v_add_f32 v38, v38, v30
v_mfma_f32_16x16x32_bf16 a[232:235], a[212:215], a[104:107], a[232:235]
ds_read_b128 a[104:107], v3 offset:34816
v_add_f32 v39, v39, v31
v_mfma_f32_16x16x32_bf16 a[236:239], a[212:215], a[108:111], a[236:239]
v_add_f32 v40, v40, v28
v_add_f32 v41, v41, v29
v_mfma_f32_16x16x32_bf16 a[236:239], a[180:183], a[140:143], a[236:239]
v_add_f32 v42, v42, v30
v_add_f32 v43, v43, v31
v_mfma_f32_16x16x32_bf16 v[236:239], a[176:179], a[140:143], v[236:239]
ds_read_b128 a[140:143], v4 offset:35840
v_add_f32 v44, v44, v28
v_mfma_f32_16x16x32_bf16 v[236:239], a[208:211], a[108:111], v[236:239]
ds_read_b128 a[108:111], v3 offset:35840
v_add_f32 v45, v45, v29
v_mfma_f32_16x16x32_bf16 v[240:243], a[208:211], a[112:115], v[240:243]
v_add_f32 v46, v46, v30
v_add_f32 v47, v47, v31
v_mfma_f32_16x16x32_bf16 v[240:243], a[176:179], a[144:147], v[240:243]
v_add_f32 v48, v48, v28
v_add_f32 v49, v49, v29
v_mfma_f32_16x16x32_bf16 a[240:243], a[180:183], a[144:147], a[240:243]
ds_read_b128 a[144:147], v4 offset:36864
v_add_f32 v50, v50, v30
v_mfma_f32_16x16x32_bf16 a[240:243], a[212:215], a[112:115], a[240:243]
ds_read_b128 a[112:115], v3 offset:36864
v_add_f32 v51, v51, v31
v_mfma_f32_16x16x32_bf16 a[244:247], a[212:215], a[116:119], a[244:247]
v_add_f32 v52, v52, v28
v_add_f32 v53, v53, v29
v_mfma_f32_16x16x32_bf16 a[244:247], a[180:183], a[148:151], a[244:247]
v_add_f32 v54, v54, v30
v_add_f32 v55, v55, v31
v_mfma_f32_16x16x32_bf16 v[244:247], a[176:179], a[148:151], v[244:247]
ds_read_b128 a[148:151], v4 offset:37888
v_add_f32 v56, v56, v28
v_mfma_f32_16x16x32_bf16 v[244:247], a[208:211], a[116:119], v[244:247]
ds_read_b128 a[116:119], v3 offset:37888
v_add_f32 v57, v57, v29
v_mfma_f32_16x16x32_bf16 v[248:251], a[208:211], a[120:123], v[248:251]
v_add_f32 v58, v58, v30
v_add_f32 v59, v59, v31
v_mfma_f32_16x16x32_bf16 v[248:251], a[176:179], a[152:155], v[248:251]
v_add_f32 v60, v60, v28
v_add_f32 v61, v61, v29
v_mfma_f32_16x16x32_bf16 a[248:251], a[180:183], a[152:155], a[248:251]
ds_read_b128 a[152:155], v4 offset:38912
v_add_f32 v62, v62, v30
v_mfma_f32_16x16x32_bf16 a[248:251], a[212:215], a[120:123], a[248:251]
ds_read_b128 a[120:123], v3 offset:38912
v_add_f32 v63, v63, v31
v_mfma_f32_16x16x32_bf16 a[252:255], a[212:215], a[124:127], a[252:255]
buffer_load_dwordx4 a[212:215], v0, s[20:23], s30 offen offset:0 sc1
v_lshlrev_b32 v28, 16, v14
v_mfma_f32_16x16x32_bf16 a[252:255], a[180:183], a[156:159], a[252:255]
buffer_load_dwordx4 a[180:183], v0, s[20:23], s30 offen offset:1024 sc1
v_and_b32 v29, s33, v14
v_mfma_f32_16x16x32_bf16 v[252:255], a[176:179], a[156:159], v[252:255]
buffer_load_dwordx4 a[176:179], v0, s[20:23], s30 offen offset:2048 sc1
ds_read_b128 a[156:159], v4 offset:39936
v_mfma_f32_16x16x32_bf16 v[252:255], a[208:211], a[124:127], v[252:255]
buffer_load_dwordx4 a[208:211], v0, s[20:23], s30 offen offset:3072 sc1
s_add_u32 s30, s30, 0x1000
ds_read_b128 a[124:127], v3 offset:39936
s_waitcnt vmcnt(12) lgkmcnt(14)
v_mfma_f32_16x16x32_bf16 v[160:163], a[216:219], a[96:99], v[160:163]
v_lshlrev_b32 v30, 16, v15
v_mfma_f32_16x16x32_bf16 v[160:163], a[184:187], a[128:131], v[160:163]
v_and_b32 v31, s33, v15
v_add_f32 v64, v64, v28
v_mfma_f32_16x16x32_bf16 v[192:195], a[188:191], a[128:131], v[192:195]
v_add_f32 v65, v65, v29
v_add_f32 v66, v66, v30
v_mfma_f32_16x16x32_bf16 v[192:195], a[220:223], a[96:99], v[192:195]
v_add_f32 v67, v67, v31
v_add_f32 v68, v68, v28
s_waitcnt lgkmcnt(12)
v_mfma_f32_16x16x32_bf16 v[196:199], a[220:223], a[100:103], v[196:199]
v_add_f32 v69, v69, v29
v_mfma_f32_16x16x32_bf16 v[196:199], a[188:191], a[132:135], v[196:199]
v_add_f32 v70, v70, v30
v_add_f32 v71, v71, v31
v_mfma_f32_16x16x32_bf16 v[164:167], a[184:187], a[132:135], v[164:167]
v_add_f32 v72, v72, v28
v_add_f32 v73, v73, v29
v_mfma_f32_16x16x32_bf16 v[164:167], a[216:219], a[100:103], v[164:167]
v_add_f32 v74, v74, v30
v_add_f32 v75, v75, v31
s_waitcnt lgkmcnt(10)
v_mfma_f32_16x16x32_bf16 v[168:171], a[216:219], a[104:107], v[168:171]
v_add_f32 v76, v76, v28
v_mfma_f32_16x16x32_bf16 v[168:171], a[184:187], a[136:139], v[168:171]
v_add_f32 v77, v77, v29
v_add_f32 v78, v78, v30
v_mfma_f32_16x16x32_bf16 v[200:203], a[188:191], a[136:139], v[200:203]
v_add_f32 v79, v79, v31
v_add_f32 v80, v80, v28
v_mfma_f32_16x16x32_bf16 v[200:203], a[220:223], a[104:107], v[200:203]
v_add_f32 v81, v81, v29
v_add_f32 v82, v82, v30
s_waitcnt lgkmcnt(8)
v_mfma_f32_16x16x32_bf16 v[204:207], a[220:223], a[108:111], v[204:207]
v_add_f32 v83, v83, v31
v_mfma_f32_16x16x32_bf16 v[204:207], a[188:191], a[140:143], v[204:207]
v_add_f32 v84, v84, v28
v_add_f32 v85, v85, v29
v_mfma_f32_16x16x32_bf16 v[172:175], a[184:187], a[140:143], v[172:175]
v_add_f32 v86, v86, v30
v_add_f32 v87, v87, v31
v_mfma_f32_16x16x32_bf16 v[172:175], a[216:219], a[108:111], v[172:175]
v_add_f32 v88, v88, v28
v_add_f32 v89, v89, v29
s_waitcnt lgkmcnt(6)
v_mfma_f32_16x16x32_bf16 v[176:179], a[216:219], a[112:115], v[176:179]
v_add_f32 v90, v90, v30
v_mfma_f32_16x16x32_bf16 v[176:179], a[184:187], a[144:147], v[176:179]
v_add_f32 v91, v91, v31
v_add_f32 v92, v92, v28
v_mfma_f32_16x16x32_bf16 v[208:211], a[188:191], a[144:147], v[208:211]
v_add_f32 v93, v93, v29
v_add_f32 v94, v94, v30
v_mfma_f32_16x16x32_bf16 v[208:211], a[220:223], a[112:115], v[208:211]
v_add_f32 v95, v95, v31
v_lshlrev_b32 v28, 16, v16
s_waitcnt lgkmcnt(4)
v_mfma_f32_16x16x32_bf16 v[212:215], a[220:223], a[116:119], v[212:215]
v_and_b32 v29, s33, v16
v_mfma_f32_16x16x32_bf16 v[212:215], a[188:191], a[148:151], v[212:215]
v_lshlrev_b32 v30, 16, v17
v_and_b32 v31, s33, v17
v_mfma_f32_16x16x32_bf16 v[180:183], a[184:187], a[148:151], v[180:183]
v_add_f32 v96, v96, v28
v_add_f32 v97, v97, v29
v_mfma_f32_16x16x32_bf16 v[180:183], a[216:219], a[116:119], v[180:183]
v_add_f32 v98, v98, v30
v_add_f32 v99, v99, v31
s_waitcnt lgkmcnt(2)
v_mfma_f32_16x16x32_bf16 v[184:187], a[216:219], a[120:123], v[184:187]
v_add_f32 v100, v100, v28
v_mfma_f32_16x16x32_bf16 v[184:187], a[184:187], a[152:155], v[184:187]
v_add_f32 v101, v101, v29
v_add_f32 v102, v102, v30
v_mfma_f32_16x16x32_bf16 v[216:219], a[188:191], a[152:155], v[216:219]
v_add_f32 v103, v103, v31
v_add_f32 v104, v104, v28
v_mfma_f32_16x16x32_bf16 v[216:219], a[220:223], a[120:123], v[216:219]
v_add_f32 v105, v105, v29
v_add_f32 v106, v106, v30
s_waitcnt lgkmcnt(0)
v_mfma_f32_16x16x32_bf16 v[220:223], a[220:223], a[124:127], v[220:223]
buffer_load_dwordx4 a[220:223], v0, s[20:23], s30 offen offset:0 sc1
v_mfma_f32_16x16x32_bf16 v[220:223], a[188:191], a[156:159], v[220:223]
buffer_load_dwordx4 a[188:191], v0, s[20:23], s30 offen offset:1024 sc1
v_add_f32 v107, v107, v31
v_mfma_f32_16x16x32_bf16 v[188:191], a[184:187], a[156:159], v[188:191]
buffer_load_dwordx4 a[184:187], v0, s[20:23], s30 offen offset:2048 sc1
v_add_f32 v108, v108, v28
v_mfma_f32_16x16x32_bf16 v[188:191], a[216:219], a[124:127], v[188:191]
buffer_load_dwordx4 a[216:219], v0, s[20:23], s30 offen offset:3072 sc1
s_add_u32 s30, s30, 0x1000
s_barrier
s_waitcnt vmcnt(12)
v_mfma_f32_16x16x32_bf16 v[224:227], a[160:163], a[96:99], v[224:227]
s_cmp_lg_u32 s28, 0
s_cbranch_scc1 L_nf5
s_add_u32 s34, s8, 5
v_mov_b32 v10, s34
v_mov_b32 v11, s9
s_mov_b64 exec, 1
buffer_store_dwordx2 v[10:11], off, s[20:23], s35 sc1
s_mov_b64 exec, -1
L_nf5:
v_mfma_f32_16x16x32_bf16 v[224:227], a[192:195], a[128:131], v[224:227]
v_add_f32 v109, v109, v29
v_add_f32 v110, v110, v30
v_mfma_f32_16x16x32_bf16 a[224:227], a[196:199], a[128:131], a[224:227]
v_xor_b32 v2, 0x12000, v6
ds_read_b128 a[128:131], v2 offset:0
v_mfma_f32_16x16x32_bf16 a[224:227], a[164:167], a[96:99], a[224:227]
v_xor_b32 v1, 0x10000, v6
ds_read_b128 a[96:99], v1 offset:0
v_mfma_f32_16x16x32_bf16 a[228:231], a[164:167], a[100:103], a[228:231]
v_add_f32 v111, v111, v31
v_add_f32 v112, v112, v28
v_mfma_f32_16x16x32_bf16 a[228:231], a[196:199], a[132:135], a[228:231]
v_add_f32 v113, v113, v29
v_add_f32 v114, v114, v30
v_mfma_f32_16x16x32_bf16 v[228:231], a[192:195], a[132:135], v[228:231]
ds_read_b128 a[132:135], v2 offset:1024
v_add_f32 v115, v115, v31
v_mfma_f32_16x16x32_bf16 v[228:231], a[160:163], a[100:103], v[228:231]
ds_read_b128 a[100:103], v1 offset:1024
v_add_f32 v116, v116, v28
v_mfma_f32_16x16x32_bf16 v[232:235], a[160:163], a[104:107], v[232:235]
buffer_load_dwordx2 v[10:11], off, s[20:23], s36 sc1
v_add_f32 v117, v117, v29
v_mfma_f32_16x16x32_bf16 v[232:235], a[192:195], a[136:139], v[232:235]
v_add_f32 v118, v118, v30
v_add_f32 v119, v119, v31
v_mfma_f32_16x16x32_bf16 a[232:235], a[196:199], a[136:139], a[232:235]
ds_read_b128 a[136:139], v2 offset:2048
v_add_f32 v120, v120, v28
v_mfma_f32_16x16x32_bf16 a[232:235], a[164:167], a[104:107], a[232:235]
ds_read_b128 a[104:107], v1 offset:2048
v_add_f32 v121, v121, v29
v_mfma_f32_16x16x32_bf16 a[236:239], a[164:167], a[108:111], a[236:239]
v_add_f32 v122, v122, v30
v_add_f32 v123, v123, v31
v_mfma_f32_16x16x32_bf16 a[236:239], a[196:199], a[140:143], a[236:239]
v_add_f32 v124, v124, v28
v_add_f32 v125, v125, v29
v_mfma_f32_16x16x32_bf16 v[236:239], a[192:195], a[140:143], v[236:239]
ds_read_b128 a[140:143], v2 offset:3072
v_add_f32 v126, v126, v30
v_mfma_f32_16x16x32_bf16 v[236:239], a[160:163], a[108:111], v[236:239]
ds_read_b128 a[108:111], v1 offset:3072
v_add_f32 v127, v127, v31
v_mfma_f32_16x16x32_bf16 v[240:243], a[160:163], a[112:115], v[240:243]
v_lshlrev_b32 v28, 16, v18
v_and_b32 v29, s33, v18
v_mfma_f32_16x16x32_bf16 v[240:243], a[192:195], a[144:147], v[240:243]
v_lshlrev_b32 v30, 16, v19
v_and_b32 v31, s33, v19
v_mfma_f32_16x16x32_bf16 a[240:243], a[196:199], a[144:147], a[240:243]
ds_read_b128 a[144:147], v2 offset:4096
v_add_f32 v128, v128, v28
v_mfma_f32_16x16x32_bf16 a[240:243], a[164:167], a[112:115], a[240:243]
ds_read_b128 a[112:115], v1 offset:4096
v_add_f32 v129, v129, v29
v_mfma_f32_16x16x32_bf16 a[244:247], a[164:167], a[116:119], a[244:247]
v_add_f32 v130, v130, v30
v_add_f32 v131, v131, v31
v_mfma_f32_16x16x32_bf16 a[244:247], a[196:199], a[148:151], a[244:247]
v_add_f32 v132, v132, v28
v_add_f32 v133, v133, v29
v_mfma_f32_16x16x32_bf16 v[244:247], a[192:195], a[148:151], v[244:247]
ds_read_b128 a[148:151], v2 offset:5120
v_add_f32 v134, v134, v30
v_mfma_f32_16x16x32_bf16 v[244:247], a[160:163], a[116:119], v[244:247]
ds_read_b128 a[116:119], v1 offset:5120
v_add_f32 v135, v135, v31
v_mfma_f32_16x16x32_bf16 v[248:251], a[160:163], a[120:123], v[248:251]
v_add_f32 v136, v136, v28
v_add_f32 v137, v137, v29
v_mfma_f32_16x16x32_bf16 v[248:251], a[192:195], a[152:155], v[248:251]
v_add_f32 v138, v138, v30
v_add_f32 v139, v139, v31
v_mfma_f32_16x16x32_bf16 a[248:251], a[196:199], a[152:155], a[248:251]
ds_read_b128 a[152:155], v2 offset:6144
v_add_f32 v140, v140, v28
v_mfma_f32_16x16x32_bf16 a[248:251], a[164:167], a[120:123], a[248:251]
ds_read_b128 a[120:123], v1 offset:6144
v_add_f32 v141, v141, v29
v_mfma_f32_16x16x32_bf16 a[252:255], a[164:167], a[124:127], a[252:255]
buffer_load_dwordx4 a[164:167], v0, s[20:23], s30 offen offset:0 sc1
v_add_f32 v142, v142, v30
v_mfma_f32_16x16x32_bf16 a[252:255], a[196:199], a[156:159], a[252:255]
buffer_load_dwordx4 a[196:199], v0, s[20:23], s30 offen offset:1024 sc1
v_add_f32 v143, v143, v31
v_mfma_f32_16x16x32_bf16 v[252:255], a[192:195], a[156:159], v[252:255]
buffer_load_dwordx4 a[192:195], v0, s[20:23], s30 offen offset:2048 sc1
ds_read_b128 a[156:159], v2 offset:7168
v_mfma_f32_16x16x32_bf16 v[252:255], a[160:163], a[124:127], v[252:255]
buffer_load_dwordx4 a[160:163], v0, s[20:23], s30 offen offset:3072 sc1
s_add_u32 s30, s30, 0x1000
ds_read_b128 a[124:127], v1 offset:7168
L_q9:
s_waitcnt vmcnt(13) lgkmcnt(14)
v_mfma_f32_16x16x32_bf16 v[32:35], a[168:171], a[96:99], v[32:35]
v_add_f32 v144, v144, v28
v_mfma_f32_16x16x32_bf16 v[32:35], a[200:203], a[128:131], v[32:35]
v_add_f32 v145, v145, v29
v_add_f32 v146, v146, v30
v_mfma_f32_16x16x32_bf16 v[64:67], a[204:207], a[128:131], v[64:67]
v_add_f32 v147, v147, v31
v_add_f32 v148, v148, v28
v_mfma_f32_16x16x32_bf16 v[64:67], a[172:175], a[96:99], v[64:67]
v_add_f32 v149, v149, v29
v_add_f32 v150, v150, v30
s_waitcnt lgkmcnt(12)
v_mfma_f32_16x16x32_bf16 v[68:71], a[172:175], a[100:103], v[68:71]
v_add_f32 v151, v151, v31
v_mfma_f32_16x16x32_bf16 v[68:71], a[204:207], a[132:135], v[68:71]
v_add_f32 v152, v152, v28
v_add_f32 v153, v153, v29
v_mfma_f32_16x16x32_bf16 v[36:39], a[200:203], a[132:135], v[36:39]
v_add_f32 v154, v154, v30
v_add_f32 v155, v155, v31
v_mfma_f32_16x16x32_bf16 v[36:39], a[168:171], a[100:103], v[36:39]
v_add_f32 v156, v156, v28
v_add_f32 v157, v157, v29
s_waitcnt lgkmcnt(10)
v_mfma_f32_16x16x32_bf16 v[40:43], a[168:171], a[104:107], v[40:43]
v_add_f32 v158, v158, v30
v_mfma_f32_16x16x32_bf16 v[40:43], a[200:203], a[136:139], v[40:43]
v_add_f32 v159, v159, v31
v_mfma_f32_16x16x32_bf16 v[72:75], a[204:207], a[136:139], v[72:75]
v_mfma_f32_16x16x32_bf16 v[72:75], a[172:175], a[104:107], v[72:75]
s_waitcnt lgkmcnt(8)
v_mfma_f32_16x16x32_bf16 v[76:79], a[172:175], a[108:111], v[76:79]
v_mfma_f32_16x16x32_bf16 v[76:79], a[204:207], a[140:143], v[76:79]
v_mfma_f32_16x16x32_bf16 v[44:47], a[200:203], a[140:143], v[44:47]
v_mfma_f32_16x16x32_bf16 v[44:47], a[168:171], a[108:111], v[44:47]
s_waitcnt lgkmcnt(6)
v_mfma_f32_16x16x32_bf16 v[48:51], a[168:171], a[112:115], v[48:51]
v_mfma_f32_16x16x32_bf16 v[48:51], a[200:203], a[144:147], v[48:51]
v_mfma_f32_16x16x32_bf16 v[80:83], a[204:207], a[144:147], v[80:83]
v_mfma_f32_16x16x32_bf16 v[80:83], a[172:175], a[112:115], v[80:83]
s_waitcnt lgkmcnt(4)
v_mfma_f32_16x16x32_bf16 v[84:87], a[172:175], a[116:119], v[84:87]
v_mfma_f32_16x16x32_bf16 v[84:87], a[204:207], a[148:151], v[84:87]
v_mfma_f32_16x16x32_bf16 v[52:55], a[200:203], a[148:151], v[52:55]
v_mfma_f32_16x16x32_bf16 v[52:55], a[168:171], a[116:119], v[52:55]
s_waitcnt lgkmcnt(2)
v_mfma_f32_16x16x32_bf16 v[56:59], a[168:171], a[120:123], v[56:59]
v_mfma_f32_16x16x32_bf16 v[56:59], a[200:203], a[152:155], v[56:59]
v_mfma_f32_16x16x32_bf16 v[88:91], a[204:207], a[152:155], v[88:91]
v_mfma_f32_16x16x32_bf16 v[88:91], a[172:175], a[120:123], v[88:91]
s_waitcnt lgkmcnt(0)
v_mfma_f32_16x16x32_bf16 v[92:95], a[172:175], a[124:127], v[92:95]
buffer_load_dwordx4 a[172:175], v0, s[20:23], s30 offen offset:0 sc1
v_mfma_f32_16x16x32_bf16 v[92:95], a[204:207], a[156:159], v[92:95]
buffer_load_dwordx4 a[204:207], v0, s[20:23], s30 offen offset:1024 sc1
v_mfma_f32_16x16x32_bf16 v[60:63], a[200:203], a[156:159], v[60:63]
buffer_load_dwordx4 a[200:203], v0, s[20:23], s30 offen offset:2048 sc1
v_mfma_f32_16x16x32_bf16 v[60:63], a[168:171], a[124:127], v[60:63]
buffer_load_dwordx4 a[168:171], v0, s[20:23], s30 offen offset:3072 sc1
s_add_u32 s30, s30, 0x1000
s_waitcnt vmcnt(13)
v_mfma_f32_16x16x32_bf16 v[96:99], a[212:215], a[96:99], v[96:99]
s_add_u32 s96, s92, L_q11-L_pc
s_addc_u32 s97, s93, 0
s_load_dword s98, s[96:97], 0
v_mfma_f32_16x16x32_bf16 v[96:99], a[180:183], a[128:131], v[96:99]
v_mfma_f32_16x16x32_bf16 v[128:131], a[208:211], a[128:131], v[128:131]
v_mfma_f32_16x16x32_bf16 v[128:131], a[176:179], a[96:99], v[128:131]
v_mfma_f32_16x16x32_bf16 v[132:135], a[176:179], a[100:103], v[132:135]
v_mfma_f32_16x16x32_bf16 v[132:135], a[208:211], a[132:135], v[132:135]
v_mfma_f32_16x16x32_bf16 v[100:103], a[180:183], a[132:135], v[100:103]
v_mfma_f32_16x16x32_bf16 v[100:103], a[212:215], a[100:103], v[100:103]
v_mfma_f32_16x16x32_bf16 v[104:107], a[212:215], a[104:107], v[104:107]
s_waitcnt vmcnt(8)
v_readfirstlane_b32 s34, v10
v_readfirstlane_b32 s11, v11
s_xor_b32 s34, s34, s8
s_sub_u32 s34, s34, 4
s_cmp_lg_u32 s11, s9
s_cbranch_scc1 L_spin4
s_cmp_gt_u32 s34, 11
s_cbranch_scc1 L_spin4
L_back4:
s_add_u32 m0, s32, 0
s_add_u32 s39, s56, 33816576
v_mfma_f32_16x16x32_bf16 v[104:107], a[180:183], a[136:139], v[104:107]
buffer_load_dwordx4 v0, s[20:23], s39 offen offset:0 sc1 lds
v_mfma_f32_16x16x32_bf16 v[136:139], a[208:211], a[136:139], v[136:139]
v_mfma_f32_16x16x32_bf16 v[136:139], a[176:179], a[104:107], v[136:139]
v_mfma_f32_16x16x32_bf16 v[140:143], a[176:179], a[108:111], v[140:143]
v_mfma_f32_16x16x32_bf16 v[140:143], a[208:211], a[140:143], v[140:143]
v_mfma_f32_16x16x32_bf16 v[108:111], a[180:183], a[140:143], v[108:111]
v_mfma_f32_16x16x32_bf16 v[108:111], a[212:215], a[108:111], v[108:111]
v_mfma_f32_16x16x32_bf16 v[112:115], a[212:215], a[112:115], v[112:115]
v_mfma_f32_16x16x32_bf16 v[112:115], a[180:183], a[144:147], v[112:115]
v_mfma_f32_16x16x32_bf16 v[144:147], a[208:211], a[144:147], v[144:147]
v_mfma_f32_16x16x32_bf16 v[144:147], a[176:179], a[112:115], v[144:147]
v_mfma_f32_16x16x32_bf16 v[148:151], a[176:179], a[116:119], v[148:151]
v_mfma_f32_16x16x32_bf16 v[148:151], a[208:211], a[148:151], v[148:151]
v_mfma_f32_16x16x32_bf16 v[116:119], a[180:183], a[148:151], v[116:119]
v_mfma_f32_16x16x32_bf16 v[116:119], a[212:215], a[116:119], v[116:119]
v_mfma_f32_16x16x32_bf16 v[120:123], a[212:215], a[120:123], v[120:123]
v_mfma_f32_16x16x32_bf16 v[120:123], a[180:183], a[152:155], v[120:123]
v_mfma_f32_16x16x32_bf16 v[152:155], a[208:211], a[152:155], v[152:155]
v_mfma_f32_16x16x32_bf16 v[152:155], a[176:179], a[120:123], v[152:155]
v_mfma_f32_16x16x32_bf16 v[156:159], a[176:179], a[124:127], v[156:159]
buffer_load_dwordx4 a[176:179], v0, s[20:23], s30 offen offset:0 sc1
v_mfma_f32_16x16x32_bf16 v[156:159], a[208:211], a[156:159], v[156:159]
buffer_load_dwordx4 a[208:211], v0, s[20:23], s30 offen offset:1024 sc1
v_mfma_f32_16x16x32_bf16 v[124:127], a[180:183], a[156:159], v[124:127]
buffer_load_dwordx4 a[180:183], v0, s[20:23], s30 offen offset:2048 sc1
v_mfma_f32_16x16x32_bf16 v[124:127], a[212:215], a[124:127], v[124:127]
buffer_load_dwordx4 a[212:215], v0, s[20:23], s30 offen offset:3072 sc1
s_add_u32 s30, s30, 0x1000
v_mfma_f32_16x16x32_bf16 v[160:163], a[220:223], a[96:99], v[160:163]
v_mfma_f32_16x16x32_bf16 v[160:163], a[188:191], a[128:131], v[160:163]
buffer_load_dwordx4 v0, s[20:23], s39 offen offset:1024 sc1 lds
v_mfma_f32_16x16x32_bf16 v[192:195], a[216:219], a[128:131], v[192:195]
v_mfma_f32_16x16x32_bf16 v[192:195], a[184:187], a[96:99], v[192:195]
v_mfma_f32_16x16x32_bf16 v[196:199], a[184:187], a[100:103], v[196:199]
v_mfma_f32_16x16x32_bf16 v[196:199], a[216:219], a[132:135], v[196:199]
v_mfma_f32_16x16x32_bf16 v[164:167], a[188:191], a[132:135], v[164:167]
v_mfma_f32_16x16x32_bf16 v[164:167], a[220:223], a[100:103], v[164:167]
v_mfma_f32_16x16x32_bf16 v[168:171], a[220:223], a[104:107], v[168:171]
v_mfma_f32_16x16x32_bf16 v[168:171], a[188:191], a[136:139], v[168:171]
v_mfma_f32_16x16x32_bf16 v[200:203], a[216:219], a[136:139], v[200:203]
v_mfma_f32_16x16x32_bf16 v[200:203], a[184:187], a[104:107], v[200:203]
v_mfma_f32_16x16x32_bf16 v[204:207], a[184:187], a[108:111], v[204:207]
v_mfma_f32_16x16x32_bf16 v[204:207], a[216:219], a[140:143], v[204:207]
v_mfma_f32_16x16x32_bf16 v[172:175], a[188:191], a[140:143], v[172:175]
v_mfma_f32_16x16x32_bf16 v[172:175], a[220:223], a[108:111], v[172:175]
v_mfma_f32_16x16x32_bf16 v[176:179], a[220:223], a[112:115], v[176:179]
v_mfma_f32_16x16x32_bf16 v[176:179], a[188:191], a[144:147], v[176:179]
v_mfma_f32_16x16x32_bf16 v[208:211], a[216:219], a[144:147], v[208:211]
v_mfma_f32_16x16x32_bf16 v[208:211], a[184:187], a[112:115], v[208:211]
v_mfma_f32_16x16x32_bf16 v[212:215], a[184:187], a[116:119], v[212:215]
v_mfma_f32_16x16x32_bf16 v[212:215], a[216:219], a[148:151], v[212:215]
v_mfma_f32_16x16x32_bf16 v[180:183], a[188:191], a[148:151], v[180:183]
v_mfma_f32_16x16x32_bf16 v[180:183], a[220:223], a[116:119], v[180:183]
v_mfma_f32_16x16x32_bf16 v[184:187], a[220:223], a[120:123], v[184:187]
v_mfma_f32_16x16x32_bf16 v[184:187], a[188:191], a[152:155], v[184:187]
buffer_load_dwordx4 v0, s[20:23], s39 offen offset:2048 sc1 lds
v_mfma_f32_16x16x32_bf16 v[216:219], a[216:219], a[152:155], v[216:219]
v_mfma_f32_16x16x32_bf16 v[216:219], a[184:187], a[120:123], v[216:219]
v_mfma_f32_16x16x32_bf16 v[220:223], a[184:187], a[124:127], v[220:223]
buffer_load_dwordx4 a[184:187], v0, s[20:23], s30 offen offset:0 sc1
v_mfma_f32_16x16x32_bf16 v[220:223], a[216:219], a[156:159], v[220:223]
buffer_load_dwordx4 a[216:219], v0, s[20:23], s30 offen offset:1024 sc1
v_mfma_f32_16x16x32_bf16 v[188:191], a[188:191], a[156:159], v[188:191]
buffer_load_dwordx4 a[188:191], v0, s[20:23], s30 offen offset:2048 sc1
v_mfma_f32_16x16x32_bf16 v[188:191], a[220:223], a[124:127], v[188:191]
buffer_load_dwordx4 a[220:223], v0, s[20:23], s30 offen offset:3072 sc1
s_add_u32 s30, s30, 0x1000
s_waitcnt vmcnt(15)
v_mfma_f32_16x16x32_bf16 v[224:227], a[164:167], a[96:99], v[224:227]
v_mfma_f32_16x16x32_bf16 v[224:227], a[196:199], a[128:131], v[224:227]
v_mfma_f32_16x16x32_bf16 a[224:227], a[160:163], a[128:131], a[224:227]
v_xor_b32 v4, 0x16000, v6
ds_read_b128 a[128:131], v4 offset:0
v_mfma_f32_16x16x32_bf16 a[224:227], a[192:195], a[96:99], a[224:227]
v_xor_b32 v3, 0x14000, v6
ds_read_b128 a[96:99], v3 offset:0
v_mfma_f32_16x16x32_bf16 a[228:231], a[192:195], a[100:103], a[228:231]
v_mfma_f32_16x16x32_bf16 a[228:231], a[160:163], a[132:135], a[228:231]
v_mfma_f32_16x16x32_bf16 v[228:231], a[196:199], a[132:135], v[228:231]
ds_read_b128 a[132:135], v4 offset:1024
v_mfma_f32_16x16x32_bf16 v[228:231], a[164:167], a[100:103], v[228:231]
ds_read_b128 a[100:103], v3 offset:1024
v_mfma_f32_16x16x32_bf16 v[232:235], a[164:167], a[104:107], v[232:235]
v_mfma_f32_16x16x32_bf16 v[232:235], a[196:199], a[136:139], v[232:235]
v_mfma_f32_16x16x32_bf16 a[232:235], a[160:163], a[136:139], a[232:235]
ds_read_b128 a[136:139], v4 offset:2048
v_mfma_f32_16x16x32_bf16 a[232:235], a[192:195], a[104:107], a[232:235]
ds_read_b128 a[104:107], v3 offset:2048
v_mfma_f32_16x16x32_bf16 a[236:239], a[192:195], a[108:111], a[236:239]
v_mfma_f32_16x16x32_bf16 a[236:239], a[160:163], a[140:143], a[236:239]
v_mfma_f32_16x16x32_bf16 v[236:239], a[196:199], a[140:143], v[236:239]
ds_read_b128 a[140:143], v4 offset:3072
v_mfma_f32_16x16x32_bf16 v[236:239], a[164:167], a[108:111], v[236:239]
ds_read_b128 a[108:111], v3 offset:3072
v_mfma_f32_16x16x32_bf16 v[240:243], a[164:167], a[112:115], v[240:243]
v_mfma_f32_16x16x32_bf16 v[240:243], a[196:199], a[144:147], v[240:243]
buffer_load_dwordx4 v0, s[20:23], s39 offen offset:3072 sc1 lds
v_mfma_f32_16x16x32_bf16 a[240:243], a[160:163], a[144:147], a[240:243]
ds_read_b128 a[144:147], v4 offset:4096
v_mfma_f32_16x16x32_bf16 a[240:243], a[192:195], a[112:115], a[240:243]
ds_read_b128 a[112:115], v3 offset:4096
v_mfma_f32_16x16x32_bf16 a[244:247], a[192:195], a[116:119], a[244:247]
v_mfma_f32_16x16x32_bf16 a[244:247], a[160:163], a[148:151], a[244:247]
v_mfma_f32_16x16x32_bf16 v[244:247], a[196:199], a[148:151], v[244:247]
ds_read_b128 a[148:151], v4 offset:5120
v_mfma_f32_16x16x32_bf16 v[244:247], a[164:167], a[116:119], v[244:247]
ds_read_b128 a[116:119], v3 offset:5120
v_mfma_f32_16x16x32_bf16 v[248:251], a[164:167], a[120:123], v[248:251]
v_mfma_f32_16x16x32_bf16 v[248:251], a[196:199], a[152:155], v[248:251]
v_mfma_f32_16x16x32_bf16 a[248:251], a[160:163], a[152:155], a[248:251]
ds_read_b128 a[152:155], v4 offset:6144
v_mfma_f32_16x16x32_bf16 a[248:251], a[192:195], a[120:123], a[248:251]
ds_read_b128 a[120:123], v3 offset:6144
v_mfma_f32_16x16x32_bf16 a[252:255], a[192:195], a[124:127], a[252:255]
buffer_load_dwordx4 a[192:195], v0, s[20:23], s30 offen offset:0 sc1
v_mfma_f32_16x16x32_bf16 a[252:255], a[160:163], a[156:159], a[252:255]
buffer_load_dwordx4 a[160:163], v0, s[20:23], s30 offen offset:1024 sc1
v_mfma_f32_16x16x32_bf16 v[252:255], a[196:199], a[156:159], v[252:255]
buffer_load_dwordx4 a[196:199], v0, s[20:23], s30 offen offset:2048 sc1
ds_read_b128 a[156:159], v4 offset:7168
v_mfma_f32_16x16x32_bf16 v[252:255], a[164:167], a[124:127], v[252:255]
buffer_load_dwordx4 a[164:167], v0, s[20:23], s30 offen offset:3072 sc1
s_add_u32 s30, s30, 0x1000
ds_read_b128 a[124:127], v3 offset:7168
s_waitcnt vmcnt(16) lgkmcnt(14)
v_mfma_f32_16x16x32_bf16 v[32:35], a[172:175], a[96:99], v[32:35]
v_mfma_f32_16x16x32_bf16 v[32:35], a[204:207], a[128:131], v[32:35]
v_mfma_f32_16x16x32_bf16 v[64:67], a[168:171], a[128:131], v[64:67]
v_mfma_f32_16x16x32_bf16 v[64:67], a[200:203], a[96:99], v[64:67]
s_waitcnt lgkmcnt(12)
v_mfma_f32_16x16x32_bf16 v[68:71], a[200:203], a[100:103], v[68:71]
v_mfma_f32_16x16x32_bf16 v[68:71], a[168:171], a[132:135], v[68:71]
v_mfma_f32_16x16x32_bf16 v[36:39], a[204:207], a[132:135], v[36:39]
v_mfma_f32_16x16x32_bf16 v[36:39], a[172:175], a[100:103], v[36:39]
s_waitcnt lgkmcnt(10)
v_mfma_f32_16x16x32_bf16 v[40:43], a[172:175], a[104:107], v[40:43]
s_add_u32 m0, s32, 4096
s_add_u32 s39, s56, 33820672
v_mfma_f32_16x16x32_bf16 v[40:43], a[204:207], a[136:139], v[40:43]
buffer_load_dwordx4 v0, s[20:23], s39 offen offset:0 sc1 lds
v_mfma_f32_16x16x32_bf16 v[72:75], a[168:171], a[136:139], v[72:75]
v_mfma_f32_16x16x32_bf16 v[72:75], a[200:203], a[104:107], v[72:75]
s_waitcnt lgkmcnt(8)
v_mfma_f32_16x16x32_bf16 v[76:79], a[200:203], a[108:111], v[76:79]
v_mfma_f32_16x16x32_bf16 v[76:79], a[168:171], a[140:143], v[76:79]
v_mfma_f32_16x16x32_bf16 v[44:47], a[204:207], a[140:143], v[44:47]
v_mfma_f32_16x16x32_bf16 v[44:47], a[172:175], a[108:111], v[44:47]
s_waitcnt lgkmcnt(6)
v_mfma_f32_16x16x32_bf16 v[48:51], a[172:175], a[112:115], v[48:51]
v_mfma_f32_16x16x32_bf16 v[48:51], a[204:207], a[144:147], v[48:51]
v_mfma_f32_16x16x32_bf16 v[80:83], a[168:171], a[144:147], v[80:83]
v_mfma_f32_16x16x32_bf16 v[80:83], a[200:203], a[112:115], v[80:83]
s_waitcnt lgkmcnt(4)
v_mfma_f32_16x16x32_bf16 v[84:87], a[200:203], a[116:119], v[84:87]
v_mfma_f32_16x16x32_bf16 v[84:87], a[168:171], a[148:151], v[84:87]
v_mfma_f32_16x16x32_bf16 v[52:55], a[204:207], a[148:151], v[52:55]
v_mfma_f32_16x16x32_bf16 v[52:55], a[172:175], a[116:119], v[52:55]
s_waitcnt lgkmcnt(2)
v_mfma_f32_16x16x32_bf16 v[56:59], a[172:175], a[120:123], v[56:59]
v_mfma_f32_16x16x32_bf16 v[56:59], a[204:207], a[152:155], v[56:59]
v_mfma_f32_16x16x32_bf16 v[88:91], a[168:171], a[152:155], v[88:91]
v_mfma_f32_16x16x32_bf16 v[88:91], a[200:203], a[120:123], v[88:91]
s_waitcnt lgkmcnt(0)
v_mfma_f32_16x16x32_bf16 v[92:95], a[200:203], a[124:127], v[92:95]
buffer_load_dwordx4 a[200:203], v0, s[20:23], s30 offen offset:0 sc1
v_mfma_f32_16x16x32_bf16 v[92:95], a[168:171], a[156:159], v[92:95]
buffer_load_dwordx4 a[168:171], v0, s[20:23], s30 offen offset:1024 sc1
v_mfma_f32_16x16x32_bf16 v[60:63], a[204:207], a[156:159], v[60:63]
buffer_load_dwordx4 a[204:207], v0, s[20:23], s30 offen offset:2048 sc1
v_mfma_f32_16x16x32_bf16 v[60:63], a[172:175], a[124:127], v[60:63]
buffer_load_dwordx4 a[172:175], v0, s[20:23], s30 offen offset:3072 sc1
s_add_u32 s30, s30, 0x1000
s_waitcnt vmcnt(16)
v_mfma_f32_16x16x32_bf16 v[96:99], a[176:179], a[96:99], v[96:99]
v_mfma_f32_16x16x32_bf16 v[96:99], a[208:211], a[128:131], v[96:99]
buffer_load_dwordx4 v0, s[20:23], s39 offen offset:1024 sc1 lds
v_mfma_f32_16x16x32_bf16 v[128:131], a[212:215], a[128:131], v[128:131]
v_mfma_f32_16x16x32_bf16 v[128:131], a[180:183], a[96:99], v[128:131]
v_mfma_f32_16x16x32_bf16 v[132:135], a[180:183], a[100:103], v[132:135]
v_mfma_f32_16x16x32_bf16 v[132:135], a[212:215], a[132:135], v[132:135]
v_mfma_f32_16x16x32_bf16 v[100:103], a[208:211], a[132:135], v[100:103]
v_mfma_f32_16x16x32_bf16 v[100:103], a[176:179], a[100:103], v[100:103]
v_mfma_f32_16x16x32_bf16 v[104:107], a[176:179], a[104:107], v[104:107]
v_mfma_f32_16x16x32_bf16 v[104:107], a[208:211], a[136:139], v[104:107]
v_mfma_f32_16x16x32_bf16 v[136:139], a[212:215], a[136:139], v[136:139]
v_mfma_f32_16x16x32_bf16 v[136:139], a[180:183], a[104:107], v[136:139]
v_mfma_f32_16x16x32_bf16 v[140:143], a[180:183], a[108:111], v[140:143]
v_mfma_f32_16x16x32_bf16 v[140:143], a[212:215], a[140:143], v[140:143]
v_mfma_f32_16x16x32_bf16 v[108:111], a[208:211], a[140:143], v[108:111]
v_mfma_f32_16x16x32_bf16 v[108:111], a[176:179], a[108:111], v[108:111]
v_mfma_f32_16x16x32_bf16 v[112:115], a[176:179], a[112:115], v[112:115]
v_mfma_f32_16x16x32_bf16 v[112:115], a[208:211], a[144:147], v[112:115]
v_mfma_f32_16x16x32_bf16 v[144:147], a[212:215], a[144:147], v[144:147]
v_mfma_f32_16x16x32_bf16 v[144:147], a[180:183], a[112:115], v[144:147]
v_mfma_f32_16x16x32_bf16 v[148:151], a[180:183], a[116:119], v[148:151]
v_mfma_f32_16x16x32_bf16 v[148:151], a[212:215], a[148:151], v[148:151]
v_mfma_f32_16x16x32_bf16 v[116:119], a[208:211], a[148:151], v[116:119]
v_mfma_f32_16x16x32_bf16 v[116:119], a[176:179], a[116:119], v[116:119]
v_mfma_f32_16x16x32_bf16 v[120:123], a[176:179], a[120:123], v[120:123]
v_mfma_f32_16x16x32_bf16 v[120:123], a[208:211], a[152:155], v[120:123]
buffer_load_dwordx4 v0, s[20:23], s39 offen offset:2048 sc1 lds
v_mfma_f32_16x16x32_bf16 v[152:155], a[212:215], a[152:155], v[152:155]
v_mfma_f32_16x16x32_bf16 v[152:155], a[180:183], a[120:123], v[152:155]
v_mfma_f32_16x16x32_bf16 v[156:159], a[180:183], a[124:127], v[156:159]
buffer_load_dwordx4 a[180:183], v0, s[20:23], s30 offen offset:0 sc1
v_mfma_f32_16x16x32_bf16 v[156:159], a[212:215], a[156:159], v[156:159]
buffer_load_dwordx4 a[212:215], v0, s[20:23], s30 offen offset:1024 sc1
v_mfma_f32_16x16x32_bf16 v[124:127], a[208:211], a[156:159], v[124:127]
buffer_load_dwordx4 a[208:211], v0, s[20:23], s30 offen offset:2048 sc1
v_mfma_f32_16x16x32_bf16 v[124:127], a[176:179], a[124:127], v[124:127]
buffer_load_dwordx4 a[176:179], v0, s[20:23], s30 offen offset:3072 sc1
s_add_u32 s30, s30, 0x1000
s_waitcnt vmcnt(16)
v_mfma_f32_16x16x32_bf16 v[160:163], a[184:187], a[96:99], v[160:163]
v_mfma_f32_16x16x32_bf16 v[160:163], a[216:219], a[128:131], v[160:163]
v_mfma_f32_16x16x32_bf16 v[192:195], a[220:223], a[128:131], v[192:195]
v_mfma_f32_16x16x32_bf16 v[192:195], a[188:191], a[96:99], v[192:195]
v_mfma_f32_16x16x32_bf16 v[196:199], a[188:191], a[100:103], v[196:199]
v_mfma_f32_16x16x32_bf16 v[196:199], a[220:223], a[132:135], v[196:199]
v_mfma_f32_16x16x32_bf16 v[164:167], a[216:219], a[132:135], v[164:167]
v_mfma_f32_16x16x32_bf16 v[164:167], a[184:187], a[100:103], v[164:167]
v_mfma_f32_16x16x32_bf16 v[168:171], a[184:187], a[104:107], v[168:171]
v_mfma_f32_16x16x32_bf16 v[168:171], a[216:219], a[136:139], v[168:171]
v_mfma_f32_16x16x32_bf16 v[200:203], a[220:223], a[136:139], v[200:203]
v_mfma_f32_16x16x32_bf16 v[200:203], a[188:191], a[104:107], v[200:203]
v_mfma_f32_16x16x32_bf16 v[204:207], a[188:191], a[108:111], v[204:207]
v_mfma_f32_16x16x32_bf16 v[204:207], a[220:223], a[140:143], v[204:207]
v_mfma_f32_16x16x32_bf16 v[172:175], a[216:219], a[140:143], v[172:175]
v_mfma_f32_16x16x32_bf16 v[172:175], a[184:187], a[108:111], v[172:175]
v_mfma_f32_16x16x32_bf16 v[176:179], a[184:187], a[112:115], v[176:179]
v_mfma_f32_16x16x32_bf16 v[176:179], a[216:219], a[144:147], v[176:179]
buffer_load_dwordx4 v0, s[20:23], s39 offen offset:3072 sc1 lds
v_mfma_f32_16x16x32_bf16 v[208:211], a[220:223], a[144:147], v[208:211]
v_mfma_f32_16x16x32_bf16 v[208:211], a[188:191], a[112:115], v[208:211]
v_mfma_f32_16x16x32_bf16 v[212:215], a[188:191], a[116:119], v[212:215]
v_mfma_f32_16x16x32_bf16 v[212:215], a[220:223], a[148:151], v[212:215]
v_mfma_f32_16x16x32_bf16 v[180:183], a[216:219], a[148:151], v[180:183]
v_mfma_f32_16x16x32_bf16 v[180:183], a[184:187], a[116:119], v[180:183]
v_mfma_f32_16x16x32_bf16 v[184:187], a[184:187], a[120:123], v[184:187]
v_mfma_f32_16x16x32_bf16 v[184:187], a[216:219], a[152:155], v[184:187]
v_mfma_f32_16x16x32_bf16 v[216:219], a[220:223], a[152:155], v[216:219]
v_mfma_f32_16x16x32_bf16 v[216:219], a[188:191], a[120:123], v[216:219]
v_mfma_f32_16x16x32_bf16 v[220:223], a[188:191], a[124:127], v[220:223]
buffer_load_dwordx4 a[188:191], v0, s[20:23], s30 offen offset:0 sc1
v_mfma_f32_16x16x32_bf16 v[220:223], a[220:223], a[156:159], v[220:223]
buffer_load_dwordx4 a[220:223], v0, s[20:23], s30 offen offset:1024 sc1
v_mfma_f32_16x16x32_bf16 v[188:191], a[216:219], a[156:159], v[188:191]
buffer_load_dwordx4 a[216:219], v0, s[20:23], s30 offen offset:2048 sc1
v_mfma_f32_16x16x32_bf16 v[188:191], a[184:187], a[124:127], v[188:191]
buffer_load_dwordx4 a[184:187], v0, s[20:23], s30 offen offset:3072 sc1
s_add_u32 s30, s30, 0x1000
s_barrier
s_waitcnt vmcnt(16)
v_mfma_f32_16x16x32_bf16 v[224:227], a[192:195], a[96:99], v[224:227]
v_mfma_f32_16x16x32_bf16 v[224:227], a[160:163], a[128:131], v[224:227]
v_mfma_f32_16x16x32_bf16 a[224:227], a[164:167], a[128:131], a[224:227]
ds_read_b128 a[128:131], v2 offset:32768
v_mfma_f32_16x16x32_bf16 a[224:227], a[196:199], a[96:99], a[224:227]
ds_read_b128 a[96:99], v1 offset:32768
v_mfma_f32_16x16x32_bf16 a[228:231], a[196:199], a[100:103], a[228:231]
v_mfma_f32_16x16x32_bf16 a[228:231], a[164:167], a[132:135], a[228:231]
v_mfma_f32_16x16x32_bf16 v[228:231], a[160:163], a[132:135], v[228:231]
ds_read_b128 a[132:135], v2 offset:33792
v_mfma_f32_16x16x32_bf16 v[228:231], a[192:195], a[100:103], v[228:231]
ds_read_b128 a[100:103], v1 offset:33792
v_mfma_f32_16x16x32_bf16 v[232:235], a[192:195], a[104:107], v[232:235]
s_add_u32 m0, s32, 32768
s_add_u32 s39, s56, 33849344
v_mfma_f32_16x16x32_bf16 v[232:235], a[160:163], a[136:139], v[232:235]
buffer_load_dwordx4 v0, s[20:23], s39 offen offset:0 sc1 lds
v_mfma_f32_16x16x32_bf16 a[232:235], a[164:167], a[136:139], a[232:235]
ds_read_b128 a[136:139], v2 offset:34816
v_mfma_f32_16x16x32_bf16 a[232:235], a[196:199], a[104:107], a[232:235]
ds_read_b128 a[104:107], v1 offset:34816
v_mfma_f32_16x16x32_bf16 a[236:239], a[196:199], a[108:111], a[236:239]
v_mfma_f32_16x16x32_bf16 a[236:239], a[164:167], a[140:143], a[236:239]
v_mfma_f32_16x16x32_bf16 v[236:239], a[160:163], a[140:143], v[236:239]
ds_read_b128 a[140:143], v2 offset:35840
v_mfma_f32_16x16x32_bf16 v[236:239], a[192:195], a[108:111], v[236:239]
ds_read_b128 a[108:111], v1 offset:35840
v_mfma_f32_16x16x32_bf16 v[240:243], a[192:195], a[112:115], v[240:243]
v_mfma_f32_16x16x32_bf16 v[240:243], a[160:163], a[144:147], v[240:243]
v_mfma_f32_16x16x32_bf16 a[240:243], a[164:167], a[144:147], a[240:243]
ds_read_b128 a[144:147], v2 offset:36864
v_mfma_f32_16x16x32_bf16 a[240:243], a[196:199], a[112:115], a[240:243]
ds_read_b128 a[112:115], v1 offset:36864
v_mfma_f32_16x16x32_bf16 a[244:247], a[196:199], a[116:119], a[244:247]
v_mfma_f32_16x16x32_bf16 a[244:247], a[164:167], a[148:151], a[244:247]
v_mfma_f32_16x16x32_bf16 v[244:247], a[160:163], a[148:151], v[244:247]
ds_read_b128 a[148:151], v2 offset:37888
v_mfma_f32_16x16x32_bf16 v[244:247], a[192:195], a[116:119], v[244:247]
ds_read_b128 a[116:119], v1 offset:37888
v_mfma_f32_16x16x32_bf16 v[248:251], a[192:195], a[120:123], v[248:251]
v_mfma_f32_16x16x32_bf16 v[248:251], a[160:163], a[152:155], v[248:251]
v_mfma_f32_16x16x32_bf16 a[248:251], a[164:167], a[152:155], a[248:251]
ds_read_b128 a[152:155], v2 offset:38912
v_mfma_f32_16x16x32_bf16 a[248:251], a[196:199], a[120:123], a[248:251]
ds_read_b128 a[120:123], v1 offset:38912
v_mfma_f32_16x16x32_bf16 a[252:255], a[196:199], a[124:127], a[252:255]
buffer_load_dwordx4 a[196:199], v0, s[20:23], s30 offen offset:0 sc1
v_mfma_f32_16x16x32_bf16 a[252:255], a[164:167], a[156:159], a[252:255]
buffer_load_dwordx4 a[164:167], v0, s[20:23], s30 offen offset:1024 sc1
v_mfma_f32_16x16x32_bf16 v[252:255], a[160:163], a[156:159], v[252:255]
buffer_load_dwordx4 a[160:163], v0, s[20:23], s30 offen offset:2048 sc1
ds_read_b128 a[156:159], v2 offset:39936
v_mfma_f32_16x16x32_bf16 v[252:255], a[192:195], a[124:127], v[252:255]
buffer_load_dwordx4 a[192:195], v0, s[20:23], s30 offen offset:3072 sc1
s_add_u32 s30, s30, 0x1000
ds_read_b128 a[124:127], v1 offset:39936
s_waitcnt vmcnt(16) lgkmcnt(14)
v_mfma_f32_16x16x32_bf16 v[32:35], a[200:203], a[96:99], v[32:35]
v_mfma_f32_16x16x32_bf16 v[32:35], a[168:171], a[128:131], v[32:35]
buffer_load_dwordx4 v0, s[20:23], s39 offen offset:1024 sc1 lds
v_mfma_f32_16x16x32_bf16 v[64:67], a[172:175], a[128:131], v[64:67]
v_mfma_f32_16x16x32_bf16 v[64:67], a[204:207], a[96:99], v[64:67]
s_waitcnt lgkmcnt(12)
v_mfma_f32_16x16x32_bf16 v[68:71], a[204:207], a[100:103], v[68:71]
v_mfma_f32_16x16x32_bf16 v[68:71], a[172:175], a[132:135], v[68:71]
v_mfma_f32_16x16x32_bf16 v[36:39], a[168:171], a[132:135], v[36:39]
v_mfma_f32_16x16x32_bf16 v[36:39], a[200:203], a[100:103], v[36:39]
s_waitcnt lgkmcnt(10)
v_mfma_f32_16x16x32_bf16 v[40:43], a[200:203], a[104:107], v[40:43]
v_mfma_f32_16x16x32_bf16 v[40:43], a[168:171], a[136:139], v[40:43]
v_mfma_f32_16x16x32_bf16 v[72:75], a[172:175], a[136:139], v[72:75]
v_mfma_f32_16x16x32_bf16 v[72:75], a[204:207], a[104:107], v[72:75]
s_waitcnt lgkmcnt(8)
v_mfma_f32_16x16x32_bf16 v[76:79], a[204:207], a[108:111], v[76:79]
v_mfma_f32_16x16x32_bf16 v[76:79], a[172:175], a[140:143], v[76:79]
v_mfma_f32_16x16x32_bf16 v[44:47], a[168:171], a[140:143], v[44:47]
v_mfma_f32_16x16x32_bf16 v[44:47], a[200:203], a[108:111], v[44:47]
s_waitcnt lgkmcnt(6)
v_mfma_f32_16x16x32_bf16 v[48:51], a[200:203], a[112:115], v[48:51]
v_mfma_f32_16x16x32_bf16 v[48:51], a[168:171], a[144:147], v[48:51]
v_mfma_f32_16x16x32_bf16 v[80:83], a[172:175], a[144:147], v[80:83]
v_mfma_f32_16x16x32_bf16 v[80:83], a[204:207], a[112:115], v[80:83]
s_waitcnt lgkmcnt(4)
v_mfma_f32_16x16x32_bf16 v[84:87], a[204:207], a[116:119], v[84:87]
v_mfma_f32_16x16x32_bf16 v[84:87], a[172:175], a[148:151], v[84:87]
v_mfma_f32_16x16x32_bf16 v[52:55], a[168:171], a[148:151], v[52:55]
v_mfma_f32_16x16x32_bf16 v[52:55], a[200:203], a[116:119], v[52:55]
s_waitcnt lgkmcnt(2)
v_mfma_f32_16x16x32_bf16 v[56:59], a[200:203], a[120:123], v[56:59]
v_mfma_f32_16x16x32_bf16 v[56:59], a[168:171], a[152:155], v[56:59]
buffer_load_dwordx4 v0, s[20:23], s39 offen offset:2048 sc1 lds
v_mfma_f32_16x16x32_bf16 v[88:91], a[172:175], a[152:155], v[88:91]
v_mfma_f32_16x16x32_bf16 v[88:91], a[204:207], a[120:123], v[88:91]
s_waitcnt lgkmcnt(0)
v_mfma_f32_16x16x32_bf16 v[92:95], a[204:207], a[124:127], v[92:95]
buffer_load_dwordx4 a[204:207], v0, s[20:23], s30 offen offset:0 sc1
v_mfma_f32_16x16x32_bf16 v[92:95], a[172:175], a[156:159], v[92:95]
buffer_load_dwordx4 a[172:175], v0, s[20:23], s30 offen offset:1024 sc1
v_mfma_f32_16x16x32_bf16 v[60:63], a[168:171], a[156:159], v[60:63]
buffer_load_dwordx4 a[168:171], v0, s[20:23], s30 offen offset:2048 sc1
v_mfma_f32_16x16x32_bf16 v[60:63], a[200:203], a[124:127], v[60:63]
buffer_load_dwordx4 a[200:203], v0, s[20:23], s30 offen offset:3072 sc1
s_add_u32 s30, s30, 0x1000
s_waitcnt vmcnt(16)
v_mfma_f32_16x16x32_bf16 v[96:99], a[180:183], a[96:99], v[96:99]
v_mfma_f32_16x16x32_bf16 v[96:99], a[212:215], a[128:131], v[96:99]
v_mfma_f32_16x16x32_bf16 v[128:131], a[176:179], a[128:131], v[128:131]
v_mfma_f32_16x16x32_bf16 v[128:131], a[208:211], a[96:99], v[128:131]
v_mfma_f32_16x16x32_bf16 v[132:135], a[208:211], a[100:103], v[132:135]
v_mfma_f32_16x16x32_bf16 v[132:135], a[176:179], a[132:135], v[132:135]
v_mfma_f32_16x16x32_bf16 v[100:103], a[212:215], a[132:135], v[100:103]
v_mfma_f32_16x16x32_bf16 v[100:103], a[180:183], a[100:103], v[100:103]
v_mfma_f32_16x16x32_bf16 v[104:107], a[180:183], a[104:107], v[104:107]
v_mfma_f32_16x16x32_bf16 v[104:107], a[212:215], a[136:139], v[104:107]
v_mfma_f32_16x16x32_bf16 v[136:139], a[176:179], a[136:139], v[136:139]
v_mfma_f32_16x16x32_bf16 v[136:139], a[208:211], a[104:107], v[136:139]
v_mfma_f32_16x16x32_bf16 v[140:143], a[208:211], a[108:111], v[140:143]
v_mfma_f32_16x16x32_bf16 v[140:143], a[176:179], a[140:143], v[140:143]
v_mfma_f32_16x16x32_bf16 v[108:111], a[212:215], a[140:143], v[108:111]
v_mfma_f32_16x16x32_bf16 v[108:111], a[180:183], a[108:111], v[108:111]
v_mfma_f32_16x16x32_bf16 v[112:115], a[180:183], a[112:115], v[112:115]
v_mfma_f32_16x16x32_bf16 v[112:115], a[212:215], a[144:147], v[112:115]
buffer_load_dwordx4 v0, s[20:23], s39 offen offset:3072 sc1 lds
v_mfma_f32_16x16x32_bf16 v[144:147], a[176:179], a[144:147], v[144:147]
v_mfma_f32_16x16x32_bf16 v[144:147], a[208:211], a[112:115], v[144:147]
v_mfma_f32_16x16x32_bf16 v[148:151], a[208:211], a[116:119], v[148:151]
v_mfma_f32_16x16x32_bf16 v[148:151], a[176:179], a[148:151], v[148:151]
v_mfma_f32_16x16x32_bf16 v[116:119], a[212:215], a[148:151], v[116:119]
v_mfma_f32_16x16x32_bf16 v[116:119], a[180:183], a[116:119], v[116:119]
v_mfma_f32_16x16x32_bf16 v[120:123], a[180:183], a[120:123], v[120:123]
v_mfma_f32_16x16x32_bf16 v[120:123], a[212:215], a[152:155], v[120:123]
v_mfma_f32_16x16x32_bf16 v[152:155], a[176:179], a[152:155], v[152:155]
v_mfma_f32_16x16x32_bf16 v[152:155], a[208:211], a[120:123], v[152:155]
v_mfma_f32_16x16x32_bf16 v[156:159], a[208:211], a[124:127], v[156:159]
buffer_load_dwordx4 a[208:211], v0, s[20:23], s30 offen offset:0 sc1
v_mfma_f32_16x16x32_bf16 v[156:159], a[176:179], a[156:159], v[156:159]
buffer_load_dwordx4 a[176:179], v0, s[20:23], s30 offen offset:1024 sc1
v_mfma_f32_16x16x32_bf16 v[124:127], a[212:215], a[156:159], v[124:127]
buffer_load_dwordx4 a[212:215], v0, s[20:23], s30 offen offset:2048 sc1
v_mfma_f32_16x16x32_bf16 v[124:127], a[180:183], a[124:127], v[124:127]
buffer_load_dwordx4 a[180:183], v0, s[20:23], s30 offen offset:3072 sc1
s_add_u32 s30, s30, 0x1000
s_waitcnt vmcnt(16)
v_mfma_f32_16x16x32_bf16 v[160:163], a[188:191], a[96:99], v[160:163]
v_mfma_f32_16x16x32_bf16 v[160:163], a[220:223], a[128:131], v[160:163]
v_mfma_f32_16x16x32_bf16 v[192:195], a[184:187], a[128:131], v[192:195]
v_mfma_f32_16x16x32_bf16 v[192:195], a[216:219], a[96:99], v[192:195]
v_mfma_f32_16x16x32_bf16 v[196:199], a[216:219], a[100:103], v[196:199]
v_mfma_f32_16x16x32_bf16 v[196:199], a[184:187], a[132:135], v[196:199]
v_mfma_f32_16x16x32_bf16 v[164:167], a[220:223], a[132:135], v[164:167]
v_mfma_f32_16x16x32_bf16 v[164:167], a[188:191], a[100:103], v[164:167]
v_mfma_f32_16x16x32_bf16 v[168:171], a[188:191], a[104:107], v[168:171]
s_add_u32 m0, s32, 36864
s_add_u32 s39, s56, 33853440
v_mfma_f32_16x16x32_bf16 v[168:171], a[220:223], a[136:139], v[168:171]
buffer_load_dwordx4 v0, s[20:23], s39 offen offset:0 sc1 lds
v_mfma_f32_16x16x32_bf16 v[200:203], a[184:187], a[136:139], v[200:203]
v_mfma_f32_16x16x32_bf16 v[200:203], a[216:219], a[104:107], v[200:203]
v_mfma_f32_16x16x32_bf16 v[204:207], a[216:219], a[108:111], v[204:207]
v_mfma_f32_16x16x32_bf16 v[204:207], a[184:187], a[140:143], v[204:207]
v_mfma_f32_16x16x32_bf16 v[172:175], a[220:223], a[140:143], v[172:175]
v_mfma_f32_16x16x32_bf16 v[172:175], a[188:191], a[108:111], v[172:175]
v_mfma_f32_16x16x32_bf16 v[176:179], a[188:191], a[112:115], v[176:179]
v_mfma_f32_16x16x32_bf16 v[176:179], a[220:223], a[144:147], v[176:179]
v_mfma_f32_16x16x32_bf16 v[208:211], a[184:187], a[144:147], v[208:211]
v_mfma_f32_16x16x32_bf16 v[208:211], a[216:219], a[112:115], v[208:211]
v_mfma_f32_16x16x32_bf16 v[212:215], a[216:219], a[116:119], v[212:215]
v_mfma_f32_16x16x32_bf16 v[212:215], a[184:187], a[148:151], v[212:215]
v_mfma_f32_16x16x32_bf16 v[180:183], a[220:223], a[148:151], v[180:183]
v_mfma_f32_16x16x32_bf16 v[180:183], a[188:191], a[116:119], v[180:183]
v_mfma_f32_16x16x32_bf16 v[184:187], a[188:191], a[120:123], v[184:187]
v_mfma_f32_16x16x32_bf16 v[184:187], a[220:223], a[152:155], v[184:187]
v_mfma_f32_16x16x32_bf16 v[216:219], a[184:187], a[152:155], v[216:219]
v_mfma_f32_16x16x32_bf16 v[216:219], a[216:219], a[120:123], v[216:219]
v_mfma_f32_16x16x32_bf16 v[220:223], a[216:219], a[124:127], v[220:223]
buffer_load_dwordx4 a[216:219], v0, s[20:23], s30 offen offset:0 sc1
v_mfma_f32_16x16x32_bf16 v[220:223], a[184:187], a[156:159], v[220:223]
buffer_load_dwordx4 a[184:187], v0, s[20:23], s30 offen offset:1024 sc1
v_mfma_f32_16x16x32_bf16 v[188:191], a[220:223], a[156:159], v[188:191]
buffer_load_dwordx4 a[220:223], v0, s[20:23], s30 offen offset:2048 sc1
v_mfma_f32_16x16x32_bf16 v[188:191], a[188:191], a[124:127], v[188:191]
buffer_load_dwordx4 a[188:191], v0, s[20:23], s30 offen offset:3072 sc1
s_add_u32 s30, s30, 0x1000
s_waitcnt vmcnt(16)
v_mfma_f32_16x16x32_bf16 v[224:227], a[196:199], a[96:99], v[224:227]
v_mfma_f32_16x16x32_bf16 v[224:227], a[164:167], a[128:131], v[224:227]
buffer_load_dwordx4 v0, s[20:23], s39 offen offset:1024 sc1 lds
v_mfma_f32_16x16x32_bf16 a[224:227], a[192:195], a[128:131], a[224:227]
ds_read_b128 a[128:131], v4 offset:32768
v_mfma_f32_16x16x32_bf16 a[224:227], a[160:163], a[96:99], a[224:227]
ds_read_b128 a[96:99], v3 offset:32768
v_mfma_f32_16x16x32_bf16 a[228:231], a[160:163], a[100:103], a[228:231]
v_mfma_f32_16x16x32_bf16 a[228:231], a[192:195], a[132:135], a[228:231]
v_mfma_f32_16x16x32_bf16 v[228:231], a[164:167], a[132:135], v[228:231]
ds_read_b128 a[132:135], v4 offset:33792
v_mfma_f32_16x16x32_bf16 v[228:231], a[196:199], a[100:103], v[228:231]
ds_read_b128 a[100:103], v3 offset:33792
v_mfma_f32_16x16x32_bf16 v[232:235], a[196:199], a[104:107], v[232:235]
v_mfma_f32_16x16x32_bf16 v[232:235], a[164:167], a[136:139], v[232:235]
v_mfma_f32_16x16x32_bf16 a[232:235], a[192:195], a[136:139], a[232:235]
ds_read_b128 a[136:139], v4 offset:34816
v_mfma_f32_16x16x32_bf16 a[232:235], a[160:163], a[104:107], a[232:235]
ds_read_b128 a[104:107], v3 offset:34816
buffer_load_dwordx2 v[10:11], off, s[20:23], s36 sc1
v_mfma_f32_16x16x32_bf16 a[236:239], a[160:163], a[108:111], a[236:239]
v_mfma_f32_16x16x32_bf16 a[236:239], a[192:195], a[140:143], a[236:239]
v_mfma_f32_16x16x32_bf16 v[236:239], a[164:167], a[140:143], v[236:239]
ds_read_b128 a[140:143], v4 offset:35840
v_mfma_f32_16x16x32_bf16 v[236:239], a[196:199], a[108:111], v[236:239]
ds_read_b128 a[108:111], v3 offset:35840
v_mfma_f32_16x16x32_bf16 v[240:243], a[196:199], a[112:115], v[240:243]
v_mfma_f32_16x16x32_bf16 v[240:243], a[164:167], a[144:147], v[240:243]
v_mfma_f32_16x16x32_bf16 a[240:243], a[192:195], a[144:147], a[240:243]
ds_read_b128 a[144:147], v4 offset:36864
v_mfma_f32_16x16x32_bf16 a[240:243], a[160:163], a[112:115], a[240:243]
ds_read_b128 a[112:115], v3 offset:36864
v_mfma_f32_16x16x32_bf16 a[244:247], a[160:163], a[116:119], a[244:247]
v_mfma_f32_16x16x32_bf16 a[244:247], a[192:195], a[148:151], a[244:247]
v_mfma_f32_16x16x32_bf16 v[244:247], a[164:167], a[148:151], v[244:247]
ds_read_b128 a[148:151], v4 offset:37888
v_mfma_f32_16x16x32_bf16 v[244:247], a[196:199], a[116:119], v[244:247]
ds_read_b128 a[116:119], v3 offset:37888
v_mfma_f32_16x16x32_bf16 v[248:251], a[196:199], a[120:123], v[248:251]
v_mfma_f32_16x16x32_bf16 v[248:251], a[164:167], a[152:155], v[248:251]
buffer_load_dwordx4 v0, s[20:23], s39 offen offset:2048 sc1 lds
v_mfma_f32_16x16x32_bf16 a[248:251], a[192:195], a[152:155], a[248:251]
ds_read_b128 a[152:155], v4 offset:38912
v_mfma_f32_16x16x32_bf16 a[248:251], a[160:163], a[120:123], a[248:251]
ds_read_b128 a[120:123], v3 offset:38912
v_mfma_f32_16x16x32_bf16 a[252:255], a[160:163], a[124:127], a[252:255]
buffer_load_dwordx4 a[160:163], v0, s[20:23], s30 offen offset:0 sc1
v_mfma_f32_16x16x32_bf16 a[252:255], a[192:195], a[156:159], a[252:255]
buffer_load_dwordx4 a[192:195], v0, s[20:23], s30 offen offset:1024 sc1
v_mfma_f32_16x16x32_bf16 v[252:255], a[164:167], a[156:159], v[252:255]
buffer_load_dwordx4 a[164:167], v0, s[20:23], s30 offen offset:2048 sc1
ds_read_b128 a[156:159], v4 offset:39936
v_mfma_f32_16x16x32_bf16 v[252:255], a[196:199], a[124:127], v[252:255]
buffer_load_dwordx4 a[196:199], v0, s[20:23], s30 offen offset:3072 sc1
s_add_u32 s30, s30, 0x1000
ds_read_b128 a[124:127], v3 offset:39936
s_waitcnt vmcnt(17) lgkmcnt(14)
v_mfma_f32_16x16x32_bf16 v[32:35], a[204:207], a[96:99], v[32:35]
v_mfma_f32_16x16x32_bf16 v[32:35], a[172:175], a[128:131], v[32:35]
v_mfma_f32_16x16x32_bf16 v[64:67], a[200:203], a[128:131], v[64:67]
v_mfma_f32_16x16x32_bf16 v[64:67], a[168:171], a[96:99], v[64:67]
s_waitcnt lgkmcnt(12)
v_mfma_f32_16x16x32_bf16 v[68:71], a[168:171], a[100:103], v[68:71]
buffer_load_dwordx4 v[20:23], v9, s[24:27], s37 offen offset:128
v_mfma_f32_16x16x32_bf16 v[68:71], a[200:203], a[132:135], v[68:71]
v_mfma_f32_16x16x32_bf16 v[36:39], a[172:175], a[132:135], v[36:39]
v_mfma_f32_16x16x32_bf16 v[36:39], a[204:207], a[100:103], v[36:39]
s_waitcnt lgkmcnt(10)
v_mfma_f32_16x16x32_bf16 v[40:43], a[204:207], a[104:107], v[40:43]
buffer_load_dwordx4 v[24:27], v9, s[24:27], s37 offen offset:192
v_mfma_f32_16x16x32_bf16 v[40:43], a[172:175], a[136:139], v[40:43]
v_mfma_f32_16x16x32_bf16 v[72:75], a[200:203], a[136:139], v[72:75]
v_mfma_f32_16x16x32_bf16 v[72:75], a[168:171], a[104:107], v[72:75]
s_waitcnt lgkmcnt(8)
v_mfma_f32_16x16x32_bf16 v[76:79], a[168:171], a[108:111], v[76:79]
v_mfma_f32_16x16x32_bf16 v[76:79], a[200:203], a[140:143], v[76:79]
v_mfma_f32_16x16x32_bf16 v[44:47], a[172:175], a[140:143], v[44:47]
v_mfma_f32_16x16x32_bf16 v[44:47], a[204:207], a[108:111], v[44:47]
s_waitcnt lgkmcnt(6)
v_mfma_f32_16x16x32_bf16 v[48:51], a[204:207], a[112:115], v[48:51]
v_mfma_f32_16x16x32_bf16 v[48:51], a[172:175], a[144:147], v[48:51]
buffer_load_dwordx4 v0, s[20:23], s39 offen offset:3072 sc1 lds
v_mfma_f32_16x16x32_bf16 v[80:83], a[200:203], a[144:147], v[80:83]
v_mfma_f32_16x16x32_bf16 v[80:83], a[168:171], a[112:115], v[80:83]
s_waitcnt lgkmcnt(4)
v_mfma_f32_16x16x32_bf16 v[84:87], a[168:171], a[116:119], v[84:87]
v_mfma_f32_16x16x32_bf16 v[84:87], a[200:203], a[148:151], v[84:87]
v_mfma_f32_16x16x32_bf16 v[52:55], a[172:175], a[148:151], v[52:55]
v_mfma_f32_16x16x32_bf16 v[52:55], a[204:207], a[116:119], v[52:55]
s_waitcnt lgkmcnt(2)
v_mfma_f32_16x16x32_bf16 v[56:59], a[204:207], a[120:123], v[56:59]
v_mfma_f32_16x16x32_bf16 v[56:59], a[172:175], a[152:155], v[56:59]
v_mfma_f32_16x16x32_bf16 v[88:91], a[200:203], a[152:155], v[88:91]
v_mfma_f32_16x16x32_bf16 v[88:91], a[168:171], a[120:123], v[88:91]
s_waitcnt lgkmcnt(0)
v_mfma_f32_16x16x32_bf16 v[92:95], a[168:171], a[124:127], v[92:95]
buffer_load_dwordx4 a[168:171], v0, s[20:23], s30 offen offset:0 sc1
v_mfma_f32_16x16x32_bf16 v[92:95], a[200:203], a[156:159], v[92:95]
buffer_load_dwordx4 a[200:203], v0, s[20:23], s30 offen offset:1024 sc1
v_mfma_f32_16x16x32_bf16 v[60:63], a[172:175], a[156:159], v[60:63]
buffer_load_dwordx4 a[172:175], v0, s[20:23], s30 offen offset:2048 sc1
v_mfma_f32_16x16x32_bf16 v[60:63], a[204:207], a[124:127], v[60:63]
buffer_load_dwordx4 a[204:207], v0, s[20:23], s30 offen offset:3072 sc1
s_add_u32 s30, s30, 0x1000
s_waitcnt vmcnt(19)
v_mfma_f32_16x16x32_bf16 v[96:99], a[208:211], a[96:99], v[96:99]
v_mfma_f32_16x16x32_bf16 v[96:99], a[176:179], a[128:131], v[96:99]
v_mfma_f32_16x16x32_bf16 v[128:131], a[180:183], a[128:131], v[128:131]
v_mfma_f32_16x16x32_bf16 v[128:131], a[212:215], a[96:99], v[128:131]
v_mfma_f32_16x16x32_bf16 v[132:135], a[212:215], a[100:103], v[132:135]
v_mfma_f32_16x16x32_bf16 v[132:135], a[180:183], a[132:135], v[132:135]
v_mfma_f32_16x16x32_bf16 v[100:103], a[176:179], a[132:135], v[100:103]
v_mfma_f32_16x16x32_bf16 v[100:103], a[208:211], a[100:103], v[100:103]
v_mfma_f32_16x16x32_bf16 v[104:107], a[208:211], a[104:107], v[104:107]
v_mfma_f32_16x16x32_bf16 v[104:107], a[176:179], a[136:139], v[104:107]
v_mfma_f32_16x16x32_bf16 v[136:139], a[180:183], a[136:139], v[136:139]
v_mfma_f32_16x16x32_bf16 v[136:139], a[212:215], a[104:107], v[136:139]
s_waitcnt vmcnt(12)
v_readfirstlane_b32 s34, v10
v_readfirstlane_b32 s11, v11
s_xor_b32 s34, s34, s8
s_sub_u32 s34, s34, 5
s_cmp_lg_u32 s11, s9
s_cbranch_scc1 L_spin5
s_cmp_gt_u32 s34, 10
s_cbranch_scc1 L_spin5
L_back5:
s_add_u32 m0, s32, 65536
s_add_u32 s39, s56, 33882112
v_mfma_f32_16x16x32_bf16 v[140:143], a[212:215], a[108:111], v[140:143]
buffer_load_dwordx4 v0, s[20:23], s39 offen offset:0 sc1 lds
v_mfma_f32_16x16x32_bf16 v[140:143], a[180:183], a[140:143], v[140:143]
v_mfma_f32_16x16x32_bf16 v[108:111], a[176:179], a[140:143], v[108:111]
v_mfma_f32_16x16x32_bf16 v[108:111], a[208:211], a[108:111], v[108:111]
v_mfma_f32_16x16x32_bf16 v[112:115], a[208:211], a[112:115], v[112:115]
v_mfma_f32_16x16x32_bf16 v[112:115], a[176:179], a[144:147], v[112:115]
v_mfma_f32_16x16x32_bf16 v[144:147], a[180:183], a[144:147], v[144:147]
v_mfma_f32_16x16x32_bf16 v[144:147], a[212:215], a[112:115], v[144:147]
v_mfma_f32_16x16x32_bf16 v[148:151], a[212:215], a[116:119], v[148:151]
v_mfma_f32_16x16x32_bf16 v[148:151], a[180:183], a[148:151], v[148:151]
v_mfma_f32_16x16x32_bf16 v[116:119], a[176:179], a[148:151], v[116:119]
v_mfma_f32_16x16x32_bf16 v[116:119], a[208:211], a[116:119], v[116:119]
v_mfma_f32_16x16x32_bf16 v[120:123], a[208:211], a[120:123], v[120:123]
v_mfma_f32_16x16x32_bf16 v[120:123], a[176:179], a[152:155], v[120:123]
v_mfma_f32_16x16x32_bf16 v[152:155], a[180:183], a[152:155], v[152:155]
v_mfma_f32_16x16x32_bf16 v[152:155], a[212:215], a[120:123], v[152:155]
v_mfma_f32_16x16x32_bf16 v[156:159], a[212:215], a[124:127], v[156:159]
buffer_load_dwordx4 a[212:215], v0, s[20:23], s30 offen offset:0 sc1
v_mfma_f32_16x16x32_bf16 v[156:159], a[180:183], a[156:159], v[156:159]
buffer_load_dwordx4 a[180:183], v0, s[20:23], s30 offen offset:1024 sc1
v_mfma_f32_16x16x32_bf16 v[124:127], a[176:179], a[156:159], v[124:127]
buffer_load_dwordx4 a[176:179], v0, s[20:23], s30 offen offset:2048 sc1
v_mfma_f32_16x16x32_bf16 v[124:127], a[208:211], a[124:127], v[124:127]
buffer_load_dwordx4 a[208:211], v0, s[20:23], s30 offen offset:3072 sc1
s_add_u32 s30, s30, 0x3000
v_mfma_f32_16x16x32_bf16 v[160:163], a[216:219], a[96:99], v[160:163]
v_mfma_f32_16x16x32_bf16 v[160:163], a[184:187], a[128:131], v[160:163]
v_mfma_f32_16x16x32_bf16 v[192:195], a[188:191], a[128:131], v[192:195]
v_mfma_f32_16x16x32_bf16 v[192:195], a[220:223], a[96:99], v[192:195]
v_mfma_f32_16x16x32_bf16 v[196:199], a[220:223], a[100:103], v[196:199]
buffer_load_dwordx4 v0, s[20:23], s39 offen offset:1024 sc1 lds
v_mfma_f32_16x16x32_bf16 v[196:199], a[188:191], a[132:135], v[196:199]
v_mfma_f32_16x16x32_bf16 v[164:167], a[184:187], a[132:135], v[164:167]
v_mfma_f32_16x16x32_bf16 v[164:167], a[216:219], a[100:103], v[164:167]
v_mfma_f32_16x16x32_bf16 v[168:171], a[216:219], a[104:107], v[168:171]
v_mfma_f32_16x16x32_bf16 v[168:171], a[184:187], a[136:139], v[168:171]
v_mfma_f32_16x16x32_bf16 v[200:203], a[188:191], a[136:139], v[200:203]
v_mfma_f32_16x16x32_bf16 v[200:203], a[220:223], a[104:107], v[200:203]
v_mfma_f32_16x16x32_bf16 v[204:207], a[220:223], a[108:111], v[204:207]
v_mfma_f32_16x16x32_bf16 v[204:207], a[188:191], a[140:143], v[204:207]
v_mfma_f32_16x16x32_bf16 v[172:175], a[184:187], a[140:143], v[172:175]
v_mfma_f32_16x16x32_bf16 v[172:175], a[216:219], a[108:111], v[172:175]
v_mfma_f32_16x16x32_bf16 v[176:179], a[216:219], a[112:115], v[176:179]
v_mfma_f32_16x16x32_bf16 v[176:179], a[184:187], a[144:147], v[176:179]
v_mfma_f32_16x16x32_bf16 v[208:211], a[188:191], a[144:147], v[208:211]
v_mfma_f32_16x16x32_bf16 v[208:211], a[220:223], a[112:115], v[208:211]
v_mfma_f32_16x16x32_bf16 v[212:215], a[220:223], a[116:119], v[212:215]
v_mfma_f32_16x16x32_bf16 v[212:215], a[188:191], a[148:151], v[212:215]
v_mfma_f32_16x16x32_bf16 v[180:183], a[184:187], a[148:151], v[180:183]
v_mfma_f32_16x16x32_bf16 v[180:183], a[216:219], a[116:119], v[180:183]
v_mfma_f32_16x16x32_bf16 v[184:187], a[216:219], a[120:123], v[184:187]
v_mfma_f32_16x16x32_bf16 v[184:187], a[184:187], a[152:155], v[184:187]
v_mfma_f32_16x16x32_bf16 v[216:219], a[188:191], a[152:155], v[216:219]
v_mfma_f32_16x16x32_bf16 v[216:219], a[220:223], a[120:123], v[216:219]
v_mfma_f32_16x16x32_bf16 v[220:223], a[220:223], a[124:127], v[220:223]
buffer_load_dwordx4 a[220:223], v0, s[20:23], s30 offen offset:0 sc1
buffer_load_dwordx4 v0, s[20:23], s39 offen offset:2048 sc1 lds
v_mfma_f32_16x16x32_bf16 v[220:223], a[188:191], a[156:159], v[220:223]
buffer_load_dwordx4 a[188:191], v0, s[20:23], s30 offen offset:1024 sc1
v_mfma_f32_16x16x32_bf16 v[188:191], a[184:187], a[156:159], v[188:191]
buffer_load_dwordx4 a[184:187], v0, s[20:23], s30 offen offset:2048 sc1
v_mfma_f32_16x16x32_bf16 v[188:191], a[216:219], a[124:127], v[188:191]
buffer_load_dwordx4 a[216:219], v0, s[20:23], s30 offen offset:3072 sc1
s_add_u32 s30, s30, 0x1000
s_barrier
s_waitcnt vmcnt(18)
v_mfma_f32_16x16x32_bf16 v[224:227], a[160:163], a[96:99], v[224:227]
v_mfma_f32_16x16x32_bf16 v[224:227], a[192:195], a[128:131], v[224:227]
v_mfma_f32_16x16x32_bf16 a[224:227], a[196:199], a[128:131], a[224:227]
v_xor_b32 v2, 0x2000, v6
ds_read_b128 a[128:131], v2 offset:0
v_mfma_f32_16x16x32_bf16 a[224:227], a[164:167], a[96:99], a[224:227]
v_xor_b32 v1, 0x0, v6
ds_read_b128 a[96:99], v1 offset:0
v_mfma_f32_16x16x32_bf16 a[228:231], a[164:167], a[100:103], a[228:231]
s_waitcnt vmcnt(17)
v_lshlrev_b32 v28, 16, v20
v_and_b32 v29, s33, v20
v_mfma_f32_16x16x32_bf16 a[228:231], a[196:199], a[132:135], a[228:231]
v_lshlrev_b32 v30, 16, v21
v_and_b32 v31, s33, v21
v_mfma_f32_16x16x32_bf16 v[228:231], a[192:195], a[132:135], v[228:231]
ds_read_b128 a[132:135], v2 offset:1024
v_add_f32 v160, v160, v28
v_mfma_f32_16x16x32_bf16 v[228:231], a[160:163], a[100:103], v[228:231]
ds_read_b128 a[100:103], v1 offset:1024
v_add_f32 v161, v161, v29
v_mfma_f32_16x16x32_bf16 v[232:235], a[160:163], a[104:107], v[232:235]
v_add_f32 v162, v162, v30
v_add_f32 v163, v163, v31
v_mfma_f32_16x16x32_bf16 v[232:235], a[192:195], a[136:139], v[232:235]
v_add_f32 v164, v164, v28
v_add_f32 v165, v165, v29
v_mfma_f32_16x16x32_bf16 a[232:235], a[196:199], a[136:139], a[232:235]
ds_read_b128 a[136:139], v2 offset:2048
v_add_f32 v166, v166, v30
v_mfma_f32_16x16x32_bf16 a[232:235], a[164:167], a[104:107], a[232:235]
ds_read_b128 a[104:107], v1 offset:2048
v_add_f32 v167, v167, v31
v_mfma_f32_16x16x32_bf16 a[236:239], a[164:167], a[108:111], a[236:239]
v_add_f32 v168, v168, v28
v_add_f32 v169, v169, v29
v_mfma_f32_16x16x32_bf16 a[236:239], a[196:199], a[140:143], a[236:239]
v_add_f32 v170, v170, v30
v_add_f32 v171, v171, v31
v_mfma_f32_16x16x32_bf16 v[236:239], a[192:195], a[140:143], v[236:239]
ds_read_b128 a[140:143], v2 offset:3072
v_add_f32 v172, v172, v28
v_mfma_f32_16x16x32_bf16 v[236:239], a[160:163], a[108:111], v[236:239]
ds_read_b128 a[108:111], v1 offset:3072
v_add_f32 v173, v173, v29
v_mfma_f32_16x16x32_bf16 v[240:243], a[160:163], a[112:115], v[240:243]
v_add_f32 v174, v174, v30
v_add_f32 v175, v175, v31
v_mfma_f32_16x16x32_bf16 v[240:243], a[192:195], a[144:147], v[240:243]
v_add_f32 v176, v176, v28
v_add_f32 v177, v177, v29
v_mfma_f32_16x16x32_bf16 a[240:243], a[196:199], a[144:147], a[240:243]
ds_read_b128 a[144:147], v2 offset:4096
v_add_f32 v178, v178, v30
v_mfma_f32_16x16x32_bf16 a[240:243], a[164:167], a[112:115], a[240:243]
ds_read_b128 a[112:115], v1 offset:4096
v_add_f32 v179, v179, v31
v_mfma_f32_16x16x32_bf16 a[244:247], a[164:167], a[116:119], a[244:247]
buffer_load_dwordx4 v0, s[20:23], s39 offen offset:3072 sc1 lds
v_add_f32 v180, v180, v28
v_mfma_f32_16x16x32_bf16 a[244:247], a[196:199], a[148:151], a[244:247]
v_add_f32 v181, v181, v29
v_add_f32 v182, v182, v30
v_mfma_f32_16x16x32_bf16 v[244:247], a[192:195], a[148:151], v[244:247]
ds_read_b128 a[148:151], v2 offset:5120
v_add_f32 v183, v183, v31
v_mfma_f32_16x16x32_bf16 v[244:247], a[160:163], a[116:119], v[244:247]
ds_read_b128 a[116:119], v1 offset:5120
v_add_f32 v184, v184, v28
v_mfma_f32_16x16x32_bf16 v[248:251], a[160:163], a[120:123], v[248:251]
v_add_f32 v185, v185, v29
v_add_f32 v186, v186, v30
v_mfma_f32_16x16x32_bf16 v[248:251], a[192:195], a[152:155], v[248:251]
v_add_f32 v187, v187, v31
v_add_f32 v188, v188, v28
v_mfma_f32_16x16x32_bf16 a[248:251], a[196:199], a[152:155], a[248:251]
ds_read_b128 a[152:155], v2 offset:6144
v_add_f32 v189, v189, v29
v_mfma_f32_16x16x32_bf16 a[248:251], a[164:167], a[120:123], a[248:251]
ds_read_b128 a[120:123], v1 offset:6144
v_add_f32 v190, v190, v30
v_mfma_f32_16x16x32_bf16 a[252:255], a[164:167], a[124:127], a[252:255]
buffer_load_dwordx4 a[164:167], v0, s[20:23], s30 offen offset:0 sc1
v_add_f32 v191, v191, v31
v_mfma_f32_16x16x32_bf16 a[252:255], a[196:199], a[156:159], a[252:255]
buffer_load_dwordx4 a[196:199], v0, s[20:23], s30 offen offset:1024 sc1
v_lshlrev_b32 v28, 16, v22
v_mfma_f32_16x16x32_bf16 v[252:255], a[192:195], a[156:159], v[252:255]
buffer_load_dwordx4 a[192:195], v0, s[20:23], s30 offen offset:2048 sc1
ds_read_b128 a[156:159], v2 offset:7168
v_mfma_f32_16x16x32_bf16 v[252:255], a[160:163], a[124:127], v[252:255]
buffer_load_dwordx4 a[160:163], v0, s[20:23], s30 offen offset:3072 sc1
s_add_u32 s30, s30, 0x3000
ds_read_b128 a[124:127], v1 offset:7168
L_q10:
s_waitcnt vmcnt(16) lgkmcnt(14)
v_mfma_f32_16x16x32_bf16 v[32:35], a[168:171], a[96:99], v[32:35]
v_and_b32 v29, s33, v22
v_mfma_f32_16x16x32_bf16 v[32:35], a[200:203], a[128:131], v[32:35]
v_lshlrev_b32 v30, 16, v23
v_and_b32 v31, s33, v23
v_mfma_f32_16x16x32_bf16 v[64:67], a[204:207], a[128:131], v[64:67]
v_add_f32 v192, v192, v28
v_add_f32 v193, v193, v29
v_mfma_f32_16x16x32_bf16 v[64:67], a[172:175], a[96:99], v[64:67]
v_add_f32 v194, v194, v30
v_add_f32 v195, v195, v31
s_waitcnt lgkmcnt(12)
v_mfma_f32_16x16x32_bf16 v[68:71], a[172:175], a[100:103], v[68:71]
v_add_f32 v196, v196, v28
v_mfma_f32_16x16x32_bf16 v[68:71], a[204:207], a[132:135], v[68:71]
v_add_f32 v197, v197, v29
v_add_f32 v198, v198, v30
v_mfma_f32_16x16x32_bf16 v[36:39], a[200:203], a[132:135], v[36:39]
v_add_f32 v199, v199, v31
v_add_f32 v200, v200, v28
v_mfma_f32_16x16x32_bf16 v[36:39], a[168:171], a[100:103], v[36:39]
v_add_f32 v201, v201, v29
v_add_f32 v202, v202, v30
s_waitcnt lgkmcnt(10)
v_mfma_f32_16x16x32_bf16 v[40:43], a[168:171], a[104:107], v[40:43]
v_add_f32 v203, v203, v31
v_mfma_f32_16x16x32_bf16 v[40:43], a[200:203], a[136:139], v[40:43]
v_add_f32 v204, v204, v28
v_add_f32 v205, v205, v29
v_mfma_f32_16x16x32_bf16 v[72:75], a[204:207], a[136:139], v[72:75]
v_add_f32 v206, v206, v30
v_add_f32 v207, v207, v31
v_mfma_f32_16x16x32_bf16 v[72:75], a[172:175], a[104:107], v[72:75]
v_add_f32 v208, v208, v28
v_add_f32 v209, v209, v29
s_add_u32 m0, s32, 69632
s_add_u32 s39, s56, 33886208
s_waitcnt lgkmcnt(8)
v_mfma_f32_16x16x32_bf16 v[76:79], a[172:175], a[108:111], v[76:79]
buffer_load_dwordx4 v0, s[20:23], s39 offen offset:0 sc1 lds
v_mfma_f32_16x16x32_bf16 v[76:79], a[204:207], a[140:143], v[76:79]
v_add_f32 v210, v210, v30
v_add_f32 v211, v211, v31
v_mfma_f32_16x16x32_bf16 v[44:47], a[200:203], a[140:143], v[44:47]
v_add_f32 v212, v212, v28
v_add_f32 v213, v213, v29
v_mfma_f32_16x16x32_bf16 v[44:47], a[168:171], a[108:111], v[44:47]
v_add_f32 v214, v214, v30
v_add_f32 v215, v215, v31
s_waitcnt lgkmcnt(6)
v_mfma_f32_16x16x32_bf16 v[48:51], a[168:171], a[112:115], v[48:51]
v_add_f32 v216, v216, v28
v_mfma_f32_16x16x32_bf16 v[48:51], a[200:203], a[144:147], v[48:51]
v_add_f32 v217, v217, v29
v_add_f32 v218, v218, v30
v_mfma_f32_16x16x32_bf16 v[80:83], a[204:207], a[144:147], v[80:83]
v_add_f32 v219, v219, v31
v_add_f32 v220, v220, v28
v_mfma_f32_16x16x32_bf16 v[80:83], a[172:175], a[112:115], v[80:83]
v_add_f32 v221, v221, v29
v_add_f32 v222, v222, v30
s_waitcnt lgkmcnt(4)
v_mfma_f32_16x16x32_bf16 v[84:87], a[172:175], a[116:119], v[84:87]
v_add_f32 v223, v223, v31
v_mfma_f32_16x16x32_bf16 v[84:87], a[204:207], a[148:151], v[84:87]
v_lshlrev_b32 v28, 16, v24
v_and_b32 v29, s33, v24
v_mfma_f32_16x16x32_bf16 v[52:55], a[200:203], a[148:151], v[52:55]
v_lshlrev_b32 v30, 16, v25
v_and_b32 v31, s33, v25
v_mfma_f32_16x16x32_bf16 v[52:55], a[168:171], a[116:119], v[52:55]
v_add_f32 v224, v224, v28
v_add_f32 v225, v225, v29
s_waitcnt lgkmcnt(2)
v_mfma_f32_16x16x32_bf16 v[56:59], a[168:171], a[120:123], v[56:59]
v_add_f32 v226, v226, v30
v_mfma_f32_16x16x32_bf16 v[56:59], a[200:203], a[152:155], v[56:59]
v_add_f32 v227, v227, v31
v_add_f32 v228, v228, v28
v_mfma_f32_16x16x32_bf16 v[88:91], a[204:207], a[152:155], v[88:91]
v_add_f32 v229, v229, v29
v_add_f32 v230, v230, v30
v_mfma_f32_16x16x32_bf16 v[88:91], a[172:175], a[120:123], v[88:91]
v_add_f32 v231, v231, v31
v_add_f32 v232, v232, v28
s_waitcnt lgkmcnt(0)
v_mfma_f32_16x16x32_bf16 v[92:95], a[172:175], a[124:127], v[92:95]
buffer_load_dwordx4 a[172:175], v0, s[20:23], s30 offen offset:0 sc1
v_mfma_f32_16x16x32_bf16 v[92:95], a[204:207], a[156:159], v[92:95]
buffer_load_dwordx4 a[204:207], v0, s[20:23], s30 offen offset:1024 sc1
v_add_f32 v233, v233, v29
v_mfma_f32_16x16x32_bf16 v[60:63], a[200:203], a[156:159], v[60:63]
buffer_load_dwordx4 a[200:203], v0, s[20:23], s30 offen offset:2048 sc1
v_add_f32 v234, v234, v30
v_mfma_f32_16x16x32_bf16 v[60:63], a[168:171], a[124:127], v[60:63]
buffer_load_dwordx4 a[168:171], v0, s[20:23], s30 offen offset:3072 sc1
s_add_u32 s30, s30, 0x1000
s_waitcnt vmcnt(16)
v_mfma_f32_16x16x32_bf16 v[96:99], a[212:215], a[96:99], v[96:99]
v_add_f32 v235, v235, v31
v_mfma_f32_16x16x32_bf16 v[96:99], a[180:183], a[128:131], v[96:99]
v_add_f32 v236, v236, v28
v_add_f32 v237, v237, v29
v_mfma_f32_16x16x32_bf16 v[128:131], a[208:211], a[128:131], v[128:131]
v_xor_b32 v4, 0x6000, v6
ds_read_b128 a[128:131], v4 offset:0
v_mfma_f32_16x16x32_bf16 v[128:131], a[176:179], a[96:99], v[128:131]
v_xor_b32 v3, 0x4000, v6
ds_read_b128 a[96:99], v3 offset:0
v_mfma_f32_16x16x32_bf16 v[132:135], a[176:179], a[100:103], v[132:135]
buffer_load_dwordx4 v0, s[20:23], s39 offen offset:1024 sc1 lds
v_add_f32 v238, v238, v30
v_mfma_f32_16x16x32_bf16 v[132:135], a[208:211], a[132:135], v[132:135]
v_add_f32 v239, v239, v31
v_add_f32 v240, v240, v28
v_mfma_f32_16x16x32_bf16 v[100:103], a[180:183], a[132:135], v[100:103]
ds_read_b128 a[132:135], v4 offset:1024
v_add_f32 v241, v241, v29
v_mfma_f32_16x16x32_bf16 v[100:103], a[212:215], a[100:103], v[100:103]
ds_read_b128 a[100:103], v3 offset:1024
v_add_f32 v242, v242, v30
v_mfma_f32_16x16x32_bf16 v[104:107], a[212:215], a[104:107], v[104:107]
v_add_f32 v243, v243, v31
v_add_f32 v244, v244, v28
v_mfma_f32_16x16x32_bf16 v[104:107], a[180:183], a[136:139], v[104:107]
v_add_f32 v245, v245, v29
v_add_f32 v246, v246, v30
v_mfma_f32_16x16x32_bf16 v[136:139], a[208:211], a[136:139], v[136:139]
ds_read_b128 a[136:139], v4 offset:2048
v_add_f32 v247, v247, v31
v_mfma_f32_16x16x32_bf16 v[136:139], a[176:179], a[104:107], v[136:139]
ds_read_b128 a[104:107], v3 offset:2048
v_add_f32 v248, v248, v28
v_mfma_f32_16x16x32_bf16 v[140:143], a[176:179], a[108:111], v[140:143]
v_add_f32 v249, v249, v29
v_add_f32 v250, v250, v30
v_mfma_f32_16x16x32_bf16 v[140:143], a[208:211], a[140:143], v[140:143]
v_add_f32 v251, v251, v31
v_add_f32 v252, v252, v28
v_mfma_f32_16x16x32_bf16 v[108:111], a[180:183], a[140:143], v[108:111]
ds_read_b128 a[140:143], v4 offset:3072
v_add_f32 v253, v253, v29
v_mfma_f32_16x16x32_bf16 v[108:111], a[212:215], a[108:111], v[108:111]
ds_read_b128 a[108:111], v3 offset:3072
v_add_f32 v254, v254, v30
v_mfma_f32_16x16x32_bf16 v[112:115], a[212:215], a[112:115], v[112:115]
v_add_f32 v255, v255, v31
v_lshlrev_b32 v28, 16, v26
v_mfma_f32_16x16x32_bf16 v[112:115], a[180:183], a[144:147], v[112:115]
v_and_b32 v29, s33, v26
v_lshlrev_b32 v30, 16, v27
v_mfma_f32_16x16x32_bf16 v[144:147], a[208:211], a[144:147], v[144:147]
ds_read_b128 a[144:147], v4 offset:4096
v_and_b32 v31, s33, v27
v_mfma_f32_16x16x32_bf16 v[144:147], a[176:179], a[112:115], v[144:147]
ds_read_b128 a[112:115], v3 offset:4096
v_accvgpr_read_b32 v12, a224
v_mfma_f32_16x16x32_bf16 v[148:151], a[176:179], a[116:119], v[148:151]
v_accvgpr_read_b32 v13, a225
v_accvgpr_read_b32 v14, a226
v_mfma_f32_16x16x32_bf16 v[148:151], a[208:211], a[148:151], v[148:151]
v_accvgpr_read_b32 v15, a227
v_add_f32 v12, v12, v28
v_mfma_f32_16x16x32_bf16 v[116:119], a[180:183], a[148:151], v[116:119]
ds_read_b128 a[148:151], v4 offset:5120
v_add_f32 v13, v13, v29
v_mfma_f32_16x16x32_bf16 v[116:119], a[212:215], a[116:119], v[116:119]
ds_read_b128 a[116:119], v3 offset:5120
v_add_f32 v14, v14, v30
v_mfma_f32_16x16x32_bf16 v[120:123], a[212:215], a[120:123], v[120:123]
v_add_f32 v15, v15, v31
v_accvgpr_write_b32 a224, v12
v_mfma_f32_16x16x32_bf16 v[120:123], a[180:183], a[152:155], v[120:123]
v_accvgpr_write_b32 a225, v13
v_accvgpr_write_b32 a226, v14
v_mfma_f32_16x16x32_bf16 v[152:155], a[208:211], a[152:155], v[152:155]
ds_read_b128 a[152:155], v4 offset:6144
v_accvgpr_write_b32 a227, v15
v_mfma_f32_16x16x32_bf16 v[152:155], a[176:179], a[120:123], v[152:155]
ds_read_b128 a[120:123], v3 offset:6144
v_accvgpr_read_b32 v12, a228
v_mfma_f32_16x16x32_bf16 v[156:159], a[176:179], a[124:127], v[156:159]
buffer_load_dwordx4 a[176:179], v0, s[20:23], s30 offen offset:0 sc1
buffer_load_dwordx4 v0, s[20:23], s39 offen offset:2048 sc1 lds
v_mfma_f32_16x16x32_bf16 v[156:159], a[208:211], a[156:159], v[156:159]
buffer_load_dwordx4 a[208:211], v0, s[20:23], s30 offen offset:1024 sc1
v_accvgpr_read_b32 v13, a229
v_mfma_f32_16x16x32_bf16 v[124:127], a[180:183], a[156:159], v[124:127]
buffer_load_dwordx4 a[180:183], v0, s[20:23], s30 offen offset:2048 sc1
ds_read_b128 a[156:159], v4 offset:7168
v_mfma_f32_16x16x32_bf16 v[124:127], a[212:215], a[124:127], v[124:127]
buffer_load_dwordx4 a[212:215], v0, s[20:23], s30 offen offset:3072 sc1
s_add_u32 s30, s30, 0x3000
ds_read_b128 a[124:127], v3 offset:7168
s_waitcnt vmcnt(16) lgkmcnt(14)
v_mfma_f32_16x16x32_bf16 v[32:35], a[220:223], a[96:99], v[32:35]
v_accvgpr_read_b32 v14, a230
v_mfma_f32_16x16x32_bf16 v[32:35], a[188:191], a[128:131], v[32:35]
v_accvgpr_read_b32 v15, a231
v_add_f32 v12, v12, v28
v_mfma_f32_16x16x32_bf16 v[64:67], a[216:219], a[128:131], v[64:67]
v_add_f32 v13, v13, v29
v_add_f32 v14, v14, v30
v_mfma_f32_16x16x32_bf16 v[64:67], a[184:187], a[96:99], v[64:67]
v_add_f32 v15, v15, v31
v_accvgpr_write_b32 a228, v12
s_waitcnt lgkmcnt(12)
v_mfma_f32_16x16x32_bf16 v[68:71], a[184:187], a[100:103], v[68:71]
v_accvgpr_write_b32 a229, v13
v_mfma_f32_16x16x32_bf16 v[68:71], a[216:219], a[132:135], v[68:71]
v_accvgpr_write_b32 a230, v14
v_accvgpr_write_b32 a231, v15
v_mfma_f32_16x16x32_bf16 v[36:39], a[188:191], a[132:135], v[36:39]
v_accvgpr_read_b32 v12, a232
v_accvgpr_read_b32 v13, a233
v_mfma_f32_16x16x32_bf16 v[36:39], a[220:223], a[100:103], v[36:39]
v_accvgpr_read_b32 v14, a234
v_accvgpr_read_b32 v15, a235
s_waitcnt lgkmcnt(10)
v_mfma_f32_16x16x32_bf16 v[40:43], a[220:223], a[104:107], v[40:43]
v_add_f32 v12, v12, v28
v_mfma_f32_16x16x32_bf16 v[40:43], a[188:191], a[136:139], v[40:43]
v_add_f32 v13, v13, v29
v_add_f32 v14, v14, v30
v_mfma_f32_16x16x32_bf16 v[72:75], a[216:219], a[136:139], v[72:75]
v_add_f32 v15, v15, v31
v_accvgpr_write_b32 a232, v12
v_mfma_f32_16x16x32_bf16 v[72:75], a[184:187], a[104:107], v[72:75]
v_accvgpr_write_b32 a233, v13
v_accvgpr_write_b32 a234, v14
s_waitcnt lgkmcnt(8)
v_mfma_f32_16x16x32_bf16 v[76:79], a[184:187], a[108:111], v[76:79]
v_accvgpr_write_b32 a235, v15
v_mfma_f32_16x16x32_bf16 v[76:79], a[216:219], a[140:143], v[76:79]
v_accvgpr_read_b32 v12, a236
v_accvgpr_read_b32 v13, a237
v_mfma_f32_16x16x32_bf16 v[44:47], a[188:191], a[140:143], v[44:47]
v_accvgpr_read_b32 v14, a238
v_accvgpr_read_b32 v15, a239
v_mfma_f32_16x16x32_bf16 v[44:47], a[220:223], a[108:111], v[44:47]
v_add_f32 v12, v12, v28
v_add_f32 v13, v13, v29
s_waitcnt lgkmcnt(6)
v_mfma_f32_16x16x32_bf16 v[48:51], a[220:223], a[112:115], v[48:51]
v_add_f32 v14, v14, v30
v_mfma_f32_16x16x32_bf16 v[48:51], a[188:191], a[144:147], v[48:51]
v_add_f32 v15, v15, v31
v_accvgpr_write_b32 a236, v12
v_mfma_f32_16x16x32_bf16 v[80:83], a[216:219], a[144:147], v[80:83]
v_accvgpr_write_b32 a237, v13
v_accvgpr_write_b32 a238, v14
v_mfma_f32_16x16x32_bf16 v[80:83], a[184:187], a[112:115], v[80:83]
v_accvgpr_write_b32 a239, v15
v_accvgpr_read_b32 v12, a240
s_waitcnt lgkmcnt(4)
v_mfma_f32_16x16x32_bf16 v[84:87], a[184:187], a[116:119], v[84:87]
buffer_load_dwordx4 v0, s[20:23], s39 offen offset:3072 sc1 lds
v_mfma_f32_16x16x32_bf16 v[84:87], a[216:219], a[148:151], v[84:87]
v_accvgpr_read_b32 v13, a241
v_accvgpr_read_b32 v14, a242
v_mfma_f32_16x16x32_bf16 v[52:55], a[188:191], a[148:151], v[52:55]
v_accvgpr_read_b32 v15, a243
v_add_f32 v12, v12, v28
v_mfma_f32_16x16x32_bf16 v[52:55], a[220:223], a[116:119], v[52:55]
v_add_f32 v13, v13, v29
v_add_f32 v14, v14, v30
s_waitcnt lgkmcnt(2)
v_mfma_f32_16x16x32_bf16 v[56:59], a[220:223], a[120:123], v[56:59]
v_add_f32 v15, v15, v31
v_mfma_f32_16x16x32_bf16 v[56:59], a[188:191], a[152:155], v[56:59]
v_accvgpr_write_b32 a240, v12
v_accvgpr_write_b32 a241, v13
v_mfma_f32_16x16x32_bf16 v[88:91], a[216:219], a[152:155], v[88:91]
v_accvgpr_write_b32 a242, v14
v_accvgpr_write_b32 a243, v15
v_mfma_f32_16x16x32_bf16 v[88:91], a[184:187], a[120:123], v[88:91]
v_accvgpr_read_b32 v12, a244
v_accvgpr_read_b32 v13, a245
s_waitcnt lgkmcnt(0)
v_mfma_f32_16x16x32_bf16 v[92:95], a[184:187], a[124:127], v[92:95]
buffer_load_dwordx4 a[184:187], v0, s[20:23], s30 offen offset:0 sc1
v_mfma_f32_16x16x32_bf16 v[92:95], a[216:219], a[156:159], v[92:95]
buffer_load_dwordx4 a[216:219], v0, s[20:23], s30 offen offset:1024 sc1
v_accvgpr_read_b32 v14, a246
v_mfma_f32_16x16x32_bf16 v[60:63], a[188:191], a[156:159], v[60:63]
buffer_load_dwordx4 a[188:191], v0, s[20:23], s30 offen offset:2048 sc1
v_accvgpr_read_b32 v15, a247
v_mfma_f32_16x16x32_bf16 v[60:63], a[220:223], a[124:127], v[60:63]
buffer_load_dwordx4 a[220:223], v0, s[20:23], s30 offen offset:3072 sc1
s_add_u32 s30, s30, 0x1000
s_barrier
s_waitcnt vmcnt(16)
v_mfma_f32_16x16x32_bf16 v[96:99], a[164:167], a[96:99], v[96:99]
v_mfma_f32_16x16x32_bf16 v[96:99], a[196:199], a[128:131], v[96:99]
v_add_f32 v12, v12, v28
v_add_f32 v13, v13, v29
v_mfma_f32_16x16x32_bf16 v[128:131], a[160:163], a[128:131], v[128:131]
ds_read_b128 a[128:131], v2 offset:32768
v_add_f32 v14, v14, v30
v_mfma_f32_16x16x32_bf16 v[128:131], a[192:195], a[96:99], v[128:131]
ds_read_b128 a[96:99], v1 offset:32768
v_add_f32 v15, v15, v31
v_mfma_f32_16x16x32_bf16 v[132:135], a[192:195], a[100:103], v[132:135]
v_accvgpr_write_b32 a244, v12
v_accvgpr_write_b32 a245, v13
v_mfma_f32_16x16x32_bf16 v[132:135], a[160:163], a[132:135], v[132:135]
v_accvgpr_write_b32 a246, v14
v_accvgpr_write_b32 a247, v15
v_mfma_f32_16x16x32_bf16 v[100:103], a[196:199], a[132:135], v[100:103]
ds_read_b128 a[132:135], v2 offset:33792
v_accvgpr_read_b32 v12, a248
v_mfma_f32_16x16x32_bf16 v[100:103], a[164:167], a[100:103], v[100:103]
ds_read_b128 a[100:103], v1 offset:33792
v_accvgpr_read_b32 v13, a249
v_mfma_f32_16x16x32_bf16 v[104:107], a[164:167], a[104:107], v[104:107]
v_accvgpr_read_b32 v14, a250
v_accvgpr_read_b32 v15, a251
v_mfma_f32_16x16x32_bf16 v[104:107], a[196:199], a[136:139], v[104:107]
v_add_f32 v12, v12, v28
v_add_f32 v13, v13, v29
v_mfma_f32_16x16x32_bf16 v[136:139], a[160:163], a[136:139], v[136:139]
ds_read_b128 a[136:139], v2 offset:34816
v_add_f32 v14, v14, v30
v_mfma_f32_16x16x32_bf16 v[136:139], a[192:195], a[104:107], v[136:139]
ds_read_b128 a[104:107], v1 offset:34816
v_add_f32 v15, v15, v31
s_add_u32 m0, s32, 98304
s_add_u32 s39, s56, 33914880
v_mfma_f32_16x16x32_bf16 v[140:143], a[192:195], a[108:111], v[140:143]
buffer_load_dwordx4 v0, s[20:23], s39 offen offset:0 sc1 lds
v_mfma_f32_16x16x32_bf16 v[140:143], a[160:163], a[140:143], v[140:143]
v_accvgpr_write_b32 a248, v12
v_accvgpr_write_b32 a249, v13
v_mfma_f32_16x16x32_bf16 v[108:111], a[196:199], a[140:143], v[108:111]
ds_read_b128 a[140:143], v2 offset:35840
v_accvgpr_write_b32 a250, v14
v_mfma_f32_16x16x32_bf16 v[108:111], a[164:167], a[108:111], v[108:111]
ds_read_b128 a[108:111], v1 offset:35840
v_accvgpr_write_b32 a251, v15
v_mfma_f32_16x16x32_bf16 v[112:115], a[164:167], a[112:115], v[112:115]
v_accvgpr_read_b32 v12, a252
v_accvgpr_read_b32 v13, a253
v_mfma_f32_16x16x32_bf16 v[112:115], a[196:199], a[144:147], v[112:115]
v_accvgpr_read_b32 v14, a254
v_accvgpr_read_b32 v15, a255
v_mfma_f32_16x16x32_bf16 v[144:147], a[160:163], a[144:147], v[144:147]
ds_read_b128 a[144:147], v2 offset:36864
v_add_f32 v12, v12, v28
v_mfma_f32_16x16x32_bf16 v[144:147], a[192:195], a[112:115], v[144:147]
ds_read_b128 a[112:115], v1 offset:36864
v_add_f32 v13, v13, v29
v_mfma_f32_16x16x32_bf16 v[148:151], a[192:195], a[116:119], v[148:151]
v_add_f32 v14, v14, v30
v_add_f32 v15, v15, v31
v_mfma_f32_16x16x32_bf16 v[148:151], a[160:163], a[148:151], v[148:151]
v_accvgpr_write_b32 a252, v12
v_accvgpr_write_b32 a253, v13
v_mfma_f32_16x16x32_bf16 v[116:119], a[196:199], a[148:151], v[116:119]
ds_read_b128 a[148:151], v2 offset:37888
v_accvgpr_write_b32 a254, v14
v_mfma_f32_16x16x32_bf16 v[116:119], a[164:167], a[116:119], v[116:119]
ds_read_b128 a[116:119], v1 offset:37888
v_accvgpr_write_b32 a255, v15
v_mfma_f32_16x16x32_bf16 v[120:123], a[164:167], a[120:123], v[120:123]
v_mfma_f32_16x16x32_bf16 v[120:123], a[196:199], a[152:155], v[120:123]
v_mfma_f32_16x16x32_bf16 v[152:155], a[160:163], a[152:155], v[152:155]
ds_read_b128 a[152:155], v2 offset:38912
v_mfma_f32_16x16x32_bf16 v[152:155], a[192:195], a[120:123], v[152:155]
ds_read_b128 a[120:123], v1 offset:38912
v_mfma_f32_16x16x32_bf16 v[156:159], a[192:195], a[124:127], v[156:159]
buffer_load_dwordx4 a[192:195], v0, s[20:23], s30 offen offset:0 sc1
v_mfma_f32_16x16x32_bf16 v[156:159], a[160:163], a[156:159], v[156:159]
buffer_load_dwordx4 a[160:163], v0, s[20:23], s30 offen offset:1024 sc1
v_mfma_f32_16x16x32_bf16 v[124:127], a[196:199], a[156:159], v[124:127]
buffer_load_dwordx4 a[196:199], v0, s[20:23], s30 offen offset:2048 sc1
ds_read_b128 a[156:159], v2 offset:39936
v_mfma_f32_16x16x32_bf16 v[124:127], a[164:167], a[124:127], v[124:127]
buffer_load_dwordx4 a[164:167], v0, s[20:23], s30 offen offset:3072 sc1
s_add_u32 s30, s30, 0x3000
ds_read_b128 a[124:127], v1 offset:39936
s_waitcnt vmcnt(16) lgkmcnt(14)
v_mfma_f32_16x16x32_bf16 v[32:35], a[172:175], a[96:99], v[32:35]
v_mfma_f32_16x16x32_bf16 v[32:35], a[204:207], a[128:131], v[32:35]
v_mfma_f32_16x16x32_bf16 v[64:67], a[168:171], a[128:131], v[64:67]
v_mfma_f32_16x16x32_bf16 v[64:67], a[200:203], a[96:99], v[64:67]
s_waitcnt lgkmcnt(12)
v_mfma_f32_16x16x32_bf16 v[68:71], a[200:203], a[100:103], v[68:71]
buffer_load_dwordx4 v0, s[20:23], s39 offen offset:1024 sc1 lds
v_mfma_f32_16x16x32_bf16 v[68:71], a[168:171], a[132:135], v[68:71]
v_mfma_f32_16x16x32_bf16 v[36:39], a[204:207], a[132:135], v[36:39]
v_mfma_f32_16x16x32_bf16 v[36:39], a[172:175], a[100:103], v[36:39]
s_waitcnt lgkmcnt(10)
v_mfma_f32_16x16x32_bf16 v[40:43], a[172:175], a[104:107], v[40:43]
v_mfma_f32_16x16x32_bf16 v[40:43], a[204:207], a[136:139], v[40:43]
v_mfma_f32_16x16x32_bf16 v[72:75], a[168:171], a[136:139], v[72:75]
v_mfma_f32_16x16x32_bf16 v[72:75], a[200:203], a[104:107], v[72:75]
s_waitcnt lgkmcnt(8)
v_mfma_f32_16x16x32_bf16 v[76:79], a[200:203], a[108:111], v[76:79]
v_mfma_f32_16x16x32_bf16 v[76:79], a[168:171], a[140:143], v[76:79]
v_mfma_f32_16x16x32_bf16 v[44:47], a[204:207], a[140:143], v[44:47]
v_mfma_f32_16x16x32_bf16 v[44:47], a[172:175], a[108:111], v[44:47]
s_waitcnt lgkmcnt(6)
v_mfma_f32_16x16x32_bf16 v[48:51], a[172:175], a[112:115], v[48:51]
v_mfma_f32_16x16x32_bf16 v[48:51], a[204:207], a[144:147], v[48:51]
v_mfma_f32_16x16x32_bf16 v[80:83], a[168:171], a[144:147], v[80:83]
v_mfma_f32_16x16x32_bf16 v[80:83], a[200:203], a[112:115], v[80:83]
s_waitcnt lgkmcnt(4)
v_mfma_f32_16x16x32_bf16 v[84:87], a[200:203], a[116:119], v[84:87]
v_mfma_f32_16x16x32_bf16 v[84:87], a[168:171], a[148:151], v[84:87]
v_mfma_f32_16x16x32_bf16 v[52:55], a[204:207], a[148:151], v[52:55]
v_mfma_f32_16x16x32_bf16 v[52:55], a[172:175], a[116:119], v[52:55]
s_waitcnt lgkmcnt(2)
v_mfma_f32_16x16x32_bf16 v[56:59], a[172:175], a[120:123], v[56:59]
v_mfma_f32_16x16x32_bf16 v[56:59], a[204:207], a[152:155], v[56:59]
v_mfma_f32_16x16x32_bf16 v[88:91], a[168:171], a[152:155], v[88:91]
v_mfma_f32_16x16x32_bf16 v[88:91], a[200:203], a[120:123], v[88:91]
s_waitcnt lgkmcnt(0)
v_mfma_f32_16x16x32_bf16 v[92:95], a[200:203], a[124:127], v[92:95]
buffer_load_dwordx4 a[200:203], v0, s[20:23], s30 offen offset:0 sc1
buffer_load_dwordx4 v0, s[20:23], s39 offen offset:2048 sc1 lds
v_mfma_f32_16x16x32_bf16 v[92:95], a[168:171], a[156:159], v[92:95]
buffer_load_dwordx4 a[168:171], v0, s[20:23], s30 offen offset:1024 sc1
v_mfma_f32_16x16x32_bf16 v[60:63], a[204:207], a[156:159], v[60:63]
buffer_load_dwordx4 a[204:207], v0, s[20:23], s30 offen offset:2048 sc1
v_mfma_f32_16x16x32_bf16 v[60:63], a[172:175], a[124:127], v[60:63]
buffer_load_dwordx4 a[172:175], v0, s[20:23], s30 offen offset:3072 sc1
s_add_u32 s30, s30, 0x1000
s_waitcnt vmcnt(16)
v_mfma_f32_16x16x32_bf16 v[96:99], a[176:179], a[96:99], v[96:99]
v_mfma_f32_16x16x32_bf16 v[96:99], a[208:211], a[128:131], v[96:99]
v_mfma_f32_16x16x32_bf16 v[128:131], a[212:215], a[128:131], v[128:131]
ds_read_b128 a[128:131], v4 offset:32768
v_mfma_f32_16x16x32_bf16 v[128:131], a[180:183], a[96:99], v[128:131]
ds_read_b128 a[96:99], v3 offset:32768
v_mfma_f32_16x16x32_bf16 v[132:135], a[180:183], a[100:103], v[132:135]
v_mfma_f32_16x16x32_bf16 v[132:135], a[212:215], a[132:135], v[132:135]
v_mfma_f32_16x16x32_bf16 v[100:103], a[208:211], a[132:135], v[100:103]
ds_read_b128 a[132:135], v4 offset:33792
v_mfma_f32_16x16x32_bf16 v[100:103], a[176:179], a[100:103], v[100:103]
ds_read_b128 a[100:103], v3 offset:33792
v_mfma_f32_16x16x32_bf16 v[104:107], a[176:179], a[104:107], v[104:107]
v_mfma_f32_16x16x32_bf16 v[104:107], a[208:211], a[136:139], v[104:107]
v_mfma_f32_16x16x32_bf16 v[136:139], a[212:215], a[136:139], v[136:139]
ds_read_b128 a[136:139], v4 offset:34816
v_mfma_f32_16x16x32_bf16 v[136:139], a[180:183], a[104:107], v[136:139]
ds_read_b128 a[104:107], v3 offset:34816
v_mfma_f32_16x16x32_bf16 v[140:143], a[180:183], a[108:111], v[140:143]
v_mfma_f32_16x16x32_bf16 v[140:143], a[212:215], a[140:143], v[140:143]
v_mfma_f32_16x16x32_bf16 v[108:111], a[208:211], a[140:143], v[108:111]
ds_read_b128 a[140:143], v4 offset:35840
v_mfma_f32_16x16x32_bf16 v[108:111], a[176:179], a[108:111], v[108:111]
ds_read_b128 a[108:111], v3 offset:35840
v_mfma_f32_16x16x32_bf16 v[112:115], a[176:179], a[112:115], v[112:115]
v_mfma_f32_16x16x32_bf16 v[112:115], a[208:211], a[144:147], v[112:115]
v_mfma_f32_16x16x32_bf16 v[144:147], a[212:215], a[144:147], v[144:147]
ds_read_b128 a[144:147], v4 offset:36864
v_mfma_f32_16x16x32_bf16 v[144:147], a[180:183], a[112:115], v[144:147]
ds_read_b128 a[112:115], v3 offset:36864
v_mfma_f32_16x16x32_bf16 v[148:151], a[180:183], a[116:119], v[148:151]
buffer_load_dwordx4 v0, s[20:23], s39 offen offset:3072 sc1 lds
v_mfma_f32_16x16x32_bf16 v[148:151], a[212:215], a[148:151], v[148:151]
v_mfma_f32_16x16x32_bf16 v[116:119], a[208:211], a[148:151], v[116:119]
ds_read_b128 a[148:151], v4 offset:37888
v_mfma_f32_16x16x32_bf16 v[116:119], a[176:179], a[116:119], v[116:119]
ds_read_b128 a[116:119], v3 offset:37888
v_mfma_f32_16x16x32_bf16 v[120:123], a[176:179], a[120:123], v[120:123]
v_mfma_f32_16x16x32_bf16 v[120:123], a[208:211], a[152:155], v[120:123]
v_mfma_f32_16x16x32_bf16 v[152:155], a[212:215], a[152:155], v[152:155]
ds_read_b128 a[152:155], v4 offset:38912
v_mfma_f32_16x16x32_bf16 v[152:155], a[180:183], a[120:123], v[152:155]
ds_read_b128 a[120:123], v3 offset:38912
v_mfma_f32_16x16x32_bf16 v[156:159], a[180:183], a[124:127], v[156:159]
buffer_load_dwordx4 a[180:183], v0, s[20:23], s30 offen offset:0 sc1
v_mfma_f32_16x16x32_bf16 v[156:159], a[212:215], a[156:159], v[156:159]
buffer_load_dwordx4 a[212:215], v0, s[20:23], s30 offen offset:1024 sc1
v_mfma_f32_16x16x32_bf16 v[124:127], a[208:211], a[156:159], v[124:127]
buffer_load_dwordx4 a[208:211], v0, s[20:23], s30 offen offset:2048 sc1
ds_read_b128 a[156:159], v4 offset:39936
v_mfma_f32_16x16x32_bf16 v[124:127], a[176:179], a[124:127], v[124:127]
buffer_load_dwordx4 a[176:179], v0, s[20:23], s30 offen offset:3072 sc1
s_add_u32 s30, s30, 0x3000
ds_read_b128 a[124:127], v3 offset:39936
s_waitcnt vmcnt(16) lgkmcnt(14)
v_mfma_f32_16x16x32_bf16 v[32:35], a[184:187], a[96:99], v[32:35]
v_mfma_f32_16x16x32_bf16 v[32:35], a[216:219], a[128:131], v[32:35]
v_mfma_f32_16x16x32_bf16 v[64:67], a[220:223], a[128:131], v[64:67]
v_mfma_f32_16x16x32_bf16 v[64:67], a[188:191], a[96:99], v[64:67]
s_waitcnt lgkmcnt(12)
v_mfma_f32_16x16x32_bf16 v[68:71], a[188:191], a[100:103], v[68:71]
v_mfma_f32_16x16x32_bf16 v[68:71], a[220:223], a[132:135], v[68:71]
v_mfma_f32_16x16x32_bf16 v[36:39], a[216:219], a[132:135], v[36:39]
v_mfma_f32_16x16x32_bf16 v[36:39], a[184:187], a[100:103], v[36:39]
s_waitcnt lgkmcnt(10)
v_mfma_f32_16x16x32_bf16 v[40:43], a[184:187], a[104:107], v[40:43]
v_mfma_f32_16x16x32_bf16 v[40:43], a[216:219], a[136:139], v[40:43]
v_mfma_f32_16x16x32_bf16 v[72:75], a[220:223], a[136:139], v[72:75]
v_mfma_f32_16x16x32_bf16 v[72:75], a[188:191], a[104:107], v[72:75]
s_add_u32 m0, s32, 102400
s_add_u32 s39, s56, 33918976
s_waitcnt lgkmcnt(8)
v_mfma_f32_16x16x32_bf16 v[76:79], a[188:191], a[108:111], v[76:79]
buffer_load_dwordx4 v0, s[20:23], s39 offen offset:0 sc1 lds
v_mfma_f32_16x16x32_bf16 v[76:79], a[220:223], a[140:143], v[76:79]
v_mfma_f32_16x16x32_bf16 v[44:47], a[216:219], a[140:143], v[44:47]
v_mfma_f32_16x16x32_bf16 v[44:47], a[184:187], a[108:111], v[44:47]
s_waitcnt lgkmcnt(6)
v_mfma_f32_16x16x32_bf16 v[48:51], a[184:187], a[112:115], v[48:51]
v_mfma_f32_16x16x32_bf16 v[48:51], a[216:219], a[144:147], v[48:51]
v_mfma_f32_16x16x32_bf16 v[80:83], a[220:223], a[144:147], v[80:83]
v_mfma_f32_16x16x32_bf16 v[80:83], a[188:191], a[112:115], v[80:83]
s_waitcnt lgkmcnt(4)
v_mfma_f32_16x16x32_bf16 v[84:87], a[188:191], a[116:119], v[84:87]
v_mfma_f32_16x16x32_bf16 v[84:87], a[220:223], a[148:151], v[84:87]
v_mfma_f32_16x16x32_bf16 v[52:55], a[216:219], a[148:151], v[52:55]
v_mfma_f32_16x16x32_bf16 v[52:55], a[184:187], a[116:119], v[52:55]
s_waitcnt lgkmcnt(2)
v_mfma_f32_16x16x32_bf16 v[56:59], a[184:187], a[120:123], v[56:59]
v_mfma_f32_16x16x32_bf16 v[56:59], a[216:219], a[152:155], v[56:59]
v_mfma_f32_16x16x32_bf16 v[88:91], a[220:223], a[152:155], v[88:91]
v_mfma_f32_16x16x32_bf16 v[88:91], a[188:191], a[120:123], v[88:91]
s_waitcnt lgkmcnt(0)
v_mfma_f32_16x16x32_bf16 v[92:95], a[188:191], a[124:127], v[92:95]
buffer_load_dwordx4 a[188:191], v0, s[20:23], s30 offen offset:0 sc1
v_mfma_f32_16x16x32_bf16 v[92:95], a[220:223], a[156:159], v[92:95]
buffer_load_dwordx4 a[220:223], v0, s[20:23], s30 offen offset:1024 sc1
v_mfma_f32_16x16x32_bf16 v[60:63], a[216:219], a[156:159], v[60:63]
buffer_load_dwordx4 a[216:219], v0, s[20:23], s30 offen offset:2048 sc1
v_mfma_f32_16x16x32_bf16 v[60:63], a[184:187], a[124:127], v[60:63]
buffer_load_dwordx4 a[184:187], v0, s[20:23], s30 offen offset:3072 sc1
s_add_u32 s30, s30, 0x1000
s_barrier
s_waitcnt vmcnt(16)
v_mfma_f32_16x16x32_bf16 v[96:99], a[192:195], a[96:99], v[96:99]
v_mfma_f32_16x16x32_bf16 v[96:99], a[160:163], a[128:131], v[96:99]
v_mfma_f32_16x16x32_bf16 v[128:131], a[164:167], a[128:131], v[128:131]
v_xor_b32 v2, 0x12000, v6
ds_read_b128 a[128:131], v2 offset:0
v_mfma_f32_16x16x32_bf16 v[128:131], a[196:199], a[96:99], v[128:131]
v_xor_b32 v1, 0x10000, v6
ds_read_b128 a[96:99], v1 offset:0
v_mfma_f32_16x16x32_bf16 v[132:135], a[196:199], a[100:103], v[132:135]
buffer_load_dwordx4 v0, s[20:23], s39 offen offset:1024 sc1 lds
v_mfma_f32_16x16x32_bf16 v[132:135], a[164:167], a[132:135], v[132:135]
v_mfma_f32_16x16x32_bf16 v[100:103], a[160:163], a[132:135], v[100:103]
ds_read_b128 a[132:135], v2 offset:1024
v_mfma_f32_16x16x32_bf16 v[100:103], a[192:195], a[100:103], v[100:103]
ds_read_b128 a[100:103], v1 offset:1024
v_mfma_f32_16x16x32_bf16 v[104:107], a[192:195], a[104:107], v[104:107]
v_mfma_f32_16x16x32_bf16 v[104:107], a[160:163], a[136:139], v[104:107]
v_mfma_f32_16x16x32_bf16 v[136:139], a[164:167], a[136:139], v[136:139]
ds_read_b128 a[136:139], v2 offset:2048
v_mfma_f32_16x16x32_bf16 v[136:139], a[196:199], a[104:107], v[136:139]
ds_read_b128 a[104:107], v1 offset:2048
v_mfma_f32_16x16x32_bf16 v[140:143], a[196:199], a[108:111], v[140:143]
v_mfma_f32_16x16x32_bf16 v[140:143], a[164:167], a[140:143], v[140:143]
v_mfma_f32_16x16x32_bf16 v[108:111], a[160:163], a[140:143], v[108:111]
ds_read_b128 a[140:143], v2 offset:3072
v_mfma_f32_16x16x32_bf16 v[108:111], a[192:195], a[108:111], v[108:111]
ds_read_b128 a[108:111], v1 offset:3072
v_mfma_f32_16x16x32_bf16 v[112:115], a[192:195], a[112:115], v[112:115]
v_mfma_f32_16x16x32_bf16 v[112:115], a[160:163], a[144:147], v[112:115]
v_mfma_f32_16x16x32_bf16 v[144:147], a[164:167], a[144:147], v[144:147]
ds_read_b128 a[144:147], v2 offset:4096
v_mfma_f32_16x16x32_bf16 v[144:147], a[196:199], a[112:115], v[144:147]
ds_read_b128 a[112:115], v1 offset:4096
v_mfma_f32_16x16x32_bf16 v[148:151], a[196:199], a[116:119], v[148:151]
v_mfma_f32_16x16x32_bf16 v[148:151], a[164:167], a[148:151], v[148:151]
v_mfma_f32_16x16x32_bf16 v[116:119], a[160:163], a[148:151], v[116:119]
ds_read_b128 a[148:151], v2 offset:5120
v_mfma_f32_16x16x32_bf16 v[116:119], a[192:195], a[116:119], v[116:119]
ds_read_b128 a[116:119], v1 offset:5120
v_mfma_f32_16x16x32_bf16 v[120:123], a[192:195], a[120:123], v[120:123]
v_mfma_f32_16x16x32_bf16 v[120:123], a[160:163], a[152:155], v[120:123]
v_mfma_f32_16x16x32_bf16 v[152:155], a[164:167], a[152:155], v[152:155]
ds_read_b128 a[152:155], v2 offset:6144
v_mfma_f32_16x16x32_bf16 v[152:155], a[196:199], a[120:123], v[152:155]
ds_read_b128 a[120:123], v1 offset:6144
v_mfma_f32_16x16x32_bf16 v[156:159], a[196:199], a[124:127], v[156:159]
buffer_load_dwordx4 a[196:199], v0, s[20:23], s30 offen offset:0 sc1
buffer_load_dwordx4 v0, s[20:23], s39 offen offset:2048 sc1 lds
v_mfma_f32_16x16x32_bf16 v[156:159], a[164:167], a[156:159], v[156:159]
buffer_load_dwordx4 a[164:167], v0, s[20:23], s30 offen offset:1024 sc1
v_mfma_f32_16x16x32_bf16 v[124:127], a[160:163], a[156:159], v[124:127]
buffer_load_dwordx4 a[160:163], v0, s[20:23], s30 offen offset:2048 sc1
ds_read_b128 a[156:159], v2 offset:7168
v_mfma_f32_16x16x32_bf16 v[124:127], a[192:195], a[124:127], v[124:127]
buffer_load_dwordx4 a[192:195], v0, s[20:23], s30 offen offset:3072 sc1
s_add_u32 s30, s30, 0x3000
ds_read_b128 a[124:127], v1 offset:7168
s_waitcnt vmcnt(16) lgkmcnt(14)
v_mfma_f32_16x16x32_bf16 v[32:35], a[200:203], a[96:99], v[32:35]
v_mfma_f32_16x16x32_bf16 v[32:35], a[168:171], a[128:131], v[32:35]
v_mfma_f32_16x16x32_bf16 v[64:67], a[172:175], a[128:131], v[64:67]
v_mfma_f32_16x16x32_bf16 v[64:67], a[204:207], a[96:99], v[64:67]
s_waitcnt lgkmcnt(12)
v_mfma_f32_16x16x32_bf16 v[68:71], a[204:207], a[100:103], v[68:71]
v_mfma_f32_16x16x32_bf16 v[68:71], a[172:175], a[132:135], v[68:71]
v_mfma_f32_16x16x32_bf16 v[36:39], a[168:171], a[132:135], v[36:39]
v_mfma_f32_16x16x32_bf16 v[36:39], a[200:203], a[100:103], v[36:39]
s_waitcnt lgkmcnt(10)
v_mfma_f32_16x16x32_bf16 v[40:43], a[200:203], a[104:107], v[40:43]
v_mfma_f32_16x16x32_bf16 v[40:43], a[168:171], a[136:139], v[40:43]
v_mfma_f32_16x16x32_bf16 v[72:75], a[172:175], a[136:139], v[72:75]
v_mfma_f32_16x16x32_bf16 v[72:75], a[204:207], a[104:107], v[72:75]
s_waitcnt lgkmcnt(8)
v_mfma_f32_16x16x32_bf16 v[76:79], a[204:207], a[108:111], v[76:79]
v_mfma_f32_16x16x32_bf16 v[76:79], a[172:175], a[140:143], v[76:79]
v_mfma_f32_16x16x32_bf16 v[44:47], a[168:171], a[140:143], v[44:47]
v_mfma_f32_16x16x32_bf16 v[44:47], a[200:203], a[108:111], v[44:47]
s_waitcnt lgkmcnt(6)
v_mfma_f32_16x16x32_bf16 v[48:51], a[200:203], a[112:115], v[48:51]
v_mfma_f32_16x16x32_bf16 v[48:51], a[168:171], a[144:147], v[48:51]
v_mfma_f32_16x16x32_bf16 v[80:83], a[172:175], a[144:147], v[80:83]
v_mfma_f32_16x16x32_bf16 v[80:83], a[204:207], a[112:115], v[80:83]
s_waitcnt lgkmcnt(4)
v_mfma_f32_16x16x32_bf16 v[84:87], a[204:207], a[116:119], v[84:87]
buffer_load_dwordx4 v0, s[20:23], s39 offen offset:3072 sc1 lds
v_mfma_f32_16x16x32_bf16 v[84:87], a[172:175], a[148:151], v[84:87]
v_mfma_f32_16x16x32_bf16 v[52:55], a[168:171], a[148:151], v[52:55]
v_mfma_f32_16x16x32_bf16 v[52:55], a[200:203], a[116:119], v[52:55]
s_waitcnt lgkmcnt(2)
v_mfma_f32_16x16x32_bf16 v[56:59], a[200:203], a[120:123], v[56:59]
v_mfma_f32_16x16x32_bf16 v[56:59], a[168:171], a[152:155], v[56:59]
v_mfma_f32_16x16x32_bf16 v[88:91], a[172:175], a[152:155], v[88:91]
v_mfma_f32_16x16x32_bf16 v[88:91], a[204:207], a[120:123], v[88:91]
s_waitcnt lgkmcnt(0)
v_mfma_f32_16x16x32_bf16 v[92:95], a[204:207], a[124:127], v[92:95]
buffer_load_dwordx4 a[204:207], v0, s[20:23], s30 offen offset:0 sc1
v_mfma_f32_16x16x32_bf16 v[92:95], a[172:175], a[156:159], v[92:95]
buffer_load_dwordx4 a[172:175], v0, s[20:23], s30 offen offset:1024 sc1
v_mfma_f32_16x16x32_bf16 v[60:63], a[168:171], a[156:159], v[60:63]
buffer_load_dwordx4 a[168:171], v0, s[20:23], s30 offen offset:2048 sc1
v_mfma_f32_16x16x32_bf16 v[60:63], a[200:203], a[124:127], v[60:63]
buffer_load_dwordx4 a[200:203], v0, s[20:23], s30 offen offset:3072 sc1
s_add_u32 s30, s30, 0x1000
s_waitcnt vmcnt(16)
v_mfma_f32_16x16x32_bf16 v[96:99], a[180:183], a[96:99], v[96:99]
v_mfma_f32_16x16x32_bf16 v[96:99], a[212:215], a[128:131], v[96:99]
v_mfma_f32_16x16x32_bf16 v[128:131], a[176:179], a[128:131], v[128:131]
v_xor_b32 v4, 0x16000, v6
ds_read_b128 a[128:131], v4 offset:0
v_mfma_f32_16x16x32_bf16 v[128:131], a[208:211], a[96:99], v[128:131]
v_xor_b32 v3, 0x14000, v6
ds_read_b128 a[96:99], v3 offset:0
v_mfma_f32_16x16x32_bf16 v[132:135], a[208:211], a[100:103], v[132:135]
v_mfma_f32_16x16x32_bf16 v[132:135], a[176:179], a[132:135], v[132:135]
v_mfma_f32_16x16x32_bf16 v[100:103], a[212:215], a[132:135], v[100:103]
ds_read_b128 a[132:135], v4 offset:1024
v_mfma_f32_16x16x32_bf16 v[100:103], a[180:183], a[100:103], v[100:103]
ds_read_b128 a[100:103], v3 offset:1024
v_mfma_f32_16x16x32_bf16 v[104:107], a[180:183], a[104:107], v[104:107]
v_mfma_f32_16x16x32_bf16 v[104:107], a[212:215], a[136:139], v[104:107]
v_mfma_f32_16x16x32_bf16 v[136:139], a[176:179], a[136:139], v[136:139]
ds_read_b128 a[136:139], v4 offset:2048
v_mfma_f32_16x16x32_bf16 v[136:139], a[208:211], a[104:107], v[136:139]
ds_read_b128 a[104:107], v3 offset:2048
v_mfma_f32_16x16x32_bf16 v[140:143], a[208:211], a[108:111], v[140:143]
v_mfma_f32_16x16x32_bf16 v[140:143], a[176:179], a[140:143], v[140:143]
v_mfma_f32_16x16x32_bf16 v[108:111], a[212:215], a[140:143], v[108:111]
ds_read_b128 a[140:143], v4 offset:3072
v_mfma_f32_16x16x32_bf16 v[108:111], a[180:183], a[108:111], v[108:111]
ds_read_b128 a[108:111], v3 offset:3072
v_mfma_f32_16x16x32_bf16 v[112:115], a[180:183], a[112:115], v[112:115]
v_mfma_f32_16x16x32_bf16 v[112:115], a[212:215], a[144:147], v[112:115]
v_mfma_f32_16x16x32_bf16 v[144:147], a[176:179], a[144:147], v[144:147]
ds_read_b128 a[144:147], v4 offset:4096
v_mfma_f32_16x16x32_bf16 v[144:147], a[208:211], a[112:115], v[144:147]
ds_read_b128 a[112:115], v3 offset:4096
v_mfma_f32_16x16x32_bf16 v[148:151], a[208:211], a[116:119], v[148:151]
v_mfma_f32_16x16x32_bf16 v[148:151], a[176:179], a[148:151], v[148:151]
v_mfma_f32_16x16x32_bf16 v[116:119], a[212:215], a[148:151], v[116:119]
ds_read_b128 a[148:151], v4 offset:5120
v_mfma_f32_16x16x32_bf16 v[116:119], a[180:183], a[116:119], v[116:119]
ds_read_b128 a[116:119], v3 offset:5120
v_mfma_f32_16x16x32_bf16 v[120:123], a[180:183], a[120:123], v[120:123]
v_mfma_f32_16x16x32_bf16 v[120:123], a[212:215], a[152:155], v[120:123]
v_mfma_f32_16x16x32_bf16 v[152:155], a[176:179], a[152:155], v[152:155]
ds_read_b128 a[152:155], v4 offset:6144
v_mfma_f32_16x16x32_bf16 v[152:155], a[208:211], a[120:123], v[152:155]
ds_read_b128 a[120:123], v3 offset:6144
v_mfma_f32_16x16x32_bf16 v[156:159], a[208:211], a[124:127], v[156:159]
buffer_load_dwordx4 a[208:211], v0, s[20:23], s30 offen offset:0 sc1
v_mfma_f32_16x16x32_bf16 v[156:159], a[176:179], a[156:159], v[156:159]
buffer_load_dwordx4 a[176:179], v0, s[20:23], s30 offen offset:1024 sc1
v_mfma_f32_16x16x32_bf16 v[124:127], a[212:215], a[156:159], v[124:127]
buffer_load_dwordx4 a[212:215], v0, s[20:23], s30 offen offset:2048 sc1
ds_read_b128 a[156:159], v4 offset:7168
v_mfma_f32_16x16x32_bf16 v[124:127], a[180:183], a[124:127], v[124:127]
buffer_load_dwordx4 a[180:183], v0, s[20:23], s30 offen offset:3072 sc1
s_add_u32 s30, s30, 0x3000
ds_read_b128 a[124:127], v3 offset:7168
s_waitcnt vmcnt(15) lgkmcnt(14)
v_mfma_f32_16x16x32_bf16 v[32:35], a[188:191], a[96:99], v[32:35]
v_mfma_f32_16x16x32_bf16 v[32:35], a[220:223], a[128:131], v[32:35]
v_mfma_f32_16x16x32_bf16 v[64:67], a[184:187], a[128:131], v[64:67]
v_mfma_f32_16x16x32_bf16 v[64:67], a[216:219], a[96:99], v[64:67]
s_waitcnt lgkmcnt(12)
v_mfma_f32_16x16x32_bf16 v[68:71], a[216:219], a[100:103], v[68:71]
v_mfma_f32_16x16x32_bf16 v[68:71], a[184:187], a[132:135], v[68:71]
v_mfma_f32_16x16x32_bf16 v[36:39], a[220:223], a[132:135], v[36:39]
v_mfma_f32_16x16x32_bf16 v[36:39], a[188:191], a[100:103], v[36:39]
s_waitcnt lgkmcnt(10)
v_mfma_f32_16x16x32_bf16 v[40:43], a[188:191], a[104:107], v[40:43]
v_mfma_f32_16x16x32_bf16 v[40:43], a[220:223], a[136:139], v[40:43]
v_mfma_f32_16x16x32_bf16 v[72:75], a[184:187], a[136:139], v[72:75]
v_mfma_f32_16x16x32_bf16 v[72:75], a[216:219], a[104:107], v[72:75]
s_waitcnt lgkmcnt(8)
v_mfma_f32_16x16x32_bf16 v[76:79], a[216:219], a[108:111], v[76:79]
v_mfma_f32_16x16x32_bf16 v[76:79], a[184:187], a[140:143], v[76:79]
v_mfma_f32_16x16x32_bf16 v[44:47], a[220:223], a[140:143], v[44:47]
v_mfma_f32_16x16x32_bf16 v[44:47], a[188:191], a[108:111], v[44:47]
s_waitcnt lgkmcnt(6)
v_mfma_f32_16x16x32_bf16 v[48:51], a[188:191], a[112:115], v[48:51]
v_mfma_f32_16x16x32_bf16 v[48:51], a[220:223], a[144:147], v[48:51]
v_mfma_f32_16x16x32_bf16 v[80:83], a[184:187], a[144:147], v[80:83]
v_mfma_f32_16x16x32_bf16 v[80:83], a[216:219], a[112:115], v[80:83]
s_waitcnt lgkmcnt(4)
v_mfma_f32_16x16x32_bf16 v[84:87], a[216:219], a[116:119], v[84:87]
v_mfma_f32_16x16x32_bf16 v[84:87], a[184:187], a[148:151], v[84:87]
v_mfma_f32_16x16x32_bf16 v[52:55], a[220:223], a[148:151], v[52:55]
v_mfma_f32_16x16x32_bf16 v[52:55], a[188:191], a[116:119], v[52:55]
s_waitcnt lgkmcnt(2)
v_mfma_f32_16x16x32_bf16 v[56:59], a[188:191], a[120:123], v[56:59]
v_mfma_f32_16x16x32_bf16 v[56:59], a[220:223], a[152:155], v[56:59]
v_mfma_f32_16x16x32_bf16 v[88:91], a[184:187], a[152:155], v[88:91]
v_mfma_f32_16x16x32_bf16 v[88:91], a[216:219], a[120:123], v[88:91]
s_waitcnt lgkmcnt(0)
v_mfma_f32_16x16x32_bf16 v[92:95], a[216:219], a[124:127], v[92:95]
buffer_load_dwordx4 a[216:219], v0, s[20:23], s30 offen offset:0 sc1
v_mfma_f32_16x16x32_bf16 v[92:95], a[184:187], a[156:159], v[92:95]
buffer_load_dwordx4 a[184:187], v0, s[20:23], s30 offen offset:1024 sc1
v_mfma_f32_16x16x32_bf16 v[60:63], a[220:223], a[156:159], v[60:63]
buffer_load_dwordx4 a[220:223], v0, s[20:23], s30 offen offset:2048 sc1
v_mfma_f32_16x16x32_bf16 v[60:63], a[188:191], a[124:127], v[60:63]
buffer_load_dwordx4 a[188:191], v0, s[20:23], s30 offen offset:3072 sc1
s_add_u32 s30, s30, 0x1000
s_waitcnt vmcnt(12)
s_barrier
v_mfma_f32_16x16x32_bf16 v[96:99], a[196:199], a[96:99], v[96:99]
v_mfma_f32_16x16x32_bf16 v[96:99], a[164:167], a[128:131], v[96:99]
v_mfma_f32_16x16x32_bf16 v[128:131], a[192:195], a[128:131], v[128:131]
ds_read_b128 a[128:131], v2 offset:32768
v_mfma_f32_16x16x32_bf16 v[128:131], a[160:163], a[96:99], v[128:131]
ds_read_b128 a[96:99], v1 offset:32768
v_mfma_f32_16x16x32_bf16 v[132:135], a[160:163], a[100:103], v[132:135]
v_mfma_f32_16x16x32_bf16 v[132:135], a[192:195], a[132:135], v[132:135]
v_mfma_f32_16x16x32_bf16 v[100:103], a[164:167], a[132:135], v[100:103]
ds_read_b128 a[132:135], v2 offset:33792
v_mfma_f32_16x16x32_bf16 v[100:103], a[196:199], a[100:103], v[100:103]
ds_read_b128 a[100:103], v1 offset:33792
v_mfma_f32_16x16x32_bf16 v[104:107], a[196:199], a[104:107], v[104:107]
v_mfma_f32_16x16x32_bf16 v[104:107], a[164:167], a[136:139], v[104:107]
v_mfma_f32_16x16x32_bf16 v[136:139], a[192:195], a[136:139], v[136:139]
ds_read_b128 a[136:139], v2 offset:34816
v_mfma_f32_16x16x32_bf16 v[136:139], a[160:163], a[104:107], v[136:139]
ds_read_b128 a[104:107], v1 offset:34816
v_mfma_f32_16x16x32_bf16 v[140:143], a[160:163], a[108:111], v[140:143]
v_mfma_f32_16x16x32_bf16 v[140:143], a[192:195], a[140:143], v[140:143]
v_mfma_f32_16x16x32_bf16 v[108:111], a[164:167], a[140:143], v[108:111]
ds_read_b128 a[140:143], v2 offset:35840
v_mfma_f32_16x16x32_bf16 v[108:111], a[196:199], a[108:111], v[108:111]
ds_read_b128 a[108:111], v1 offset:35840
v_mfma_f32_16x16x32_bf16 v[112:115], a[196:199], a[112:115], v[112:115]
v_mfma_f32_16x16x32_bf16 v[112:115], a[164:167], a[144:147], v[112:115]
v_mfma_f32_16x16x32_bf16 v[144:147], a[192:195], a[144:147], v[144:147]
ds_read_b128 a[144:147], v2 offset:36864
v_mfma_f32_16x16x32_bf16 v[144:147], a[160:163], a[112:115], v[144:147]
ds_read_b128 a[112:115], v1 offset:36864
v_mfma_f32_16x16x32_bf16 v[148:151], a[160:163], a[116:119], v[148:151]
v_mfma_f32_16x16x32_bf16 v[148:151], a[192:195], a[148:151], v[148:151]
v_mfma_f32_16x16x32_bf16 v[116:119], a[164:167], a[148:151], v[116:119]
ds_read_b128 a[148:151], v2 offset:37888
v_mfma_f32_16x16x32_bf16 v[116:119], a[196:199], a[116:119], v[116:119]
ds_read_b128 a[116:119], v1 offset:37888
v_mfma_f32_16x16x32_bf16 v[120:123], a[196:199], a[120:123], v[120:123]
v_mfma_f32_16x16x32_bf16 v[120:123], a[164:167], a[152:155], v[120:123]
v_mfma_f32_16x16x32_bf16 v[152:155], a[192:195], a[152:155], v[152:155]
ds_read_b128 a[152:155], v2 offset:38912
v_mfma_f32_16x16x32_bf16 v[152:155], a[160:163], a[120:123], v[152:155]
ds_read_b128 a[120:123], v1 offset:38912
v_mfma_f32_16x16x32_bf16 v[156:159], a[160:163], a[124:127], v[156:159]
buffer_load_dwordx4 a[160:163], v0, s[20:23], s30 offen offset:0 sc1
v_mfma_f32_16x16x32_bf16 v[156:159], a[192:195], a[156:159], v[156:159]
buffer_load_dwordx4 a[192:195], v0, s[20:23], s30 offen offset:1024 sc1
v_mfma_f32_16x16x32_bf16 v[124:127], a[164:167], a[156:159], v[124:127]
buffer_load_dwordx4 a[164:167], v0, s[20:23], s30 offen offset:2048 sc1
ds_read_b128 a[156:159], v2 offset:39936
v_mfma_f32_16x16x32_bf16 v[124:127], a[196:199], a[124:127], v[124:127]
buffer_load_dwordx4 a[196:199], v0, s[20:23], s30 offen offset:3072 sc1
s_add_u32 s30, s30, 0xfffe5000
ds_read_b128 a[124:127], v1 offset:39936
s_waitcnt vmcnt(12) lgkmcnt(14)
v_mfma_f32_16x16x32_bf16 v[32:35], a[204:207], a[96:99], v[32:35]
v_mfma_f32_16x16x32_bf16 v[32:35], a[172:175], a[128:131], v[32:35]
v_mfma_f32_16x16x32_bf16 v[64:67], a[200:203], a[128:131], v[64:67]
v_mfma_f32_16x16x32_bf16 v[64:67], a[168:171], a[96:99], v[64:67]
s_waitcnt lgkmcnt(12)
v_mfma_f32_16x16x32_bf16 v[68:71], a[168:171], a[100:103], v[68:71]
v_mfma_f32_16x16x32_bf16 v[68:71], a[200:203], a[132:135], v[68:71]
v_mfma_f32_16x16x32_bf16 v[36:39], a[172:175], a[132:135], v[36:39]
v_mfma_f32_16x16x32_bf16 v[36:39], a[204:207], a[100:103], v[36:39]
s_waitcnt lgkmcnt(10)
v_mfma_f32_16x16x32_bf16 v[40:43], a[204:207], a[104:107], v[40:43]
v_mfma_f32_16x16x32_bf16 v[40:43], a[172:175], a[136:139], v[40:43]
v_mfma_f32_16x16x32_bf16 v[72:75], a[200:203], a[136:139], v[72:75]
v_mfma_f32_16x16x32_bf16 v[72:75], a[168:171], a[104:107], v[72:75]
s_waitcnt lgkmcnt(8)
v_mfma_f32_16x16x32_bf16 v[76:79], a[168:171], a[108:111], v[76:79]
v_mfma_f32_16x16x32_bf16 v[76:79], a[200:203], a[140:143], v[76:79]
v_mfma_f32_16x16x32_bf16 v[44:47], a[172:175], a[140:143], v[44:47]
v_mfma_f32_16x16x32_bf16 v[44:47], a[204:207], a[108:111], v[44:47]
s_waitcnt lgkmcnt(6)
v_mfma_f32_16x16x32_bf16 v[48:51], a[204:207], a[112:115], v[48:51]
v_mfma_f32_16x16x32_bf16 v[48:51], a[172:175], a[144:147], v[48:51]
v_mfma_f32_16x16x32_bf16 v[80:83], a[200:203], a[144:147], v[80:83]
v_mfma_f32_16x16x32_bf16 v[80:83], a[168:171], a[112:115], v[80:83]
s_waitcnt lgkmcnt(4)
v_mfma_f32_16x16x32_bf16 v[84:87], a[168:171], a[116:119], v[84:87]
v_mfma_f32_16x16x32_bf16 v[84:87], a[200:203], a[148:151], v[84:87]
v_mfma_f32_16x16x32_bf16 v[52:55], a[172:175], a[148:151], v[52:55]
v_mfma_f32_16x16x32_bf16 v[52:55], a[204:207], a[116:119], v[52:55]
s_waitcnt lgkmcnt(2)
v_mfma_f32_16x16x32_bf16 v[56:59], a[204:207], a[120:123], v[56:59]
v_mfma_f32_16x16x32_bf16 v[56:59], a[172:175], a[152:155], v[56:59]
v_mfma_f32_16x16x32_bf16 v[88:91], a[200:203], a[152:155], v[88:91]
v_mfma_f32_16x16x32_bf16 v[88:91], a[168:171], a[120:123], v[88:91]
s_waitcnt lgkmcnt(0)
v_mfma_f32_16x16x32_bf16 v[92:95], a[168:171], a[124:127], v[92:95]
buffer_load_dwordx4 a[168:171], v0, s[20:23], s30 offen offset:0 sc1
v_mfma_f32_16x16x32_bf16 v[92:95], a[200:203], a[156:159], v[92:95]
buffer_load_dwordx4 a[200:203], v0, s[20:23], s30 offen offset:1024 sc1
v_mfma_f32_16x16x32_bf16 v[60:63], a[172:175], a[156:159], v[60:63]
buffer_load_dwordx4 a[172:175], v0, s[20:23], s30 offen offset:2048 sc1
v_mfma_f32_16x16x32_bf16 v[60:63], a[204:207], a[124:127], v[60:63]
buffer_load_dwordx4 a[204:207], v0, s[20:23], s30 offen offset:3072 sc1
s_add_u32 s30, s30, 0x1000
s_waitcnt vmcnt(12)
v_mfma_f32_16x16x32_bf16 v[96:99], a[208:211], a[96:99], v[96:99]
v_mfma_f32_16x16x32_bf16 v[96:99], a[176:179], a[128:131], v[96:99]
v_mfma_f32_16x16x32_bf16 v[128:131], a[180:183], a[128:131], v[128:131]
ds_read_b128 a[128:131], v4 offset:32768
v_mfma_f32_16x16x32_bf16 v[128:131], a[212:215], a[96:99], v[128:131]
ds_read_b128 a[96:99], v3 offset:32768
v_mfma_f32_16x16x32_bf16 v[132:135], a[212:215], a[100:103], v[132:135]
v_mfma_f32_16x16x32_bf16 v[132:135], a[180:183], a[132:135], v[132:135]
v_mfma_f32_16x16x32_bf16 v[100:103], a[176:179], a[132:135], v[100:103]
ds_read_b128 a[132:135], v4 offset:33792
v_mfma_f32_16x16x32_bf16 v[100:103], a[208:211], a[100:103], v[100:103]
ds_read_b128 a[100:103], v3 offset:33792
v_mfma_f32_16x16x32_bf16 v[104:107], a[208:211], a[104:107], v[104:107]
v_mfma_f32_16x16x32_bf16 v[104:107], a[176:179], a[136:139], v[104:107]
v_mfma_f32_16x16x32_bf16 v[136:139], a[180:183], a[136:139], v[136:139]
ds_read_b128 a[136:139], v4 offset:34816
v_mfma_f32_16x16x32_bf16 v[136:139], a[212:215], a[104:107], v[136:139]
ds_read_b128 a[104:107], v3 offset:34816
v_mfma_f32_16x16x32_bf16 v[140:143], a[212:215], a[108:111], v[140:143]
v_mfma_f32_16x16x32_bf16 v[140:143], a[180:183], a[140:143], v[140:143]
v_mfma_f32_16x16x32_bf16 v[108:111], a[176:179], a[140:143], v[108:111]
ds_read_b128 a[140:143], v4 offset:35840
v_mfma_f32_16x16x32_bf16 v[108:111], a[208:211], a[108:111], v[108:111]
ds_read_b128 a[108:111], v3 offset:35840
v_mfma_f32_16x16x32_bf16 v[112:115], a[208:211], a[112:115], v[112:115]
v_mfma_f32_16x16x32_bf16 v[112:115], a[176:179], a[144:147], v[112:115]
v_mfma_f32_16x16x32_bf16 v[144:147], a[180:183], a[144:147], v[144:147]
ds_read_b128 a[144:147], v4 offset:36864
v_mfma_f32_16x16x32_bf16 v[144:147], a[212:215], a[112:115], v[144:147]
ds_read_b128 a[112:115], v3 offset:36864
v_mfma_f32_16x16x32_bf16 v[148:151], a[212:215], a[116:119], v[148:151]
v_mfma_f32_16x16x32_bf16 v[148:151], a[180:183], a[148:151], v[148:151]
v_mfma_f32_16x16x32_bf16 v[116:119], a[176:179], a[148:151], v[116:119]
ds_read_b128 a[148:151], v4 offset:37888
v_mfma_f32_16x16x32_bf16 v[116:119], a[208:211], a[116:119], v[116:119]
ds_read_b128 a[116:119], v3 offset:37888
v_mfma_f32_16x16x32_bf16 v[120:123], a[208:211], a[120:123], v[120:123]
v_mfma_f32_16x16x32_bf16 v[120:123], a[176:179], a[152:155], v[120:123]
v_mfma_f32_16x16x32_bf16 v[152:155], a[180:183], a[152:155], v[152:155]
ds_read_b128 a[152:155], v4 offset:38912
v_mfma_f32_16x16x32_bf16 v[152:155], a[212:215], a[120:123], v[152:155]
ds_read_b128 a[120:123], v3 offset:38912
v_mfma_f32_16x16x32_bf16 v[156:159], a[212:215], a[124:127], v[156:159]
buffer_load_dwordx4 a[212:215], v0, s[20:23], s30 offen offset:0 sc1
v_mfma_f32_16x16x32_bf16 v[156:159], a[180:183], a[156:159], v[156:159]
buffer_load_dwordx4 a[180:183], v0, s[20:23], s30 offen offset:1024 sc1
v_mfma_f32_16x16x32_bf16 v[124:127], a[176:179], a[156:159], v[124:127]
buffer_load_dwordx4 a[176:179], v0, s[20:23], s30 offen offset:2048 sc1
ds_read_b128 a[156:159], v4 offset:39936
v_mfma_f32_16x16x32_bf16 v[124:127], a[208:211], a[124:127], v[124:127]
buffer_load_dwordx4 a[208:211], v0, s[20:23], s30 offen offset:3072 sc1
s_add_u32 s30, s30, 0x3000
ds_read_b128 a[124:127], v3 offset:39936
s_waitcnt vmcnt(12) lgkmcnt(14)
v_mfma_f32_16x16x32_bf16 v[32:35], a[216:219], a[96:99], v[32:35]
v_mfma_f32_16x16x32_bf16 v[32:35], a[184:187], a[128:131], v[32:35]
v_mfma_f32_16x16x32_bf16 v[64:67], a[188:191], a[128:131], v[64:67]
v_mfma_f32_16x16x32_bf16 v[64:67], a[220:223], a[96:99], v[64:67]
s_waitcnt lgkmcnt(12)
v_mfma_f32_16x16x32_bf16 v[68:71], a[220:223], a[100:103], v[68:71]
v_mfma_f32_16x16x32_bf16 v[68:71], a[188:191], a[132:135], v[68:71]
v_mfma_f32_16x16x32_bf16 v[36:39], a[184:187], a[132:135], v[36:39]
v_mfma_f32_16x16x32_bf16 v[36:39], a[216:219], a[100:103], v[36:39]
s_waitcnt lgkmcnt(10)
v_mfma_f32_16x16x32_bf16 v[40:43], a[216:219], a[104:107], v[40:43]
v_lshrrev_b32 v24, 7, v0
v_mfma_f32_16x16x32_bf16 v[40:43], a[184:187], a[136:139], v[40:43]
v_lshlrev_b32 v25, 4, v24
v_xor_b32 v22, v25, v8
v_mfma_f32_16x16x32_bf16 v[72:75], a[188:191], a[136:139], v[72:75]
v_and_b32 v25, 0x70, v0
v_lshl_add_u32 v23, v24, 11, v25
v_mfma_f32_16x16x32_bf16 v[72:75], a[220:223], a[104:107], v[72:75]
v_lshrrev_b32 v24, 4, v0
v_and_b32 v24, 0x30, v24
s_waitcnt lgkmcnt(8)
v_mfma_f32_16x16x32_bf16 v[76:79], a[220:223], a[108:111], v[76:79]
v_xor_b32 v24, v24, v25
v_mfma_f32_16x16x32_bf16 v[76:79], a[188:191], a[140:143], v[76:79]
v_and_b32 v25, 0xf0, v0
v_lshl_add_u32 v24, v25, 3, v24
v_mfma_f32_16x16x32_bf16 v[44:47], a[184:187], a[140:143], v[44:47]
v_sub_u32 v25, v8, v0
v_add_u32 v20, v24, v25
v_mfma_f32_16x16x32_bf16 v[44:47], a[216:219], a[108:111], v[44:47]
v_xor_b32 v21, 64, v20
v_accvgpr_read_b32 v12, a0
s_waitcnt lgkmcnt(6)
v_mfma_f32_16x16x32_bf16 v[48:51], a[216:219], a[112:115], v[48:51]
v_accvgpr_read_b32 v13, a1
v_mfma_f32_16x16x32_bf16 v[48:51], a[184:187], a[144:147], v[48:51]
v_accvgpr_read_b32 v14, a2
v_accvgpr_read_b32 v15, a3
v_mfma_f32_16x16x32_bf16 v[80:83], a[188:191], a[144:147], v[80:83]
v_lshlrev_b32 v24, 16, v12
v_and_b32 v25, s33, v12
v_mfma_f32_16x16x32_bf16 v[80:83], a[220:223], a[112:115], v[80:83]
v_lshlrev_b32 v26, 16, v13
v_and_b32 v27, s33, v13
s_waitcnt lgkmcnt(4)
v_mfma_f32_16x16x32_bf16 v[84:87], a[220:223], a[116:119], v[84:87]
v_mul_f32 v24, v24, v32
v_mfma_f32_16x16x32_bf16 v[84:87], a[188:191], a[148:151], v[84:87]
v_mul_f32 v25, v25, v33
v_mul_f32 v26, v26, v34
v_mfma_f32_16x16x32_bf16 v[52:55], a[184:187], a[148:151], v[52:55]
v_mul_f32 v27, v27, v35
v_cvt_pk_bf16_f32 v12, v24, v25
v_mfma_f32_16x16x32_bf16 v[52:55], a[216:219], a[116:119], v[52:55]
v_cvt_pk_bf16_f32 v13, v26, v27
v_lshlrev_b32 v24, 16, v14
s_waitcnt lgkmcnt(2)
v_mfma_f32_16x16x32_bf16 v[56:59], a[216:219], a[120:123], v[56:59]
v_and_b32 v25, s33, v14
v_mfma_f32_16x16x32_bf16 v[56:59], a[184:187], a[152:155], v[56:59]
v_lshlrev_b32 v26, 16, v15
v_and_b32 v27, s33, v15
v_mfma_f32_16x16x32_bf16 v[88:91], a[188:191], a[152:155], v[88:91]
v_mul_f32 v24, v24, v64
v_mul_f32 v25, v25, v65
v_mfma_f32_16x16x32_bf16 v[88:91], a[220:223], a[120:123], v[88:91]
v_mul_f32 v26, v26, v66
v_mul_f32 v27, v27, v67
s_waitcnt lgkmcnt(0)
v_mfma_f32_16x16x32_bf16 v[92:95], a[220:223], a[124:127], v[92:95]
buffer_load_dwordx4 a[220:223], v0, s[20:23], s30 offen offset:0 sc1
v_mfma_f32_16x16x32_bf16 v[92:95], a[188:191], a[156:159], v[92:95]
buffer_load_dwordx4 a[188:191], v0, s[20:23], s30 offen offset:1024 sc1
v_cvt_pk_bf16_f32 v14, v24, v25
v_mfma_f32_16x16x32_bf16 v[60:63], a[184:187], a[156:159], v[60:63]
buffer_load_dwordx4 a[184:187], v0, s[20:23], s30 offen offset:2048 sc1
v_cvt_pk_bf16_f32 v15, v26, v27
v_mfma_f32_16x16x32_bf16 v[60:63], a[216:219], a[124:127], v[60:63]
buffer_load_dwordx4 a[216:219], v0, s[20:23], s30 offen offset:3072 sc1
s_add_u32 s30, s30, 0x1000
s_waitcnt vmcnt(12)
v_mfma_f32_16x16x32_bf16 v[96:99], a[160:163], a[96:99], v[96:99]
ds_read_b128 v[32:35], v8 offset:0
v_mfma_f32_16x16x32_bf16 v[96:99], a[192:195], a[128:131], v[96:99]
ds_read_b128 v[64:67], v8 offset:1024
ds_write_b128 v20, v[12:15] offset:0
v_mfma_f32_16x16x32_bf16 v[128:131], a[196:199], a[128:131], v[128:131]
v_xor_b32 v2, 0x2000, v6
ds_read_b128 a[128:131], v2 offset:0
v_mfma_f32_16x16x32_bf16 v[128:131], a[164:167], a[96:99], v[128:131]
v_xor_b32 v1, 0x0, v6
ds_read_b128 a[96:99], v1 offset:0
v_mfma_f32_16x16x32_bf16 v[132:135], a[164:167], a[100:103], v[132:135]
v_mfma_f32_16x16x32_bf16 v[132:135], a[196:199], a[132:135], v[132:135]
v_mfma_f32_16x16x32_bf16 v[100:103], a[192:195], a[132:135], v[100:103]
ds_read_b128 a[132:135], v2 offset:1024
v_mfma_f32_16x16x32_bf16 v[100:103], a[160:163], a[100:103], v[100:103]
ds_read_b128 a[100:103], v1 offset:1024
v_mfma_f32_16x16x32_bf16 v[104:107], a[160:163], a[104:107], v[104:107]
v_accvgpr_read_b32 v16, a32
v_accvgpr_read_b32 v17, a33
v_mfma_f32_16x16x32_bf16 v[104:107], a[192:195], a[136:139], v[104:107]
v_accvgpr_read_b32 v18, a34
v_accvgpr_read_b32 v19, a35
v_mfma_f32_16x16x32_bf16 v[136:139], a[196:199], a[136:139], v[136:139]
ds_read_b128 a[136:139], v2 offset:2048
v_lshlrev_b32 v24, 16, v16
v_mfma_f32_16x16x32_bf16 v[136:139], a[164:167], a[104:107], v[136:139]
ds_read_b128 a[104:107], v1 offset:2048
v_and_b32 v25, s33, v16
v_mfma_f32_16x16x32_bf16 v[140:143], a[164:167], a[108:111], v[140:143]
v_lshlrev_b32 v26, 16, v17
v_and_b32 v27, s33, v17
v_mfma_f32_16x16x32_bf16 v[140:143], a[196:199], a[140:143], v[140:143]
v_mul_f32 v24, v24, v96
v_mul_f32 v25, v25, v97
v_mfma_f32_16x16x32_bf16 v[108:111], a[192:195], a[140:143], v[108:111]
ds_read_b128 a[140:143], v2 offset:3072
v_mul_f32 v26, v26, v98
v_mfma_f32_16x16x32_bf16 v[108:111], a[160:163], a[108:111], v[108:111]
ds_read_b128 a[108:111], v1 offset:3072
v_mul_f32 v27, v27, v99
v_mfma_f32_16x16x32_bf16 v[112:115], a[160:163], a[112:115], v[112:115]
v_cvt_pk_bf16_f32 v16, v24, v25
v_cvt_pk_bf16_f32 v17, v26, v27
v_mfma_f32_16x16x32_bf16 v[112:115], a[192:195], a[144:147], v[112:115]
v_lshlrev_b32 v24, 16, v18
v_and_b32 v25, s33, v18
v_mfma_f32_16x16x32_bf16 v[144:147], a[196:199], a[144:147], v[144:147]
ds_read_b128 a[144:147], v2 offset:4096
v_lshlrev_b32 v26, 16, v19
v_mfma_f32_16x16x32_bf16 v[144:147], a[164:167], a[112:115], v[144:147]
ds_read_b128 a[112:115], v1 offset:4096
v_and_b32 v27, s33, v19
v_mfma_f32_16x16x32_bf16 v[148:151], a[164:167], a[116:119], v[148:151]
v_mul_f32 v24, v24, v128
v_mul_f32 v25, v25, v129
v_mfma_f32_16x16x32_bf16 v[148:151], a[196:199], a[148:151], v[148:151]
v_mul_f32 v26, v26, v130
v_mul_f32 v27, v27, v131
v_mfma_f32_16x16x32_bf16 v[116:119], a[192:195], a[148:151], v[116:119]
ds_read_b128 a[148:151], v2 offset:5120
v_cvt_pk_bf16_f32 v18, v24, v25
v_mfma_f32_16x16x32_bf16 v[116:119], a[160:163], a[116:119], v[116:119]
ds_read_b128 a[116:119], v1 offset:5120
v_cvt_pk_bf16_f32 v19, v26, v27
v_mfma_f32_16x16x32_bf16 v[120:123], a[160:163], a[120:123], v[120:123]
ds_read_b128 v[96:99], v8 offset:2048
ds_read_b128 v[128:131], v8 offset:3072
v_mfma_f32_16x16x32_bf16 v[120:123], a[192:195], a[152:155], v[120:123]
ds_write_b128 v21, v[16:19] offset:0
ds_read_b128 a[0:3], v22 offset:0
v_mfma_f32_16x16x32_bf16 v[152:155], a[196:199], a[152:155], v[152:155]
ds_read_b128 a[152:155], v2 offset:6144
ds_read_b128 a[32:35], v22 offset:1024
v_mfma_f32_16x16x32_bf16 v[152:155], a[164:167], a[120:123], v[152:155]
ds_read_b128 a[120:123], v1 offset:6144
v_accvgpr_read_b32 v12, a4
v_mfma_f32_16x16x32_bf16 v[156:159], a[164:167], a[124:127], v[156:159]
buffer_load_dwordx4 a[164:167], v0, s[20:23], s30 offen offset:0 sc1
v_accvgpr_read_b32 v13, a5
v_mfma_f32_16x16x32_bf16 v[156:159], a[196:199], a[156:159], v[156:159]
buffer_load_dwordx4 a[196:199], v0, s[20:23], s30 offen offset:1024 sc1
v_accvgpr_read_b32 v14, a6
v_mfma_f32_16x16x32_bf16 v[124:127], a[192:195], a[156:159], v[124:127]
buffer_load_dwordx4 a[192:195], v0, s[20:23], s30 offen offset:2048 sc1
ds_read_b128 a[156:159], v2 offset:7168
v_mfma_f32_16x16x32_bf16 v[124:127], a[160:163], a[124:127], v[124:127]
buffer_load_dwordx4 a[160:163], v0, s[20:23], s30 offen offset:3072 sc1
s_add_u32 s30, s30, 0x3000
ds_read_b128 a[124:127], v1 offset:7168
L_q11:
s_waitcnt vmcnt(12) lgkmcnt(15)
v_mfma_f32_16x16x32_bf16 v[160:163], a[168:171], a[96:99], v[160:163]
v_accvgpr_read_b32 v15, a7
v_mfma_f32_16x16x32_bf16 v[160:163], a[200:203], a[128:131], v[160:163]
s_waitcnt lgkmcnt(5)
buffer_store_dwordx4 a[0:3], v23, s[16:19], s40 offen offset:0 sc1
v_lshlrev_b32 v24, 16, v12
v_mfma_f32_16x16x32_bf16 v[192:195], a[204:207], a[128:131], v[192:195]
v_and_b32 v25, s33, v12
v_lshlrev_b32 v26, 16, v13
v_mfma_f32_16x16x32_bf16 v[192:195], a[172:175], a[96:99], v[192:195]
v_and_b32 v27, s33, v13
v_mul_f32 v24, v24, v36
v_mfma_f32_16x16x32_bf16 v[196:199], a[172:175], a[100:103], v[196:199]
v_mul_f32 v25, v25, v37
v_mul_f32 v26, v26, v38
v_mfma_f32_16x16x32_bf16 v[196:199], a[204:207], a[132:135], v[196:199]
buffer_load_dwordx4 a[0:3], v0, s[20:23], s30 offen offset:0 sc1
v_mul_f32 v27, v27, v39
v_mfma_f32_16x16x32_bf16 v[164:167], a[200:203], a[132:135], v[164:167]
v_cvt_pk_bf16_f32 v12, v24, v25
v_cvt_pk_bf16_f32 v13, v26, v27
v_mfma_f32_16x16x32_bf16 v[164:167], a[168:171], a[100:103], v[164:167]
v_lshlrev_b32 v24, 16, v14
v_and_b32 v25, s33, v14
v_mfma_f32_16x16x32_bf16 v[168:171], a[168:171], a[104:107], v[168:171]
v_lshlrev_b32 v26, 16, v15
v_and_b32 v27, s33, v15
v_mfma_f32_16x16x32_bf16 v[168:171], a[200:203], a[136:139], v[168:171]
v_mul_f32 v24, v24, v68
v_mul_f32 v25, v25, v69
v_mfma_f32_16x16x32_bf16 v[200:203], a[204:207], a[136:139], v[200:203]
v_mul_f32 v26, v26, v70
v_mul_f32 v27, v27, v71
v_mfma_f32_16x16x32_bf16 v[200:203], a[172:175], a[104:107], v[200:203]
v_cvt_pk_bf16_f32 v14, v24, v25
v_cvt_pk_bf16_f32 v15, v26, v27
v_mfma_f32_16x16x32_bf16 v[204:207], a[172:175], a[108:111], v[204:207]
ds_read_b128 v[36:39], v8 offset:4096
ds_read_b128 v[68:71], v8 offset:5120
v_mfma_f32_16x16x32_bf16 v[204:207], a[204:207], a[140:143], v[204:207]
ds_write_b128 v20, v[12:15] offset:2048
v_accvgpr_read_b32 v16, a36
v_mfma_f32_16x16x32_bf16 v[172:175], a[200:203], a[140:143], v[172:175]
v_accvgpr_read_b32 v17, a37
v_accvgpr_read_b32 v18, a38
v_mfma_f32_16x16x32_bf16 v[172:175], a[168:171], a[108:111], v[172:175]
v_accvgpr_read_b32 v19, a39
v_lshlrev_b32 v24, 16, v16
v_mfma_f32_16x16x32_bf16 v[176:179], a[168:171], a[112:115], v[176:179]
v_and_b32 v25, s33, v16
v_lshlrev_b32 v26, 16, v17
v_mfma_f32_16x16x32_bf16 v[176:179], a[200:203], a[144:147], v[176:179]
v_and_b32 v27, s33, v17
v_mul_f32 v24, v24, v100
v_mfma_f32_16x16x32_bf16 v[208:211], a[204:207], a[144:147], v[208:211]
v_mul_f32 v25, v25, v101
v_mul_f32 v26, v26, v102
v_mfma_f32_16x16x32_bf16 v[208:211], a[172:175], a[112:115], v[208:211]
v_mul_f32 v27, v27, v103
v_cvt_pk_bf16_f32 v16, v24, v25
v_mfma_f32_16x16x32_bf16 v[212:215], a[172:175], a[116:119], v[212:215]
v_cvt_pk_bf16_f32 v17, v26, v27
v_lshlrev_b32 v24, 16, v18
v_mfma_f32_16x16x32_bf16 v[212:215], a[204:207], a[148:151], v[212:215]
v_and_b32 v25, s33, v18
v_lshlrev_b32 v26, 16, v19
v_mfma_f32_16x16x32_bf16 v[180:183], a[200:203], a[148:151], v[180:183]
v_and_b32 v27, s33, v19
v_mul_f32 v24, v24, v132
v_mfma_f32_16x16x32_bf16 v[180:183], a[168:171], a[116:119], v[180:183]
v_mul_f32 v25, v25, v133
v_mul_f32 v26, v26, v134
s_waitcnt lgkmcnt(5)
v_mfma_f32_16x16x32_bf16 v[184:187], a[168:171], a[120:123], v[184:187]
v_mul_f32 v27, v27, v135
v_mfma_f32_16x16x32_bf16 v[184:187], a[200:203], a[152:155], v[184:187]
v_cvt_pk_bf16_f32 v18, v24, v25
v_cvt_pk_bf16_f32 v19, v26, v27
v_mfma_f32_16x16x32_bf16 v[216:219], a[204:207], a[152:155], v[216:219]
ds_read_b128 v[100:103], v8 offset:6144
ds_read_b128 v[132:135], v8 offset:7168
v_mfma_f32_16x16x32_bf16 v[216:219], a[172:175], a[120:123], v[216:219]
s_add_u32 s54, s40, 16384
buffer_store_dwordx4 a[32:35], v23, s[16:19], s54 offen offset:0 sc1
ds_write_b128 v21, v[16:19] offset:2048
s_waitcnt lgkmcnt(6)
v_mfma_f32_16x16x32_bf16 v[220:223], a[172:175], a[124:127], v[220:223]
buffer_load_dwordx4 a[32:35], v0, s[20:23], s30 offen offset:1024 sc1
v_mfma_f32_16x16x32_bf16 v[220:223], a[204:207], a[156:159], v[220:223]
buffer_load_dwordx4 a[172:175], v0, s[20:23], s30 offen offset:2048 sc1
ds_read_b128 a[4:7], v22 offset:2048
v_mfma_f32_16x16x32_bf16 v[188:191], a[200:203], a[156:159], v[188:191]
buffer_load_dwordx4 a[204:207], v0, s[20:23], s30 offen offset:3072 sc1
s_add_u32 s30, s30, 0x1000
v_mfma_f32_16x16x32_bf16 v[188:191], a[168:171], a[124:127], v[188:191]
buffer_load_dwordx4 a[200:203], v0, s[20:23], s30 offen offset:0 sc1
ds_read_b128 a[36:39], v22 offset:3072
s_waitcnt vmcnt(15)
v_mfma_f32_16x16x32_bf16 v[224:227], a[212:215], a[96:99], v[224:227]
v_accvgpr_read_b32 v12, a8
v_mfma_f32_16x16x32_bf16 v[224:227], a[180:183], a[128:131], v[224:227]
buffer_load_dwordx4 a[168:171], v0, s[20:23], s30 offen offset:1024 sc1
v_accvgpr_read_b32 v13, a9
v_mfma_f32_16x16x32_bf16 a[224:227], a[208:211], a[128:131], a[224:227]
v_xor_b32 v4, 0x6000, v6
ds_read_b128 a[128:131], v4 offset:0
v_mfma_f32_16x16x32_bf16 a[224:227], a[176:179], a[96:99], a[224:227]
v_xor_b32 v3, 0x4000, v6
ds_read_b128 a[96:99], v3 offset:0
v_mfma_f32_16x16x32_bf16 a[228:231], a[176:179], a[100:103], a[228:231]
v_accvgpr_read_b32 v14, a10
v_accvgpr_read_b32 v15, a11
v_mfma_f32_16x16x32_bf16 a[228:231], a[208:211], a[132:135], a[228:231]
v_lshlrev_b32 v24, 16, v12
v_and_b32 v25, s33, v12
v_mfma_f32_16x16x32_bf16 v[228:231], a[180:183], a[132:135], v[228:231]
ds_read_b128 a[132:135], v4 offset:1024
v_lshlrev_b32 v26, 16, v13
v_mfma_f32_16x16x32_bf16 v[228:231], a[212:215], a[100:103], v[228:231]
ds_read_b128 a[100:103], v3 offset:1024
v_and_b32 v27, s33, v13
v_mfma_f32_16x16x32_bf16 v[232:235], a[212:215], a[104:107], v[232:235]
v_mul_f32 v24, v24, v40
v_mul_f32 v25, v25, v41
v_mfma_f32_16x16x32_bf16 v[232:235], a[180:183], a[136:139], v[232:235]
v_mul_f32 v26, v26, v42
v_mul_f32 v27, v27, v43
v_mfma_f32_16x16x32_bf16 a[232:235], a[208:211], a[136:139], a[232:235]
ds_read_b128 a[136:139], v4 offset:2048
v_cvt_pk_bf16_f32 v12, v24, v25
v_mfma_f32_16x16x32_bf16 a[232:235], a[176:179], a[104:107], a[232:235]
ds_read_b128 a[104:107], v3 offset:2048
v_cvt_pk_bf16_f32 v13, v26, v27
v_mfma_f32_16x16x32_bf16 a[236:239], a[176:179], a[108:111], a[236:239]
v_lshlrev_b32 v24, 16, v14
v_and_b32 v25, s33, v14
v_mfma_f32_16x16x32_bf16 a[236:239], a[208:211], a[140:143], a[236:239]
v_lshlrev_b32 v26, 16, v15
v_and_b32 v27, s33, v15
v_mfma_f32_16x16x32_bf16 v[236:239], a[180:183], a[140:143], v[236:239]
ds_read_b128 a[140:143], v4 offset:3072
v_mul_f32 v24, v24, v72
v_mfma_f32_16x16x32_bf16 v[236:239], a[212:215], a[108:111], v[236:239]
ds_read_b128 a[108:111], v3 offset:3072
v_mul_f32 v25, v25, v73
v_mfma_f32_16x16x32_bf16 v[240:243], a[212:215], a[112:115], v[240:243]
v_mul_f32 v26, v26, v74
v_mul_f32 v27, v27, v75
v_mfma_f32_16x16x32_bf16 v[240:243], a[180:183], a[144:147], v[240:243]
v_cvt_pk_bf16_f32 v14, v24, v25
v_cvt_pk_bf16_f32 v15, v26, v27
v_mfma_f32_16x16x32_bf16 a[240:243], a[208:211], a[144:147], a[240:243]
ds_read_b128 a[144:147], v4 offset:4096
ds_write_b128 v20, v[12:15] offset:4096
v_mfma_f32_16x16x32_bf16 a[240:243], a[176:179], a[112:115], a[240:243]
ds_read_b128 a[112:115], v3 offset:4096
v_accvgpr_read_b32 v16, a40
v_mfma_f32_16x16x32_bf16 a[244:247], a[176:179], a[116:119], a[244:247]
v_accvgpr_read_b32 v17, a41
v_accvgpr_read_b32 v18, a42
v_mfma_f32_16x16x32_bf16 a[244:247], a[208:211], a[148:151], a[244:247]
buffer_load_dwordx4 v[40:43], v0, s[20:23], s30 offen offset:2048 sc1
s_waitcnt lgkmcnt(12)
buffer_store_dwordx4 a[4:7], v23, s[16:19], s41 offen offset:0 sc1
v_mfma_f32_16x16x32_bf16 v[244:247], a[180:183], a[148:151], v[244:247]
ds_read_b128 a[148:151], v4 offset:5120
v_accvgpr_read_b32 v19, a43
v_mfma_f32_16x16x32_bf16 v[244:247], a[212:215], a[116:119], v[244:247]
ds_read_b128 a[116:119], v3 offset:5120
v_lshlrev_b32 v24, 16, v16
v_mfma_f32_16x16x32_bf16 v[248:251], a[212:215], a[120:123], v[248:251]
v_and_b32 v25, s33, v16
v_lshlrev_b32 v26, 16, v17
v_mfma_f32_16x16x32_bf16 v[248:251], a[180:183], a[152:155], v[248:251]
buffer_load_dwordx4 v[72:75], v0, s[20:23], s30 offen offset:3072 sc1
s_add_u32 s30, s30, 0x3000
v_mfma_f32_16x16x32_bf16 a[248:251], a[208:211], a[152:155], a[248:251]
ds_read_b128 a[152:155], v4 offset:6144
v_and_b32 v27, s33, v17
v_mfma_f32_16x16x32_bf16 a[248:251], a[176:179], a[120:123], a[248:251]
ds_read_b128 a[120:123], v3 offset:6144
v_mul_f32 v24, v24, v104
v_mfma_f32_16x16x32_bf16 a[252:255], a[176:179], a[124:127], a[252:255]
buffer_load_dwordx4 a[4:7], v0, s[20:23], s30 offen offset:0 sc1
v_mul_f32 v25, v25, v105
v_mfma_f32_16x16x32_bf16 a[252:255], a[208:211], a[156:159], a[252:255]
buffer_load_dwordx4 a[176:179], v0, s[20:23], s30 offen offset:1024 sc1
v_mul_f32 v26, v26, v106
v_mfma_f32_16x16x32_bf16 v[252:255], a[180:183], a[156:159], v[252:255]
buffer_load_dwordx4 a[208:211], v0, s[20:23], s30 offen offset:2048 sc1
ds_read_b128 a[156:159], v4 offset:7168
v_mfma_f32_16x16x32_bf16 v[252:255], a[212:215], a[124:127], v[252:255]
buffer_load_dwordx4 a[180:183], v0, s[20:23], s30 offen offset:3072 sc1
s_add_u32 s30, s30, 0x1000
ds_read_b128 a[124:127], v3 offset:7168
s_waitcnt vmcnt(19) lgkmcnt(15)
v_mfma_f32_16x16x32_bf16 v[160:163], a[220:223], a[96:99], v[160:163]
v_mul_f32 v27, v27, v107
v_mfma_f32_16x16x32_bf16 v[160:163], a[188:191], a[128:131], v[160:163]
buffer_load_dwordx4 a[212:215], v0, s[20:23], s30 offen offset:0 sc1
v_cvt_pk_bf16_f32 v16, v24, v25
v_mfma_f32_16x16x32_bf16 v[192:195], a[216:219], a[128:131], v[192:195]
v_cvt_pk_bf16_f32 v17, v26, v27
v_lshlrev_b32 v24, 16, v18
v_mfma_f32_16x16x32_bf16 v[192:195], a[184:187], a[96:99], v[192:195]
v_and_b32 v25, s33, v18
v_lshlrev_b32 v26, 16, v19
s_waitcnt lgkmcnt(13)
v_mfma_f32_16x16x32_bf16 v[196:199], a[184:187], a[100:103], v[196:199]
v_and_b32 v27, s33, v19
v_mfma_f32_16x16x32_bf16 v[196:199], a[216:219], a[132:135], v[196:199]
v_mul_f32 v24, v24, v136
v_mul_f32 v25, v25, v137
v_mfma_f32_16x16x32_bf16 v[164:167], a[188:191], a[132:135], v[164:167]
v_mul_f32 v26, v26, v138
v_mul_f32 v27, v27, v139
v_mfma_f32_16x16x32_bf16 v[164:167], a[220:223], a[100:103], v[164:167]
v_cvt_pk_bf16_f32 v18, v24, v25
v_cvt_pk_bf16_f32 v19, v26, v27
s_waitcnt lgkmcnt(11)
v_mfma_f32_16x16x32_bf16 v[168:171], a[220:223], a[104:107], v[168:171]
ds_write_b128 v21, v[16:19] offset:4096
v_mfma_f32_16x16x32_bf16 v[168:171], a[188:191], a[136:139], v[168:171]
buffer_load_dwordx4 v[104:107], v0, s[20:23], s30 offen offset:1024 sc1
ds_read_b128 a[8:11], v22 offset:4096
v_mfma_f32_16x16x32_bf16 v[200:203], a[216:219], a[136:139], v[200:203]
ds_read_b128 a[40:43], v22 offset:5120
v_accvgpr_read_b32 v12, a12
v_mfma_f32_16x16x32_bf16 v[200:203], a[184:187], a[104:107], v[200:203]
v_accvgpr_read_b32 v13, a13
v_accvgpr_read_b32 v14, a14
s_waitcnt lgkmcnt(12)
v_mfma_f32_16x16x32_bf16 v[204:207], a[184:187], a[108:111], v[204:207]
v_accvgpr_read_b32 v15, a15
v_mfma_f32_16x16x32_bf16 v[204:207], a[216:219], a[140:143], v[204:207]
buffer_load_dwordx4 v[136:139], v0, s[20:23], s30 offen offset:2048 sc1
v_lshlrev_b32 v24, 16, v12
v_mfma_f32_16x16x32_bf16 v[172:175], a[188:191], a[140:143], v[172:175]
v_and_b32 v25, s33, v12
v_lshlrev_b32 v26, 16, v13
v_mfma_f32_16x16x32_bf16 v[172:175], a[220:223], a[108:111], v[172:175]
s_add_u32 s54, s41, 16384
buffer_store_dwordx4 a[36:39], v23, s[16:19], s54 offen offset:0 sc1
v_and_b32 v27, s33, v13
s_waitcnt lgkmcnt(9)
v_mfma_f32_16x16x32_bf16 v[176:179], a[220:223], a[112:115], v[176:179]
v_mul_f32 v24, v24, v44
v_mfma_f32_16x16x32_bf16 v[176:179], a[188:191], a[144:147], v[176:179]
buffer_load_dwordx4 a[36:39], v0, s[20:23], s30 offen offset:3072 sc1
s_add_u32 s30, s30, 0x3000
v_mfma_f32_16x16x32_bf16 v[208:211], a[216:219], a[144:147], v[208:211]
v_mul_f32 v25, v25, v45
v_mul_f32 v26, v26, v46
v_mfma_f32_16x16x32_bf16 v[208:211], a[184:187], a[112:115], v[208:211]
v_mul_f32 v27, v27, v47
v_cvt_pk_bf16_f32 v12, v24, v25
s_waitcnt lgkmcnt(7)
v_mfma_f32_16x16x32_bf16 v[212:215], a[184:187], a[116:119], v[212:215]
v_cvt_pk_bf16_f32 v13, v26, v27
v_mfma_f32_16x16x32_bf16 v[212:215], a[216:219], a[148:151], v[212:215]
v_lshlrev_b32 v24, 16, v14
v_and_b32 v25, s33, v14
v_mfma_f32_16x16x32_bf16 v[180:183], a[188:191], a[148:151], v[180:183]
v_lshlrev_b32 v26, 16, v15
v_and_b32 v27, s33, v15
v_mfma_f32_16x16x32_bf16 v[180:183], a[220:223], a[116:119], v[180:183]
v_mul_f32 v24, v24, v76
v_mul_f32 v25, v25, v77
s_waitcnt lgkmcnt(5)
v_mfma_f32_16x16x32_bf16 v[184:187], a[220:223], a[120:123], v[184:187]
v_mul_f32 v26, v26, v78
v_mfma_f32_16x16x32_bf16 v[184:187], a[188:191], a[152:155], v[184:187]
v_mul_f32 v27, v27, v79
v_cvt_pk_bf16_f32 v14, v24, v25
v_mfma_f32_16x16x32_bf16 v[216:219], a[216:219], a[152:155], v[216:219]
v_cvt_pk_bf16_f32 v15, v26, v27
ds_write_b128 v20, v[12:15] offset:6144
v_mfma_f32_16x16x32_bf16 v[216:219], a[184:187], a[120:123], v[216:219]
v_accvgpr_read_b32 v16, a44
v_accvgpr_read_b32 v17, a45
s_waitcnt lgkmcnt(4)
v_mfma_f32_16x16x32_bf16 v[220:223], a[184:187], a[124:127], v[220:223]
buffer_load_dwordx4 v[44:47], v0, s[20:23], s30 offen offset:0 sc1
v_mfma_f32_16x16x32_bf16 v[220:223], a[216:219], a[156:159], v[220:223]
buffer_load_dwordx4 v[76:79], v0, s[20:23], s30 offen offset:1024 sc1
v_accvgpr_read_b32 v18, a46
v_mfma_f32_16x16x32_bf16 v[188:191], a[188:191], a[156:159], v[188:191]
buffer_load_dwordx4 a[184:187], v0, s[20:23], s30 offen offset:2048 sc1
v_accvgpr_read_b32 v19, a47
v_mfma_f32_16x16x32_bf16 v[188:191], a[220:223], a[124:127], v[188:191]
buffer_load_dwordx4 a[216:219], v0, s[20:23], s30 offen offset:3072 sc1
s_add_u32 s30, s30, 0x1000
s_waitcnt vmcnt(24)
v_mfma_f32_16x16x32_bf16 v[224:227], a[164:167], a[96:99], v[224:227]
v_lshlrev_b32 v24, 16, v16
v_mfma_f32_16x16x32_bf16 v[224:227], a[196:199], a[128:131], v[224:227]
buffer_load_dwordx4 a[188:191], v0, s[20:23], s30 offen offset:0 sc1
v_and_b32 v25, s33, v16
v_mfma_f32_16x16x32_bf16 a[224:227], a[160:163], a[128:131], a[224:227]
ds_read_b128 a[128:131], v2 offset:32768
v_lshlrev_b32 v26, 16, v17
v_mfma_f32_16x16x32_bf16 a[224:227], a[192:195], a[96:99], a[224:227]
ds_read_b128 a[96:99], v1 offset:32768
v_and_b32 v27, s33, v17
v_mfma_f32_16x16x32_bf16 a[228:231], a[192:195], a[100:103], a[228:231]
v_mul_f32 v24, v24, v108
v_mul_f32 v25, v25, v109
v_mfma_f32_16x16x32_bf16 a[228:231], a[160:163], a[132:135], a[228:231]
buffer_load_dwordx4 a[220:223], v0, s[20:23], s30 offen offset:1024 sc1
v_mul_f32 v26, v26, v110
v_mfma_f32_16x16x32_bf16 v[228:231], a[196:199], a[132:135], v[228:231]
ds_read_b128 a[132:135], v2 offset:33792
v_mul_f32 v27, v27, v111
v_mfma_f32_16x16x32_bf16 v[228:231], a[164:167], a[100:103], v[228:231]
ds_read_b128 a[100:103], v1 offset:33792
v_cvt_pk_bf16_f32 v16, v24, v25
v_mfma_f32_16x16x32_bf16 v[232:235], a[164:167], a[104:107], v[232:235]
v_cvt_pk_bf16_f32 v17, v26, v27
v_lshlrev_b32 v24, 16, v18
v_mfma_f32_16x16x32_bf16 v[232:235], a[196:199], a[136:139], v[232:235]
s_waitcnt lgkmcnt(6)
buffer_store_dwordx4 a[8:11], v23, s[16:19], s42 offen offset:0 sc1
v_and_b32 v25, s33, v18
v_mfma_f32_16x16x32_bf16 a[232:235], a[160:163], a[136:139], a[232:235]
ds_read_b128 a[136:139], v2 offset:34816
v_lshlrev_b32 v26, 16, v19
v_mfma_f32_16x16x32_bf16 a[232:235], a[192:195], a[104:107], a[232:235]
ds_read_b128 a[104:107], v1 offset:34816
v_and_b32 v27, s33, v19
v_mfma_f32_16x16x32_bf16 a[236:239], a[192:195], a[108:111], a[236:239]
v_mul_f32 v24, v24, v140
v_mul_f32 v25, v25, v141
v_mfma_f32_16x16x32_bf16 a[236:239], a[160:163], a[140:143], a[236:239]
buffer_load_dwordx4 a[8:11], v0, s[20:23], s30 offen offset:2048 sc1
v_mul_f32 v26, v26, v142
v_mfma_f32_16x16x32_bf16 v[236:239], a[196:199], a[140:143], v[236:239]
ds_read_b128 a[140:143], v2 offset:35840
v_mul_f32 v27, v27, v143
v_mfma_f32_16x16x32_bf16 v[236:239], a[164:167], a[108:111], v[236:239]
ds_read_b128 a[108:111], v1 offset:35840
v_cvt_pk_bf16_f32 v18, v24, v25
v_mfma_f32_16x16x32_bf16 v[240:243], a[164:167], a[112:115], v[240:243]
v_cvt_pk_bf16_f32 v19, v26, v27
ds_write_b128 v21, v[16:19] offset:6144
v_mfma_f32_16x16x32_bf16 v[240:243], a[196:199], a[144:147], v[240:243]
buffer_load_dwordx4 v[108:111], v0, s[20:23], s30 offen offset:3072 sc1
s_add_u32 s30, s30, 0x3000
v_mfma_f32_16x16x32_bf16 a[240:243], a[160:163], a[144:147], a[240:243]
ds_read_b128 a[144:147], v2 offset:36864
ds_read_b128 a[12:15], v22 offset:6144
v_mfma_f32_16x16x32_bf16 a[240:243], a[192:195], a[112:115], a[240:243]
ds_read_b128 a[112:115], v1 offset:36864
ds_read_b128 a[44:47], v22 offset:7168
v_mfma_f32_16x16x32_bf16 a[244:247], a[192:195], a[116:119], a[244:247]
v_accvgpr_read_b32 v12, a16
v_accvgpr_read_b32 v13, a17
v_mfma_f32_16x16x32_bf16 a[244:247], a[160:163], a[148:151], a[244:247]
buffer_load_dwordx4 v[140:143], v0, s[20:23], s30 offen offset:0 sc1
v_accvgpr_read_b32 v14, a18
v_mfma_f32_16x16x32_bf16 v[244:247], a[196:199], a[148:151], v[244:247]
ds_read_b128 a[148:151], v2 offset:37888
v_accvgpr_read_b32 v15, a19
v_mfma_f32_16x16x32_bf16 v[244:247], a[164:167], a[116:119], v[244:247]
ds_read_b128 a[116:119], v1 offset:37888
v_lshlrev_b32 v24, 16, v12
v_mfma_f32_16x16x32_bf16 v[248:251], a[164:167], a[120:123], v[248:251]
v_and_b32 v25, s33, v12
v_lshlrev_b32 v26, 16, v13
v_mfma_f32_16x16x32_bf16 v[248:251], a[196:199], a[152:155], v[248:251]
v_and_b32 v27, s33, v13
v_mul_f32 v24, v24, v48
v_mfma_f32_16x16x32_bf16 a[248:251], a[160:163], a[152:155], a[248:251]
ds_read_b128 a[152:155], v2 offset:38912
v_mul_f32 v25, v25, v49
v_mfma_f32_16x16x32_bf16 a[248:251], a[192:195], a[120:123], a[248:251]
ds_read_b128 a[120:123], v1 offset:38912
v_mul_f32 v26, v26, v50
v_mfma_f32_16x16x32_bf16 a[252:255], a[192:195], a[124:127], a[252:255]
buffer_load_dwordx4 a[192:195], v0, s[20:23], s30 offen offset:1024 sc1
v_mul_f32 v27, v27, v51
v_mfma_f32_16x16x32_bf16 a[252:255], a[160:163], a[156:159], a[252:255]
buffer_load_dwordx4 a[160:163], v0, s[20:23], s30 offen offset:2048 sc1
v_cvt_pk_bf16_f32 v12, v24, v25
v_mfma_f32_16x16x32_bf16 v[252:255], a[196:199], a[156:159], v[252:255]
buffer_load_dwordx4 a[196:199], v0, s[20:23], s30 offen offset:3072 sc1
s_add_u32 s30, s30, 0x1000
ds_read_b128 a[156:159], v2 offset:39936
v_mfma_f32_16x16x32_bf16 v[252:255], a[164:167], a[124:127], v[252:255]
buffer_load_dwordx4 a[164:167], v0, s[20:23], s30 offen offset:0 sc1
ds_read_b128 a[124:127], v1 offset:39936
s_waitcnt vmcnt(28) lgkmcnt(15)
v_mfma_f32_16x16x32_bf16 v[160:163], a[0:3], a[96:99], v[160:163]
v_cvt_pk_bf16_f32 v13, v26, v27
v_mfma_f32_16x16x32_bf16 v[160:163], a[32:35], a[128:131], v[160:163]
v_lshlrev_b32 v24, 16, v14
v_and_b32 v25, s33, v14
v_mfma_f32_16x16x32_bf16 v[192:195], a[204:207], a[128:131], v[192:195]
v_lshlrev_b32 v26, 16, v15
v_and_b32 v27, s33, v15
v_mfma_f32_16x16x32_bf16 v[192:195], a[172:175], a[96:99], v[192:195]
s_add_u32 s54, s42, 16384
buffer_store_dwordx4 a[40:43], v23, s[16:19], s54 offen offset:0 sc1
v_mul_f32 v24, v24, v80
v_mfma_f32_16x16x32_bf16 v[196:199], a[172:175], a[100:103], v[196:199]
v_mul_f32 v25, v25, v81
v_mul_f32 v26, v26, v82
v_mfma_f32_16x16x32_bf16 v[196:199], a[204:207], a[132:135], v[196:199]
buffer_load_dwordx4 a[40:43], v0, s[20:23], s30 offen offset:1024 sc1
v_mul_f32 v27, v27, v83
v_mfma_f32_16x16x32_bf16 v[164:167], a[32:35], a[132:135], v[164:167]
v_cvt_pk_bf16_f32 v14, v24, v25
v_cvt_pk_bf16_f32 v15, v26, v27
v_mfma_f32_16x16x32_bf16 v[164:167], a[0:3], a[100:103], v[164:167]
ds_write_b128 v20, v[12:15] offset:0
v_accvgpr_read_b32 v16, a48
s_waitcnt lgkmcnt(14)
v_mfma_f32_16x16x32_bf16 v[168:171], a[0:3], a[104:107], v[168:171]
v_accvgpr_read_b32 v17, a49
v_mfma_f32_16x16x32_bf16 v[168:171], a[32:35], a[136:139], v[168:171]
buffer_load_dwordx4 v[48:51], v0, s[20:23], s30 offen offset:2048 sc1
v_accvgpr_read_b32 v18, a50
v_mfma_f32_16x16x32_bf16 v[200:203], a[204:207], a[136:139], v[200:203]
v_accvgpr_read_b32 v19, a51
v_lshlrev_b32 v24, 16, v16
v_mfma_f32_16x16x32_bf16 v[200:203], a[172:175], a[104:107], v[200:203]
v_and_b32 v25, s33, v16
v_lshlrev_b32 v26, 16, v17
s_waitcnt lgkmcnt(12)
v_mfma_f32_16x16x32_bf16 v[204:207], a[172:175], a[108:111], v[204:207]
v_and_b32 v27, s33, v17
v_mfma_f32_16x16x32_bf16 v[204:207], a[204:207], a[140:143], v[204:207]
buffer_load_dwordx4 v[80:83], v0, s[20:23], s30 offen offset:3072 sc1
s_add_u32 s30, s30, 0x3000
v_mfma_f32_16x16x32_bf16 v[172:175], a[32:35], a[140:143], v[172:175]
v_mul_f32 v24, v24, v112
v_mul_f32 v25, v25, v113
v_mfma_f32_16x16x32_bf16 v[172:175], a[0:3], a[108:111], v[172:175]
v_mul_f32 v26, v26, v114
v_mul_f32 v27, v27, v115
s_waitcnt lgkmcnt(8)
v_mfma_f32_16x16x32_bf16 v[176:179], a[0:3], a[112:115], v[176:179]
v_cvt_pk_bf16_f32 v16, v24, v25
v_mfma_f32_16x16x32_bf16 v[176:179], a[32:35], a[144:147], v[176:179]
v_cvt_pk_bf16_f32 v17, v26, v27
v_lshlrev_b32 v24, 16, v18
v_mfma_f32_16x16x32_bf16 v[208:211], a[204:207], a[144:147], v[208:211]
v_and_b32 v25, s33, v18
v_lshlrev_b32 v26, 16, v19
v_mfma_f32_16x16x32_bf16 v[208:211], a[172:175], a[112:115], v[208:211]
v_and_b32 v27, s33, v19
v_mul_f32 v24, v24, v144
s_waitcnt lgkmcnt(5)
v_mfma_f32_16x16x32_bf16 v[212:215], a[172:175], a[116:119], v[212:215]
v_mul_f32 v25, v25, v145
v_mfma_f32_16x16x32_bf16 v[212:215], a[204:207], a[148:151], v[212:215]
v_mul_f32 v26, v26, v146
v_mul_f32 v27, v27, v147
v_mfma_f32_16x16x32_bf16 v[180:183], a[32:35], a[148:151], v[180:183]
v_cvt_pk_bf16_f32 v18, v24, v25
v_cvt_pk_bf16_f32 v19, v26, v27
v_mfma_f32_16x16x32_bf16 v[180:183], a[0:3], a[116:119], v[180:183]
ds_write_b128 v21, v[16:19] offset:0
ds_read_b128 a[16:19], v22 offset:0
s_waitcnt lgkmcnt(5)
v_mfma_f32_16x16x32_bf16 v[184:187], a[0:3], a[120:123], v[184:187]
ds_read_b128 a[48:51], v22 offset:1024
v_mfma_f32_16x16x32_bf16 v[184:187], a[32:35], a[152:155], v[184:187]
buffer_load_dwordx4 v[112:115], v0, s[20:23], s30 offen offset:0 sc1
v_accvgpr_read_b32 v12, a20
v_mfma_f32_16x16x32_bf16 v[216:219], a[204:207], a[152:155], v[216:219]
v_accvgpr_read_b32 v13, a21
v_accvgpr_read_b32 v14, a22
v_mfma_f32_16x16x32_bf16 v[216:219], a[172:175], a[120:123], v[216:219]
v_accvgpr_read_b32 v15, a23
v_lshlrev_b32 v24, 16, v12
s_waitcnt lgkmcnt(4)
v_mfma_f32_16x16x32_bf16 v[220:223], a[172:175], a[124:127], v[220:223]
buffer_load_dwordx4 v[144:147], v0, s[20:23], s30 offen offset:1024 sc1
v_mfma_f32_16x16x32_bf16 v[220:223], a[204:207], a[156:159], v[220:223]
buffer_load_dwordx4 a[172:175], v0, s[20:23], s30 offen offset:2048 sc1
buffer_store_dwordx4 a[12:15], v23, s[16:19], s43 offen offset:0 sc1
v_mfma_f32_16x16x32_bf16 v[188:191], a[32:35], a[156:159], v[188:191]
buffer_load_dwordx4 a[204:207], v0, s[20:23], s30 offen offset:3072 sc1
s_add_u32 s30, s30, 0x1000
v_mfma_f32_16x16x32_bf16 v[188:191], a[0:3], a[124:127], v[188:191]
buffer_load_dwordx4 a[12:15], v0, s[20:23], s30 offen offset:0 sc1
v_and_b32 v25, s33, v12
s_waitcnt vmcnt(33)
v_mfma_f32_16x16x32_bf16 v[224:227], a[200:203], a[96:99], v[224:227]
v_lshlrev_b32 v26, 16, v13
v_mfma_f32_16x16x32_bf16 v[224:227], a[168:171], a[128:131], v[224:227]
buffer_load_dwordx4 a[32:35], v0, s[20:23], s30 offen offset:1024 sc1
v_and_b32 v27, s33, v13
v_mfma_f32_16x16x32_bf16 a[224:227], v[72:75], a[128:131], a[224:227]
ds_read_b128 a[128:131], v4 offset:32768
v_mul_f32 v24, v24, v52
v_mfma_f32_16x16x32_bf16 a[224:227], v[40:43], a[96:99], a[224:227]
ds_read_b128 a[96:99], v3 offset:32768
v_mul_f32 v25, v25, v53
v_mfma_f32_16x16x32_bf16 a[228:231], v[40:43], a[100:103], a[228:231]
v_mul_f32 v26, v26, v54
v_mul_f32 v27, v27, v55
v_mfma_f32_16x16x32_bf16 a[228:231], v[72:75], a[132:135], a[228:231]
buffer_load_dwordx4 a[0:3], v0, s[20:23], s30 offen offset:2048 sc1
v_cvt_pk_bf16_f32 v12, v24, v25
v_mfma_f32_16x16x32_bf16 v[228:231], a[168:171], a[132:135], v[228:231]
ds_read_b128 a[132:135], v4 offset:33792
v_cvt_pk_bf16_f32 v13, v26, v27
v_mfma_f32_16x16x32_bf16 v[228:231], a[200:203], a[100:103], v[228:231]
ds_read_b128 a[100:103], v3 offset:33792
v_lshlrev_b32 v24, 16, v14
v_mfma_f32_16x16x32_bf16 v[232:235], a[200:203], a[104:107], v[232:235]
v_and_b32 v25, s33, v14
v_lshlrev_b32 v26, 16, v15
v_mfma_f32_16x16x32_bf16 v[232:235], a[168:171], a[136:139], v[232:235]
v_and_b32 v27, s33, v15
v_mul_f32 v24, v24, v84
v_mfma_f32_16x16x32_bf16 a[232:235], v[72:75], a[136:139], a[232:235]
ds_read_b128 a[136:139], v4 offset:34816
v_mul_f32 v25, v25, v85
v_mfma_f32_16x16x32_bf16 a[232:235], v[40:43], a[104:107], a[232:235]
ds_read_b128 a[104:107], v3 offset:34816
v_mul_f32 v26, v26, v86
v_mfma_f32_16x16x32_bf16 a[236:239], v[40:43], a[108:111], a[236:239]
v_mul_f32 v27, v27, v87
v_cvt_pk_bf16_f32 v14, v24, v25
v_mfma_f32_16x16x32_bf16 a[236:239], v[72:75], a[140:143], a[236:239]
v_cvt_pk_bf16_f32 v15, v26, v27
ds_write_b128 v20, v[12:15] offset:2048
v_mfma_f32_16x16x32_bf16 v[236:239], a[168:171], a[140:143], v[236:239]
ds_read_b128 a[140:143], v4 offset:35840
v_accvgpr_read_b32 v16, a52
v_mfma_f32_16x16x32_bf16 v[236:239], a[200:203], a[108:111], v[236:239]
ds_read_b128 a[108:111], v3 offset:35840
v_accvgpr_read_b32 v17, a53
v_mfma_f32_16x16x32_bf16 v[240:243], a[200:203], a[112:115], v[240:243]
v_accvgpr_read_b32 v18, a54
v_accvgpr_read_b32 v19, a55
v_mfma_f32_16x16x32_bf16 v[240:243], a[168:171], a[144:147], v[240:243]
buffer_load_dwordx4 v[52:55], v0, s[20:23], s30 offen offset:3072 sc1
s_add_u32 s30, s30, 0x3000
v_mfma_f32_16x16x32_bf16 a[240:243], v[72:75], a[144:147], a[240:243]
ds_read_b128 a[144:147], v4 offset:36864
v_lshlrev_b32 v24, 16, v16
v_mfma_f32_16x16x32_bf16 a[240:243], v[40:43], a[112:115], a[240:243]
ds_read_b128 a[112:115], v3 offset:36864
v_and_b32 v25, s33, v16
v_mfma_f32_16x16x32_bf16 a[244:247], v[40:43], a[116:119], a[244:247]
v_lshlrev_b32 v26, 16, v17
v_and_b32 v27, s33, v17
v_mfma_f32_16x16x32_bf16 a[244:247], v[72:75], a[148:151], a[244:247]
buffer_load_dwordx4 v[84:87], v0, s[20:23], s30 offen offset:0 sc1
v_mul_f32 v24, v24, v116
v_mfma_f32_16x16x32_bf16 v[244:247], a[168:171], a[148:151], v[244:247]
ds_read_b128 a[148:151], v4 offset:37888
v_mul_f32 v25, v25, v117
v_mfma_f32_16x16x32_bf16 v[244:247], a[200:203], a[116:119], v[244:247]
ds_read_b128 a[116:119], v3 offset:37888
s_add_u32 s54, s43, 16384
buffer_store_dwordx4 a[44:47], v23, s[16:19], s54 offen offset:0 sc1
v_mfma_f32_16x16x32_bf16 v[248:251], a[200:203], a[120:123], v[248:251]
v_mul_f32 v26, v26, v118
v_mul_f32 v27, v27, v119
v_mfma_f32_16x16x32_bf16 v[248:251], a[168:171], a[152:155], v[248:251]
buffer_load_dwordx4 a[44:47], v0, s[20:23], s30 offen offset:1024 sc1
v_cvt_pk_bf16_f32 v16, v24, v25
v_mfma_f32_16x16x32_bf16 a[248:251], v[72:75], a[152:155], a[248:251]
ds_read_b128 a[152:155], v4 offset:38912
v_cvt_pk_bf16_f32 v17, v26, v27
v_mfma_f32_16x16x32_bf16 a[248:251], v[40:43], a[120:123], a[248:251]
ds_read_b128 a[120:123], v3 offset:38912
v_lshlrev_b32 v24, 16, v18
v_mfma_f32_16x16x32_bf16 a[252:255], v[40:43], a[124:127], a[252:255]
buffer_load_dwordx4 v[40:43], v0, s[20:23], s30 offen offset:2048 sc1
v_and_b32 v25, s33, v18
v_mfma_f32_16x16x32_bf16 a[252:255], v[72:75], a[156:159], a[252:255]
buffer_load_dwordx4 v[72:75], v0, s[20:23], s30 offen offset:3072 sc1
s_add_u32 s30, s30, 0x1000
v_mfma_f32_16x16x32_bf16 v[252:255], a[168:171], a[156:159], v[252:255]
buffer_load_dwordx4 a[168:171], v0, s[20:23], s30 offen offset:0 sc1
ds_read_b128 a[156:159], v4 offset:39936
v_mfma_f32_16x16x32_bf16 v[252:255], a[200:203], a[124:127], v[252:255]
buffer_load_dwordx4 a[200:203], v0, s[20:23], s30 offen offset:1024 sc1
ds_read_b128 a[124:127], v3 offset:39936
s_waitcnt vmcnt(39) lgkmcnt(15)
v_mfma_f32_16x16x32_bf16 v[160:163], a[4:7], a[96:99], v[160:163]
v_lshlrev_b32 v26, 16, v19
v_mfma_f32_16x16x32_bf16 v[160:163], a[176:179], a[128:131], v[160:163]
v_and_b32 v27, s33, v19
v_mul_f32 v24, v24, v148
v_mfma_f32_16x16x32_bf16 v[192:195], a[180:183], a[128:131], v[192:195]
v_mul_f32 v25, v25, v149
v_mul_f32 v26, v26, v150
v_mfma_f32_16x16x32_bf16 v[192:195], a[208:211], a[96:99], v[192:195]
v_mul_f32 v27, v27, v151
v_cvt_pk_bf16_f32 v18, v24, v25
s_waitcnt lgkmcnt(13)
v_mfma_f32_16x16x32_bf16 v[196:199], a[208:211], a[100:103], v[196:199]
v_cvt_pk_bf16_f32 v19, v26, v27
v_mfma_f32_16x16x32_bf16 v[196:199], a[180:183], a[132:135], v[196:199]
ds_write_b128 v21, v[16:19] offset:2048
ds_read_b128 a[20:23], v22 offset:2048
v_mfma_f32_16x16x32_bf16 v[164:167], a[176:179], a[132:135], v[164:167]
ds_read_b128 a[52:55], v22 offset:3072
v_accvgpr_read_b32 v12, a24
v_mfma_f32_16x16x32_bf16 v[164:167], a[4:7], a[100:103], v[164:167]
v_accvgpr_read_b32 v13, a25
v_accvgpr_read_b32 v14, a26
s_waitcnt lgkmcnt(14)
v_mfma_f32_16x16x32_bf16 v[168:171], a[4:7], a[104:107], v[168:171]
v_accvgpr_read_b32 v15, a27
v_mfma_f32_16x16x32_bf16 v[168:171], a[176:179], a[136:139], v[168:171]
buffer_load_dwordx4 v[116:119], v0, s[20:23], s30 offen offset:2048 sc1
v_lshlrev_b32 v24, 16, v12
v_mfma_f32_16x16x32_bf16 v[200:203], a[180:183], a[136:139], v[200:203]
v_and_b32 v25, s33, v12
v_lshlrev_b32 v26, 16, v13
v_mfma_f32_16x16x32_bf16 v[200:203], a[208:211], a[104:107], v[200:203]
v_and_b32 v27, s33, v13
v_mul_f32 v24, v24, v56
s_waitcnt lgkmcnt(11)
v_mfma_f32_16x16x32_bf16 v[204:207], a[208:211], a[108:111], v[204:207]
v_mul_f32 v25, v25, v57
v_mfma_f32_16x16x32_bf16 v[204:207], a[180:183], a[140:143], v[204:207]
buffer_load_dwordx4 v[148:151], v0, s[20:23], s30 offen offset:3072 sc1
v_mul_f32 v26, v26, v58
v_mfma_f32_16x16x32_bf16 v[172:175], a[176:179], a[140:143], v[172:175]
v_mul_f32 v27, v27, v59
v_cvt_pk_bf16_f32 v12, v24, v25
v_mfma_f32_16x16x32_bf16 v[172:175], a[4:7], a[108:111], v[172:175]
v_cvt_pk_bf16_f32 v13, v26, v27
v_lshlrev_b32 v24, 16, v14
s_waitcnt lgkmcnt(9)
v_mfma_f32_16x16x32_bf16 v[176:179], a[4:7], a[112:115], v[176:179]
v_and_b32 v25, s33, v14
v_mfma_f32_16x16x32_bf16 v[176:179], a[176:179], a[144:147], v[176:179]
buffer_store_dwordx4 a[16:19], v23, s[16:19], s44 offen offset:0 sc1
v_lshlrev_b32 v26, 16, v15
v_mfma_f32_16x16x32_bf16 v[208:211], a[180:183], a[144:147], v[208:211]
v_and_b32 v27, s33, v15
v_mul_f32 v24, v24, v88
v_mfma_f32_16x16x32_bf16 v[208:211], a[208:211], a[112:115], v[208:211]
v_mul_f32 v25, v25, v89
v_mul_f32 v26, v26, v90
s_waitcnt lgkmcnt(7)
v_mfma_f32_16x16x32_bf16 v[212:215], a[208:211], a[116:119], v[212:215]
v_mul_f32 v27, v27, v91
v_mfma_f32_16x16x32_bf16 v[212:215], a[180:183], a[148:151], v[212:215]
v_cvt_pk_bf16_f32 v14, v24, v25
v_cvt_pk_bf16_f32 v15, v26, v27
v_mfma_f32_16x16x32_bf16 v[180:183], a[176:179], a[148:151], v[180:183]
ds_write_b128 v20, v[12:15] offset:4096
v_accvgpr_read_b32 v16, a56
v_mfma_f32_16x16x32_bf16 v[180:183], a[4:7], a[116:119], v[180:183]
v_accvgpr_read_b32 v17, a57
v_accvgpr_read_b32 v18, a58
s_waitcnt lgkmcnt(6)
v_mfma_f32_16x16x32_bf16 v[184:187], a[4:7], a[120:123], v[184:187]
v_accvgpr_read_b32 v19, a59
v_mfma_f32_16x16x32_bf16 v[184:187], a[176:179], a[152:155], v[184:187]
v_lshlrev_b32 v24, 16, v16
v_and_b32 v25, s33, v16
v_mfma_f32_16x16x32_bf16 v[216:219], a[180:183], a[152:155], v[216:219]
v_lshlrev_b32 v26, 16, v17
v_and_b32 v27, s33, v17
v_mfma_f32_16x16x32_bf16 v[216:219], a[208:211], a[120:123], v[216:219]
v_mul_f32 v24, v24, v120
v_mul_f32 v25, v25, v121
s_waitcnt lgkmcnt(4)
v_mfma_f32_16x16x32_bf16 v[220:223], a[208:211], a[124:127], v[220:223]
v_mul_f32 v26, v26, v122
v_mfma_f32_16x16x32_bf16 v[220:223], a[180:183], a[156:159], v[220:223]
v_mul_f32 v27, v27, v123
v_cvt_pk_bf16_f32 v16, v24, v25
v_mfma_f32_16x16x32_bf16 v[188:191], a[176:179], a[156:159], v[188:191]
v_cvt_pk_bf16_f32 v17, v26, v27
v_lshlrev_b32 v24, 16, v18
v_mfma_f32_16x16x32_bf16 v[188:191], a[4:7], a[124:127], v[188:191]
v_and_b32 v25, s33, v18
v_lshlrev_b32 v26, 16, v19
s_waitcnt vmcnt(37)
v_mfma_f32_16x16x32_bf16 v[224:227], a[212:215], a[96:99], v[224:227]
v_and_b32 v27, s33, v19
v_mfma_f32_16x16x32_bf16 v[224:227], v[104:107], a[128:131], v[224:227]
v_mul_f32 v24, v24, v152
v_mul_f32 v25, v25, v153
v_mfma_f32_16x16x32_bf16 a[224:227], a[36:39], a[128:131], a[224:227]
v_xor_b32 v2, 0x12000, v6
ds_read_b128 a[128:131], v2 offset:0
v_mfma_f32_16x16x32_bf16 a[224:227], v[136:139], a[96:99], a[224:227]
v_xor_b32 v1, 0x10000, v6
ds_read_b128 a[96:99], v1 offset:0
v_mfma_f32_16x16x32_bf16 a[228:231], v[136:139], a[100:103], a[228:231]
v_mul_f32 v26, v26, v154
v_mul_f32 v27, v27, v155
v_mfma_f32_16x16x32_bf16 a[228:231], a[36:39], a[132:135], a[228:231]
v_cvt_pk_bf16_f32 v18, v24, v25
v_cvt_pk_bf16_f32 v19, v26, v27
v_mfma_f32_16x16x32_bf16 v[228:231], v[104:107], a[132:135], v[228:231]
ds_read_b128 a[132:135], v2 offset:1024
ds_write_b128 v21, v[16:19] offset:4096
v_mfma_f32_16x16x32_bf16 v[228:231], a[212:215], a[100:103], v[228:231]
ds_read_b128 a[100:103], v1 offset:1024
ds_read_b128 a[24:27], v22 offset:4096
v_mfma_f32_16x16x32_bf16 v[232:235], a[212:215], a[104:107], v[232:235]
ds_read_b128 a[56:59], v22 offset:5120
v_accvgpr_read_b32 v12, a28
v_mfma_f32_16x16x32_bf16 v[232:235], v[104:107], a[136:139], v[232:235]
v_accvgpr_read_b32 v13, a29
v_accvgpr_read_b32 v14, a30
v_mfma_f32_16x16x32_bf16 a[232:235], a[36:39], a[136:139], a[232:235]
ds_read_b128 a[136:139], v2 offset:2048
v_accvgpr_read_b32 v15, a31
v_mfma_f32_16x16x32_bf16 a[232:235], v[136:139], a[104:107], a[232:235]
ds_read_b128 a[104:107], v1 offset:2048
s_add_u32 s54, s44, 16384
buffer_store_dwordx4 a[48:51], v23, s[16:19], s54 offen offset:0 sc1
v_mfma_f32_16x16x32_bf16 a[236:239], v[136:139], a[108:111], a[236:239]
v_lshlrev_b32 v24, 16, v12
v_and_b32 v25, s33, v12
v_mfma_f32_16x16x32_bf16 a[236:239], a[36:39], a[140:143], a[236:239]
v_lshlrev_b32 v26, 16, v13
v_and_b32 v27, s33, v13
v_mfma_f32_16x16x32_bf16 v[236:239], v[104:107], a[140:143], v[236:239]
ds_read_b128 a[140:143], v2 offset:3072
v_mul_f32 v24, v24, v60
v_mfma_f32_16x16x32_bf16 v[236:239], a[212:215], a[108:111], v[236:239]
ds_read_b128 a[108:111], v1 offset:3072
v_mul_f32 v25, v25, v61
v_mfma_f32_16x16x32_bf16 v[240:243], a[212:215], a[112:115], v[240:243]
v_mul_f32 v26, v26, v62
v_mul_f32 v27, v27, v63
v_mfma_f32_16x16x32_bf16 v[240:243], v[104:107], a[144:147], v[240:243]
v_cvt_pk_bf16_f32 v12, v24, v25
v_cvt_pk_bf16_f32 v13, v26, v27
v_mfma_f32_16x16x32_bf16 a[240:243], a[36:39], a[144:147], a[240:243]
ds_read_b128 a[144:147], v2 offset:4096
v_lshlrev_b32 v24, 16, v14
v_mfma_f32_16x16x32_bf16 a[240:243], v[136:139], a[112:115], a[240:243]
ds_read_b128 a[112:115], v1 offset:4096
v_and_b32 v25, s33, v14
v_mfma_f32_16x16x32_bf16 a[244:247], v[136:139], a[116:119], a[244:247]
v_lshlrev_b32 v26, 16, v15
v_and_b32 v27, s33, v15
v_mfma_f32_16x16x32_bf16 a[244:247], a[36:39], a[148:151], a[244:247]
v_mul_f32 v24, v24, v92
v_mul_f32 v25, v25, v93
v_mfma_f32_16x16x32_bf16 v[244:247], v[104:107], a[148:151], v[244:247]
ds_read_b128 a[148:151], v2 offset:5120
v_mul_f32 v26, v26, v94
v_mfma_f32_16x16x32_bf16 v[244:247], a[212:215], a[116:119], v[244:247]
ds_read_b128 a[116:119], v1 offset:5120
v_mul_f32 v27, v27, v95
v_mfma_f32_16x16x32_bf16 v[248:251], a[212:215], a[120:123], v[248:251]
v_cvt_pk_bf16_f32 v14, v24, v25
v_cvt_pk_bf16_f32 v15, v26, v27
v_mfma_f32_16x16x32_bf16 v[248:251], v[104:107], a[152:155], v[248:251]
ds_write_b128 v20, v[12:15] offset:6144
v_accvgpr_read_b32 v16, a60
v_mfma_f32_16x16x32_bf16 a[248:251], a[36:39], a[152:155], a[248:251]
ds_read_b128 a[152:155], v2 offset:6144
v_accvgpr_read_b32 v17, a61
v_mfma_f32_16x16x32_bf16 a[248:251], v[136:139], a[120:123], a[248:251]
ds_read_b128 a[120:123], v1 offset:6144
v_accvgpr_read_b32 v18, a62
v_mfma_f32_16x16x32_bf16 a[252:255], v[136:139], a[124:127], a[252:255]
v_accvgpr_read_b32 v19, a63
v_lshlrev_b32 v24, 16, v16
v_mfma_f32_16x16x32_bf16 a[252:255], a[36:39], a[156:159], a[252:255]
v_and_b32 v25, s33, v16
v_lshlrev_b32 v26, 16, v17
v_mfma_f32_16x16x32_bf16 v[252:255], v[104:107], a[156:159], v[252:255]
ds_read_b128 a[156:159], v2 offset:7168
v_and_b32 v27, s33, v17
v_mfma_f32_16x16x32_bf16 v[252:255], a[212:215], a[124:127], v[252:255]
ds_read_b128 a[124:127], v1 offset:7168
v_mul_f32 v24, v24, v124
s_waitcnt vmcnt(34) lgkmcnt(15)
v_mfma_f32_16x16x32_bf16 v[160:163], v[44:47], a[96:99], v[160:163]
v_mul_f32 v25, v25, v125
v_mfma_f32_16x16x32_bf16 v[160:163], v[76:79], a[128:131], v[160:163]
v_mul_f32 v26, v26, v126
v_mul_f32 v27, v27, v127
v_mfma_f32_16x16x32_bf16 v[192:195], a[216:219], a[128:131], v[192:195]
v_cvt_pk_bf16_f32 v16, v24, v25
v_cvt_pk_bf16_f32 v17, v26, v27
v_mfma_f32_16x16x32_bf16 v[192:195], a[184:187], a[96:99], v[192:195]
v_lshlrev_b32 v24, 16, v18
v_and_b32 v25, s33, v18
v_mfma_f32_16x16x32_bf16 v[196:199], a[184:187], a[100:103], v[196:199]
v_lshlrev_b32 v26, 16, v19
v_and_b32 v27, s33, v19
v_mfma_f32_16x16x32_bf16 v[196:199], a[216:219], a[132:135], v[196:199]
buffer_store_dwordx4 a[20:23], v23, s[16:19], s45 offen offset:0 sc1
v_mul_f32 v24, v24, v156
v_mfma_f32_16x16x32_bf16 v[164:167], v[76:79], a[132:135], v[164:167]
v_mul_f32 v25, v25, v157
v_mul_f32 v26, v26, v158
v_mfma_f32_16x16x32_bf16 v[164:167], v[44:47], a[100:103], v[164:167]
v_mul_f32 v27, v27, v159
v_cvt_pk_bf16_f32 v18, v24, v25
s_waitcnt lgkmcnt(11)
v_mfma_f32_16x16x32_bf16 v[168:171], v[44:47], a[104:107], v[168:171]
v_cvt_pk_bf16_f32 v19, v26, v27
v_mfma_f32_16x16x32_bf16 v[168:171], v[76:79], a[136:139], v[168:171]
ds_write_b128 v21, v[16:19] offset:6144
ds_read_b128 a[28:31], v22 offset:6144
v_mfma_f32_16x16x32_bf16 v[200:203], a[216:219], a[136:139], v[200:203]
ds_read_b128 a[60:63], v22 offset:7168
v_mfma_f32_16x16x32_bf16 v[200:203], a[184:187], a[104:107], v[200:203]
s_waitcnt lgkmcnt(12)
v_mfma_f32_16x16x32_bf16 v[204:207], a[184:187], a[108:111], v[204:207]
v_mfma_f32_16x16x32_bf16 v[204:207], a[216:219], a[140:143], v[204:207]
v_mfma_f32_16x16x32_bf16 v[172:175], v[76:79], a[140:143], v[172:175]
v_mfma_f32_16x16x32_bf16 v[172:175], v[44:47], a[108:111], v[172:175]
s_waitcnt lgkmcnt(10)
v_mfma_f32_16x16x32_bf16 v[176:179], v[44:47], a[112:115], v[176:179]
v_mfma_f32_16x16x32_bf16 v[176:179], v[76:79], a[144:147], v[176:179]
v_mfma_f32_16x16x32_bf16 v[208:211], a[216:219], a[144:147], v[208:211]
v_mfma_f32_16x16x32_bf16 v[208:211], a[184:187], a[112:115], v[208:211]
s_waitcnt lgkmcnt(8)
v_mfma_f32_16x16x32_bf16 v[212:215], a[184:187], a[116:119], v[212:215]
v_mfma_f32_16x16x32_bf16 v[212:215], a[216:219], a[148:151], v[212:215]
v_mfma_f32_16x16x32_bf16 v[180:183], v[76:79], a[148:151], v[180:183]
v_mfma_f32_16x16x32_bf16 v[180:183], v[44:47], a[116:119], v[180:183]
s_waitcnt lgkmcnt(5)
v_mfma_f32_16x16x32_bf16 v[184:187], v[44:47], a[120:123], v[184:187]
v_mfma_f32_16x16x32_bf16 v[184:187], v[76:79], a[152:155], v[184:187]
v_mfma_f32_16x16x32_bf16 v[216:219], a[216:219], a[152:155], v[216:219]
v_mfma_f32_16x16x32_bf16 v[216:219], a[184:187], a[120:123], v[216:219]
s_waitcnt lgkmcnt(3)
v_mfma_f32_16x16x32_bf16 v[220:223], a[184:187], a[124:127], v[220:223]
v_mfma_f32_16x16x32_bf16 v[220:223], a[216:219], a[156:159], v[220:223]
v_mfma_f32_16x16x32_bf16 v[188:191], v[76:79], a[156:159], v[188:191]
v_mfma_f32_16x16x32_bf16 v[188:191], v[44:47], a[124:127], v[188:191]
s_add_u32 s54, s45, 16384
buffer_store_dwordx4 a[52:55], v23, s[16:19], s54 offen offset:0 sc1
s_waitcnt vmcnt(31)
v_mfma_f32_16x16x32_bf16 v[224:227], a[188:191], a[96:99], v[224:227]
v_mfma_f32_16x16x32_bf16 v[224:227], a[220:223], a[128:131], v[224:227]
v_mfma_f32_16x16x32_bf16 a[224:227], v[108:111], a[128:131], a[224:227]
v_xor_b32 v4, 0x16000, v6
ds_read_b128 a[128:131], v4 offset:0
v_mfma_f32_16x16x32_bf16 a[224:227], a[8:11], a[96:99], a[224:227]
v_xor_b32 v3, 0x14000, v6
ds_read_b128 a[96:99], v3 offset:0
v_mfma_f32_16x16x32_bf16 a[228:231], a[8:11], a[100:103], a[228:231]
v_mfma_f32_16x16x32_bf16 a[228:231], v[108:111], a[132:135], a[228:231]
v_mfma_f32_16x16x32_bf16 v[228:231], a[220:223], a[132:135], v[228:231]
ds_read_b128 a[132:135], v4 offset:1024
v_mfma_f32_16x16x32_bf16 v[228:231], a[188:191], a[100:103], v[228:231]
ds_read_b128 a[100:103], v3 offset:1024
v_mfma_f32_16x16x32_bf16 v[232:235], a[188:191], a[104:107], v[232:235]
v_mfma_f32_16x16x32_bf16 v[232:235], a[220:223], a[136:139], v[232:235]
v_mfma_f32_16x16x32_bf16 a[232:235], v[108:111], a[136:139], a[232:235]
ds_read_b128 a[136:139], v4 offset:2048
v_mfma_f32_16x16x32_bf16 a[232:235], a[8:11], a[104:107], a[232:235]
ds_read_b128 a[104:107], v3 offset:2048
v_mfma_f32_16x16x32_bf16 a[236:239], a[8:11], a[108:111], a[236:239]
v_mfma_f32_16x16x32_bf16 a[236:239], v[108:111], a[140:143], a[236:239]
v_mfma_f32_16x16x32_bf16 v[236:239], a[220:223], a[140:143], v[236:239]
ds_read_b128 a[140:143], v4 offset:3072
v_mfma_f32_16x16x32_bf16 v[236:239], a[188:191], a[108:111], v[236:239]
ds_read_b128 a[108:111], v3 offset:3072
v_mfma_f32_16x16x32_bf16 v[240:243], a[188:191], a[112:115], v[240:243]
v_mfma_f32_16x16x32_bf16 v[240:243], a[220:223], a[144:147], v[240:243]
v_mfma_f32_16x16x32_bf16 a[240:243], v[108:111], a[144:147], a[240:243]
ds_read_b128 a[144:147], v4 offset:4096
v_mfma_f32_16x16x32_bf16 a[240:243], a[8:11], a[112:115], a[240:243]
ds_read_b128 a[112:115], v3 offset:4096
v_mfma_f32_16x16x32_bf16 a[244:247], a[8:11], a[116:119], a[244:247]
v_mfma_f32_16x16x32_bf16 a[244:247], v[108:111], a[148:151], a[244:247]
v_mfma_f32_16x16x32_bf16 v[244:247], a[220:223], a[148:151], v[244:247]
ds_read_b128 a[148:151], v4 offset:5120
v_mfma_f32_16x16x32_bf16 v[244:247], a[188:191], a[116:119], v[244:247]
ds_read_b128 a[116:119], v3 offset:5120
v_mfma_f32_16x16x32_bf16 v[248:251], a[188:191], a[120:123], v[248:251]
v_mfma_f32_16x16x32_bf16 v[248:251], a[220:223], a[152:155], v[248:251]
buffer_store_dwordx4 a[24:27], v23, s[16:19], s46 offen offset:0 sc1
v_mfma_f32_16x16x32_bf16 a[248:251], v[108:111], a[152:155], a[248:251]
ds_read_b128 a[152:155], v4 offset:6144
v_mfma_f32_16x16x32_bf16 a[248:251], a[8:11], a[120:123], a[248:251]
ds_read_b128 a[120:123], v3 offset:6144
v_mfma_f32_16x16x32_bf16 a[252:255], a[8:11], a[124:127], a[252:255]
v_mfma_f32_16x16x32_bf16 a[252:255], v[108:111], a[156:159], a[252:255]
v_mfma_f32_16x16x32_bf16 v[252:255], a[220:223], a[156:159], v[252:255]
ds_read_b128 a[156:159], v4 offset:7168
v_mfma_f32_16x16x32_bf16 v[252:255], a[188:191], a[124:127], v[252:255]
ds_read_b128 a[124:127], v3 offset:7168
s_waitcnt vmcnt(28) lgkmcnt(14)
v_mfma_f32_16x16x32_bf16 v[160:163], v[140:143], a[96:99], v[160:163]
v_mfma_f32_16x16x32_bf16 v[160:163], a[192:195], a[128:131], v[160:163]
v_mfma_f32_16x16x32_bf16 v[192:195], a[196:199], a[128:131], v[192:195]
v_mfma_f32_16x16x32_bf16 v[192:195], a[160:163], a[96:99], v[192:195]
s_waitcnt lgkmcnt(12)
v_mfma_f32_16x16x32_bf16 v[196:199], a[160:163], a[100:103], v[196:199]
v_mfma_f32_16x16x32_bf16 v[196:199], a[196:199], a[132:135], v[196:199]
v_mfma_f32_16x16x32_bf16 v[164:167], a[192:195], a[132:135], v[164:167]
v_mfma_f32_16x16x32_bf16 v[164:167], v[140:143], a[100:103], v[164:167]
s_waitcnt lgkmcnt(10)
v_mfma_f32_16x16x32_bf16 v[168:171], v[140:143], a[104:107], v[168:171]
v_mfma_f32_16x16x32_bf16 v[168:171], a[192:195], a[136:139], v[168:171]
v_mfma_f32_16x16x32_bf16 v[200:203], a[196:199], a[136:139], v[200:203]
v_mfma_f32_16x16x32_bf16 v[200:203], a[160:163], a[104:107], v[200:203]
s_waitcnt lgkmcnt(8)
v_mfma_f32_16x16x32_bf16 v[204:207], a[160:163], a[108:111], v[204:207]
v_mfma_f32_16x16x32_bf16 v[204:207], a[196:199], a[140:143], v[204:207]
v_mfma_f32_16x16x32_bf16 v[172:175], a[192:195], a[140:143], v[172:175]
v_mfma_f32_16x16x32_bf16 v[172:175], v[140:143], a[108:111], v[172:175]
s_waitcnt lgkmcnt(6)
v_mfma_f32_16x16x32_bf16 v[176:179], v[140:143], a[112:115], v[176:179]
v_mfma_f32_16x16x32_bf16 v[176:179], a[192:195], a[144:147], v[176:179]
v_mfma_f32_16x16x32_bf16 v[208:211], a[196:199], a[144:147], v[208:211]
v_mfma_f32_16x16x32_bf16 v[208:211], a[160:163], a[112:115], v[208:211]
s_add_u32 s54, s46, 16384
buffer_store_dwordx4 a[56:59], v23, s[16:19], s54 offen offset:0 sc1
s_waitcnt lgkmcnt(4)
v_mfma_f32_16x16x32_bf16 v[212:215], a[160:163], a[116:119], v[212:215]
v_mfma_f32_16x16x32_bf16 v[212:215], a[196:199], a[148:151], v[212:215]
v_mfma_f32_16x16x32_bf16 v[180:183], a[192:195], a[148:151], v[180:183]
v_mfma_f32_16x16x32_bf16 v[180:183], v[140:143], a[116:119], v[180:183]
s_waitcnt lgkmcnt(2)
v_mfma_f32_16x16x32_bf16 v[184:187], v[140:143], a[120:123], v[184:187]
v_mfma_f32_16x16x32_bf16 v[184:187], a[192:195], a[152:155], v[184:187]
v_mfma_f32_16x16x32_bf16 v[216:219], a[196:199], a[152:155], v[216:219]
v_mfma_f32_16x16x32_bf16 v[216:219], a[160:163], a[120:123], v[216:219]
s_waitcnt lgkmcnt(0)
v_mfma_f32_16x16x32_bf16 v[220:223], a[160:163], a[124:127], v[220:223]
v_mfma_f32_16x16x32_bf16 v[220:223], a[196:199], a[156:159], v[220:223]
v_mfma_f32_16x16x32_bf16 v[188:191], a[192:195], a[156:159], v[188:191]
v_mfma_f32_16x16x32_bf16 v[188:191], v[140:143], a[124:127], v[188:191]
s_waitcnt vmcnt(24)
v_mfma_f32_16x16x32_bf16 v[224:227], a[164:167], a[96:99], v[224:227]
v_mfma_f32_16x16x32_bf16 v[224:227], a[40:43], a[128:131], v[224:227]
v_mfma_f32_16x16x32_bf16 a[224:227], v[80:83], a[128:131], a[224:227]
ds_read_b128 a[128:131], v2 offset:32768
v_mfma_f32_16x16x32_bf16 a[224:227], v[48:51], a[96:99], a[224:227]
ds_read_b128 a[96:99], v1 offset:32768
v_mfma_f32_16x16x32_bf16 a[228:231], v[48:51], a[100:103], a[228:231]
v_mfma_f32_16x16x32_bf16 a[228:231], v[80:83], a[132:135], a[228:231]
v_mfma_f32_16x16x32_bf16 v[228:231], a[40:43], a[132:135], v[228:231]
ds_read_b128 a[132:135], v2 offset:33792
v_mfma_f32_16x16x32_bf16 v[228:231], a[164:167], a[100:103], v[228:231]
ds_read_b128 a[100:103], v1 offset:33792
v_mfma_f32_16x16x32_bf16 v[232:235], a[164:167], a[104:107], v[232:235]
v_mfma_f32_16x16x32_bf16 v[232:235], a[40:43], a[136:139], v[232:235]
v_mfma_f32_16x16x32_bf16 a[232:235], v[80:83], a[136:139], a[232:235]
ds_read_b128 a[136:139], v2 offset:34816
v_mfma_f32_16x16x32_bf16 a[232:235], v[48:51], a[104:107], a[232:235]
ds_read_b128 a[104:107], v1 offset:34816
v_mfma_f32_16x16x32_bf16 a[236:239], v[48:51], a[108:111], a[236:239]
v_mfma_f32_16x16x32_bf16 a[236:239], v[80:83], a[140:143], a[236:239]
buffer_store_dwordx4 a[28:31], v23, s[16:19], s47 offen offset:0 sc1
v_mfma_f32_16x16x32_bf16 v[236:239], a[40:43], a[140:143], v[236:239]
ds_read_b128 a[140:143], v2 offset:35840
v_mfma_f32_16x16x32_bf16 v[236:239], a[164:167], a[108:111], v[236:239]
ds_read_b128 a[108:111], v1 offset:35840
v_mfma_f32_16x16x32_bf16 v[240:243], a[164:167], a[112:115], v[240:243]
v_mfma_f32_16x16x32_bf16 v[240:243], a[40:43], a[144:147], v[240:243]
v_mfma_f32_16x16x32_bf16 a[240:243], v[80:83], a[144:147], a[240:243]
ds_read_b128 a[144:147], v2 offset:36864
v_mfma_f32_16x16x32_bf16 a[240:243], v[48:51], a[112:115], a[240:243]
ds_read_b128 a[112:115], v1 offset:36864
v_mfma_f32_16x16x32_bf16 a[244:247], v[48:51], a[116:119], a[244:247]
v_mfma_f32_16x16x32_bf16 a[244:247], v[80:83], a[148:151], a[244:247]
v_mfma_f32_16x16x32_bf16 v[244:247], a[40:43], a[148:151], v[244:247]
ds_read_b128 a[148:151], v2 offset:37888
v_mfma_f32_16x16x32_bf16 v[244:247], a[164:167], a[116:119], v[244:247]
ds_read_b128 a[116:119], v1 offset:37888
v_mfma_f32_16x16x32_bf16 v[248:251], a[164:167], a[120:123], v[248:251]
v_mfma_f32_16x16x32_bf16 v[248:251], a[40:43], a[152:155], v[248:251]
v_mfma_f32_16x16x32_bf16 a[248:251], v[80:83], a[152:155], a[248:251]
ds_read_b128 a[152:155], v2 offset:38912
v_mfma_f32_16x16x32_bf16 a[248:251], v[48:51], a[120:123], a[248:251]
ds_read_b128 a[120:123], v1 offset:38912
v_mfma_f32_16x16x32_bf16 a[252:255], v[48:51], a[124:127], a[252:255]
v_mfma_f32_16x16x32_bf16 a[252:255], v[80:83], a[156:159], a[252:255]
v_mfma_f32_16x16x32_bf16 v[252:255], a[40:43], a[156:159], v[252:255]
ds_read_b128 a[156:159], v2 offset:39936
v_mfma_f32_16x16x32_bf16 v[252:255], a[164:167], a[124:127], v[252:255]
ds_read_b128 a[124:127], v1 offset:39936
s_waitcnt vmcnt(20) lgkmcnt(14)
v_mfma_f32_16x16x32_bf16 v[160:163], v[112:115], a[96:99], v[160:163]
v_mfma_f32_16x16x32_bf16 v[160:163], v[144:147], a[128:131], v[160:163]
v_mfma_f32_16x16x32_bf16 v[192:195], a[204:207], a[128:131], v[192:195]
v_mfma_f32_16x16x32_bf16 v[192:195], a[172:175], a[96:99], v[192:195]
s_waitcnt vmcnt(16)
v_mfma_f32_16x16x32_bf16 v[224:227], a[12:15], a[96:99], v[224:227]
v_mfma_f32_16x16x32_bf16 v[224:227], a[32:35], a[128:131], v[224:227]
v_mfma_f32_16x16x32_bf16 a[224:227], v[52:55], a[128:131], a[224:227]
ds_read_b128 a[128:131], v4 offset:32768
v_mfma_f32_16x16x32_bf16 a[224:227], a[0:3], a[96:99], a[224:227]
ds_read_b128 a[96:99], v3 offset:32768
s_add_u32 s54, s47, 16384
buffer_store_dwordx4 a[60:63], v23, s[16:19], s54 offen offset:0 sc1
s_waitcnt lgkmcnt(14)
v_mfma_f32_16x16x32_bf16 v[164:167], v[112:115], a[100:103], v[164:167]
v_mfma_f32_16x16x32_bf16 v[164:167], v[144:147], a[132:135], v[164:167]
v_mfma_f32_16x16x32_bf16 v[196:199], a[204:207], a[132:135], v[196:199]
v_mfma_f32_16x16x32_bf16 v[196:199], a[172:175], a[100:103], v[196:199]
v_mfma_f32_16x16x32_bf16 v[228:231], a[12:15], a[100:103], v[228:231]
v_mfma_f32_16x16x32_bf16 v[228:231], a[32:35], a[132:135], v[228:231]
v_mfma_f32_16x16x32_bf16 a[228:231], v[52:55], a[132:135], a[228:231]
ds_read_b128 a[132:135], v4 offset:33792
v_mfma_f32_16x16x32_bf16 a[228:231], a[0:3], a[100:103], a[228:231]
ds_read_b128 a[100:103], v3 offset:33792
s_waitcnt lgkmcnt(14)
v_mfma_f32_16x16x32_bf16 v[168:171], v[112:115], a[104:107], v[168:171]
v_mfma_f32_16x16x32_bf16 v[168:171], v[144:147], a[136:139], v[168:171]
v_mfma_f32_16x16x32_bf16 v[200:203], a[204:207], a[136:139], v[200:203]
v_mfma_f32_16x16x32_bf16 v[200:203], a[172:175], a[104:107], v[200:203]
v_mfma_f32_16x16x32_bf16 v[232:235], a[12:15], a[104:107], v[232:235]
v_mfma_f32_16x16x32_bf16 v[232:235], a[32:35], a[136:139], v[232:235]
v_mfma_f32_16x16x32_bf16 a[232:235], v[52:55], a[136:139], a[232:235]
ds_read_b128 a[136:139], v4 offset:34816
v_mfma_f32_16x16x32_bf16 a[232:235], a[0:3], a[104:107], a[232:235]
ds_read_b128 a[104:107], v3 offset:34816
s_waitcnt lgkmcnt(14)
v_mfma_f32_16x16x32_bf16 v[172:175], v[112:115], a[108:111], v[172:175]
v_mfma_f32_16x16x32_bf16 v[172:175], v[144:147], a[140:143], v[172:175]
v_mfma_f32_16x16x32_bf16 v[204:207], a[204:207], a[140:143], v[204:207]
v_mfma_f32_16x16x32_bf16 v[204:207], a[172:175], a[108:111], v[204:207]
v_mfma_f32_16x16x32_bf16 v[236:239], a[12:15], a[108:111], v[236:239]
v_mfma_f32_16x16x32_bf16 v[236:239], a[32:35], a[140:143], v[236:239]
v_mfma_f32_16x16x32_bf16 a[236:239], v[52:55], a[140:143], a[236:239]
ds_read_b128 a[140:143], v4 offset:35840
v_mfma_f32_16x16x32_bf16 a[236:239], a[0:3], a[108:111], a[236:239]
ds_read_b128 a[108:111], v3 offset:35840
s_waitcnt vmcnt(12) lgkmcnt(6)
v_mfma_f32_16x16x32_bf16 v[160:163], v[84:87], a[96:99], v[160:163]
v_mfma_f32_16x16x32_bf16 v[160:163], a[44:47], a[128:131], v[160:163]
v_mfma_f32_16x16x32_bf16 v[192:195], v[72:75], a[128:131], v[192:195]
v_mfma_f32_16x16x32_bf16 v[192:195], v[40:43], a[96:99], v[192:195]
s_waitcnt vmcnt(8)
v_mfma_f32_16x16x32_bf16 v[224:227], a[168:171], a[96:99], v[224:227]
v_mfma_f32_16x16x32_bf16 v[224:227], a[200:203], a[128:131], v[224:227]
v_mfma_f32_16x16x32_bf16 a[224:227], v[148:151], a[128:131], a[224:227]
v_mfma_f32_16x16x32_bf16 a[224:227], v[116:119], a[96:99], a[224:227]
s_waitcnt lgkmcnt(4)
v_mfma_f32_16x16x32_bf16 v[164:167], v[84:87], a[100:103], v[164:167]
v_accvgpr_read_b32 v12, a64
v_mfma_f32_16x16x32_bf16 v[164:167], a[44:47], a[132:135], v[164:167]
v_accvgpr_read_b32 v13, a65
v_accvgpr_read_b32 v14, a66
v_mfma_f32_16x16x32_bf16 v[196:199], v[72:75], a[132:135], v[196:199]
v_accvgpr_read_b32 v15, a67
v_lshlrev_b32 v24, 16, v12
v_mfma_f32_16x16x32_bf16 v[196:199], v[40:43], a[100:103], v[196:199]
v_and_b32 v25, s33, v12
v_lshlrev_b32 v26, 16, v13
v_mfma_f32_16x16x32_bf16 v[228:231], a[168:171], a[100:103], v[228:231]
v_and_b32 v27, s33, v13
v_mul_f32 v24, v24, v160
v_mfma_f32_16x16x32_bf16 v[228:231], a[200:203], a[132:135], v[228:231]
v_mul_f32 v25, v25, v161
v_mul_f32 v26, v26, v162
v_mfma_f32_16x16x32_bf16 a[228:231], v[148:151], a[132:135], a[228:231]
v_mul_f32 v27, v27, v163
v_cvt_pk_bf16_f32 v12, v24, v25
v_mfma_f32_16x16x32_bf16 a[228:231], v[116:119], a[100:103], a[228:231]
v_cvt_pk_bf16_f32 v13, v26, v27
v_lshlrev_b32 v24, 16, v14
s_waitcnt lgkmcnt(2)
v_mfma_f32_16x16x32_bf16 v[168:171], v[84:87], a[104:107], v[168:171]
v_and_b32 v25, s33, v14
v_mfma_f32_16x16x32_bf16 v[168:171], a[44:47], a[136:139], v[168:171]
v_lshlrev_b32 v26, 16, v15
v_and_b32 v27, s33, v15
v_mfma_f32_16x16x32_bf16 v[200:203], v[72:75], a[136:139], v[200:203]
v_mul_f32 v24, v24, v192
v_mul_f32 v25, v25, v193
v_mfma_f32_16x16x32_bf16 v[200:203], v[40:43], a[104:107], v[200:203]
v_mul_f32 v26, v26, v194
v_mul_f32 v27, v27, v195
v_mfma_f32_16x16x32_bf16 v[232:235], a[168:171], a[104:107], v[232:235]
v_cvt_pk_bf16_f32 v14, v24, v25
v_cvt_pk_bf16_f32 v15, v26, v27
v_mfma_f32_16x16x32_bf16 v[232:235], a[200:203], a[136:139], v[232:235]
ds_write_b128 v20, v[12:15] offset:0
v_lshlrev_b32 v24, 16, v32
v_mfma_f32_16x16x32_bf16 a[232:235], v[148:151], a[136:139], a[232:235]
v_and_b32 v25, s33, v32
v_lshlrev_b32 v26, 16, v33
v_mfma_f32_16x16x32_bf16 a[232:235], v[116:119], a[104:107], a[232:235]
v_and_b32 v27, s33, v33
v_mul_f32 v24, v24, v224
s_waitcnt lgkmcnt(1)
v_mfma_f32_16x16x32_bf16 v[172:175], v[84:87], a[108:111], v[172:175]
v_mul_f32 v25, v25, v225
v_mfma_f32_16x16x32_bf16 v[172:175], a[44:47], a[140:143], v[172:175]
v_mul_f32 v26, v26, v226
v_mul_f32 v27, v27, v227
v_mfma_f32_16x16x32_bf16 v[204:207], v[72:75], a[140:143], v[204:207]
v_cvt_pk_bf16_f32 v16, v24, v25
v_cvt_pk_bf16_f32 v17, v26, v27
v_mfma_f32_16x16x32_bf16 v[204:207], v[40:43], a[108:111], v[204:207]
v_lshlrev_b32 v24, 16, v34
v_and_b32 v25, s33, v34
v_mfma_f32_16x16x32_bf16 v[236:239], a[168:171], a[108:111], v[236:239]
v_lshlrev_b32 v26, 16, v35
v_and_b32 v27, s33, v35
v_mfma_f32_16x16x32_bf16 v[236:239], a[200:203], a[140:143], v[236:239]
v_accvgpr_read_b32 v28, a224
v_mul_f32 v24, v24, v28
v_mfma_f32_16x16x32_bf16 a[236:239], v[148:151], a[140:143], a[236:239]
v_accvgpr_read_b32 v29, a225
v_mul_f32 v25, v25, v29
v_mfma_f32_16x16x32_bf16 a[236:239], v[116:119], a[108:111], a[236:239]
v_accvgpr_read_b32 v30, a226
v_mul_f32 v26, v26, v30
v_mfma_f32_16x16x32_bf16 v[176:179], v[112:115], a[112:115], v[176:179]
v_accvgpr_read_b32 v31, a227
v_mul_f32 v27, v27, v31
v_mfma_f32_16x16x32_bf16 v[176:179], v[144:147], a[144:147], v[176:179]
v_cvt_pk_bf16_f32 v18, v24, v25
v_cvt_pk_bf16_f32 v19, v26, v27
v_mfma_f32_16x16x32_bf16 v[208:211], a[204:207], a[144:147], v[208:211]
ds_write_b128 v21, v[16:19] offset:0
ds_read_b128 v[160:163], v22 offset:0
v_mfma_f32_16x16x32_bf16 v[208:211], a[172:175], a[112:115], v[208:211]
ds_read_b128 v[192:195], v22 offset:1024
v_accvgpr_read_b32 v12, a68
v_mfma_f32_16x16x32_bf16 v[240:243], a[12:15], a[112:115], v[240:243]
v_accvgpr_read_b32 v13, a69
v_accvgpr_read_b32 v14, a70
v_mfma_f32_16x16x32_bf16 v[240:243], a[32:35], a[144:147], v[240:243]
v_accvgpr_read_b32 v15, a71
v_lshlrev_b32 v24, 16, v12
v_mfma_f32_16x16x32_bf16 a[240:243], v[52:55], a[144:147], a[240:243]
ds_read_b128 a[144:147], v4 offset:36864
v_and_b32 v25, s33, v12
v_mfma_f32_16x16x32_bf16 a[240:243], a[0:3], a[112:115], a[240:243]
ds_read_b128 a[112:115], v3 offset:36864
v_lshlrev_b32 v26, 16, v13
v_mfma_f32_16x16x32_bf16 v[180:183], v[112:115], a[116:119], v[180:183]
v_and_b32 v27, s33, v13
v_mul_f32 v24, v24, v164
v_mfma_f32_16x16x32_bf16 v[180:183], v[144:147], a[148:151], v[180:183]
v_mul_f32 v25, v25, v165
v_mul_f32 v26, v26, v166
v_mfma_f32_16x16x32_bf16 v[212:215], a[204:207], a[148:151], v[212:215]
v_mul_f32 v27, v27, v167
v_cvt_pk_bf16_f32 v12, v24, v25
v_mfma_f32_16x16x32_bf16 v[212:215], a[172:175], a[116:119], v[212:215]
v_cvt_pk_bf16_f32 v13, v26, v27
v_lshlrev_b32 v24, 16, v14
v_mfma_f32_16x16x32_bf16 v[244:247], a[12:15], a[116:119], v[244:247]
v_and_b32 v25, s33, v14
v_lshlrev_b32 v26, 16, v15
v_mfma_f32_16x16x32_bf16 v[244:247], a[32:35], a[148:151], v[244:247]
v_and_b32 v27, s33, v15
v_mul_f32 v24, v24, v196
v_mfma_f32_16x16x32_bf16 a[244:247], v[52:55], a[148:151], a[244:247]
ds_read_b128 a[148:151], v4 offset:37888
v_mul_f32 v25, v25, v197
v_mfma_f32_16x16x32_bf16 a[244:247], a[0:3], a[116:119], a[244:247]
ds_read_b128 a[116:119], v3 offset:37888
v_mul_f32 v26, v26, v198
v_mfma_f32_16x16x32_bf16 v[184:187], v[112:115], a[120:123], v[184:187]
v_mul_f32 v27, v27, v199
v_cvt_pk_bf16_f32 v14, v24, v25
v_mfma_f32_16x16x32_bf16 v[184:187], v[144:147], a[152:155], v[184:187]
v_cvt_pk_bf16_f32 v15, v26, v27
ds_write_b128 v20, v[12:15] offset:2048
v_mfma_f32_16x16x32_bf16 v[216:219], a[204:207], a[152:155], v[216:219]
s_waitcnt lgkmcnt(6)
buffer_store_dwordx4 v[160:163], v23, s[16:19], s40 offen offset:128 sc1
s_waitcnt lgkmcnt(5)
s_add_u32 s54, s40, 16384
buffer_store_dwordx4 v[192:195], v23, s[16:19], s54 offen offset:128 sc1
v_mfma_f32_16x16x32_bf16 v[216:219], a[172:175], a[120:123], v[216:219]
v_lshlrev_b32 v24, 16, v64
v_and_b32 v25, s33, v64
v_mfma_f32_16x16x32_bf16 v[248:251], a[12:15], a[120:123], v[248:251]
v_lshlrev_b32 v26, 16, v65
v_and_b32 v27, s33, v65
v_mfma_f32_16x16x32_bf16 v[248:251], a[32:35], a[152:155], v[248:251]
v_mul_f32 v24, v24, v228
v_mul_f32 v25, v25, v229
v_mfma_f32_16x16x32_bf16 a[248:251], v[52:55], a[152:155], a[248:251]
ds_read_b128 a[152:155], v4 offset:38912
v_mul_f32 v26, v26, v230
v_mfma_f32_16x16x32_bf16 a[248:251], a[0:3], a[120:123], a[248:251]
ds_read_b128 a[120:123], v3 offset:38912
v_mul_f32 v27, v27, v231
v_mfma_f32_16x16x32_bf16 v[188:191], v[112:115], a[124:127], v[188:191]
v_cvt_pk_bf16_f32 v16, v24, v25
v_cvt_pk_bf16_f32 v17, v26, v27
v_mfma_f32_16x16x32_bf16 v[188:191], v[144:147], a[156:159], v[188:191]
v_lshlrev_b32 v24, 16, v66
v_and_b32 v25, s33, v66
v_mfma_f32_16x16x32_bf16 v[220:223], a[204:207], a[156:159], v[220:223]
v_lshlrev_b32 v26, 16, v67
v_and_b32 v27, s33, v67
v_mfma_f32_16x16x32_bf16 v[220:223], a[172:175], a[124:127], v[220:223]
v_accvgpr_read_b32 v28, a228
v_mul_f32 v24, v24, v28
v_mfma_f32_16x16x32_bf16 v[252:255], a[12:15], a[124:127], v[252:255]
v_accvgpr_read_b32 v29, a229
v_mul_f32 v25, v25, v29
v_mfma_f32_16x16x32_bf16 v[252:255], a[32:35], a[156:159], v[252:255]
v_accvgpr_read_b32 v30, a230
v_mul_f32 v26, v26, v30
v_mfma_f32_16x16x32_bf16 a[252:255], v[52:55], a[156:159], a[252:255]
ds_read_b128 a[156:159], v4 offset:39936
v_accvgpr_read_b32 v31, a231
v_mfma_f32_16x16x32_bf16 a[252:255], a[0:3], a[124:127], a[252:255]
ds_read_b128 a[124:127], v3 offset:39936
v_mul_f32 v27, v27, v31
s_waitcnt lgkmcnt(7)
v_mfma_f32_16x16x32_bf16 v[176:179], v[84:87], a[112:115], v[176:179]
v_cvt_pk_bf16_f32 v18, v24, v25
v_mfma_f32_16x16x32_bf16 v[176:179], a[44:47], a[144:147], v[176:179]
v_cvt_pk_bf16_f32 v19, v26, v27
ds_write_b128 v21, v[16:19] offset:2048
v_mfma_f32_16x16x32_bf16 v[208:211], v[72:75], a[144:147], v[208:211]
ds_read_b128 v[164:167], v22 offset:2048
ds_read_b128 v[196:199], v22 offset:3072
v_mfma_f32_16x16x32_bf16 v[208:211], v[40:43], a[112:115], v[208:211]
v_accvgpr_read_b32 v12, a72
v_accvgpr_read_b32 v13, a73
v_mfma_f32_16x16x32_bf16 v[240:243], a[168:171], a[112:115], v[240:243]
v_accvgpr_read_b32 v14, a74
v_accvgpr_read_b32 v15, a75
v_mfma_f32_16x16x32_bf16 v[240:243], a[200:203], a[144:147], v[240:243]
v_lshlrev_b32 v24, 16, v12
v_and_b32 v25, s33, v12
v_mfma_f32_16x16x32_bf16 a[240:243], v[148:151], a[144:147], a[240:243]
v_lshlrev_b32 v26, 16, v13
v_and_b32 v27, s33, v13
v_mfma_f32_16x16x32_bf16 a[240:243], v[116:119], a[112:115], a[240:243]
v_mul_f32 v24, v24, v168
v_mul_f32 v25, v25, v169
s_waitcnt lgkmcnt(8)
v_mfma_f32_16x16x32_bf16 v[180:183], v[84:87], a[116:119], v[180:183]
v_mul_f32 v26, v26, v170
v_mfma_f32_16x16x32_bf16 v[180:183], a[44:47], a[148:151], v[180:183]
v_mul_f32 v27, v27, v171
v_cvt_pk_bf16_f32 v12, v24, v25
v_mfma_f32_16x16x32_bf16 v[212:215], v[72:75], a[148:151], v[212:215]
v_cvt_pk_bf16_f32 v13, v26, v27
v_lshlrev_b32 v24, 16, v14
v_mfma_f32_16x16x32_bf16 v[212:215], v[40:43], a[116:119], v[212:215]
v_and_b32 v25, s33, v14
v_lshlrev_b32 v26, 16, v15
v_mfma_f32_16x16x32_bf16 v[244:247], a[168:171], a[116:119], v[244:247]
v_and_b32 v27, s33, v15
v_mul_f32 v24, v24, v200
v_mfma_f32_16x16x32_bf16 v[244:247], a[200:203], a[148:151], v[244:247]
v_mul_f32 v25, v25, v201
v_mul_f32 v26, v26, v202
v_mfma_f32_16x16x32_bf16 a[244:247], v[148:151], a[148:151], a[244:247]
v_mul_f32 v27, v27, v203
v_cvt_pk_bf16_f32 v14, v24, v25
v_mfma_f32_16x16x32_bf16 a[244:247], v[116:119], a[116:119], a[244:247]
v_cvt_pk_bf16_f32 v15, v26, v27
ds_write_b128 v20, v[12:15] offset:4096
s_waitcnt lgkmcnt(6)
v_mfma_f32_16x16x32_bf16 v[184:187], v[84:87], a[120:123], v[184:187]
s_waitcnt lgkmcnt(2)
buffer_store_dwordx4 v[164:167], v23, s[16:19], s41 offen offset:128 sc1
v_mfma_f32_16x16x32_bf16 v[184:187], a[44:47], a[152:155], v[184:187]
s_waitcnt lgkmcnt(1)
s_add_u32 s54, s41, 16384
buffer_store_dwordx4 v[196:199], v23, s[16:19], s54 offen offset:128 sc1
v_lshlrev_b32 v24, 16, v96
v_mfma_f32_16x16x32_bf16 v[216:219], v[72:75], a[152:155], v[216:219]
v_and_b32 v25, s33, v96
v_lshlrev_b32 v26, 16, v97
v_mfma_f32_16x16x32_bf16 v[216:219], v[40:43], a[120:123], v[216:219]
v_and_b32 v27, s33, v97
v_mul_f32 v24, v24, v232
v_mfma_f32_16x16x32_bf16 v[248:251], a[168:171], a[120:123], v[248:251]
v_mul_f32 v25, v25, v233
v_mul_f32 v26, v26, v234
v_mfma_f32_16x16x32_bf16 v[248:251], a[200:203], a[152:155], v[248:251]
v_mul_f32 v27, v27, v235
v_cvt_pk_bf16_f32 v16, v24, v25
v_mfma_f32_16x16x32_bf16 a[248:251], v[148:151], a[152:155], a[248:251]
v_cvt_pk_bf16_f32 v17, v26, v27
v_lshlrev_b32 v24, 16, v98
v_mfma_f32_16x16x32_bf16 a[248:251], v[116:119], a[120:123], a[248:251]
v_and_b32 v25, s33, v98
v_lshlrev_b32 v26, 16, v99
v_mfma_f32_16x16x32_bf16 v[188:191], v[84:87], a[124:127], v[188:191]
v_and_b32 v27, s33, v99
v_accvgpr_read_b32 v28, a232
v_mfma_f32_16x16x32_bf16 v[188:191], a[44:47], a[156:159], v[188:191]
v_mul_f32 v24, v24, v28
v_accvgpr_read_b32 v29, a233
v_mfma_f32_16x16x32_bf16 v[220:223], v[72:75], a[156:159], v[220:223]
v_mul_f32 v25, v25, v29
v_accvgpr_read_b32 v30, a234
v_mfma_f32_16x16x32_bf16 v[220:223], v[40:43], a[124:127], v[220:223]
v_mul_f32 v26, v26, v30
v_accvgpr_read_b32 v31, a235
v_mfma_f32_16x16x32_bf16 v[252:255], a[168:171], a[124:127], v[252:255]
v_mul_f32 v27, v27, v31
v_cvt_pk_bf16_f32 v18, v24, v25
v_mfma_f32_16x16x32_bf16 v[252:255], a[200:203], a[156:159], v[252:255]
v_cvt_pk_bf16_f32 v19, v26, v27
ds_write_b128 v21, v[16:19] offset:4096
v_mfma_f32_16x16x32_bf16 a[252:255], v[148:151], a[156:159], a[252:255]
ds_read_b128 v[168:171], v22 offset:4096
ds_read_b128 v[200:203], v22 offset:5120
v_mfma_f32_16x16x32_bf16 a[252:255], v[116:119], a[124:127], a[252:255]
v_accvgpr_read_b32 v12, a76
v_accvgpr_read_b32 v13, a77
s_nop 7
v_accvgpr_read_b32 v14, a78
v_accvgpr_read_b32 v15, a79
v_lshlrev_b32 v24, 16, v12
v_and_b32 v25, s33, v12
v_lshlrev_b32 v26, 16, v13
v_and_b32 v27, s33, v13
v_mul_f32 v24, v24, v172
v_mul_f32 v25, v25, v173
v_mul_f32 v26, v26, v174
v_mul_f32 v27, v27, v175
v_cvt_pk_bf16_f32 v12, v24, v25
v_cvt_pk_bf16_f32 v13, v26, v27
v_lshlrev_b32 v24, 16, v14
v_and_b32 v25, s33, v14
v_lshlrev_b32 v26, 16, v15
v_and_b32 v27, s33, v15
v_mul_f32 v24, v24, v204
v_mul_f32 v25, v25, v205
v_mul_f32 v26, v26, v206
v_mul_f32 v27, v27, v207
v_cvt_pk_bf16_f32 v14, v24, v25
v_cvt_pk_bf16_f32 v15, v26, v27
ds_write_b128 v20, v[12:15] offset:6144
s_waitcnt lgkmcnt(2)
buffer_store_dwordx4 v[168:171], v23, s[16:19], s42 offen offset:128 sc1
s_waitcnt lgkmcnt(1)
s_add_u32 s54, s42, 16384
buffer_store_dwordx4 v[200:203], v23, s[16:19], s54 offen offset:128 sc1
v_lshlrev_b32 v24, 16, v128
v_and_b32 v25, s33, v128
v_lshlrev_b32 v26, 16, v129
v_and_b32 v27, s33, v129
v_mul_f32 v24, v24, v236
v_mul_f32 v25, v25, v237
v_mul_f32 v26, v26, v238
v_mul_f32 v27, v27, v239
v_cvt_pk_bf16_f32 v16, v24, v25
v_cvt_pk_bf16_f32 v17, v26, v27
v_lshlrev_b32 v24, 16, v130
v_and_b32 v25, s33, v130
v_lshlrev_b32 v26, 16, v131
v_and_b32 v27, s33, v131
v_accvgpr_read_b32 v28, a236
v_mul_f32 v24, v24, v28
v_accvgpr_read_b32 v29, a237
v_mul_f32 v25, v25, v29
v_accvgpr_read_b32 v30, a238
v_mul_f32 v26, v26, v30
v_accvgpr_read_b32 v31, a239
v_mul_f32 v27, v27, v31
v_cvt_pk_bf16_f32 v18, v24, v25
v_cvt_pk_bf16_f32 v19, v26, v27
ds_write_b128 v21, v[16:19] offset:6144
ds_read_b128 v[172:175], v22 offset:6144
ds_read_b128 v[204:207], v22 offset:7168
v_accvgpr_read_b32 v12, a80
v_accvgpr_read_b32 v13, a81
v_accvgpr_read_b32 v14, a82
v_accvgpr_read_b32 v15, a83
v_lshlrev_b32 v24, 16, v12
v_and_b32 v25, s33, v12
v_lshlrev_b32 v26, 16, v13
v_and_b32 v27, s33, v13
v_mul_f32 v24, v24, v176
v_mul_f32 v25, v25, v177
v_mul_f32 v26, v26, v178
v_mul_f32 v27, v27, v179
v_cvt_pk_bf16_f32 v12, v24, v25
v_cvt_pk_bf16_f32 v13, v26, v27
v_lshlrev_b32 v24, 16, v14
v_and_b32 v25, s33, v14
v_lshlrev_b32 v26, 16, v15
v_and_b32 v27, s33, v15
v_mul_f32 v24, v24, v208
v_mul_f32 v25, v25, v209
v_mul_f32 v26, v26, v210
v_mul_f32 v27, v27, v211
v_cvt_pk_bf16_f32 v14, v24, v25
v_cvt_pk_bf16_f32 v15, v26, v27
ds_write_b128 v20, v[12:15] offset:0
s_waitcnt lgkmcnt(2)
buffer_store_dwordx4 v[172:175], v23, s[16:19], s43 offen offset:128 sc1
s_waitcnt lgkmcnt(1)
s_add_u32 s54, s43, 16384
buffer_store_dwordx4 v[204:207], v23, s[16:19], s54 offen offset:128 sc1
v_lshlrev_b32 v24, 16, v36
v_and_b32 v25, s33, v36
v_lshlrev_b32 v26, 16, v37
v_and_b32 v27, s33, v37
v_mul_f32 v24, v24, v240
v_mul_f32 v25, v25, v241
v_mul_f32 v26, v26, v242
v_mul_f32 v27, v27, v243
v_cvt_pk_bf16_f32 v16, v24, v25
v_cvt_pk_bf16_f32 v17, v26, v27
v_lshlrev_b32 v24, 16, v38
v_and_b32 v25, s33, v38
v_lshlrev_b32 v26, 16, v39
v_and_b32 v27, s33, v39
v_accvgpr_read_b32 v28, a240
v_mul_f32 v24, v24, v28
v_accvgpr_read_b32 v29, a241
v_mul_f32 v25, v25, v29
v_accvgpr_read_b32 v30, a242
v_mul_f32 v26, v26, v30
v_accvgpr_read_b32 v31, a243
v_mul_f32 v27, v27, v31
v_cvt_pk_bf16_f32 v18, v24, v25
v_cvt_pk_bf16_f32 v19, v26, v27
ds_write_b128 v21, v[16:19] offset:0
ds_read_b128 v[176:179], v22 offset:0
ds_read_b128 v[208:211], v22 offset:1024
v_accvgpr_read_b32 v12, a84
v_accvgpr_read_b32 v13, a85
v_accvgpr_read_b32 v14, a86
v_accvgpr_read_b32 v15, a87
v_lshlrev_b32 v24, 16, v12
v_and_b32 v25, s33, v12
v_lshlrev_b32 v26, 16, v13
v_and_b32 v27, s33, v13
v_mul_f32 v24, v24, v180
v_mul_f32 v25, v25, v181
v_mul_f32 v26, v26, v182
v_mul_f32 v27, v27, v183
v_cvt_pk_bf16_f32 v12, v24, v25
v_cvt_pk_bf16_f32 v13, v26, v27
v_lshlrev_b32 v24, 16, v14
v_and_b32 v25, s33, v14
v_lshlrev_b32 v26, 16, v15
v_and_b32 v27, s33, v15
v_mul_f32 v24, v24, v212
v_mul_f32 v25, v25, v213
v_mul_f32 v26, v26, v214
v_mul_f32 v27, v27, v215
v_cvt_pk_bf16_f32 v14, v24, v25
v_cvt_pk_bf16_f32 v15, v26, v27
ds_write_b128 v20, v[12:15] offset:2048
s_waitcnt lgkmcnt(2)
buffer_store_dwordx4 v[176:179], v23, s[16:19], s44 offen offset:128 sc1
s_waitcnt lgkmcnt(1)
s_add_u32 s54, s44, 16384
buffer_store_dwordx4 v[208:211], v23, s[16:19], s54 offen offset:128 sc1
v_lshlrev_b32 v24, 16, v68
v_and_b32 v25, s33, v68
v_lshlrev_b32 v26, 16, v69
v_and_b32 v27, s33, v69
v_mul_f32 v24, v24, v244
v_mul_f32 v25, v25, v245
v_mul_f32 v26, v26, v246
v_mul_f32 v27, v27, v247
v_cvt_pk_bf16_f32 v16, v24, v25
v_cvt_pk_bf16_f32 v17, v26, v27
v_lshlrev_b32 v24, 16, v70
v_and_b32 v25, s33, v70
v_lshlrev_b32 v26, 16, v71
v_and_b32 v27, s33, v71
v_accvgpr_read_b32 v28, a244
v_mul_f32 v24, v24, v28
v_accvgpr_read_b32 v29, a245
v_mul_f32 v25, v25, v29
v_accvgpr_read_b32 v30, a246
v_mul_f32 v26, v26, v30
v_accvgpr_read_b32 v31, a247
v_mul_f32 v27, v27, v31
v_cvt_pk_bf16_f32 v18, v24, v25
v_cvt_pk_bf16_f32 v19, v26, v27
ds_write_b128 v21, v[16:19] offset:2048
ds_read_b128 v[180:183], v22 offset:2048
ds_read_b128 v[212:215], v22 offset:3072
v_accvgpr_read_b32 v12, a88
v_accvgpr_read_b32 v13, a89
v_accvgpr_read_b32 v14, a90
v_accvgpr_read_b32 v15, a91
v_lshlrev_b32 v24, 16, v12
v_and_b32 v25, s33, v12
v_lshlrev_b32 v26, 16, v13
v_and_b32 v27, s33, v13
v_mul_f32 v24, v24, v184
v_mul_f32 v25, v25, v185
v_mul_f32 v26, v26, v186
v_mul_f32 v27, v27, v187
v_cvt_pk_bf16_f32 v12, v24, v25
v_cvt_pk_bf16_f32 v13, v26, v27
v_lshlrev_b32 v24, 16, v14
v_and_b32 v25, s33, v14
v_lshlrev_b32 v26, 16, v15
v_and_b32 v27, s33, v15
v_mul_f32 v24, v24, v216
v_mul_f32 v25, v25, v217
v_mul_f32 v26, v26, v218
v_mul_f32 v27, v27, v219
v_cvt_pk_bf16_f32 v14, v24, v25
v_cvt_pk_bf16_f32 v15, v26, v27
ds_write_b128 v20, v[12:15] offset:4096
s_waitcnt lgkmcnt(2)
buffer_store_dwordx4 v[180:183], v23, s[16:19], s45 offen offset:128 sc1
s_waitcnt lgkmcnt(1)
s_add_u32 s54, s45, 16384
buffer_store_dwordx4 v[212:215], v23, s[16:19], s54 offen offset:128 sc1
v_lshlrev_b32 v24, 16, v100
v_and_b32 v25, s33, v100
v_lshlrev_b32 v26, 16, v101
v_and_b32 v27, s33, v101
v_mul_f32 v24, v24, v248
v_mul_f32 v25, v25, v249
v_mul_f32 v26, v26, v250
v_mul_f32 v27, v27, v251
v_cvt_pk_bf16_f32 v16, v24, v25
v_cvt_pk_bf16_f32 v17, v26, v27
v_lshlrev_b32 v24, 16, v102
v_and_b32 v25, s33, v102
v_lshlrev_b32 v26, 16, v103
v_and_b32 v27, s33, v103
v_accvgpr_read_b32 v28, a248
v_mul_f32 v24, v24, v28
v_accvgpr_read_b32 v29, a249
v_mul_f32 v25, v25, v29
v_accvgpr_read_b32 v30, a250
v_mul_f32 v26, v26, v30
v_accvgpr_read_b32 v31, a251
v_mul_f32 v27, v27, v31
v_cvt_pk_bf16_f32 v18, v24, v25
v_cvt_pk_bf16_f32 v19, v26, v27
ds_write_b128 v21, v[16:19] offset:4096
ds_read_b128 v[184:187], v22 offset:4096
ds_read_b128 v[216:219], v22 offset:5120
v_accvgpr_read_b32 v12, a92
v_accvgpr_read_b32 v13, a93
v_accvgpr_read_b32 v14, a94
v_accvgpr_read_b32 v15, a95
v_lshlrev_b32 v24, 16, v12
v_and_b32 v25, s33, v12
v_lshlrev_b32 v26, 16, v13
v_and_b32 v27, s33, v13
v_mul_f32 v24, v24, v188
v_mul_f32 v25, v25, v189
v_mul_f32 v26, v26, v190
v_mul_f32 v27, v27, v191
v_cvt_pk_bf16_f32 v12, v24, v25
v_cvt_pk_bf16_f32 v13, v26, v27
v_lshlrev_b32 v24, 16, v14
v_and_b32 v25, s33, v14
v_lshlrev_b32 v26, 16, v15
v_and_b32 v27, s33, v15
v_mul_f32 v24, v24, v220
v_mul_f32 v25, v25, v221
v_mul_f32 v26, v26, v222
v_mul_f32 v27, v27, v223
v_cvt_pk_bf16_f32 v14, v24, v25
v_cvt_pk_bf16_f32 v15, v26, v27
ds_write_b128 v20, v[12:15] offset:6144
s_waitcnt lgkmcnt(2)
buffer_store_dwordx4 v[184:187], v23, s[16:19], s46 offen offset:128 sc1
s_waitcnt lgkmcnt(1)
s_add_u32 s54, s46, 16384
buffer_store_dwordx4 v[216:219], v23, s[16:19], s54 offen offset:128 sc1
v_lshlrev_b32 v24, 16, v132
v_and_b32 v25, s33, v132
v_lshlrev_b32 v26, 16, v133
v_and_b32 v27, s33, v133
v_mul_f32 v24, v24, v252
v_mul_f32 v25, v25, v253
v_mul_f32 v26, v26, v254
v_mul_f32 v27, v27, v255
v_cvt_pk_bf16_f32 v16, v24, v25
v_cvt_pk_bf16_f32 v17, v26, v27
v_lshlrev_b32 v24, 16, v134
v_and_b32 v25, s33, v134
v_lshlrev_b32 v26, 16, v135
v_and_b32 v27, s33, v135
v_accvgpr_read_b32 v28, a252
v_mul_f32 v24, v24, v28
v_accvgpr_read_b32 v29, a253
v_mul_f32 v25, v25, v29
v_accvgpr_read_b32 v30, a254
v_mul_f32 v26, v26, v30
v_accvgpr_read_b32 v31, a255
v_mul_f32 v27, v27, v31
v_cvt_pk_bf16_f32 v18, v24, v25
v_cvt_pk_bf16_f32 v19, v26, v27
ds_write_b128 v21, v[16:19] offset:6144
ds_read_b128 v[188:191], v22 offset:6144
ds_read_b128 v[220:223], v22 offset:7168
s_waitcnt lgkmcnt(1)
buffer_store_dwordx4 v[188:191], v23, s[16:19], s47 offen offset:128 sc1
s_waitcnt lgkmcnt(0)
s_add_u32 s54, s47, 16384
buffer_store_dwordx4 v[220:223], v23, s[16:19], s54 offen offset:128 sc1
s_cmp_lg_u32 s2, 0
s_cbranch_scc1 L_end
s_cmp_lg_u32 s28, 0
s_cbranch_scc1 L_end
v_mov_b32 v10, s8
v_mov_b32 v11, s9
s_mov_b64 exec, 1
s_mov_b32 s34, 8454144
buffer_store_dwordx2 v[10:11], off, s[20:23], s34
L_end:
s_endpgm
L_spin2:
s_mov_b32 s38, 0x40000
L_spinl2:
s_sleep 1
buffer_load_dwordx2 v[10:11], off, s[20:23], s36 sc1
s_sub_u32 s38, s38, 1
s_waitcnt vmcnt(0)
s_cmp_eq_u32 s38, 0
s_cbranch_scc1 L_back2
v_readfirstlane_b32 s34, v10
v_readfirstlane_b32 s11, v11
s_xor_b32 s34, s34, s8
s_sub_u32 s34, s34, 2
s_cmp_lg_u32 s11, s9
s_cbranch_scc1 L_spinl2
s_cmp_gt_u32 s34, 13
s_cbranch_scc1 L_spinl2
s_branch L_back2
L_spin3:
s_mov_b32 s38, 0x40000
L_spinl3:
s_sleep 1
buffer_load_dwordx2 v[10:11], off, s[20:23], s36 sc1
s_sub_u32 s38, s38, 1
s_waitcnt vmcnt(0)
s_cmp_eq_u32 s38, 0
s_cbranch_scc1 L_back3
v_readfirstlane_b32 s34, v10
v_readfirstlane_b32 s11, v11
s_xor_b32 s34, s34, s8
s_sub_u32 s34, s34, 3
s_cmp_lg_u32 s11, s9
s_cbranch_scc1 L_spinl3
s_cmp_gt_u32 s34, 12
s_cbranch_scc1 L_spinl3
s_branch L_back3
L_spin4:
s_mov_b32 s38, 0x40000
L_spinl4:
s_sleep 1
buffer_load_dwordx2 v[10:11], off, s[20:23], s36 sc1
s_sub_u32 s38, s38, 1
s_waitcnt vmcnt(0)
s_cmp_eq_u32 s38, 0
s_cbranch_scc1 L_back4
v_readfirstlane_b32 s34, v10
v_readfirstlane_b32 s11, v11
s_xor_b32 s34, s34, s8
s_sub_u32 s34, s34, 4
s_cmp_lg_u32 s11, s9
s_cbranch_scc1 L_spinl4
s_cmp_gt_u32 s34, 11
s_cbranch_scc1 L_spinl4
s_branch L_back4
L_spin5:
s_mov_b32 s38, 0x40000
L_spinl5:
s_sleep 1
buffer_load_dwordx2 v[10:11], off, s[20:23], s36 sc1
s_sub_u32 s38, s38, 1
s_waitcnt vmcnt(0)
s_cmp_eq_u32 s38, 0
s_cbranch_scc1 L_back5
v_readfirstlane_b32 s34, v10
v_readfirstlane_b32 s11, v11
s_xor_b32 s34, s34, s8
s_sub_u32 s34, s34, 5
s_cmp_lg_u32 s11, s9
s_cbranch_scc1 L_spinl5
s_cmp_gt_u32 s34, 10
s_cbranch_scc1 L_spinl5
s_branch L_back5
L_wspin0:
s_mov_b32 s38, 0x40000
L_wspinl0:
s_sleep 2
v_and_b32 v10, 0x1f0, v0
v_lshlrev_b32 v10, 6, v10
buffer_load_dwordx2 v[10:11], v10, s[20:23], s59 offen sc1
s_sub_u32 s38, s38, 1
s_waitcnt vmcnt(0)
s_cmp_eq_u32 s38, 0
s_cbranch_scc1 L_wback0
s_add_u32 s34, s8, 0
v_subrev_u32 v10, s34, v10
v_xor_b32 v11, s9, v11
s_nop 0
v_cmp_gt_u64 vcc, 16, v[10:11]
s_nop 3
s_cmp_lg_u64 vcc, -1
s_cbranch_scc1 L_wspinl0
s_branch L_wback0
L_wspin1:
s_mov_b32 s38, 0x40000
L_wspinl1:
s_sleep 2
v_and_b32 v10, 0x1f0, v0
v_lshlrev_b32 v10, 6, v10
buffer_load_dwordx2 v[10:11], v10, s[20:23], s59 offen sc1
s_sub_u32 s38, s38, 1
s_waitcnt vmcnt(0)
s_cmp_eq_u32 s38, 0
s_cbranch_scc1 L_wback1
s_add_u32 s34, s8, 1
v_subrev_u32 v10, s34, v10
v_xor_b32 v11, s9, v11
s_nop 0
v_cmp_gt_u64 vcc, 15, v[10:11]
s_nop 3
s_cmp_lg_u64 vcc, -1
s_cbranch_scc1 L_wspinl1
s_branch L_wback1
.fill 4096, 4, 0xBF800000
.section .rodata,"a"
.p2align 6
.amdhsa_kernel standalone__cross_network_dcn__recsys_kernel
  .amdhsa_next_free_vgpr 512
  .amdhsa_next_free_sgpr 102
  .amdhsa_accum_offset 256
  .amdhsa_group_segment_fixed_size 0
  .amdhsa_kernarg_size 48
  .amdhsa_user_sgpr_count 2
  .amdhsa_user_sgpr_kernarg_segment_ptr 1
  .amdhsa_system_sgpr_workgroup_id_x 1
.end_amdhsa_kernel
```
